```python
import torch

def _softmax(x, axis=-1):
    return torch.softmax(x, dim=axis)
def _gelu(x):
    return torch.nn.functional.gelu(x, approximate="tanh")
def _silu(x):
    return torch.nn.functional.silu(x)
def _sigmoid(x):
    return torch.sigmoid(x)
def _layernorm(x, axis=-1, eps=1e-5):
    m = x.mean(dim=axis, keepdim=True)
    v = x.var(dim=axis, keepdim=True, unbiased=False)
    return (x - m) / torch.sqrt(v + eps)
def _scatter_add(tgt, idx, src, axis=0):
    return tgt.clone().index_add_(axis, idx, src)
def _segment_sum(src, seg, n):
    out = torch.zeros((n,) + src.shape[1:], dtype=src.dtype)
    return out.index_add_(0, seg, src)
def _pad(x, pw):
    flat = tuple(v for pair in reversed(pw) for v in pair)
    return torch.nn.functional.pad(x, flat)

kernel_name = 'parallel_sum__softmax_full_mha__dense_activation_relu__prompt'

def setup_inputs():

    _w = (lambda a: (lambda t: t.to(torch.bfloat16) if t.is_floating_point() else t)(torch.as_tensor(a)))
    def _A_setup():
        B, S, D = 1, 2048, 576
        return {
            "x": _w((lambda *s: torch.randn(*s, dtype=torch.bfloat16) * 0.05)(B, S, D)),
            "wqkv": _w((lambda *s: torch.randn(*s, dtype=torch.bfloat16) * 0.2)(D, 3 * D)),
            "wo": _w((lambda *s: torch.randn(*s, dtype=torch.bfloat16) * 0.1)(D, D)),
        }
    _A_in = _A_setup()

    def _B_setup():
        B, S, D, Dff = 1, 2048, 576, 4608
        return {
            "x": _w((lambda *s: torch.randn(*s, dtype=torch.bfloat16) * 0.05)(B, S, D)),
            "w1": _w((lambda *s: torch.randn(*s, dtype=torch.bfloat16) * 0.1)(D, Dff)),
            "w2": _w((lambda *s: torch.randn(*s, dtype=torch.bfloat16) * 0.1)(Dff, D)),
        }
    _B_in = _B_setup()

    return {
        "A_x": _A_in["x"],
        "A_wqkv": _A_in["wqkv"],
        "A_wo": _A_in["wo"],
        "B_x": _B_in["x"],
        "B_w1": _B_in["w1"],
        "B_w2": _B_in["w2"],
    }

def reference(A_x, A_wqkv, A_wo, B_x, B_w1, B_w2):
    def _A_ref(x, wqkv, wo):
        B, S, D = x.shape
        H = 32; Dh = D // H
        qkv = (lambda x, *d: x.permute(*d))((x @ wqkv).reshape(B, S, 3, H, Dh), 2, 0, 3, 1, 4)
        q, k, v = qkv[0], qkv[1], qkv[2]
        scale = Dh ** -0.5
        scores = torch.einsum("bhqd,bhkd->bhqk", q, k) * scale
        p = _softmax(scores, axis=-1)
        o = torch.einsum("bhqk,bhkd->bhqd", p, v)
        return (lambda x, *d: x.permute(*d))(o, 0, 2, 1, 3).reshape(B, S, D) @ wo

    def _B_ref(x, w1, w2):
        h = torch.einsum("bsd,df->bsf", x, w1)
        zero = torch.zeros_like(h)
        h = torch.maximum(h, zero)
        return torch.einsum("bsf,fd->bsd", h, w2)

    x = A_x
    xn = _layernorm(x, axis=-1)
    return x + _A_ref(xn, A_wqkv, A_wo) + _B_ref(xn, B_w1, B_w2)
```

```asm
; @launch grid=(256,1,1) block=(512,1,1) lds=163840
.amdgcn_target "amdgcn-amd-amdhsa--gfx950"
.text
.globl parallel_sum__softmax_full_mha__dense_activation_relu__prompt_kernel
.p2align 8
.type parallel_sum__softmax_full_mha__dense_activation_relu__prompt_kernel,@function
parallel_sum__softmax_full_mha__dense_activation_relu__prompt_kernel:
    s_cmp_ge_u32 s2, 256
    s_cbranch_scc1 parallel_sum__softmax_full_mha__dense_activation_relu__prompt_kernel_end
    s_load_dwordx2 s[4:5], s[0:1], 0
    s_load_dwordx2 s[6:7], s[0:1], 64
    s_load_dwordx2 s[36:37], s[0:1], 8
    s_load_dwordx2 s[38:39], s[0:1], 32
    s_load_dwordx2 s[90:91], s[0:1], 56
    v_lshrrev_b32 v1, 6, v0
    v_and_b32 v0, 63, v0
    s_and_b32 s28, s2, 7
    v_readfirstlane_b32 s26, v1
    s_lshr_b32 s29, s2, 3
    s_and_b32 s25, s28, 3
    s_lshl_b32 s25, s25, 2
    s_and_b32 s30, s29, 3
    s_add_u32 s25, s25, s30
    s_lshr_b32 s24, s28, 2
    s_lshl_b32 s24, s24, 3
    s_lshr_b32 s30, s29, 2
    s_add_u32 s24, s24, s30
    s_and_b32 s27, s26, 3
    s_lshl_b32 s30, s24, 2
    s_add_u32 s27, s27, s30
    s_waitcnt lgkmcnt(0)
    s_mov_b32 s8, s4
    s_and_b32 s9, s5, 0xffff
    s_mov_b32 s10, 2359296
    s_mov_b32 s11, 0x20000
    s_mov_b32 s12, s6
    s_and_b32 s13, s7, 0xffff
    s_mov_b32 s14, 39337984
    s_mov_b32 s15, 0x20000
    s_mov_b32 s16, s36
    s_and_b32 s17, s37, 0xffff
    s_mov_b32 s18, 1990656
    s_mov_b32 s19, 0x20000
    s_mov_b32 s20, s38
    s_and_b32 s21, s39, 0xffff
    s_mov_b32 s22, 5308416
    s_mov_b32 s23, 0x20000
    s_cmp_lt_u32 s26, 4
    s_cbranch_scc1 parallel_sum__softmax_full_mha__dense_activation_relu__prompt_kernel_consumer
    s_sub_u32 s28, s26, 4
    v_mov_b32 v20, 0
    s_getpc_b64 s[76:77]
parallel_sum__softmax_full_mha__dense_activation_relu__prompt_kernel_pc:
    s_sub_u32 s76, s76, parallel_sum__softmax_full_mha__dense_activation_relu__prompt_kernel_pc-parallel_sum__softmax_full_mha__dense_activation_relu__prompt_kernel
    s_subb_u32 s77, s77, 0
    s_and_b32 s77, s77, 0xffff
    s_mov_b32 s78, parallel_sum__softmax_full_mha__dense_activation_relu__prompt_kernel_end-parallel_sum__softmax_full_mha__dense_activation_relu__prompt_kernel
    s_mov_b32 s79, 0x20000
    s_lshr_b32 s73, s2, 3
    s_lshl_b32 s73, s73, 2
    s_add_u32 s73, s73, s28
    s_mul_i32 s73, s73, 768
    v_lshlrev_b32 v2, 7, v0
    s_mov_b32 exec_hi, 0
    s_mov_b32 exec_lo, 0x3f
    buffer_load_dword v21, v2, s[76:79], s73 offen
    s_mov_b64 exec, -1
    s_cmp_eq_u32 s2, 0
    s_cbranch_scc0 parallel_sum__softmax_full_mha__dense_activation_relu__prompt_kernel_nozero
    s_cmp_eq_u32 s28, 0
    s_cbranch_scc0 parallel_sum__softmax_full_mha__dense_activation_relu__prompt_kernel_nozero
    v_lshlrev_b32 v2, 7, v0
    v_add_u32 v2, 39321600, v2
    buffer_store_dword v20, v2, s[12:15], 0 offen sc1
    v_add_u32 v2, 8192, v2
    buffer_store_dword v20, v2, s[12:15], 0 offen sc1
parallel_sum__softmax_full_mha__dense_activation_relu__prompt_kernel_nozero:
    s_lshl_b32 s29, s24, 2
    s_add_u32 s29, s29, s28
    s_mul_i32 s29, s29, 36864
    s_mul_i32 s41, s28, 36864
    s_add_u32 s41, s41, 16384
    s_movk_i32 s30, 29128
    s_movk_i32 s31, 1152
    s_mul_i32 s33, s25, 9
    s_lshr_b32 s33, s33, 2
    s_lshl_b32 s34, s33, 6
    v_add_u32 v2, s34, v0
    v_mul_u32_u24 v3, s30, v2
    v_lshrrev_b32 v3, 21, v3
    v_mul_u32_u24 v4, 72, v3
    v_sub_u32 v4, v2, v4
    v_lshrrev_b32 v5, 1, v3
    v_xor_b32 v5, v5, v4
    v_and_b32 v5, 7, v5
    v_and_b32 v4, 0x78, v4
    v_or_b32 v4, v4, v5
    v_lshlrev_b32 v4, 4, v4
    v_mad_u32_u24 v4, v3, s31, v4
    s_lshl_b32 s34, s33, 10
    s_add_u32 m0, s41, s34
    s_add_u32 s33, s33, 1
    buffer_load_dwordx4 v4, s[8:11], s29 offen lds
    s_cmp_eq_u32 s33, 36
    s_cselect_b32 s33, 0, s33
    s_lshl_b32 s34, s33, 6
    v_add_u32 v2, s34, v0
    v_mul_u32_u24 v3, s30, v2
    v_lshrrev_b32 v3, 21, v3
    v_mul_u32_u24 v4, 72, v3
    v_sub_u32 v4, v2, v4
    v_lshrrev_b32 v5, 1, v3
    v_xor_b32 v5, v5, v4
    v_and_b32 v5, 7, v5
    v_and_b32 v4, 0x78, v4
    v_or_b32 v4, v4, v5
    v_lshlrev_b32 v4, 4, v4
    v_mad_u32_u24 v4, v3, s31, v4
    s_lshl_b32 s34, s33, 10
    s_add_u32 m0, s41, s34
    s_add_u32 s33, s33, 1
    buffer_load_dwordx4 v4, s[8:11], s29 offen lds
    s_cmp_eq_u32 s33, 36
    s_cselect_b32 s33, 0, s33
    s_lshl_b32 s34, s33, 6
    v_add_u32 v2, s34, v0
    v_mul_u32_u24 v3, s30, v2
    v_lshrrev_b32 v3, 21, v3
    v_mul_u32_u24 v4, 72, v3
    v_sub_u32 v4, v2, v4
    v_lshrrev_b32 v5, 1, v3
    v_xor_b32 v5, v5, v4
    v_and_b32 v5, 7, v5
    v_and_b32 v4, 0x78, v4
    v_or_b32 v4, v4, v5
    v_lshlrev_b32 v4, 4, v4
    v_mad_u32_u24 v4, v3, s31, v4
    s_lshl_b32 s34, s33, 10
    s_add_u32 m0, s41, s34
    s_add_u32 s33, s33, 1
    buffer_load_dwordx4 v4, s[8:11], s29 offen lds
    s_cmp_eq_u32 s33, 36
    s_cselect_b32 s33, 0, s33
    s_lshl_b32 s34, s33, 6
    v_add_u32 v2, s34, v0
    v_mul_u32_u24 v3, s30, v2
    v_lshrrev_b32 v3, 21, v3
    v_mul_u32_u24 v4, 72, v3
    v_sub_u32 v4, v2, v4
    v_lshrrev_b32 v5, 1, v3
    v_xor_b32 v5, v5, v4
    v_and_b32 v5, 7, v5
    v_and_b32 v4, 0x78, v4
    v_or_b32 v4, v4, v5
    v_lshlrev_b32 v4, 4, v4
    v_mad_u32_u24 v4, v3, s31, v4
    s_lshl_b32 s34, s33, 10
    s_add_u32 m0, s41, s34
    s_add_u32 s33, s33, 1
    buffer_load_dwordx4 v4, s[8:11], s29 offen lds
    s_cmp_eq_u32 s33, 36
    s_cselect_b32 s33, 0, s33
    s_lshl_b32 s34, s33, 6
    v_add_u32 v2, s34, v0
    v_mul_u32_u24 v3, s30, v2
    v_lshrrev_b32 v3, 21, v3
    v_mul_u32_u24 v4, 72, v3
    v_sub_u32 v4, v2, v4
    v_lshrrev_b32 v5, 1, v3
    v_xor_b32 v5, v5, v4
    v_and_b32 v5, 7, v5
    v_and_b32 v4, 0x78, v4
    v_or_b32 v4, v4, v5
    v_lshlrev_b32 v4, 4, v4
    v_mad_u32_u24 v4, v3, s31, v4
    s_lshl_b32 s34, s33, 10
    s_add_u32 m0, s41, s34
    s_add_u32 s33, s33, 1
    buffer_load_dwordx4 v4, s[8:11], s29 offen lds
    s_cmp_eq_u32 s33, 36
    s_cselect_b32 s33, 0, s33
    s_lshl_b32 s34, s33, 6
    v_add_u32 v2, s34, v0
    v_mul_u32_u24 v3, s30, v2
    v_lshrrev_b32 v3, 21, v3
    v_mul_u32_u24 v4, 72, v3
    v_sub_u32 v4, v2, v4
    v_lshrrev_b32 v5, 1, v3
    v_xor_b32 v5, v5, v4
    v_and_b32 v5, 7, v5
    v_and_b32 v4, 0x78, v4
    v_or_b32 v4, v4, v5
    v_lshlrev_b32 v4, 4, v4
    v_mad_u32_u24 v4, v3, s31, v4
    s_lshl_b32 s34, s33, 10
    s_add_u32 m0, s41, s34
    s_add_u32 s33, s33, 1
    buffer_load_dwordx4 v4, s[8:11], s29 offen lds
    s_cmp_eq_u32 s33, 36
    s_cselect_b32 s33, 0, s33
    s_lshl_b32 s34, s33, 6
    v_add_u32 v2, s34, v0
    v_mul_u32_u24 v3, s30, v2
    v_lshrrev_b32 v3, 21, v3
    v_mul_u32_u24 v4, 72, v3
    v_sub_u32 v4, v2, v4
    v_lshrrev_b32 v5, 1, v3
    v_xor_b32 v5, v5, v4
    v_and_b32 v5, 7, v5
    v_and_b32 v4, 0x78, v4
    v_or_b32 v4, v4, v5
    v_lshlrev_b32 v4, 4, v4
    v_mad_u32_u24 v4, v3, s31, v4
    s_lshl_b32 s34, s33, 10
    s_add_u32 m0, s41, s34
    s_add_u32 s33, s33, 1
    buffer_load_dwordx4 v4, s[8:11], s29 offen lds
    s_cmp_eq_u32 s33, 36
    s_cselect_b32 s33, 0, s33
    s_lshl_b32 s34, s33, 6
    v_add_u32 v2, s34, v0
    v_mul_u32_u24 v3, s30, v2
    v_lshrrev_b32 v3, 21, v3
    v_mul_u32_u24 v4, 72, v3
    v_sub_u32 v4, v2, v4
    v_lshrrev_b32 v5, 1, v3
    v_xor_b32 v5, v5, v4
    v_and_b32 v5, 7, v5
    v_and_b32 v4, 0x78, v4
    v_or_b32 v4, v4, v5
    v_lshlrev_b32 v4, 4, v4
    v_mad_u32_u24 v4, v3, s31, v4
    s_lshl_b32 s34, s33, 10
    s_add_u32 m0, s41, s34
    s_add_u32 s33, s33, 1
    buffer_load_dwordx4 v4, s[8:11], s29 offen lds
    s_cmp_eq_u32 s33, 36
    s_cselect_b32 s33, 0, s33
    s_lshl_b32 s34, s33, 6
    v_add_u32 v2, s34, v0
    v_mul_u32_u24 v3, s30, v2
    v_lshrrev_b32 v3, 21, v3
    v_mul_u32_u24 v4, 72, v3
    v_sub_u32 v4, v2, v4
    v_lshrrev_b32 v5, 1, v3
    v_xor_b32 v5, v5, v4
    v_and_b32 v5, 7, v5
    v_and_b32 v4, 0x78, v4
    v_or_b32 v4, v4, v5
    v_lshlrev_b32 v4, 4, v4
    v_mad_u32_u24 v4, v3, s31, v4
    s_lshl_b32 s34, s33, 10
    s_add_u32 m0, s41, s34
    s_add_u32 s33, s33, 1
    buffer_load_dwordx4 v4, s[8:11], s29 offen lds
    s_cmp_eq_u32 s33, 36
    s_cselect_b32 s33, 0, s33
    s_lshl_b32 s34, s33, 6
    v_add_u32 v2, s34, v0
    v_mul_u32_u24 v3, s30, v2
    v_lshrrev_b32 v3, 21, v3
    v_mul_u32_u24 v4, 72, v3
    v_sub_u32 v4, v2, v4
    v_lshrrev_b32 v5, 1, v3
    v_xor_b32 v5, v5, v4
    v_and_b32 v5, 7, v5
    v_and_b32 v4, 0x78, v4
    v_or_b32 v4, v4, v5
    v_lshlrev_b32 v4, 4, v4
    v_mad_u32_u24 v4, v3, s31, v4
    s_lshl_b32 s34, s33, 10
    s_add_u32 m0, s41, s34
    s_add_u32 s33, s33, 1
    buffer_load_dwordx4 v4, s[8:11], s29 offen lds
    s_cmp_eq_u32 s33, 36
    s_cselect_b32 s33, 0, s33
    s_lshl_b32 s34, s33, 6
    v_add_u32 v2, s34, v0
    v_mul_u32_u24 v3, s30, v2
    v_lshrrev_b32 v3, 21, v3
    v_mul_u32_u24 v4, 72, v3
    v_sub_u32 v4, v2, v4
    v_lshrrev_b32 v5, 1, v3
    v_xor_b32 v5, v5, v4
    v_and_b32 v5, 7, v5
    v_and_b32 v4, 0x78, v4
    v_or_b32 v4, v4, v5
    v_lshlrev_b32 v4, 4, v4
    v_mad_u32_u24 v4, v3, s31, v4
    s_lshl_b32 s34, s33, 10
    s_add_u32 m0, s41, s34
    s_add_u32 s33, s33, 1
    buffer_load_dwordx4 v4, s[8:11], s29 offen lds
    s_cmp_eq_u32 s33, 36
    s_cselect_b32 s33, 0, s33
    s_lshl_b32 s34, s33, 6
    v_add_u32 v2, s34, v0
    v_mul_u32_u24 v3, s30, v2
    v_lshrrev_b32 v3, 21, v3
    v_mul_u32_u24 v4, 72, v3
    v_sub_u32 v4, v2, v4
    v_lshrrev_b32 v5, 1, v3
    v_xor_b32 v5, v5, v4
    v_and_b32 v5, 7, v5
    v_and_b32 v4, 0x78, v4
    v_or_b32 v4, v4, v5
    v_lshlrev_b32 v4, 4, v4
    v_mad_u32_u24 v4, v3, s31, v4
    s_lshl_b32 s34, s33, 10
    s_add_u32 m0, s41, s34
    s_add_u32 s33, s33, 1
    buffer_load_dwordx4 v4, s[8:11], s29 offen lds
    s_cmp_eq_u32 s33, 36
    s_cselect_b32 s33, 0, s33
    s_lshl_b32 s34, s33, 6
    v_add_u32 v2, s34, v0
    v_mul_u32_u24 v3, s30, v2
    v_lshrrev_b32 v3, 21, v3
    v_mul_u32_u24 v4, 72, v3
    v_sub_u32 v4, v2, v4
    v_lshrrev_b32 v5, 1, v3
    v_xor_b32 v5, v5, v4
    v_and_b32 v5, 7, v5
    v_and_b32 v4, 0x78, v4
    v_or_b32 v4, v4, v5
    v_lshlrev_b32 v4, 4, v4
    v_mad_u32_u24 v4, v3, s31, v4
    s_lshl_b32 s34, s33, 10
    s_add_u32 m0, s41, s34
    s_add_u32 s33, s33, 1
    buffer_load_dwordx4 v4, s[8:11], s29 offen lds
    s_cmp_eq_u32 s33, 36
    s_cselect_b32 s33, 0, s33
    s_lshl_b32 s34, s33, 6
    v_add_u32 v2, s34, v0
    v_mul_u32_u24 v3, s30, v2
    v_lshrrev_b32 v3, 21, v3
    v_mul_u32_u24 v4, 72, v3
    v_sub_u32 v4, v2, v4
    v_lshrrev_b32 v5, 1, v3
    v_xor_b32 v5, v5, v4
    v_and_b32 v5, 7, v5
    v_and_b32 v4, 0x78, v4
    v_or_b32 v4, v4, v5
    v_lshlrev_b32 v4, 4, v4
    v_mad_u32_u24 v4, v3, s31, v4
    s_lshl_b32 s34, s33, 10
    s_add_u32 m0, s41, s34
    s_add_u32 s33, s33, 1
    buffer_load_dwordx4 v4, s[8:11], s29 offen lds
    s_cmp_eq_u32 s33, 36
    s_cselect_b32 s33, 0, s33
    s_lshl_b32 s34, s33, 6
    v_add_u32 v2, s34, v0
    v_mul_u32_u24 v3, s30, v2
    v_lshrrev_b32 v3, 21, v3
    v_mul_u32_u24 v4, 72, v3
    v_sub_u32 v4, v2, v4
    v_lshrrev_b32 v5, 1, v3
    v_xor_b32 v5, v5, v4
    v_and_b32 v5, 7, v5
    v_and_b32 v4, 0x78, v4
    v_or_b32 v4, v4, v5
    v_lshlrev_b32 v4, 4, v4
    v_mad_u32_u24 v4, v3, s31, v4
    s_lshl_b32 s34, s33, 10
    s_add_u32 m0, s41, s34
    s_add_u32 s33, s33, 1
    buffer_load_dwordx4 v4, s[8:11], s29 offen lds
    s_cmp_eq_u32 s33, 36
    s_cselect_b32 s33, 0, s33
    s_lshl_b32 s34, s33, 6
    v_add_u32 v2, s34, v0
    v_mul_u32_u24 v3, s30, v2
    v_lshrrev_b32 v3, 21, v3
    v_mul_u32_u24 v4, 72, v3
    v_sub_u32 v4, v2, v4
    v_lshrrev_b32 v5, 1, v3
    v_xor_b32 v5, v5, v4
    v_and_b32 v5, 7, v5
    v_and_b32 v4, 0x78, v4
    v_or_b32 v4, v4, v5
    v_lshlrev_b32 v4, 4, v4
    v_mad_u32_u24 v4, v3, s31, v4
    s_lshl_b32 s34, s33, 10
    s_add_u32 m0, s41, s34
    s_add_u32 s33, s33, 1
    buffer_load_dwordx4 v4, s[8:11], s29 offen lds
    s_cmp_eq_u32 s33, 36
    s_cselect_b32 s33, 0, s33
    s_lshl_b32 s34, s33, 6
    v_add_u32 v2, s34, v0
    v_mul_u32_u24 v3, s30, v2
    v_lshrrev_b32 v3, 21, v3
    v_mul_u32_u24 v4, 72, v3
    v_sub_u32 v4, v2, v4
    v_lshrrev_b32 v5, 1, v3
    v_xor_b32 v5, v5, v4
    v_and_b32 v5, 7, v5
    v_and_b32 v4, 0x78, v4
    v_or_b32 v4, v4, v5
    v_lshlrev_b32 v4, 4, v4
    v_mad_u32_u24 v4, v3, s31, v4
    s_lshl_b32 s34, s33, 10
    s_add_u32 m0, s41, s34
    s_add_u32 s33, s33, 1
    buffer_load_dwordx4 v4, s[8:11], s29 offen lds
    s_cmp_eq_u32 s33, 36
    s_cselect_b32 s33, 0, s33
    s_lshl_b32 s34, s33, 6
    v_add_u32 v2, s34, v0
    v_mul_u32_u24 v3, s30, v2
    v_lshrrev_b32 v3, 21, v3
    v_mul_u32_u24 v4, 72, v3
    v_sub_u32 v4, v2, v4
    v_lshrrev_b32 v5, 1, v3
    v_xor_b32 v5, v5, v4
    v_and_b32 v5, 7, v5
    v_and_b32 v4, 0x78, v4
    v_or_b32 v4, v4, v5
    v_lshlrev_b32 v4, 4, v4
    v_mad_u32_u24 v4, v3, s31, v4
    s_lshl_b32 s34, s33, 10
    s_add_u32 m0, s41, s34
    s_add_u32 s33, s33, 1
    buffer_load_dwordx4 v4, s[8:11], s29 offen lds
    s_cmp_eq_u32 s33, 36
    s_cselect_b32 s33, 0, s33
    s_lshl_b32 s34, s33, 6
    v_add_u32 v2, s34, v0
    v_mul_u32_u24 v3, s30, v2
    v_lshrrev_b32 v3, 21, v3
    v_mul_u32_u24 v4, 72, v3
    v_sub_u32 v4, v2, v4
    v_lshrrev_b32 v5, 1, v3
    v_xor_b32 v5, v5, v4
    v_and_b32 v5, 7, v5
    v_and_b32 v4, 0x78, v4
    v_or_b32 v4, v4, v5
    v_lshlrev_b32 v4, 4, v4
    v_mad_u32_u24 v4, v3, s31, v4
    s_lshl_b32 s34, s33, 10
    s_add_u32 m0, s41, s34
    s_add_u32 s33, s33, 1
    buffer_load_dwordx4 v4, s[8:11], s29 offen lds
    s_cmp_eq_u32 s33, 36
    s_cselect_b32 s33, 0, s33
    s_lshl_b32 s34, s33, 6
    v_add_u32 v2, s34, v0
    v_mul_u32_u24 v3, s30, v2
    v_lshrrev_b32 v3, 21, v3
    v_mul_u32_u24 v4, 72, v3
    v_sub_u32 v4, v2, v4
    v_lshrrev_b32 v5, 1, v3
    v_xor_b32 v5, v5, v4
    v_and_b32 v5, 7, v5
    v_and_b32 v4, 0x78, v4
    v_or_b32 v4, v4, v5
    v_lshlrev_b32 v4, 4, v4
    v_mad_u32_u24 v4, v3, s31, v4
    s_lshl_b32 s34, s33, 10
    s_add_u32 m0, s41, s34
    s_add_u32 s33, s33, 1
    buffer_load_dwordx4 v4, s[8:11], s29 offen lds
    s_cmp_eq_u32 s33, 36
    s_cselect_b32 s33, 0, s33
    s_lshl_b32 s34, s33, 6
    v_add_u32 v2, s34, v0
    v_mul_u32_u24 v3, s30, v2
    v_lshrrev_b32 v3, 21, v3
    v_mul_u32_u24 v4, 72, v3
    v_sub_u32 v4, v2, v4
    v_lshrrev_b32 v5, 1, v3
    v_xor_b32 v5, v5, v4
    v_and_b32 v5, 7, v5
    v_and_b32 v4, 0x78, v4
    v_or_b32 v4, v4, v5
    v_lshlrev_b32 v4, 4, v4
    v_mad_u32_u24 v4, v3, s31, v4
    s_lshl_b32 s34, s33, 10
    s_add_u32 m0, s41, s34
    s_add_u32 s33, s33, 1
    buffer_load_dwordx4 v4, s[8:11], s29 offen lds
    s_cmp_eq_u32 s33, 36
    s_cselect_b32 s33, 0, s33
    s_lshl_b32 s34, s33, 6
    v_add_u32 v2, s34, v0
    v_mul_u32_u24 v3, s30, v2
    v_lshrrev_b32 v3, 21, v3
    v_mul_u32_u24 v4, 72, v3
    v_sub_u32 v4, v2, v4
    v_lshrrev_b32 v5, 1, v3
    v_xor_b32 v5, v5, v4
    v_and_b32 v5, 7, v5
    v_and_b32 v4, 0x78, v4
    v_or_b32 v4, v4, v5
    v_lshlrev_b32 v4, 4, v4
    v_mad_u32_u24 v4, v3, s31, v4
    s_lshl_b32 s34, s33, 10
    s_add_u32 m0, s41, s34
    s_add_u32 s33, s33, 1
    buffer_load_dwordx4 v4, s[8:11], s29 offen lds
    s_cmp_eq_u32 s33, 36
    s_cselect_b32 s33, 0, s33
    s_lshl_b32 s34, s33, 6
    v_add_u32 v2, s34, v0
    v_mul_u32_u24 v3, s30, v2
    v_lshrrev_b32 v3, 21, v3
    v_mul_u32_u24 v4, 72, v3
    v_sub_u32 v4, v2, v4
    v_lshrrev_b32 v5, 1, v3
    v_xor_b32 v5, v5, v4
    v_and_b32 v5, 7, v5
    v_and_b32 v4, 0x78, v4
    v_or_b32 v4, v4, v5
    v_lshlrev_b32 v4, 4, v4
    v_mad_u32_u24 v4, v3, s31, v4
    s_lshl_b32 s34, s33, 10
    s_add_u32 m0, s41, s34
    s_add_u32 s33, s33, 1
    buffer_load_dwordx4 v4, s[8:11], s29 offen lds
    s_cmp_eq_u32 s33, 36
    s_cselect_b32 s33, 0, s33
    s_lshl_b32 s34, s33, 6
    v_add_u32 v2, s34, v0
    v_mul_u32_u24 v3, s30, v2
    v_lshrrev_b32 v3, 21, v3
    v_mul_u32_u24 v4, 72, v3
    v_sub_u32 v4, v2, v4
    v_lshrrev_b32 v5, 1, v3
    v_xor_b32 v5, v5, v4
    v_and_b32 v5, 7, v5
    v_and_b32 v4, 0x78, v4
    v_or_b32 v4, v4, v5
    v_lshlrev_b32 v4, 4, v4
    v_mad_u32_u24 v4, v3, s31, v4
    s_lshl_b32 s34, s33, 10
    s_add_u32 m0, s41, s34
    s_add_u32 s33, s33, 1
    buffer_load_dwordx4 v4, s[8:11], s29 offen lds
    s_cmp_eq_u32 s33, 36
    s_cselect_b32 s33, 0, s33
    s_lshl_b32 s34, s33, 6
    v_add_u32 v2, s34, v0
    v_mul_u32_u24 v3, s30, v2
    v_lshrrev_b32 v3, 21, v3
    v_mul_u32_u24 v4, 72, v3
    v_sub_u32 v4, v2, v4
    v_lshrrev_b32 v5, 1, v3
    v_xor_b32 v5, v5, v4
    v_and_b32 v5, 7, v5
    v_and_b32 v4, 0x78, v4
    v_or_b32 v4, v4, v5
    v_lshlrev_b32 v4, 4, v4
    v_mad_u32_u24 v4, v3, s31, v4
    s_lshl_b32 s34, s33, 10
    s_add_u32 m0, s41, s34
    s_add_u32 s33, s33, 1
    buffer_load_dwordx4 v4, s[8:11], s29 offen lds
    s_cmp_eq_u32 s33, 36
    s_cselect_b32 s33, 0, s33
    s_lshl_b32 s34, s33, 6
    v_add_u32 v2, s34, v0
    v_mul_u32_u24 v3, s30, v2
    v_lshrrev_b32 v3, 21, v3
    v_mul_u32_u24 v4, 72, v3
    v_sub_u32 v4, v2, v4
    v_lshrrev_b32 v5, 1, v3
    v_xor_b32 v5, v5, v4
    v_and_b32 v5, 7, v5
    v_and_b32 v4, 0x78, v4
    v_or_b32 v4, v4, v5
    v_lshlrev_b32 v4, 4, v4
    v_mad_u32_u24 v4, v3, s31, v4
    s_lshl_b32 s34, s33, 10
    s_add_u32 m0, s41, s34
    s_add_u32 s33, s33, 1
    buffer_load_dwordx4 v4, s[8:11], s29 offen lds
    s_cmp_eq_u32 s33, 36
    s_cselect_b32 s33, 0, s33
    s_lshl_b32 s34, s33, 6
    v_add_u32 v2, s34, v0
    v_mul_u32_u24 v3, s30, v2
    v_lshrrev_b32 v3, 21, v3
    v_mul_u32_u24 v4, 72, v3
    v_sub_u32 v4, v2, v4
    v_lshrrev_b32 v5, 1, v3
    v_xor_b32 v5, v5, v4
    v_and_b32 v5, 7, v5
    v_and_b32 v4, 0x78, v4
    v_or_b32 v4, v4, v5
    v_lshlrev_b32 v4, 4, v4
    v_mad_u32_u24 v4, v3, s31, v4
    s_lshl_b32 s34, s33, 10
    s_add_u32 m0, s41, s34
    s_add_u32 s33, s33, 1
    buffer_load_dwordx4 v4, s[8:11], s29 offen lds
    s_cmp_eq_u32 s33, 36
    s_cselect_b32 s33, 0, s33
    s_lshl_b32 s34, s33, 6
    v_add_u32 v2, s34, v0
    v_mul_u32_u24 v3, s30, v2
    v_lshrrev_b32 v3, 21, v3
    v_mul_u32_u24 v4, 72, v3
    v_sub_u32 v4, v2, v4
    v_lshrrev_b32 v5, 1, v3
    v_xor_b32 v5, v5, v4
    v_and_b32 v5, 7, v5
    v_and_b32 v4, 0x78, v4
    v_or_b32 v4, v4, v5
    v_lshlrev_b32 v4, 4, v4
    v_mad_u32_u24 v4, v3, s31, v4
    s_lshl_b32 s34, s33, 10
    s_add_u32 m0, s41, s34
    s_add_u32 s33, s33, 1
    buffer_load_dwordx4 v4, s[8:11], s29 offen lds
    s_cmp_eq_u32 s33, 36
    s_cselect_b32 s33, 0, s33
    s_lshl_b32 s34, s33, 6
    v_add_u32 v2, s34, v0
    v_mul_u32_u24 v3, s30, v2
    v_lshrrev_b32 v3, 21, v3
    v_mul_u32_u24 v4, 72, v3
    v_sub_u32 v4, v2, v4
    v_lshrrev_b32 v5, 1, v3
    v_xor_b32 v5, v5, v4
    v_and_b32 v5, 7, v5
    v_and_b32 v4, 0x78, v4
    v_or_b32 v4, v4, v5
    v_lshlrev_b32 v4, 4, v4
    v_mad_u32_u24 v4, v3, s31, v4
    s_lshl_b32 s34, s33, 10
    s_add_u32 m0, s41, s34
    s_add_u32 s33, s33, 1
    buffer_load_dwordx4 v4, s[8:11], s29 offen lds
    s_cmp_eq_u32 s33, 36
    s_cselect_b32 s33, 0, s33
    s_lshl_b32 s34, s33, 6
    v_add_u32 v2, s34, v0
    v_mul_u32_u24 v3, s30, v2
    v_lshrrev_b32 v3, 21, v3
    v_mul_u32_u24 v4, 72, v3
    v_sub_u32 v4, v2, v4
    v_lshrrev_b32 v5, 1, v3
    v_xor_b32 v5, v5, v4
    v_and_b32 v5, 7, v5
    v_and_b32 v4, 0x78, v4
    v_or_b32 v4, v4, v5
    v_lshlrev_b32 v4, 4, v4
    v_mad_u32_u24 v4, v3, s31, v4
    s_lshl_b32 s34, s33, 10
    s_add_u32 m0, s41, s34
    s_add_u32 s33, s33, 1
    buffer_load_dwordx4 v4, s[8:11], s29 offen lds
    s_cmp_eq_u32 s33, 36
    s_cselect_b32 s33, 0, s33
    s_lshl_b32 s34, s33, 6
    v_add_u32 v2, s34, v0
    v_mul_u32_u24 v3, s30, v2
    v_lshrrev_b32 v3, 21, v3
    v_mul_u32_u24 v4, 72, v3
    v_sub_u32 v4, v2, v4
    v_lshrrev_b32 v5, 1, v3
    v_xor_b32 v5, v5, v4
    v_and_b32 v5, 7, v5
    v_and_b32 v4, 0x78, v4
    v_or_b32 v4, v4, v5
    v_lshlrev_b32 v4, 4, v4
    v_mad_u32_u24 v4, v3, s31, v4
    s_lshl_b32 s34, s33, 10
    s_add_u32 m0, s41, s34
    s_add_u32 s33, s33, 1
    buffer_load_dwordx4 v4, s[8:11], s29 offen lds
    s_cmp_eq_u32 s33, 36
    s_cselect_b32 s33, 0, s33
    s_lshl_b32 s34, s33, 6
    v_add_u32 v2, s34, v0
    v_mul_u32_u24 v3, s30, v2
    v_lshrrev_b32 v3, 21, v3
    v_mul_u32_u24 v4, 72, v3
    v_sub_u32 v4, v2, v4
    v_lshrrev_b32 v5, 1, v3
    v_xor_b32 v5, v5, v4
    v_and_b32 v5, 7, v5
    v_and_b32 v4, 0x78, v4
    v_or_b32 v4, v4, v5
    v_lshlrev_b32 v4, 4, v4
    v_mad_u32_u24 v4, v3, s31, v4
    s_lshl_b32 s34, s33, 10
    s_add_u32 m0, s41, s34
    s_add_u32 s33, s33, 1
    buffer_load_dwordx4 v4, s[8:11], s29 offen lds
    s_cmp_eq_u32 s33, 36
    s_cselect_b32 s33, 0, s33
    s_lshl_b32 s34, s33, 6
    v_add_u32 v2, s34, v0
    v_mul_u32_u24 v3, s30, v2
    v_lshrrev_b32 v3, 21, v3
    v_mul_u32_u24 v4, 72, v3
    v_sub_u32 v4, v2, v4
    v_lshrrev_b32 v5, 1, v3
    v_xor_b32 v5, v5, v4
    v_and_b32 v5, 7, v5
    v_and_b32 v4, 0x78, v4
    v_or_b32 v4, v4, v5
    v_lshlrev_b32 v4, 4, v4
    v_mad_u32_u24 v4, v3, s31, v4
    s_lshl_b32 s34, s33, 10
    s_add_u32 m0, s41, s34
    s_add_u32 s33, s33, 1
    buffer_load_dwordx4 v4, s[8:11], s29 offen lds
    s_cmp_eq_u32 s33, 36
    s_cselect_b32 s33, 0, s33
    s_lshl_b32 s34, s33, 6
    v_add_u32 v2, s34, v0
    v_mul_u32_u24 v3, s30, v2
    v_lshrrev_b32 v3, 21, v3
    v_mul_u32_u24 v4, 72, v3
    v_sub_u32 v4, v2, v4
    v_lshrrev_b32 v5, 1, v3
    v_xor_b32 v5, v5, v4
    v_and_b32 v5, 7, v5
    v_and_b32 v4, 0x78, v4
    v_or_b32 v4, v4, v5
    v_lshlrev_b32 v4, 4, v4
    v_mad_u32_u24 v4, v3, s31, v4
    s_lshl_b32 s34, s33, 10
    s_add_u32 m0, s41, s34
    s_add_u32 s33, s33, 1
    buffer_load_dwordx4 v4, s[8:11], s29 offen lds
    s_cmp_eq_u32 s33, 36
    s_cselect_b32 s33, 0, s33
    s_lshl_b32 s34, s33, 6
    v_add_u32 v2, s34, v0
    v_mul_u32_u24 v3, s30, v2
    v_lshrrev_b32 v3, 21, v3
    v_mul_u32_u24 v4, 72, v3
    v_sub_u32 v4, v2, v4
    v_lshrrev_b32 v5, 1, v3
    v_xor_b32 v5, v5, v4
    v_and_b32 v5, 7, v5
    v_and_b32 v4, 0x78, v4
    v_or_b32 v4, v4, v5
    v_lshlrev_b32 v4, 4, v4
    v_mad_u32_u24 v4, v3, s31, v4
    s_lshl_b32 s34, s33, 10
    s_add_u32 m0, s41, s34
    s_add_u32 s33, s33, 1
    buffer_load_dwordx4 v4, s[8:11], s29 offen lds
    s_cmp_eq_u32 s33, 36
    s_cselect_b32 s33, 0, s33
    s_lshl_b32 s34, s33, 6
    v_add_u32 v2, s34, v0
    v_mul_u32_u24 v3, s30, v2
    v_lshrrev_b32 v3, 21, v3
    v_mul_u32_u24 v4, 72, v3
    v_sub_u32 v4, v2, v4
    v_lshrrev_b32 v5, 1, v3
    v_xor_b32 v5, v5, v4
    v_and_b32 v5, 7, v5
    v_and_b32 v4, 0x78, v4
    v_or_b32 v4, v4, v5
    v_lshlrev_b32 v4, 4, v4
    v_mad_u32_u24 v4, v3, s31, v4
    s_lshl_b32 s34, s33, 10
    s_add_u32 m0, s41, s34
    s_add_u32 s33, s33, 1
    buffer_load_dwordx4 v4, s[8:11], s29 offen lds
    s_cmp_eq_u32 s33, 36
    s_cselect_b32 s33, 0, s33
    s_movk_i32 s30, 3456
    v_lshrrev_b32 v2, 4, v0
    v_mul_lo_u32 v2, v2, s30
    v_and_b32 v3, 15, v0
    v_lshrrev_b32 v4, 4, v0
    v_lshlrev_b32 v4, 2, v4
    v_xor_b32 v3, v3, v4
    v_lshlrev_b32 v6, 4, v3
    v_cmp_eq_u32 vcc, 13, v3
    v_mov_b32 v9, 200
    s_nop 0
    v_cndmask_b32 v6, v6, v9, vcc
    v_cmp_lt_u32 vcc, 13, v3
    v_mov_b32 v9, 0x40000000
    s_nop 0
    v_cndmask_b32 v6, v6, v9, vcc
    v_add_u32 v6, v6, v2
    s_movk_i32 s31, 9216
    v_lshrrev_b32 v2, 2, v0
    v_mul_lo_u32 v2, v2, s31
    v_and_b32 v3, 3, v0
    v_lshlrev_b32 v3, 4, v3
    v_add_u32 v7, v2, v3
    v_lshrrev_b32 v2, 3, v0
    v_mul_lo_u32 v8, v2, s31
    v_bfe_u32 v2, v0, 4, 1
    v_bfe_u32 v4, v0, 2, 1
    v_xor_b32 v2, v2, v4
    v_lshlrev_b32 v2, 6, v2
    v_add3_u32 v8, v8, v2, v3
    s_mul_i32 s32, s28, 124416
    s_mul_i32 s33, s25, 216
    s_add_u32 s32, s32, s33
    s_and_b32 s33, s25, 1
    s_mul_i32 s35, s25, 576
    s_mul_i32 s34, s28, 1327104
    s_add_u32 s34, s34, s35
    s_cmp_eq_u32 s33, 0
    s_cselect_b32 s36, 512, 0
    s_add_u32 s34, s34, s36
    s_mul_i32 s40, s28, 663552
    s_add_u32 s40, s40, s35
    s_lshl_b32 s36, s33, 6
    s_add_u32 s40, s40, s36
    s_mul_i32 s41, s28, 9216
    s_waitcnt vmcnt(0)
    s_cmp_eq_u32 s2, 0
    s_cbranch_scc0 parallel_sum__softmax_full_mha__dense_activation_relu__prompt_kernel_nozs
    s_cmp_eq_u32 s28, 0
    s_cbranch_scc0 parallel_sum__softmax_full_mha__dense_activation_relu__prompt_kernel_nozs
    v_mov_b32 v22, 64
    v_mov_b32 v23, 1
    s_mov_b64 exec, 1
    global_atomic_add v22, v23, s[90:91] sc1
    s_mov_b64 exec, -1
parallel_sum__softmax_full_mha__dense_activation_relu__prompt_kernel_nozs:
    s_barrier
    s_barrier
    s_and_b32 s73, s24, 7
    s_mul_i32 s67, s73, 36
    s_mul_i32 s74, s28, 9
    s_add_u32 s67, s67, s74
    s_mul_i32 s67, s67, 9216
    s_add_u32 s67, s67, s35
    s_and_b32 s74, s25, 1
    s_lshl_b32 s75, s74, 6
    s_add_u32 s67, s67, s75
    s_mul_i32 s66, s73, 72
    s_mul_i32 s75, s28, 18
    s_add_u32 s66, s66, s75
    s_mul_i32 s66, s66, 9216
    s_add_u32 s66, s66, s35
    s_cmp_eq_u32 s74, 0
    s_cselect_b32 s75, 512, 0
    s_add_u32 s66, s66, s75
    v_mul_u32_u24 v26, 9216, v0
    s_add_u32 m0, s41, 16384
    s_add_u32 s29, s32, 0
    buffer_load_dwordx4 v6, s[16:19], s29 offen lds
    s_add_u32 m0, s41, 17408
    s_add_u32 s29, s32, 13824
    buffer_load_dwordx4 v6, s[16:19], s29 offen lds
    s_add_u32 m0, s41, 18432
    s_add_u32 s29, s32, 27648
    buffer_load_dwordx4 v6, s[16:19], s29 offen lds
    s_add_u32 m0, s41, 19456
    s_add_u32 s29, s32, 41472
    buffer_load_dwordx4 v6, s[16:19], s29 offen lds
    s_add_u32 m0, s41, 20480
    s_add_u32 s29, s32, 55296
    buffer_load_dwordx4 v6, s[16:19], s29 offen lds
    s_add_u32 m0, s41, 21504
    s_add_u32 s29, s32, 69120
    buffer_load_dwordx4 v6, s[16:19], s29 offen lds
    s_add_u32 m0, s41, 22528
    s_add_u32 s29, s32, 82944
    buffer_load_dwordx4 v6, s[16:19], s29 offen lds
    s_add_u32 m0, s41, 23552
    s_add_u32 s29, s32, 96768
    buffer_load_dwordx4 v6, s[16:19], s29 offen lds
    s_add_u32 m0, s41, 24576
    s_add_u32 s29, s32, 110592
    buffer_load_dwordx4 v6, s[16:19], s29 offen lds
    s_add_u32 m0, s41, 53248
    s_add_u32 s29, s32, 497664
    buffer_load_dwordx4 v6, s[16:19], s29 offen lds
    s_add_u32 m0, s41, 54272
    s_add_u32 s29, s32, 511488
    buffer_load_dwordx4 v6, s[16:19], s29 offen lds
    s_add_u32 m0, s41, 55296
    s_add_u32 s29, s32, 525312
    buffer_load_dwordx4 v6, s[16:19], s29 offen lds
    s_add_u32 m0, s41, 56320
    s_add_u32 s29, s32, 539136
    buffer_load_dwordx4 v6, s[16:19], s29 offen lds
    s_add_u32 m0, s41, 57344
    s_add_u32 s29, s32, 552960
    buffer_load_dwordx4 v6, s[16:19], s29 offen lds
    s_add_u32 m0, s41, 58368
    s_add_u32 s29, s32, 566784
    buffer_load_dwordx4 v6, s[16:19], s29 offen lds
    s_add_u32 m0, s41, 59392
    s_add_u32 s29, s32, 580608
    buffer_load_dwordx4 v6, s[16:19], s29 offen lds
    s_add_u32 m0, s41, 60416
    s_add_u32 s29, s32, 594432
    buffer_load_dwordx4 v6, s[16:19], s29 offen lds
    s_add_u32 m0, s41, 61440
    s_add_u32 s29, s32, 608256
    buffer_load_dwordx4 v6, s[16:19], s29 offen lds
    s_waitcnt vmcnt(9)
    s_barrier
    s_add_u32 m0, s41, 90112
    s_add_u32 s29, s32, 995328
    buffer_load_dwordx4 v6, s[16:19], s29 offen lds
    s_add_u32 m0, s41, 91136
    s_add_u32 s29, s32, 1009152
    buffer_load_dwordx4 v6, s[16:19], s29 offen lds
    s_add_u32 m0, s41, 92160
    s_add_u32 s29, s32, 1022976
    buffer_load_dwordx4 v6, s[16:19], s29 offen lds
    s_add_u32 m0, s41, 93184
    s_add_u32 s29, s32, 1036800
    buffer_load_dwordx4 v6, s[16:19], s29 offen lds
    s_add_u32 m0, s41, 94208
    s_add_u32 s29, s32, 1050624
    buffer_load_dwordx4 v6, s[16:19], s29 offen lds
    s_add_u32 m0, s41, 95232
    s_add_u32 s29, s32, 1064448
    buffer_load_dwordx4 v6, s[16:19], s29 offen lds
    s_add_u32 m0, s41, 96256
    s_add_u32 s29, s32, 1078272
    buffer_load_dwordx4 v6, s[16:19], s29 offen lds
    s_add_u32 m0, s41, 97280
    s_add_u32 s29, s32, 1092096
    buffer_load_dwordx4 v6, s[16:19], s29 offen lds
    s_add_u32 m0, s41, 98304
    s_add_u32 s29, s32, 1105920
    buffer_load_dwordx4 v6, s[16:19], s29 offen lds
    s_waitcnt vmcnt(9)
    s_barrier
    s_add_u32 m0, s41, 126976
    s_add_u32 s29, s32, 1492992
    buffer_load_dwordx4 v6, s[16:19], s29 offen lds
    s_add_u32 m0, s41, 128000
    s_add_u32 s29, s32, 1506816
    buffer_load_dwordx4 v6, s[16:19], s29 offen lds
    s_add_u32 m0, s41, 129024
    s_add_u32 s29, s32, 1520640
    buffer_load_dwordx4 v6, s[16:19], s29 offen lds
    s_add_u32 m0, s41, 130048
    s_add_u32 s29, s32, 1534464
    buffer_load_dwordx4 v6, s[16:19], s29 offen lds
    s_add_u32 m0, s41, 131072
    s_add_u32 s29, s32, 1548288
    buffer_load_dwordx4 v6, s[16:19], s29 offen lds
    s_add_u32 m0, s41, 132096
    s_add_u32 s29, s32, 1562112
    buffer_load_dwordx4 v6, s[16:19], s29 offen lds
    s_add_u32 m0, s41, 133120
    s_add_u32 s29, s32, 1575936
    buffer_load_dwordx4 v6, s[16:19], s29 offen lds
    s_add_u32 m0, s41, 134144
    s_add_u32 s29, s32, 1589760
    buffer_load_dwordx4 v6, s[16:19], s29 offen lds
    s_add_u32 m0, s41, 135168
    s_add_u32 s29, s32, 1603584
    buffer_load_dwordx4 v6, s[16:19], s29 offen lds
    s_waitcnt vmcnt(9)
    s_barrier
    s_add_u32 m0, s41, 16384
    s_add_u32 s29, s34, 0
    buffer_load_dwordx4 v7, s[20:23], s29 offen lds
    s_add_u32 m0, s41, 17408
    s_add_u32 s29, s34, 147456
    buffer_load_dwordx4 v7, s[20:23], s29 offen lds
    s_add_u32 m0, s41, 18432
    s_add_u32 s29, s34, 294912
    buffer_load_dwordx4 v7, s[20:23], s29 offen lds
    s_add_u32 m0, s41, 19456
    s_add_u32 s29, s34, 442368
    buffer_load_dwordx4 v7, s[20:23], s29 offen lds
    s_add_u32 m0, s41, 20480
    s_add_u32 s29, s34, 589824
    buffer_load_dwordx4 v7, s[20:23], s29 offen lds
    s_add_u32 m0, s41, 21504
    s_add_u32 s29, s34, 737280
    buffer_load_dwordx4 v7, s[20:23], s29 offen lds
    s_add_u32 m0, s41, 22528
    s_add_u32 s29, s34, 884736
    buffer_load_dwordx4 v7, s[20:23], s29 offen lds
    s_add_u32 m0, s41, 23552
    s_add_u32 s29, s34, 1032192
    buffer_load_dwordx4 v7, s[20:23], s29 offen lds
    s_add_u32 m0, s41, 24576
    s_add_u32 s29, s34, 1179648
    buffer_load_dwordx4 v7, s[20:23], s29 offen lds
    s_waitcnt vmcnt(9)
    s_barrier
    s_add_u32 m0, s41, 53248
    s_add_u32 s29, s40, 0
    buffer_load_dwordx4 v8, s[20:23], s29 offen lds
    s_add_u32 m0, s41, 54272
    s_add_u32 s29, s40, 73728
    buffer_load_dwordx4 v8, s[20:23], s29 offen lds
    s_add_u32 m0, s41, 55296
    s_add_u32 s29, s40, 147456
    buffer_load_dwordx4 v8, s[20:23], s29 offen lds
    s_add_u32 m0, s41, 56320
    s_add_u32 s29, s40, 221184
    buffer_load_dwordx4 v8, s[20:23], s29 offen lds
    s_add_u32 m0, s41, 57344
    s_add_u32 s29, s40, 294912
    buffer_load_dwordx4 v8, s[20:23], s29 offen lds
    s_add_u32 m0, s41, 58368
    s_add_u32 s29, s40, 368640
    buffer_load_dwordx4 v8, s[20:23], s29 offen lds
    s_add_u32 m0, s41, 59392
    s_add_u32 s29, s40, 442368
    buffer_load_dwordx4 v8, s[20:23], s29 offen lds
    s_add_u32 m0, s41, 60416
    s_add_u32 s29, s40, 516096
    buffer_load_dwordx4 v8, s[20:23], s29 offen lds
    s_add_u32 m0, s41, 61440
    s_add_u32 s29, s40, 589824
    buffer_load_dwordx4 v8, s[20:23], s29 offen lds
    s_waitcnt vmcnt(9)
    s_barrier
    s_add_u32 m0, s41, 90112
    s_add_u32 s29, s40, 2654208
    buffer_load_dwordx4 v8, s[20:23], s29 offen lds
    s_add_u32 m0, s41, 91136
    s_add_u32 s29, s40, 2727936
    buffer_load_dwordx4 v8, s[20:23], s29 offen lds
    s_add_u32 m0, s41, 92160
    s_add_u32 s29, s40, 2801664
    buffer_load_dwordx4 v8, s[20:23], s29 offen lds
    s_add_u32 m0, s41, 93184
    s_add_u32 s29, s40, 2875392
    buffer_load_dwordx4 v8, s[20:23], s29 offen lds
    s_add_u32 m0, s41, 94208
    s_add_u32 s29, s40, 2949120
    buffer_load_dwordx4 v8, s[20:23], s29 offen lds
    s_add_u32 m0, s41, 95232
    s_add_u32 s29, s40, 3022848
    buffer_load_dwordx4 v8, s[20:23], s29 offen lds
    s_add_u32 m0, s41, 96256
    s_add_u32 s29, s40, 3096576
    buffer_load_dwordx4 v8, s[20:23], s29 offen lds
    s_add_u32 m0, s41, 97280
    s_add_u32 s29, s40, 3170304
    buffer_load_dwordx4 v8, s[20:23], s29 offen lds
    s_add_u32 m0, s41, 98304
    s_add_u32 s29, s40, 3244032
    buffer_load_dwordx4 v8, s[20:23], s29 offen lds
    s_waitcnt vmcnt(9)
    s_barrier
    s_add_u32 m0, s41, 126976
    s_add_u32 s29, s40, 128
    buffer_load_dwordx4 v8, s[20:23], s29 offen lds
    s_add_u32 m0, s41, 128000
    s_add_u32 s29, s40, 73856
    buffer_load_dwordx4 v8, s[20:23], s29 offen lds
    s_add_u32 m0, s41, 129024
    s_add_u32 s29, s40, 147584
    buffer_load_dwordx4 v8, s[20:23], s29 offen lds
    s_add_u32 m0, s41, 130048
    s_add_u32 s29, s40, 221312
    buffer_load_dwordx4 v8, s[20:23], s29 offen lds
    s_add_u32 m0, s41, 131072
    s_add_u32 s29, s40, 295040
    buffer_load_dwordx4 v8, s[20:23], s29 offen lds
    s_add_u32 m0, s41, 132096
    s_add_u32 s29, s40, 368768
    buffer_load_dwordx4 v8, s[20:23], s29 offen lds
    s_add_u32 m0, s41, 133120
    s_add_u32 s29, s40, 442496
    buffer_load_dwordx4 v8, s[20:23], s29 offen lds
    s_add_u32 m0, s41, 134144
    s_add_u32 s29, s40, 516224
    buffer_load_dwordx4 v8, s[20:23], s29 offen lds
    s_add_u32 m0, s41, 135168
    s_add_u32 s29, s40, 589952
    buffer_load_dwordx4 v8, s[20:23], s29 offen lds
    s_waitcnt vmcnt(9)
    s_barrier
    s_add_u32 m0, s41, 16384
    s_add_u32 s29, s40, 2654336
    buffer_load_dwordx4 v8, s[20:23], s29 offen lds
    s_add_u32 m0, s41, 17408
    s_add_u32 s29, s40, 2728064
    buffer_load_dwordx4 v8, s[20:23], s29 offen lds
    s_add_u32 m0, s41, 18432
    s_add_u32 s29, s40, 2801792
    buffer_load_dwordx4 v8, s[20:23], s29 offen lds
    s_add_u32 m0, s41, 19456
    s_add_u32 s29, s40, 2875520
    buffer_load_dwordx4 v8, s[20:23], s29 offen lds
    s_add_u32 m0, s41, 20480
    s_add_u32 s29, s40, 2949248
    buffer_load_dwordx4 v8, s[20:23], s29 offen lds
    s_add_u32 m0, s41, 21504
    s_add_u32 s29, s40, 3022976
    buffer_load_dwordx4 v8, s[20:23], s29 offen lds
    s_add_u32 m0, s41, 22528
    s_add_u32 s29, s40, 3096704
    buffer_load_dwordx4 v8, s[20:23], s29 offen lds
    s_add_u32 m0, s41, 23552
    s_add_u32 s29, s40, 3170432
    buffer_load_dwordx4 v8, s[20:23], s29 offen lds
    s_add_u32 m0, s41, 24576
    s_add_u32 s29, s40, 3244160
    buffer_load_dwordx4 v8, s[20:23], s29 offen lds
    s_waitcnt vmcnt(9)
    s_barrier
    s_cmp_eq_u32 s28, 0
    s_cbranch_scc0 parallel_sum__softmax_full_mha__dense_activation_relu__prompt_kernel_noq
    s_lshl_b32 s73, s25, 2
    v_mov_b32 v22, s73
    v_mov_b32 v23, 1
    s_mov_b64 exec, 1
    global_atomic_add v22, v23, s[90:91] sc1
    s_mov_b64 exec, -1
parallel_sum__softmax_full_mha__dense_activation_relu__prompt_kernel_noq:
    s_add_u32 m0, s41, 53248
    s_add_u32 s29, s40, 256
    buffer_load_dwordx4 v8, s[20:23], s29 offen lds
    s_add_u32 m0, s41, 54272
    s_add_u32 s29, s40, 73984
    buffer_load_dwordx4 v8, s[20:23], s29 offen lds
    s_add_u32 m0, s41, 55296
    s_add_u32 s29, s40, 147712
    buffer_load_dwordx4 v8, s[20:23], s29 offen lds
    s_add_u32 m0, s41, 56320
    s_add_u32 s29, s40, 221440
    buffer_load_dwordx4 v8, s[20:23], s29 offen lds
    s_add_u32 m0, s41, 57344
    s_add_u32 s29, s40, 295168
    buffer_load_dwordx4 v8, s[20:23], s29 offen lds
    s_add_u32 m0, s41, 58368
    s_add_u32 s29, s40, 368896
    buffer_load_dwordx4 v8, s[20:23], s29 offen lds
    s_add_u32 m0, s41, 59392
    s_add_u32 s29, s40, 442624
    buffer_load_dwordx4 v8, s[20:23], s29 offen lds
    s_add_u32 m0, s41, 60416
    s_add_u32 s29, s40, 516352
    buffer_load_dwordx4 v8, s[20:23], s29 offen lds
    s_add_u32 m0, s41, 61440
    s_add_u32 s29, s40, 590080
    buffer_load_dwordx4 v8, s[20:23], s29 offen lds
    s_waitcnt vmcnt(9)
    s_barrier
    s_add_u32 m0, s41, 90112
    s_add_u32 s29, s40, 2654464
    buffer_load_dwordx4 v8, s[20:23], s29 offen lds
    s_add_u32 m0, s41, 91136
    s_add_u32 s29, s40, 2728192
    buffer_load_dwordx4 v8, s[20:23], s29 offen lds
    s_add_u32 m0, s41, 92160
    s_add_u32 s29, s40, 2801920
    buffer_load_dwordx4 v8, s[20:23], s29 offen lds
    s_add_u32 m0, s41, 93184
    s_add_u32 s29, s40, 2875648
    buffer_load_dwordx4 v8, s[20:23], s29 offen lds
    s_add_u32 m0, s41, 94208
    s_add_u32 s29, s40, 2949376
    buffer_load_dwordx4 v8, s[20:23], s29 offen lds
    s_add_u32 m0, s41, 95232
    s_add_u32 s29, s40, 3023104
    buffer_load_dwordx4 v8, s[20:23], s29 offen lds
    s_add_u32 m0, s41, 96256
    s_add_u32 s29, s40, 3096832
    buffer_load_dwordx4 v8, s[20:23], s29 offen lds
    s_add_u32 m0, s41, 97280
    s_add_u32 s29, s40, 3170560
    buffer_load_dwordx4 v8, s[20:23], s29 offen lds
    s_add_u32 m0, s41, 98304
    s_add_u32 s29, s40, 3244288
    buffer_load_dwordx4 v8, s[20:23], s29 offen lds
    s_waitcnt vmcnt(9)
    s_barrier
    s_add_u32 m0, s41, 126976
    s_add_u32 s29, s40, 384
    buffer_load_dwordx4 v8, s[20:23], s29 offen lds
    s_add_u32 m0, s41, 128000
    s_add_u32 s29, s40, 74112
    buffer_load_dwordx4 v8, s[20:23], s29 offen lds
    s_add_u32 m0, s41, 129024
    s_add_u32 s29, s40, 147840
    buffer_load_dwordx4 v8, s[20:23], s29 offen lds
    s_add_u32 m0, s41, 130048
    s_add_u32 s29, s40, 221568
    buffer_load_dwordx4 v8, s[20:23], s29 offen lds
    s_add_u32 m0, s41, 131072
    s_add_u32 s29, s40, 295296
    buffer_load_dwordx4 v8, s[20:23], s29 offen lds
    s_add_u32 m0, s41, 132096
    s_add_u32 s29, s40, 369024
    buffer_load_dwordx4 v8, s[20:23], s29 offen lds
    s_add_u32 m0, s41, 133120
    s_add_u32 s29, s40, 442752
    buffer_load_dwordx4 v8, s[20:23], s29 offen lds
    s_add_u32 m0, s41, 134144
    s_add_u32 s29, s40, 516480
    buffer_load_dwordx4 v8, s[20:23], s29 offen lds
    s_add_u32 m0, s41, 135168
    s_add_u32 s29, s40, 590208
    buffer_load_dwordx4 v8, s[20:23], s29 offen lds
    s_waitcnt vmcnt(9)
    s_barrier
    s_add_u32 m0, s41, 16384
    s_add_u32 s29, s40, 2654592
    buffer_load_dwordx4 v8, s[20:23], s29 offen lds
    s_add_u32 m0, s41, 17408
    s_add_u32 s29, s40, 2728320
    buffer_load_dwordx4 v8, s[20:23], s29 offen lds
    s_add_u32 m0, s41, 18432
    s_add_u32 s29, s40, 2802048
    buffer_load_dwordx4 v8, s[20:23], s29 offen lds
    s_add_u32 m0, s41, 19456
    s_add_u32 s29, s40, 2875776
    buffer_load_dwordx4 v8, s[20:23], s29 offen lds
    s_add_u32 m0, s41, 20480
    s_add_u32 s29, s40, 2949504
    buffer_load_dwordx4 v8, s[20:23], s29 offen lds
    s_add_u32 m0, s41, 21504
    s_add_u32 s29, s40, 3023232
    buffer_load_dwordx4 v8, s[20:23], s29 offen lds
    s_add_u32 m0, s41, 22528
    s_add_u32 s29, s40, 3096960
    buffer_load_dwordx4 v8, s[20:23], s29 offen lds
    s_add_u32 m0, s41, 23552
    s_add_u32 s29, s40, 3170688
    buffer_load_dwordx4 v8, s[20:23], s29 offen lds
    s_add_u32 m0, s41, 24576
    s_add_u32 s29, s40, 3244416
    buffer_load_dwordx4 v8, s[20:23], s29 offen lds
    s_waitcnt vmcnt(9)
    s_barrier
    s_waitcnt vmcnt(0)
    s_cmp_eq_u32 s28, 0
    s_cbranch_scc0 parallel_sum__softmax_full_mha__dense_activation_relu__prompt_kernel_noqp
    s_and_b32 s73, s2, 7
    s_lshl_b32 s73, s73, 1
    s_bfe_u32 s74, s2, 0x10004
    s_add_u32 s72, s73, s74
    s_mul_i32 s73, s72, 43691
    s_lshr_b32 s73, s73, 17
    s_lshl_b32 s73, s73, 2
    s_add_u32 s74, s72, 16
    s_mul_i32 s74, s74, 43691
    s_lshr_b32 s74, s74, 17
    s_lshl_b32 s74, s74, 2
    s_add_u32 s75, s72, 32
    s_mul_i32 s75, s75, 43691
    s_lshr_b32 s75, s75, 17
    s_lshl_b32 s75, s75, 2
    s_mov_b32 s94, 65536
parallel_sum__softmax_full_mha__dense_activation_relu__prompt_kernel_poll_qkv:
    v_mov_b32 v22, s73
    global_load_dword v24, v22, s[90:91] sc1
    v_mov_b32 v22, s74
    global_load_dword v25, v22, s[90:91] sc1
    v_mov_b32 v22, s75
    global_load_dword v26, v22, s[90:91] sc1
    v_mov_b32 v22, 64
    global_load_dword v27, v22, s[90:91] sc1
    s_waitcnt vmcnt(0)
    v_readfirstlane_b32 s95, v24
    s_nop 0
    s_cmp_ge_u32 s95, 16
    s_cbranch_scc0 parallel_sum__softmax_full_mha__dense_activation_relu__prompt_kernel_again_qkv
    v_readfirstlane_b32 s95, v25
    s_nop 0
    s_cmp_ge_u32 s95, 16
    s_cbranch_scc0 parallel_sum__softmax_full_mha__dense_activation_relu__prompt_kernel_again_qkv
    v_readfirstlane_b32 s95, v26
    s_nop 0
    s_cmp_ge_u32 s95, 16
    s_cbranch_scc0 parallel_sum__softmax_full_mha__dense_activation_relu__prompt_kernel_again_qkv
    v_readfirstlane_b32 s95, v27
    s_nop 0
    s_cmp_ge_u32 s95, 1
    s_cbranch_scc0 parallel_sum__softmax_full_mha__dense_activation_relu__prompt_kernel_again_qkv
    s_branch parallel_sum__softmax_full_mha__dense_activation_relu__prompt_kernel_ok_qkv
parallel_sum__softmax_full_mha__dense_activation_relu__prompt_kernel_again_qkv:
    s_sub_u32 s94, s94, 1
    s_cmp_eq_u32 s94, 0
    s_cbranch_scc1 parallel_sum__softmax_full_mha__dense_activation_relu__prompt_kernel_ok_qkv
    s_sleep 8
    s_branch parallel_sum__softmax_full_mha__dense_activation_relu__prompt_kernel_poll_qkv
parallel_sum__softmax_full_mha__dense_activation_relu__prompt_kernel_ok_qkv:
parallel_sum__softmax_full_mha__dense_activation_relu__prompt_kernel_noqp:
    s_barrier
    s_branch parallel_sum__softmax_full_mha__dense_activation_relu__prompt_kernel_p2
parallel_sum__softmax_full_mha__dense_activation_relu__prompt_kernel_consumer:
    s_lshl_b32 s28, s2, 2
    s_and_b32 s29, s26, 3
    s_add_u32 s28, s28, s29
    v_lshlrev_b32 v16, 7, v0
    s_mul_i32 s30, s28, 2048
    s_mov_b32 exec_hi, 0
    s_mov_b32 exec_lo, 0xffff
    buffer_load_dword v14, v16, s[16:19], s30 offen
    s_mov_b64 exec, -1
    s_load_dwordx2 s[74:75], s[0:1], 40
    s_load_dwordx2 s[76:77], s[0:1], 16
    s_waitcnt lgkmcnt(0)
    s_mov_b32 s68, s74
    s_and_b32 s69, s75, 0xffff
    s_mov_b32 s70, 5308416
    s_mov_b32 s71, 0x20000
    s_mov_b32 s72, s76
    s_and_b32 s73, s77, 0xffff
    s_mov_b32 s74, 663552
    s_mov_b32 s75, 0x20000
    s_lshl_b32 s78, s2, 2
    s_and_b32 s79, s26, 3
    s_add_u32 s78, s78, s79
    s_mul_i32 s79, s78, 768
    s_mul_i32 s78, s78, 5248
    v_and_b32 v16, 31, v0
    v_lshrrev_b32 v17, 5, v0
    v_lshlrev_b32 v1, 4, v0
    v_and_b32 v18, 15, v0
    v_lshrrev_b32 v19, 2, v18
    v_and_b32 v20, 3, v18
    v_bfe_u32 v21, v0, 4, 1
    v_lshlrev_b32 v22, 3, v17
    v_add_u32 v22, v22, v19
    v_lshlrev_b32 v23, 6, v22
    v_lshlrev_b32 v24, 3, v20
    v_lshlrev_b32 v25, 5, v21
    v_add3_u32 v10, v23, v24, v25
    v_lshlrev_b32 v23, 7, v22
    v_bfe_u32 v26, v19, 1, 1
    v_lshlrev_b32 v26, 6, v26
    v_add3_u32 v23, v23, v24, v25
    v_add_u32 v11, v23, v26
    v_xor_b32 v26, 64, v26
    v_add_u32 v12, v23, v26
    v_lshlrev_b32 v23, 8, v22
    v_lshlrev_b32 v26, 3, v19
    v_lshlrev_b32 v27, 2, v21
    v_add_u32 v27, v27, v20
    v_mov_b32 v2, 0
    v_mov_b32 v3, 0
    v_mov_b32 v4, 0
    v_mov_b32 v5, 0
    v_mov_b32 v6, 0
    s_lshr_b32 s31, s27, 3
    s_mul_i32 s31, s31, 20480
    s_add_u32 s31, s31, 2359296
    s_and_b32 s32, s27, 7
    s_mul_i32 s33, s32, 1280
    s_add_u32 s48, s31, s33
    s_add_u32 s48, s48, 9216
    s_mul_i32 s28, s25, 3
    s_add_u32 s28, s28, 0
    s_sub_u32 s29, s28, 16
    s_lshl_b32 s30, s28, 17
    s_lshl_b32 s33, s27, 10
    s_add_u32 s30, s30, s33
    s_add_u32 s30, s30, 0
    s_mul_i32 s29, s29, 327680
    s_add_u32 s29, s29, s31
    s_lshl_b32 s33, s32, 10
    s_add_u32 s29, s29, s33
    s_cmp_lt_u32 s28, 16
    s_cselect_b32 s45, s30, s29
    s_mov_b32 s29, 163840
    s_cselect_b32 s60, 65536, s29
    s_mov_b32 s29, 0x3eae1a93
    s_cselect_b32 s63, s29, 1.0
    s_mul_i32 s28, s25, 3
    s_add_u32 s28, s28, 1
    s_sub_u32 s29, s28, 16
    s_lshl_b32 s30, s28, 17
    s_lshl_b32 s33, s27, 10
    s_add_u32 s30, s30, s33
    s_add_u32 s30, s30, 0
    s_mul_i32 s29, s29, 327680
    s_add_u32 s29, s29, s31
    s_lshl_b32 s33, s32, 10
    s_add_u32 s29, s29, s33
    s_cmp_lt_u32 s28, 16
    s_cselect_b32 s46, s30, s29
    s_mov_b32 s29, 163840
    s_cselect_b32 s61, 65536, s29
    s_mov_b32 s29, 0x3eae1a93
    s_cselect_b32 s64, s29, 1.0
    s_mul_i32 s28, s25, 3
    s_add_u32 s28, s28, 2
    s_sub_u32 s29, s28, 16
    s_lshl_b32 s30, s28, 17
    s_lshl_b32 s33, s27, 10
    s_add_u32 s30, s30, s33
    s_add_u32 s30, s30, 0
    s_mul_i32 s29, s29, 327680
    s_add_u32 s29, s29, s31
    s_lshl_b32 s33, s32, 10
    s_add_u32 s29, s29, s33
    s_cmp_lt_u32 s28, 16
    s_cselect_b32 s47, s30, s29
    s_mov_b32 s29, 163840
    s_cselect_b32 s62, 65536, s29
    s_mov_b32 s29, 0x3eae1a93
    s_cselect_b32 s65, s29, 1.0
    s_cmp_lt_u32 s25, 10
    s_cbranch_scc1 parallel_sum__softmax_full_mha__dense_activation_relu__prompt_kernel_vsA
    s_cmp_eq_u32 s25, 10
    s_cbranch_scc1 parallel_sum__softmax_full_mha__dense_activation_relu__prompt_kernel_vsB
    v_add_u32 v28, 0, v27
    v_xor_b32 v29, v28, v26
    v_lshlrev_b32 v29, 3, v29
    v_add_u32 v7, v23, v29
    v_add_u32 v28, 8, v27
    v_xor_b32 v29, v28, v26
    v_lshlrev_b32 v29, 3, v29
    v_add_u32 v13, v23, v29
    v_add_u32 v28, 16, v27
    v_xor_b32 v29, v28, v26
    v_lshlrev_b32 v29, 3, v29
    v_add_u32 v9, v23, v29
    v_add_u32 v28, 24, v27
    v_cmp_eq_u32 vcc, 2, v27
    v_mov_b32 v29, 27
    s_nop 0
    v_cndmask_b32 v28, v28, v29, vcc
    v_cmp_eq_u32 vcc, 3, v27
    v_mov_b32 v29, 28
    s_nop 0
    v_cndmask_b32 v28, v28, v29, vcc
    v_cmp_eq_u32 vcc, 5, v27
    v_mov_b32 v29, 28
    s_nop 0
    v_cndmask_b32 v28, v28, v29, vcc
    v_cmp_eq_u32 vcc, 6, v27
    v_mov_b32 v29, 28
    s_nop 0
    v_cndmask_b32 v28, v28, v29, vcc
    v_cmp_eq_u32 vcc, 7, v27
    v_mov_b32 v29, 28
    s_nop 0
    v_cndmask_b32 v28, v28, v29, vcc
    v_xor_b32 v29, v28, v26
    v_lshlrev_b32 v29, 3, v29
    v_add_u32 v8, v23, v29
    v_mul_u32_u24 v24, 320, v17
    s_mul_i32 s28, s25, 6
    s_sub_u32 s28, s28, 64
    v_add_u32 v25, 0, v16
    v_mul_u32_u24 v28, 3641, v25
    v_lshrrev_b32 v28, 16, v28
    v_mul_u32_u24 v29, 18, v28
    v_sub_u32 v29, v25, v29
    v_lshlrev_b32 v29, 4, v29
    v_add_u32 v28, s28, v28
    v_mul_u32_u24 v28, 163840, v28
    v_add3_u32 v2, v28, v29, v24
    v_add_u32 v25, 32, v16
    v_mul_u32_u24 v28, 3641, v25
    v_lshrrev_b32 v28, 16, v28
    v_mul_u32_u24 v29, 18, v28
    v_sub_u32 v29, v25, v29
    v_lshlrev_b32 v29, 4, v29
    v_add_u32 v28, s28, v28
    v_mul_u32_u24 v28, 163840, v28
    v_add3_u32 v3, v28, v29, v24
    v_add_u32 v25, 64, v16
    v_mul_u32_u24 v28, 3641, v25
    v_lshrrev_b32 v28, 16, v28
    v_mul_u32_u24 v29, 18, v28
    v_sub_u32 v29, v25, v29
    v_lshlrev_b32 v29, 4, v29
    v_add_u32 v28, s28, v28
    v_mul_u32_u24 v28, 163840, v28
    v_add3_u32 v4, v28, v29, v24
    v_add_u32 v25, 96, v16
    v_mul_u32_u24 v28, 3641, v25
    v_lshrrev_b32 v28, 16, v28
    v_mul_u32_u24 v29, 18, v28
    v_sub_u32 v29, v25, v29
    v_lshlrev_b32 v29, 4, v29
    v_add_u32 v28, s28, v28
    v_mul_u32_u24 v28, 163840, v28
    v_add3_u32 v5, v28, v29, v24
    v_subrev_u32 v25, 12, v16
    v_and_b32 v28, 1, v25
    v_add_u32 v28, 18, v28
    v_lshlrev_b32 v28, 4, v28
    v_lshrrev_b32 v25, 1, v25
    v_add_u32 v25, s28, v25
    v_mul_u32_u24 v25, 163840, v25
    v_add3_u32 v25, v25, v28, v24
    v_cmp_le_u32 vcc, 12, v16
    s_nop 1
    v_cndmask_b32 v5, v5, v25, vcc
    v_and_b32 v25, 1, v16
    v_cmp_eq_u32 vcc, 0, v25
    v_mov_b32 v28, 0x3f803f80
    s_nop 0
    v_cndmask_b32 v6, 0, v28, vcc
    s_mov_b32 s50, 0xfff000
    s_mov_b32 s51, 0xfff000
    s_mov_b32 s52, 0xffffff
    s_mov_b32 s53, 0xffffff
    s_branch parallel_sum__softmax_full_mha__dense_activation_relu__prompt_kernel_vsE
parallel_sum__softmax_full_mha__dense_activation_relu__prompt_kernel_vsB:
    v_add_u32 v28, 0, v27
    v_cmp_eq_u32 vcc, 4, v27
    v_mov_b32 v29, 5
    s_nop 0
    v_cndmask_b32 v28, v28, v29, vcc
    v_cmp_eq_u32 vcc, 5, v27
    v_mov_b32 v29, 6
    s_nop 0
    v_cndmask_b32 v28, v28, v29, vcc
    v_cmp_eq_u32 vcc, 6, v27
    v_mov_b32 v29, 7
    s_nop 0
    v_cndmask_b32 v28, v28, v29, vcc
    v_cmp_eq_u32 vcc, 7, v27
    v_mov_b32 v29, 8
    s_nop 0
    v_cndmask_b32 v28, v28, v29, vcc
    v_xor_b32 v29, v28, v26
    v_lshlrev_b32 v29, 3, v29
    v_add_u32 v7, v23, v29
    v_add_u32 v28, 9, v27
    v_cmp_eq_u32 vcc, 4, v27
    v_mov_b32 v29, 14
    s_nop 0
    v_cndmask_b32 v28, v28, v29, vcc
    v_cmp_eq_u32 vcc, 5, v27
    v_mov_b32 v29, 15
    s_nop 0
    v_cndmask_b32 v28, v28, v29, vcc
    v_cmp_eq_u32 vcc, 6, v27
    v_mov_b32 v29, 16
    s_nop 0
    v_cndmask_b32 v28, v28, v29, vcc
    v_cmp_eq_u32 vcc, 7, v27
    v_mov_b32 v29, 17
    s_nop 0
    v_cndmask_b32 v28, v28, v29, vcc
    v_xor_b32 v29, v28, v26
    v_lshlrev_b32 v29, 3, v29
    v_add_u32 v13, v23, v29
    v_add_u32 v28, 18, v27
    v_xor_b32 v29, v28, v26
    v_lshlrev_b32 v29, 3, v29
    v_add_u32 v9, v23, v29
    v_add_u32 v28, 27, v27
    v_cmp_eq_u32 vcc, 1, v27
    v_mov_b32 v29, 4
    s_nop 0
    v_cndmask_b32 v28, v28, v29, vcc
    v_cmp_eq_u32 vcc, 2, v27
    v_mov_b32 v29, 13
    s_nop 0
    v_cndmask_b32 v28, v28, v29, vcc
    v_cmp_eq_u32 vcc, 3, v27
    v_mov_b32 v29, 28
    s_nop 0
    v_cndmask_b32 v28, v28, v29, vcc
    v_cmp_eq_u32 vcc, 4, v27
    v_mov_b32 v29, 28
    s_nop 0
    v_cndmask_b32 v28, v28, v29, vcc
    v_cmp_eq_u32 vcc, 5, v27
    v_mov_b32 v29, 28
    s_nop 0
    v_cndmask_b32 v28, v28, v29, vcc
    v_cmp_eq_u32 vcc, 6, v27
    v_mov_b32 v29, 28
    s_nop 0
    v_cndmask_b32 v28, v28, v29, vcc
    v_cmp_eq_u32 vcc, 7, v27
    v_mov_b32 v29, 28
    s_nop 0
    v_cndmask_b32 v28, v28, v29, vcc
    v_xor_b32 v29, v28, v26
    v_lshlrev_b32 v29, 3, v29
    v_add_u32 v8, v23, v29
    v_mul_u32_u24 v24, 320, v17
    v_add_u32 v25, 0, v16
    v_mul_u32_u24 v28, 3641, v25
    v_lshrrev_b32 v28, 16, v28
    v_mul_u32_u24 v29, 18, v28
    v_sub_u32 v29, v25, v29
    v_lshlrev_b32 v29, 4, v29
    v_add_u32 v28, 0, v28
    v_mul_u32_u24 v28, 163840, v28
    v_add3_u32 v2, v28, v29, v24
    v_add_u32 v25, 32, v16
    v_mul_u32_u24 v28, 3641, v25
    v_lshrrev_b32 v28, 16, v28
    v_mul_u32_u24 v29, 18, v28
    v_sub_u32 v29, v25, v29
    v_lshlrev_b32 v29, 4, v29
    v_add_u32 v28, 0, v28
    v_mul_u32_u24 v28, 163840, v28
    v_add3_u32 v3, v28, v29, v24
    v_subrev_u32 v25, 12, v16
    v_and_b32 v28, 1, v25
    v_add_u32 v28, 18, v28
    v_lshlrev_b32 v28, 4, v28
    v_lshrrev_b32 v25, 1, v25
    v_add_u32 v25, 0, v25
    v_mul_u32_u24 v25, 163840, v25
    v_add3_u32 v25, v25, v28, v24
    v_cmp_le_u32 vcc, 12, v16
    s_nop 1
    v_cndmask_b32 v3, v3, v25, vcc
    v_and_b32 v25, 1, v16
    v_cmp_eq_u32 vcc, 0, v25
    v_mov_b32 v28, 0x3f803f80
    s_nop 0
    v_cndmask_b32 v6, 0, v28, vcc
    v_bfe_u32 v25, v16, 1, 1
    v_mov_b32 v4, 0
    s_mul_i32 s28, s25, 3
    s_add_u32 s28, s28, 0
    s_sub_u32 s29, s28, 16
    s_lshl_b32 s30, s28, 14
    s_lshl_b32 s33, s27, 7
    s_add_u32 s30, s30, s33
    s_add_u32 s30, s30, 2097152
    s_mul_i32 s29, s29, 327680
    s_add_u32 s29, s29, s31
    s_lshl_b32 s33, s32, 7
    s_add_u32 s29, s29, s33
    s_add_u32 s29, s29, 8192
    s_cmp_lt_u32 s28, 16
    s_cselect_b32 s28, s30, s29
    s_mov_b32 s29, 163840
    s_cselect_b32 s29, 8192, s29
    v_mul_lo_u32 v28, v25, s29
    v_add_u32 v28, s28, v28
    v_lshrrev_b32 v29, 2, v16
    v_cmp_eq_u32 vcc, 1, v29
    s_nop 1
    v_cndmask_b32 v4, v4, v28, vcc
    s_mul_i32 s28, s25, 3
    s_add_u32 s28, s28, 1
    s_sub_u32 s29, s28, 16
    s_lshl_b32 s30, s28, 14
    s_lshl_b32 s33, s27, 7
    s_add_u32 s30, s30, s33
    s_add_u32 s30, s30, 2097152
    s_mul_i32 s29, s29, 327680
    s_add_u32 s29, s29, s31
    s_lshl_b32 s33, s32, 7
    s_add_u32 s29, s29, s33
    s_add_u32 s29, s29, 8192
    s_cmp_lt_u32 s28, 16
    s_cselect_b32 s28, s30, s29
    s_mov_b32 s29, 163840
    s_cselect_b32 s29, 8192, s29
    v_mul_lo_u32 v28, v25, s29
    v_add_u32 v28, s28, v28
    v_lshrrev_b32 v29, 2, v16
    v_cmp_eq_u32 vcc, 2, v29
    s_nop 1
    v_cndmask_b32 v4, v4, v28, vcc
    v_lshlrev_b32 v28, 4, v17
    v_add_u32 v4, v4, v28
    s_mov_b32 s50, 0xf000
    s_mov_b32 s51, 0xf000
    s_mov_b32 s52, 0xf00f
    s_mov_b32 s53, 0xf00f
    s_mov_b32 s54, 0x550
    s_mov_b32 s55, 0x550
    s_branch parallel_sum__softmax_full_mha__dense_activation_relu__prompt_kernel_vsE
parallel_sum__softmax_full_mha__dense_activation_relu__prompt_kernel_vsA:
    v_add_u32 v28, 0, v27
    v_cmp_eq_u32 vcc, 4, v27
    v_mov_b32 v29, 5
    s_nop 0
    v_cndmask_b32 v28, v28, v29, vcc
    v_cmp_eq_u32 vcc, 5, v27
    v_mov_b32 v29, 6
    s_nop 0
    v_cndmask_b32 v28, v28, v29, vcc
    v_cmp_eq_u32 vcc, 6, v27
    v_mov_b32 v29, 7
    s_nop 0
    v_cndmask_b32 v28, v28, v29, vcc
    v_cmp_eq_u32 vcc, 7, v27
    v_mov_b32 v29, 8
    s_nop 0
    v_cndmask_b32 v28, v28, v29, vcc
    v_xor_b32 v29, v28, v26
    v_lshlrev_b32 v29, 3, v29
    v_add_u32 v7, v23, v29
    v_add_u32 v28, 9, v27
    v_cmp_eq_u32 vcc, 4, v27
    v_mov_b32 v29, 14
    s_nop 0
    v_cndmask_b32 v28, v28, v29, vcc
    v_cmp_eq_u32 vcc, 5, v27
    v_mov_b32 v29, 15
    s_nop 0
    v_cndmask_b32 v28, v28, v29, vcc
    v_cmp_eq_u32 vcc, 6, v27
    v_mov_b32 v29, 16
    s_nop 0
    v_cndmask_b32 v28, v28, v29, vcc
    v_cmp_eq_u32 vcc, 7, v27
    v_mov_b32 v29, 17
    s_nop 0
    v_cndmask_b32 v28, v28, v29, vcc
    v_xor_b32 v29, v28, v26
    v_lshlrev_b32 v29, 3, v29
    v_add_u32 v13, v23, v29
    v_add_u32 v28, 18, v27
    v_cmp_eq_u32 vcc, 4, v27
    v_mov_b32 v29, 23
    s_nop 0
    v_cndmask_b32 v28, v28, v29, vcc
    v_cmp_eq_u32 vcc, 5, v27
    v_mov_b32 v29, 24
    s_nop 0
    v_cndmask_b32 v28, v28, v29, vcc
    v_cmp_eq_u32 vcc, 6, v27
    v_mov_b32 v29, 25
    s_nop 0
    v_cndmask_b32 v28, v28, v29, vcc
    v_cmp_eq_u32 vcc, 7, v27
    v_mov_b32 v29, 27
    s_nop 0
    v_cndmask_b32 v28, v28, v29, vcc
    v_xor_b32 v29, v28, v26
    v_lshlrev_b32 v29, 3, v29
    v_add_u32 v9, v23, v29
    v_add_u32 v28, 4, v27
    v_cmp_eq_u32 vcc, 1, v27
    v_mov_b32 v29, 13
    s_nop 0
    v_cndmask_b32 v28, v28, v29, vcc
    v_cmp_eq_u32 vcc, 2, v27
    v_mov_b32 v29, 22
    s_nop 0
    v_cndmask_b32 v28, v28, v29, vcc
    v_cmp_eq_u32 vcc, 3, v27
    v_mov_b32 v29, 28
    s_nop 0
    v_cndmask_b32 v28, v28, v29, vcc
    v_cmp_eq_u32 vcc, 4, v27
    v_mov_b32 v29, 28
    s_nop 0
    v_cndmask_b32 v28, v28, v29, vcc
    v_cmp_eq_u32 vcc, 5, v27
    v_mov_b32 v29, 28
    s_nop 0
    v_cndmask_b32 v28, v28, v29, vcc
    v_cmp_eq_u32 vcc, 6, v27
    v_mov_b32 v29, 28
    s_nop 0
    v_cndmask_b32 v28, v28, v29, vcc
    v_cmp_eq_u32 vcc, 7, v27
    v_mov_b32 v29, 28
    s_nop 0
    v_cndmask_b32 v28, v28, v29, vcc
    v_xor_b32 v29, v28, v26
    v_lshlrev_b32 v29, 3, v29
    v_add_u32 v8, v23, v29
    v_mul_u32_u24 v24, 320, v17
    v_bfe_u32 v25, v16, 1, 1
    v_mov_b32 v4, 0
    s_mul_i32 s28, s25, 3
    s_add_u32 s28, s28, 0
    s_sub_u32 s29, s28, 16
    s_lshl_b32 s30, s28, 14
    s_lshl_b32 s33, s27, 7
    s_add_u32 s30, s30, s33
    s_add_u32 s30, s30, 2097152
    s_mul_i32 s29, s29, 327680
    s_add_u32 s29, s29, s31
    s_lshl_b32 s33, s32, 7
    s_add_u32 s29, s29, s33
    s_add_u32 s29, s29, 8192
    s_cmp_lt_u32 s28, 16
    s_cselect_b32 s28, s30, s29
    s_mov_b32 s29, 163840
    s_cselect_b32 s29, 8192, s29
    v_mul_lo_u32 v28, v25, s29
    v_add_u32 v28, s28, v28
    v_lshrrev_b32 v29, 2, v16
    v_cmp_eq_u32 vcc, 0, v29
    s_nop 1
    v_cndmask_b32 v4, v4, v28, vcc
    s_mul_i32 s28, s25, 3
    s_add_u32 s28, s28, 1
    s_sub_u32 s29, s28, 16
    s_lshl_b32 s30, s28, 14
    s_lshl_b32 s33, s27, 7
    s_add_u32 s30, s30, s33
    s_add_u32 s30, s30, 2097152
    s_mul_i32 s29, s29, 327680
    s_add_u32 s29, s29, s31
    s_lshl_b32 s33, s32, 7
    s_add_u32 s29, s29, s33
    s_add_u32 s29, s29, 8192
    s_cmp_lt_u32 s28, 16
    s_cselect_b32 s28, s30, s29
    s_mov_b32 s29, 163840
    s_cselect_b32 s29, 8192, s29
    v_mul_lo_u32 v28, v25, s29
    v_add_u32 v28, s28, v28
    v_lshrrev_b32 v29, 2, v16
    v_cmp_eq_u32 vcc, 1, v29
    s_nop 1
    v_cndmask_b32 v4, v4, v28, vcc
    s_mul_i32 s28, s25, 3
    s_add_u32 s28, s28, 2
    s_sub_u32 s29, s28, 16
    s_lshl_b32 s30, s28, 14
    s_lshl_b32 s33, s27, 7
    s_add_u32 s30, s30, s33
    s_add_u32 s30, s30, 2097152
    s_mul_i32 s29, s29, 327680
    s_add_u32 s29, s29, s31
    s_lshl_b32 s33, s32, 7
    s_add_u32 s29, s29, s33
    s_add_u32 s29, s29, 8192
    s_cmp_lt_u32 s28, 16
    s_cselect_b32 s28, s30, s29
    s_mov_b32 s29, 163840
    s_cselect_b32 s29, 8192, s29
    v_mul_lo_u32 v28, v25, s29
    v_add_u32 v28, s28, v28
    v_lshrrev_b32 v29, 2, v16
    v_cmp_eq_u32 vcc, 2, v29
    s_nop 1
    v_cndmask_b32 v4, v4, v28, vcc
    v_lshlrev_b32 v28, 4, v17
    v_add_u32 v4, v4, v28
    v_lshrrev_b32 v29, 2, v16
    v_mov_b32 v5, s63
    v_cmp_eq_u32 vcc, 1, v29
    v_mov_b32 v28, s64
    s_nop 0
    v_cndmask_b32 v5, v5, v28, vcc
    v_cmp_eq_u32 vcc, 2, v29
    v_mov_b32 v28, s65
    s_nop 0
    v_cndmask_b32 v5, v5, v28, vcc
    s_mov_b32 s54, 0x555
    s_mov_b32 s55, 0x555
parallel_sum__softmax_full_mha__dense_activation_relu__prompt_kernel_vsE:
    s_mul_i32 s44, s27, 294912
    s_mul_i32 s32, s25, 18432
    s_add_u32 s44, s44, s32
    s_add_u32 s44, s44, 9961472
    s_and_b32 s32, s25, 1
    s_cmp_eq_u32 s32, 0
    s_cselect_b32 s33, 16384, 0
    s_add_u32 s42, s44, s33
    s_lshl_b32 s32, s32, 11
    s_add_u32 s43, s44, s32
    s_and_b32 s32, s26, 3
    s_mul_i32 s32, s32, 36864
    s_add_u32 s32, s32, 16384
    v_mul_u32_u24 v23, 1152, v16
    v_add_u32 v23, s32, v23
    v_lshrrev_b32 v24, 1, v16
    v_and_b32 v24, 7, v24
    v_lshlrev_b32 v25, 0, v17
    v_add_u32 v25, 0, v25
    v_xor_b32 v25, v25, v24
    v_lshlrev_b32 v25, 4, v25
    v_add_u32 v28, v23, v25
    v_lshlrev_b32 v25, 0, v17
    v_add_u32 v25, 2, v25
    v_xor_b32 v25, v25, v24
    v_lshlrev_b32 v25, 4, v25
    v_add_u32 v29, v23, v25
    v_lshlrev_b32 v25, 0, v17
    v_add_u32 v25, 4, v25
    v_xor_b32 v25, v25, v24
    v_lshlrev_b32 v25, 4, v25
    v_add_u32 v30, v23, v25
    v_lshlrev_b32 v25, 0, v17
    v_add_u32 v25, 6, v25
    v_xor_b32 v25, v25, v24
    v_lshlrev_b32 v25, 4, v25
    v_add_u32 v31, v23, v25
    s_barrier
    s_lshl_b32 s28, s2, 2
    s_and_b32 s29, s26, 3
    s_add_u32 s28, s28, s29
    v_lshlrev_b32 v16, 7, v0
    s_mul_i32 s30, s28, 5248
    s_mov_b32 exec_hi, 0x1ff
    buffer_load_dword v14, v16, s[20:23], s30 offen
    s_mov_b64 exec, -1
    s_mov_b32 s56, 0x3f803f80
    s_mov_b32 s57, 0xffff0000
    v_mov_b32 v32, 0
    v_mov_b32 v33, 0
    v_mov_b32 v34, 0
    v_mov_b32 v35, 0
    v_mov_b32 v36, 0
    v_mov_b32 v37, 0
    v_mov_b32 v38, 0
    v_mov_b32 v39, 0
    ds_read_b128 v[112:115], v28 offset:0
    ds_read_b128 v[116:119], v29 offset:0
    ds_read_b128 v[120:123], v30 offset:0
    ds_read_b128 v[124:127], v31 offset:0
    ds_read_b128 v[128:131], v28 offset:128
    ds_read_b128 v[132:135], v29 offset:128
    ds_read_b128 v[136:139], v30 offset:128
    ds_read_b128 v[140:143], v31 offset:128
    ds_read_b128 v[144:147], v28 offset:256
    ds_read_b128 v[148:151], v29 offset:256
    ds_read_b128 v[152:155], v30 offset:256
    ds_read_b128 v[156:159], v31 offset:256
    ds_read_b128 v[160:163], v28 offset:384
    s_waitcnt lgkmcnt(12)
    v_dot2_f32_bf16 v32, v112, s56, v32
    v_dot2_f32_bf16 v36, v112, v112, v36
    ds_read_b128 v[164:167], v29 offset:384
    s_waitcnt lgkmcnt(12)
    v_dot2_f32_bf16 v33, v113, s56, v33
    v_dot2_f32_bf16 v37, v113, v113, v37
    ds_read_b128 v[168:171], v30 offset:384
    s_waitcnt lgkmcnt(12)
    v_dot2_f32_bf16 v34, v114, s56, v34
    v_dot2_f32_bf16 v38, v114, v114, v38
    ds_read_b128 v[172:175], v31 offset:384
    s_waitcnt lgkmcnt(12)
    v_dot2_f32_bf16 v35, v115, s56, v35
    v_dot2_f32_bf16 v39, v115, v115, v39
    ds_read_b128 v[176:179], v28 offset:512
    s_waitcnt lgkmcnt(12)
    v_dot2_f32_bf16 v32, v116, s56, v32
    v_dot2_f32_bf16 v36, v116, v116, v36
    ds_read_b128 v[180:183], v29 offset:512
    s_waitcnt lgkmcnt(12)
    v_dot2_f32_bf16 v33, v117, s56, v33
    v_dot2_f32_bf16 v37, v117, v117, v37
    ds_read_b128 v[184:187], v30 offset:512
    s_waitcnt lgkmcnt(12)
    v_dot2_f32_bf16 v34, v118, s56, v34
    v_dot2_f32_bf16 v38, v118, v118, v38
    ds_read_b128 v[188:191], v31 offset:512
    s_waitcnt lgkmcnt(12)
    v_dot2_f32_bf16 v35, v119, s56, v35
    v_dot2_f32_bf16 v39, v119, v119, v39
    ds_read_b128 v[192:195], v28 offset:640
    s_waitcnt lgkmcnt(12)
    v_dot2_f32_bf16 v32, v120, s56, v32
    v_dot2_f32_bf16 v36, v120, v120, v36
    ds_read_b128 v[196:199], v29 offset:640
    s_waitcnt lgkmcnt(12)
    v_dot2_f32_bf16 v33, v121, s56, v33
    v_dot2_f32_bf16 v37, v121, v121, v37
    ds_read_b128 v[200:203], v30 offset:640
    s_waitcnt lgkmcnt(12)
    v_dot2_f32_bf16 v34, v122, s56, v34
    v_dot2_f32_bf16 v38, v122, v122, v38
    ds_read_b128 v[204:207], v31 offset:640
    s_waitcnt lgkmcnt(12)
    v_dot2_f32_bf16 v35, v123, s56, v35
    v_dot2_f32_bf16 v39, v123, v123, v39
    ds_read_b128 v[208:211], v28 offset:768
    s_waitcnt lgkmcnt(12)
    v_dot2_f32_bf16 v32, v124, s56, v32
    v_dot2_f32_bf16 v36, v124, v124, v36
    ds_read_b128 v[212:215], v29 offset:768
    s_waitcnt lgkmcnt(12)
    v_dot2_f32_bf16 v33, v125, s56, v33
    v_dot2_f32_bf16 v37, v125, v125, v37
    ds_read_b128 v[216:219], v30 offset:768
    s_waitcnt lgkmcnt(12)
    v_dot2_f32_bf16 v34, v126, s56, v34
    v_dot2_f32_bf16 v38, v126, v126, v38
    ds_read_b128 v[220:223], v31 offset:768
    s_waitcnt lgkmcnt(12)
    v_dot2_f32_bf16 v35, v127, s56, v35
    v_dot2_f32_bf16 v39, v127, v127, v39
    ds_read_b128 v[224:227], v28 offset:896
    s_waitcnt lgkmcnt(12)
    v_dot2_f32_bf16 v32, v128, s56, v32
    v_dot2_f32_bf16 v36, v128, v128, v36
    ds_read_b128 v[228:231], v29 offset:896
    s_waitcnt lgkmcnt(12)
    v_dot2_f32_bf16 v33, v129, s56, v33
    v_dot2_f32_bf16 v37, v129, v129, v37
    ds_read_b128 v[232:235], v30 offset:896
    s_waitcnt lgkmcnt(12)
    v_dot2_f32_bf16 v34, v130, s56, v34
    v_dot2_f32_bf16 v38, v130, v130, v38
    ds_read_b128 v[236:239], v31 offset:896
    s_waitcnt lgkmcnt(12)
    v_dot2_f32_bf16 v35, v131, s56, v35
    v_dot2_f32_bf16 v39, v131, v131, v39
    ds_read_b128 v[240:243], v28 offset:1024
    s_waitcnt lgkmcnt(12)
    v_dot2_f32_bf16 v32, v132, s56, v32
    v_dot2_f32_bf16 v36, v132, v132, v36
    ds_read_b128 v[244:247], v29 offset:1024
    s_waitcnt lgkmcnt(12)
    v_dot2_f32_bf16 v33, v133, s56, v33
    v_dot2_f32_bf16 v37, v133, v133, v37
    ds_read_b128 v[248:251], v30 offset:1024
    s_waitcnt lgkmcnt(12)
    v_dot2_f32_bf16 v34, v134, s56, v34
    v_dot2_f32_bf16 v38, v134, v134, v38
    ds_read_b128 v[252:255], v31 offset:1024
    s_waitcnt lgkmcnt(12)
    v_dot2_f32_bf16 v35, v135, s56, v35
    v_dot2_f32_bf16 v39, v135, v135, v39
    s_waitcnt lgkmcnt(0)
    s_barrier
    v_dot2_f32_bf16 v32, v136, s56, v32
    v_dot2_f32_bf16 v36, v136, v136, v36
    v_dot2_f32_bf16 v33, v137, s56, v33
    v_dot2_f32_bf16 v37, v137, v137, v37
    v_dot2_f32_bf16 v34, v138, s56, v34
    v_dot2_f32_bf16 v38, v138, v138, v38
    v_dot2_f32_bf16 v35, v139, s56, v35
    v_dot2_f32_bf16 v39, v139, v139, v39
    v_dot2_f32_bf16 v32, v140, s56, v32
    v_dot2_f32_bf16 v36, v140, v140, v36
    v_dot2_f32_bf16 v33, v141, s56, v33
    v_dot2_f32_bf16 v37, v141, v141, v37
    v_dot2_f32_bf16 v34, v142, s56, v34
    v_dot2_f32_bf16 v38, v142, v142, v38
    v_dot2_f32_bf16 v35, v143, s56, v35
    v_dot2_f32_bf16 v39, v143, v143, v39
    v_dot2_f32_bf16 v32, v144, s56, v32
    v_dot2_f32_bf16 v36, v144, v144, v36
    v_dot2_f32_bf16 v33, v145, s56, v33
    v_dot2_f32_bf16 v37, v145, v145, v37
    v_dot2_f32_bf16 v34, v146, s56, v34
    v_dot2_f32_bf16 v38, v146, v146, v38
    v_dot2_f32_bf16 v35, v147, s56, v35
    v_dot2_f32_bf16 v39, v147, v147, v39
    v_dot2_f32_bf16 v32, v148, s56, v32
    v_dot2_f32_bf16 v36, v148, v148, v36
    v_dot2_f32_bf16 v33, v149, s56, v33
    v_dot2_f32_bf16 v37, v149, v149, v37
    v_dot2_f32_bf16 v34, v150, s56, v34
    v_dot2_f32_bf16 v38, v150, v150, v38
    v_dot2_f32_bf16 v35, v151, s56, v35
    v_dot2_f32_bf16 v39, v151, v151, v39
    v_dot2_f32_bf16 v32, v152, s56, v32
    v_dot2_f32_bf16 v36, v152, v152, v36
    v_dot2_f32_bf16 v33, v153, s56, v33
    v_dot2_f32_bf16 v37, v153, v153, v37
    v_dot2_f32_bf16 v34, v154, s56, v34
    v_dot2_f32_bf16 v38, v154, v154, v38
    v_dot2_f32_bf16 v35, v155, s56, v35
    v_dot2_f32_bf16 v39, v155, v155, v39
    v_dot2_f32_bf16 v32, v156, s56, v32
    v_dot2_f32_bf16 v36, v156, v156, v36
    v_dot2_f32_bf16 v33, v157, s56, v33
    v_dot2_f32_bf16 v37, v157, v157, v37
    v_dot2_f32_bf16 v34, v158, s56, v34
    v_dot2_f32_bf16 v38, v158, v158, v38
    v_dot2_f32_bf16 v35, v159, s56, v35
    v_dot2_f32_bf16 v39, v159, v159, v39
    v_dot2_f32_bf16 v32, v160, s56, v32
    v_dot2_f32_bf16 v36, v160, v160, v36
    v_dot2_f32_bf16 v33, v161, s56, v33
    v_dot2_f32_bf16 v37, v161, v161, v37
    v_dot2_f32_bf16 v34, v162, s56, v34
    v_dot2_f32_bf16 v38, v162, v162, v38
    v_dot2_f32_bf16 v35, v163, s56, v35
    v_dot2_f32_bf16 v39, v163, v163, v39
    v_dot2_f32_bf16 v32, v164, s56, v32
    v_dot2_f32_bf16 v36, v164, v164, v36
    v_dot2_f32_bf16 v33, v165, s56, v33
    v_dot2_f32_bf16 v37, v165, v165, v37
    v_dot2_f32_bf16 v34, v166, s56, v34
    v_dot2_f32_bf16 v38, v166, v166, v38
    v_dot2_f32_bf16 v35, v167, s56, v35
    v_dot2_f32_bf16 v39, v167, v167, v39
    v_dot2_f32_bf16 v32, v168, s56, v32
    v_dot2_f32_bf16 v36, v168, v168, v36
    v_dot2_f32_bf16 v33, v169, s56, v33
    v_dot2_f32_bf16 v37, v169, v169, v37
    v_dot2_f32_bf16 v34, v170, s56, v34
    v_dot2_f32_bf16 v38, v170, v170, v38
    v_dot2_f32_bf16 v35, v171, s56, v35
    v_dot2_f32_bf16 v39, v171, v171, v39
    v_dot2_f32_bf16 v32, v172, s56, v32
    v_dot2_f32_bf16 v36, v172, v172, v36
    v_dot2_f32_bf16 v33, v173, s56, v33
    v_dot2_f32_bf16 v37, v173, v173, v37
    v_dot2_f32_bf16 v34, v174, s56, v34
    v_dot2_f32_bf16 v38, v174, v174, v38
    v_dot2_f32_bf16 v35, v175, s56, v35
    v_dot2_f32_bf16 v39, v175, v175, v39
    v_dot2_f32_bf16 v32, v176, s56, v32
    v_dot2_f32_bf16 v36, v176, v176, v36
    v_dot2_f32_bf16 v33, v177, s56, v33
    v_dot2_f32_bf16 v37, v177, v177, v37
    v_dot2_f32_bf16 v34, v178, s56, v34
    v_dot2_f32_bf16 v38, v178, v178, v38
    v_dot2_f32_bf16 v35, v179, s56, v35
    v_dot2_f32_bf16 v39, v179, v179, v39
    v_dot2_f32_bf16 v32, v180, s56, v32
    v_dot2_f32_bf16 v36, v180, v180, v36
    v_dot2_f32_bf16 v33, v181, s56, v33
    v_dot2_f32_bf16 v37, v181, v181, v37
    v_dot2_f32_bf16 v34, v182, s56, v34
    v_dot2_f32_bf16 v38, v182, v182, v38
    v_dot2_f32_bf16 v35, v183, s56, v35
    v_dot2_f32_bf16 v39, v183, v183, v39
    v_dot2_f32_bf16 v32, v184, s56, v32
    v_dot2_f32_bf16 v36, v184, v184, v36
    v_dot2_f32_bf16 v33, v185, s56, v33
    v_dot2_f32_bf16 v37, v185, v185, v37
    v_dot2_f32_bf16 v34, v186, s56, v34
    v_dot2_f32_bf16 v38, v186, v186, v38
    v_dot2_f32_bf16 v35, v187, s56, v35
    v_dot2_f32_bf16 v39, v187, v187, v39
    v_dot2_f32_bf16 v32, v188, s56, v32
    v_dot2_f32_bf16 v36, v188, v188, v36
    v_dot2_f32_bf16 v33, v189, s56, v33
    v_dot2_f32_bf16 v37, v189, v189, v37
    v_dot2_f32_bf16 v34, v190, s56, v34
    v_dot2_f32_bf16 v38, v190, v190, v38
    v_dot2_f32_bf16 v35, v191, s56, v35
    v_dot2_f32_bf16 v39, v191, v191, v39
    v_dot2_f32_bf16 v32, v192, s56, v32
    v_dot2_f32_bf16 v36, v192, v192, v36
    v_dot2_f32_bf16 v33, v193, s56, v33
    v_dot2_f32_bf16 v37, v193, v193, v37
    v_dot2_f32_bf16 v34, v194, s56, v34
    v_dot2_f32_bf16 v38, v194, v194, v38
    v_dot2_f32_bf16 v35, v195, s56, v35
    v_dot2_f32_bf16 v39, v195, v195, v39
    v_dot2_f32_bf16 v32, v196, s56, v32
    v_dot2_f32_bf16 v36, v196, v196, v36
    v_dot2_f32_bf16 v33, v197, s56, v33
    v_dot2_f32_bf16 v37, v197, v197, v37
    v_dot2_f32_bf16 v34, v198, s56, v34
    v_dot2_f32_bf16 v38, v198, v198, v38
    v_dot2_f32_bf16 v35, v199, s56, v35
    v_dot2_f32_bf16 v39, v199, v199, v39
    v_dot2_f32_bf16 v32, v200, s56, v32
    v_dot2_f32_bf16 v36, v200, v200, v36
    v_dot2_f32_bf16 v33, v201, s56, v33
    v_dot2_f32_bf16 v37, v201, v201, v37
    v_dot2_f32_bf16 v34, v202, s56, v34
    v_dot2_f32_bf16 v38, v202, v202, v38
    v_dot2_f32_bf16 v35, v203, s56, v35
    v_dot2_f32_bf16 v39, v203, v203, v39
    v_dot2_f32_bf16 v32, v204, s56, v32
    v_dot2_f32_bf16 v36, v204, v204, v36
    v_dot2_f32_bf16 v33, v205, s56, v33
    v_dot2_f32_bf16 v37, v205, v205, v37
    v_dot2_f32_bf16 v34, v206, s56, v34
    v_dot2_f32_bf16 v38, v206, v206, v38
    v_dot2_f32_bf16 v35, v207, s56, v35
    v_dot2_f32_bf16 v39, v207, v207, v39
    v_dot2_f32_bf16 v32, v208, s56, v32
    v_dot2_f32_bf16 v36, v208, v208, v36
    v_dot2_f32_bf16 v33, v209, s56, v33
    v_dot2_f32_bf16 v37, v209, v209, v37
    v_dot2_f32_bf16 v34, v210, s56, v34
    v_dot2_f32_bf16 v38, v210, v210, v38
    v_dot2_f32_bf16 v35, v211, s56, v35
    v_dot2_f32_bf16 v39, v211, v211, v39
    v_dot2_f32_bf16 v32, v212, s56, v32
    v_dot2_f32_bf16 v36, v212, v212, v36
    v_dot2_f32_bf16 v33, v213, s56, v33
    v_dot2_f32_bf16 v37, v213, v213, v37
    v_dot2_f32_bf16 v34, v214, s56, v34
    v_dot2_f32_bf16 v38, v214, v214, v38
    v_dot2_f32_bf16 v35, v215, s56, v35
    v_dot2_f32_bf16 v39, v215, v215, v39
    v_dot2_f32_bf16 v32, v216, s56, v32
    v_dot2_f32_bf16 v36, v216, v216, v36
    v_dot2_f32_bf16 v33, v217, s56, v33
    v_dot2_f32_bf16 v37, v217, v217, v37
    v_dot2_f32_bf16 v34, v218, s56, v34
    v_dot2_f32_bf16 v38, v218, v218, v38
    v_dot2_f32_bf16 v35, v219, s56, v35
    v_dot2_f32_bf16 v39, v219, v219, v39
    v_dot2_f32_bf16 v32, v220, s56, v32
    v_dot2_f32_bf16 v36, v220, v220, v36
    v_dot2_f32_bf16 v33, v221, s56, v33
    v_dot2_f32_bf16 v37, v221, v221, v37
    v_dot2_f32_bf16 v34, v222, s56, v34
    v_dot2_f32_bf16 v38, v222, v222, v38
    v_dot2_f32_bf16 v35, v223, s56, v35
    v_dot2_f32_bf16 v39, v223, v223, v39
    v_dot2_f32_bf16 v32, v224, s56, v32
    v_dot2_f32_bf16 v36, v224, v224, v36
    v_dot2_f32_bf16 v33, v225, s56, v33
    v_dot2_f32_bf16 v37, v225, v225, v37
    v_dot2_f32_bf16 v34, v226, s56, v34
    v_dot2_f32_bf16 v38, v226, v226, v38
    v_dot2_f32_bf16 v35, v227, s56, v35
    v_dot2_f32_bf16 v39, v227, v227, v39
    v_dot2_f32_bf16 v32, v228, s56, v32
    v_dot2_f32_bf16 v36, v228, v228, v36
    v_dot2_f32_bf16 v33, v229, s56, v33
    v_dot2_f32_bf16 v37, v229, v229, v37
    v_dot2_f32_bf16 v34, v230, s56, v34
    v_dot2_f32_bf16 v38, v230, v230, v38
    v_dot2_f32_bf16 v35, v231, s56, v35
    v_dot2_f32_bf16 v39, v231, v231, v39
    v_dot2_f32_bf16 v32, v232, s56, v32
    v_dot2_f32_bf16 v36, v232, v232, v36
    v_dot2_f32_bf16 v33, v233, s56, v33
    v_dot2_f32_bf16 v37, v233, v233, v37
    v_dot2_f32_bf16 v34, v234, s56, v34
    v_dot2_f32_bf16 v38, v234, v234, v38
    v_dot2_f32_bf16 v35, v235, s56, v35
    v_dot2_f32_bf16 v39, v235, v235, v39
    v_dot2_f32_bf16 v32, v236, s56, v32
    v_dot2_f32_bf16 v36, v236, v236, v36
    v_dot2_f32_bf16 v33, v237, s56, v33
    v_dot2_f32_bf16 v37, v237, v237, v37
    v_dot2_f32_bf16 v34, v238, s56, v34
    v_dot2_f32_bf16 v38, v238, v238, v38
    v_dot2_f32_bf16 v35, v239, s56, v35
    v_dot2_f32_bf16 v39, v239, v239, v39
    v_dot2_f32_bf16 v32, v240, s56, v32
    v_dot2_f32_bf16 v36, v240, v240, v36
    v_dot2_f32_bf16 v33, v241, s56, v33
    v_dot2_f32_bf16 v37, v241, v241, v37
    v_dot2_f32_bf16 v34, v242, s56, v34
    v_dot2_f32_bf16 v38, v242, v242, v38
    v_dot2_f32_bf16 v35, v243, s56, v35
    v_dot2_f32_bf16 v39, v243, v243, v39
    v_dot2_f32_bf16 v32, v244, s56, v32
    v_dot2_f32_bf16 v36, v244, v244, v36
    v_dot2_f32_bf16 v33, v245, s56, v33
    v_dot2_f32_bf16 v37, v245, v245, v37
    v_dot2_f32_bf16 v34, v246, s56, v34
    v_dot2_f32_bf16 v38, v246, v246, v38
    v_dot2_f32_bf16 v35, v247, s56, v35
    v_dot2_f32_bf16 v39, v247, v247, v39
    v_dot2_f32_bf16 v32, v248, s56, v32
    v_dot2_f32_bf16 v36, v248, v248, v36
    v_dot2_f32_bf16 v33, v249, s56, v33
    v_dot2_f32_bf16 v37, v249, v249, v37
    v_dot2_f32_bf16 v34, v250, s56, v34
    v_dot2_f32_bf16 v38, v250, v250, v38
    v_dot2_f32_bf16 v35, v251, s56, v35
    v_dot2_f32_bf16 v39, v251, v251, v39
    v_dot2_f32_bf16 v32, v252, s56, v32
    v_dot2_f32_bf16 v36, v252, v252, v36
    v_dot2_f32_bf16 v33, v253, s56, v33
    v_dot2_f32_bf16 v37, v253, v253, v37
    v_dot2_f32_bf16 v34, v254, s56, v34
    v_dot2_f32_bf16 v38, v254, v254, v38
    v_dot2_f32_bf16 v35, v255, s56, v35
    v_dot2_f32_bf16 v39, v255, v255, v39
    s_nop 2
    v_add_f32 v32, v32, v33
    v_add_f32 v34, v34, v35
    v_add_f32 v36, v36, v37
    v_add_f32 v38, v38, v39
    v_add_f32 v32, v32, v34
    v_add_f32 v36, v36, v38
    v_mov_b32 v33, v32
    v_mov_b32 v37, v36
    s_nop 1
    v_permlane32_swap_b32 v32, v33
    v_permlane32_swap_b32 v36, v37
    s_nop 1
    v_add_f32 v32, v32, v33
    v_add_f32 v36, v36, v37
    v_mul_f32 v32, 0x3ae38e39, v32
    v_mul_f32 v36, 0x3ae38e39, v36
    v_fma_f32 v36, -v32, v32, v36
    v_max_f32 v36, 0, v36
    v_add_f32 v36, 0x3727c5ac, v36
    v_rsq_f32 v36, v36
    s_nop 0
    v_mul_f32 v38, v32, v36
    v_sub_f32 v38, 0, v38
    v_lshlrev_b32 v40, 16, v112
    v_and_b32 v41, s57, v112
    v_pk_fma_f32 v[40:41], v[40:41], v[36:37], v[38:39] op_sel_hi:[1,0,0]
    v_cvt_pk_bf16_f32 v112, v40, v41
    v_lshlrev_b32 v42, 16, v113
    v_and_b32 v43, s57, v113
    v_pk_fma_f32 v[42:43], v[42:43], v[36:37], v[38:39] op_sel_hi:[1,0,0]
    v_cvt_pk_bf16_f32 v113, v42, v43
    v_lshlrev_b32 v44, 16, v114
    v_and_b32 v45, s57, v114
    v_pk_fma_f32 v[44:45], v[44:45], v[36:37], v[38:39] op_sel_hi:[1,0,0]
    v_cvt_pk_bf16_f32 v114, v44, v45
    v_lshlrev_b32 v46, 16, v115
    v_and_b32 v47, s57, v115
    v_pk_fma_f32 v[46:47], v[46:47], v[36:37], v[38:39] op_sel_hi:[1,0,0]
    v_cvt_pk_bf16_f32 v115, v46, v47
    v_lshlrev_b32 v40, 16, v116
    v_and_b32 v41, s57, v116
    v_pk_fma_f32 v[40:41], v[40:41], v[36:37], v[38:39] op_sel_hi:[1,0,0]
    v_cvt_pk_bf16_f32 v116, v40, v41
    v_lshlrev_b32 v42, 16, v117
    v_and_b32 v43, s57, v117
    v_pk_fma_f32 v[42:43], v[42:43], v[36:37], v[38:39] op_sel_hi:[1,0,0]
    v_cvt_pk_bf16_f32 v117, v42, v43
    v_lshlrev_b32 v44, 16, v118
    v_and_b32 v45, s57, v118
    v_pk_fma_f32 v[44:45], v[44:45], v[36:37], v[38:39] op_sel_hi:[1,0,0]
    v_cvt_pk_bf16_f32 v118, v44, v45
    v_lshlrev_b32 v46, 16, v119
    v_and_b32 v47, s57, v119
    v_pk_fma_f32 v[46:47], v[46:47], v[36:37], v[38:39] op_sel_hi:[1,0,0]
    v_cvt_pk_bf16_f32 v119, v46, v47
    v_lshlrev_b32 v40, 16, v120
    v_and_b32 v41, s57, v120
    v_pk_fma_f32 v[40:41], v[40:41], v[36:37], v[38:39] op_sel_hi:[1,0,0]
    v_cvt_pk_bf16_f32 v120, v40, v41
    v_lshlrev_b32 v42, 16, v121
    v_and_b32 v43, s57, v121
    v_pk_fma_f32 v[42:43], v[42:43], v[36:37], v[38:39] op_sel_hi:[1,0,0]
    v_cvt_pk_bf16_f32 v121, v42, v43
    v_lshlrev_b32 v44, 16, v122
    v_and_b32 v45, s57, v122
    v_pk_fma_f32 v[44:45], v[44:45], v[36:37], v[38:39] op_sel_hi:[1,0,0]
    v_cvt_pk_bf16_f32 v122, v44, v45
    v_lshlrev_b32 v46, 16, v123
    v_and_b32 v47, s57, v123
    v_pk_fma_f32 v[46:47], v[46:47], v[36:37], v[38:39] op_sel_hi:[1,0,0]
    v_cvt_pk_bf16_f32 v123, v46, v47
    v_lshlrev_b32 v40, 16, v124
    v_and_b32 v41, s57, v124
    v_pk_fma_f32 v[40:41], v[40:41], v[36:37], v[38:39] op_sel_hi:[1,0,0]
    v_cvt_pk_bf16_f32 v124, v40, v41
    v_lshlrev_b32 v42, 16, v125
    v_and_b32 v43, s57, v125
    v_pk_fma_f32 v[42:43], v[42:43], v[36:37], v[38:39] op_sel_hi:[1,0,0]
    v_cvt_pk_bf16_f32 v125, v42, v43
    v_lshlrev_b32 v44, 16, v126
    v_and_b32 v45, s57, v126
    v_pk_fma_f32 v[44:45], v[44:45], v[36:37], v[38:39] op_sel_hi:[1,0,0]
    v_cvt_pk_bf16_f32 v126, v44, v45
    v_lshlrev_b32 v46, 16, v127
    v_and_b32 v47, s57, v127
    v_pk_fma_f32 v[46:47], v[46:47], v[36:37], v[38:39] op_sel_hi:[1,0,0]
    v_cvt_pk_bf16_f32 v127, v46, v47
    v_lshlrev_b32 v40, 16, v128
    v_and_b32 v41, s57, v128
    v_pk_fma_f32 v[40:41], v[40:41], v[36:37], v[38:39] op_sel_hi:[1,0,0]
    v_cvt_pk_bf16_f32 v128, v40, v41
    v_lshlrev_b32 v42, 16, v129
    v_and_b32 v43, s57, v129
    v_pk_fma_f32 v[42:43], v[42:43], v[36:37], v[38:39] op_sel_hi:[1,0,0]
    v_cvt_pk_bf16_f32 v129, v42, v43
    v_lshlrev_b32 v44, 16, v130
    v_and_b32 v45, s57, v130
    v_pk_fma_f32 v[44:45], v[44:45], v[36:37], v[38:39] op_sel_hi:[1,0,0]
    v_cvt_pk_bf16_f32 v130, v44, v45
    v_lshlrev_b32 v46, 16, v131
    v_and_b32 v47, s57, v131
    v_pk_fma_f32 v[46:47], v[46:47], v[36:37], v[38:39] op_sel_hi:[1,0,0]
    v_cvt_pk_bf16_f32 v131, v46, v47
    v_lshlrev_b32 v40, 16, v132
    v_and_b32 v41, s57, v132
    v_pk_fma_f32 v[40:41], v[40:41], v[36:37], v[38:39] op_sel_hi:[1,0,0]
    v_cvt_pk_bf16_f32 v132, v40, v41
    v_lshlrev_b32 v42, 16, v133
    v_and_b32 v43, s57, v133
    v_pk_fma_f32 v[42:43], v[42:43], v[36:37], v[38:39] op_sel_hi:[1,0,0]
    v_cvt_pk_bf16_f32 v133, v42, v43
    v_lshlrev_b32 v44, 16, v134
    v_and_b32 v45, s57, v134
    v_pk_fma_f32 v[44:45], v[44:45], v[36:37], v[38:39] op_sel_hi:[1,0,0]
    v_cvt_pk_bf16_f32 v134, v44, v45
    v_lshlrev_b32 v46, 16, v135
    v_and_b32 v47, s57, v135
    v_pk_fma_f32 v[46:47], v[46:47], v[36:37], v[38:39] op_sel_hi:[1,0,0]
    v_cvt_pk_bf16_f32 v135, v46, v47
    v_lshlrev_b32 v40, 16, v136
    v_and_b32 v41, s57, v136
    v_pk_fma_f32 v[40:41], v[40:41], v[36:37], v[38:39] op_sel_hi:[1,0,0]
    v_cvt_pk_bf16_f32 v136, v40, v41
    v_lshlrev_b32 v42, 16, v137
    v_and_b32 v43, s57, v137
    v_pk_fma_f32 v[42:43], v[42:43], v[36:37], v[38:39] op_sel_hi:[1,0,0]
    v_cvt_pk_bf16_f32 v137, v42, v43
    v_lshlrev_b32 v44, 16, v138
    v_and_b32 v45, s57, v138
    v_pk_fma_f32 v[44:45], v[44:45], v[36:37], v[38:39] op_sel_hi:[1,0,0]
    v_cvt_pk_bf16_f32 v138, v44, v45
    v_lshlrev_b32 v46, 16, v139
    v_and_b32 v47, s57, v139
    v_pk_fma_f32 v[46:47], v[46:47], v[36:37], v[38:39] op_sel_hi:[1,0,0]
    v_cvt_pk_bf16_f32 v139, v46, v47
    v_lshlrev_b32 v40, 16, v140
    v_and_b32 v41, s57, v140
    v_pk_fma_f32 v[40:41], v[40:41], v[36:37], v[38:39] op_sel_hi:[1,0,0]
    v_cvt_pk_bf16_f32 v140, v40, v41
    v_lshlrev_b32 v42, 16, v141
    v_and_b32 v43, s57, v141
    v_pk_fma_f32 v[42:43], v[42:43], v[36:37], v[38:39] op_sel_hi:[1,0,0]
    v_cvt_pk_bf16_f32 v141, v42, v43
    v_lshlrev_b32 v44, 16, v142
    v_and_b32 v45, s57, v142
    v_pk_fma_f32 v[44:45], v[44:45], v[36:37], v[38:39] op_sel_hi:[1,0,0]
    v_cvt_pk_bf16_f32 v142, v44, v45
    v_lshlrev_b32 v46, 16, v143
    v_and_b32 v47, s57, v143
    v_pk_fma_f32 v[46:47], v[46:47], v[36:37], v[38:39] op_sel_hi:[1,0,0]
    v_cvt_pk_bf16_f32 v143, v46, v47
    v_lshlrev_b32 v40, 16, v144
    v_and_b32 v41, s57, v144
    v_pk_fma_f32 v[40:41], v[40:41], v[36:37], v[38:39] op_sel_hi:[1,0,0]
    v_cvt_pk_bf16_f32 v144, v40, v41
    v_lshlrev_b32 v42, 16, v145
    v_and_b32 v43, s57, v145
    v_pk_fma_f32 v[42:43], v[42:43], v[36:37], v[38:39] op_sel_hi:[1,0,0]
    v_cvt_pk_bf16_f32 v145, v42, v43
    v_lshlrev_b32 v44, 16, v146
    v_and_b32 v45, s57, v146
    v_pk_fma_f32 v[44:45], v[44:45], v[36:37], v[38:39] op_sel_hi:[1,0,0]
    v_cvt_pk_bf16_f32 v146, v44, v45
    v_lshlrev_b32 v46, 16, v147
    v_and_b32 v47, s57, v147
    v_pk_fma_f32 v[46:47], v[46:47], v[36:37], v[38:39] op_sel_hi:[1,0,0]
    v_cvt_pk_bf16_f32 v147, v46, v47
    v_lshlrev_b32 v40, 16, v148
    v_and_b32 v41, s57, v148
    v_pk_fma_f32 v[40:41], v[40:41], v[36:37], v[38:39] op_sel_hi:[1,0,0]
    v_cvt_pk_bf16_f32 v148, v40, v41
    v_lshlrev_b32 v42, 16, v149
    v_and_b32 v43, s57, v149
    v_pk_fma_f32 v[42:43], v[42:43], v[36:37], v[38:39] op_sel_hi:[1,0,0]
    v_cvt_pk_bf16_f32 v149, v42, v43
    v_lshlrev_b32 v44, 16, v150
    v_and_b32 v45, s57, v150
    v_pk_fma_f32 v[44:45], v[44:45], v[36:37], v[38:39] op_sel_hi:[1,0,0]
    v_cvt_pk_bf16_f32 v150, v44, v45
    v_lshlrev_b32 v46, 16, v151
    v_and_b32 v47, s57, v151
    v_pk_fma_f32 v[46:47], v[46:47], v[36:37], v[38:39] op_sel_hi:[1,0,0]
    v_cvt_pk_bf16_f32 v151, v46, v47
    v_lshlrev_b32 v40, 16, v152
    v_and_b32 v41, s57, v152
    v_pk_fma_f32 v[40:41], v[40:41], v[36:37], v[38:39] op_sel_hi:[1,0,0]
    v_cvt_pk_bf16_f32 v152, v40, v41
    v_lshlrev_b32 v42, 16, v153
    v_and_b32 v43, s57, v153
    v_pk_fma_f32 v[42:43], v[42:43], v[36:37], v[38:39] op_sel_hi:[1,0,0]
    v_cvt_pk_bf16_f32 v153, v42, v43
    v_lshlrev_b32 v44, 16, v154
    v_and_b32 v45, s57, v154
    v_pk_fma_f32 v[44:45], v[44:45], v[36:37], v[38:39] op_sel_hi:[1,0,0]
    v_cvt_pk_bf16_f32 v154, v44, v45
    v_lshlrev_b32 v46, 16, v155
    v_and_b32 v47, s57, v155
    v_pk_fma_f32 v[46:47], v[46:47], v[36:37], v[38:39] op_sel_hi:[1,0,0]
    v_cvt_pk_bf16_f32 v155, v46, v47
    v_lshlrev_b32 v40, 16, v156
    v_and_b32 v41, s57, v156
    v_pk_fma_f32 v[40:41], v[40:41], v[36:37], v[38:39] op_sel_hi:[1,0,0]
    v_cvt_pk_bf16_f32 v156, v40, v41
    v_lshlrev_b32 v42, 16, v157
    v_and_b32 v43, s57, v157
    v_pk_fma_f32 v[42:43], v[42:43], v[36:37], v[38:39] op_sel_hi:[1,0,0]
    v_cvt_pk_bf16_f32 v157, v42, v43
    v_lshlrev_b32 v44, 16, v158
    v_and_b32 v45, s57, v158
    v_pk_fma_f32 v[44:45], v[44:45], v[36:37], v[38:39] op_sel_hi:[1,0,0]
    v_cvt_pk_bf16_f32 v158, v44, v45
    v_lshlrev_b32 v46, 16, v159
    v_and_b32 v47, s57, v159
    v_pk_fma_f32 v[46:47], v[46:47], v[36:37], v[38:39] op_sel_hi:[1,0,0]
    v_cvt_pk_bf16_f32 v159, v46, v47
    v_lshlrev_b32 v40, 16, v160
    v_and_b32 v41, s57, v160
    v_pk_fma_f32 v[40:41], v[40:41], v[36:37], v[38:39] op_sel_hi:[1,0,0]
    v_cvt_pk_bf16_f32 v160, v40, v41
    v_lshlrev_b32 v42, 16, v161
    v_and_b32 v43, s57, v161
    v_pk_fma_f32 v[42:43], v[42:43], v[36:37], v[38:39] op_sel_hi:[1,0,0]
    v_cvt_pk_bf16_f32 v161, v42, v43
    v_lshlrev_b32 v44, 16, v162
    v_and_b32 v45, s57, v162
    v_pk_fma_f32 v[44:45], v[44:45], v[36:37], v[38:39] op_sel_hi:[1,0,0]
    v_cvt_pk_bf16_f32 v162, v44, v45
    v_lshlrev_b32 v46, 16, v163
    v_and_b32 v47, s57, v163
    v_pk_fma_f32 v[46:47], v[46:47], v[36:37], v[38:39] op_sel_hi:[1,0,0]
    v_cvt_pk_bf16_f32 v163, v46, v47
    v_lshlrev_b32 v40, 16, v164
    v_and_b32 v41, s57, v164
    v_pk_fma_f32 v[40:41], v[40:41], v[36:37], v[38:39] op_sel_hi:[1,0,0]
    v_cvt_pk_bf16_f32 v164, v40, v41
    v_lshlrev_b32 v42, 16, v165
    v_and_b32 v43, s57, v165
    v_pk_fma_f32 v[42:43], v[42:43], v[36:37], v[38:39] op_sel_hi:[1,0,0]
    v_cvt_pk_bf16_f32 v165, v42, v43
    v_lshlrev_b32 v44, 16, v166
    v_and_b32 v45, s57, v166
    v_pk_fma_f32 v[44:45], v[44:45], v[36:37], v[38:39] op_sel_hi:[1,0,0]
    v_cvt_pk_bf16_f32 v166, v44, v45
    v_lshlrev_b32 v46, 16, v167
    v_and_b32 v47, s57, v167
    v_pk_fma_f32 v[46:47], v[46:47], v[36:37], v[38:39] op_sel_hi:[1,0,0]
    v_cvt_pk_bf16_f32 v167, v46, v47
    v_lshlrev_b32 v40, 16, v168
    v_and_b32 v41, s57, v168
    v_pk_fma_f32 v[40:41], v[40:41], v[36:37], v[38:39] op_sel_hi:[1,0,0]
    v_cvt_pk_bf16_f32 v168, v40, v41
    v_lshlrev_b32 v42, 16, v169
    v_and_b32 v43, s57, v169
    v_pk_fma_f32 v[42:43], v[42:43], v[36:37], v[38:39] op_sel_hi:[1,0,0]
    v_cvt_pk_bf16_f32 v169, v42, v43
    v_lshlrev_b32 v44, 16, v170
    v_and_b32 v45, s57, v170
    v_pk_fma_f32 v[44:45], v[44:45], v[36:37], v[38:39] op_sel_hi:[1,0,0]
    v_cvt_pk_bf16_f32 v170, v44, v45
    v_lshlrev_b32 v46, 16, v171
    v_and_b32 v47, s57, v171
    v_pk_fma_f32 v[46:47], v[46:47], v[36:37], v[38:39] op_sel_hi:[1,0,0]
    v_cvt_pk_bf16_f32 v171, v46, v47
    v_lshlrev_b32 v40, 16, v172
    v_and_b32 v41, s57, v172
    v_pk_fma_f32 v[40:41], v[40:41], v[36:37], v[38:39] op_sel_hi:[1,0,0]
    v_cvt_pk_bf16_f32 v172, v40, v41
    v_lshlrev_b32 v42, 16, v173
    v_and_b32 v43, s57, v173
    v_pk_fma_f32 v[42:43], v[42:43], v[36:37], v[38:39] op_sel_hi:[1,0,0]
    v_cvt_pk_bf16_f32 v173, v42, v43
    v_lshlrev_b32 v44, 16, v174
    v_and_b32 v45, s57, v174
    v_pk_fma_f32 v[44:45], v[44:45], v[36:37], v[38:39] op_sel_hi:[1,0,0]
    v_cvt_pk_bf16_f32 v174, v44, v45
    v_lshlrev_b32 v46, 16, v175
    v_and_b32 v47, s57, v175
    v_pk_fma_f32 v[46:47], v[46:47], v[36:37], v[38:39] op_sel_hi:[1,0,0]
    v_cvt_pk_bf16_f32 v175, v46, v47
    v_lshlrev_b32 v40, 16, v176
    v_and_b32 v41, s57, v176
    v_pk_fma_f32 v[40:41], v[40:41], v[36:37], v[38:39] op_sel_hi:[1,0,0]
    v_cvt_pk_bf16_f32 v176, v40, v41
    v_lshlrev_b32 v42, 16, v177
    v_and_b32 v43, s57, v177
    v_pk_fma_f32 v[42:43], v[42:43], v[36:37], v[38:39] op_sel_hi:[1,0,0]
    v_cvt_pk_bf16_f32 v177, v42, v43
    v_lshlrev_b32 v44, 16, v178
    v_and_b32 v45, s57, v178
    v_pk_fma_f32 v[44:45], v[44:45], v[36:37], v[38:39] op_sel_hi:[1,0,0]
    v_cvt_pk_bf16_f32 v178, v44, v45
    v_lshlrev_b32 v46, 16, v179
    v_and_b32 v47, s57, v179
    v_pk_fma_f32 v[46:47], v[46:47], v[36:37], v[38:39] op_sel_hi:[1,0,0]
    v_cvt_pk_bf16_f32 v179, v46, v47
    v_lshlrev_b32 v40, 16, v180
    v_and_b32 v41, s57, v180
    v_pk_fma_f32 v[40:41], v[40:41], v[36:37], v[38:39] op_sel_hi:[1,0,0]
    v_cvt_pk_bf16_f32 v180, v40, v41
    v_lshlrev_b32 v42, 16, v181
    v_and_b32 v43, s57, v181
    v_pk_fma_f32 v[42:43], v[42:43], v[36:37], v[38:39] op_sel_hi:[1,0,0]
    v_cvt_pk_bf16_f32 v181, v42, v43
    v_lshlrev_b32 v44, 16, v182
    v_and_b32 v45, s57, v182
    v_pk_fma_f32 v[44:45], v[44:45], v[36:37], v[38:39] op_sel_hi:[1,0,0]
    v_cvt_pk_bf16_f32 v182, v44, v45
    v_lshlrev_b32 v46, 16, v183
    v_and_b32 v47, s57, v183
    v_pk_fma_f32 v[46:47], v[46:47], v[36:37], v[38:39] op_sel_hi:[1,0,0]
    v_cvt_pk_bf16_f32 v183, v46, v47
    v_lshlrev_b32 v40, 16, v184
    v_and_b32 v41, s57, v184
    v_pk_fma_f32 v[40:41], v[40:41], v[36:37], v[38:39] op_sel_hi:[1,0,0]
    v_cvt_pk_bf16_f32 v184, v40, v41
    v_lshlrev_b32 v42, 16, v185
    v_and_b32 v43, s57, v185
    v_pk_fma_f32 v[42:43], v[42:43], v[36:37], v[38:39] op_sel_hi:[1,0,0]
    v_cvt_pk_bf16_f32 v185, v42, v43
    v_lshlrev_b32 v44, 16, v186
    v_and_b32 v45, s57, v186
    v_pk_fma_f32 v[44:45], v[44:45], v[36:37], v[38:39] op_sel_hi:[1,0,0]
    v_cvt_pk_bf16_f32 v186, v44, v45
    v_lshlrev_b32 v46, 16, v187
    v_and_b32 v47, s57, v187
    v_pk_fma_f32 v[46:47], v[46:47], v[36:37], v[38:39] op_sel_hi:[1,0,0]
    v_cvt_pk_bf16_f32 v187, v46, v47
    v_lshlrev_b32 v40, 16, v188
    v_and_b32 v41, s57, v188
    v_pk_fma_f32 v[40:41], v[40:41], v[36:37], v[38:39] op_sel_hi:[1,0,0]
    v_cvt_pk_bf16_f32 v188, v40, v41
    v_lshlrev_b32 v42, 16, v189
    v_and_b32 v43, s57, v189
    v_pk_fma_f32 v[42:43], v[42:43], v[36:37], v[38:39] op_sel_hi:[1,0,0]
    v_cvt_pk_bf16_f32 v189, v42, v43
    v_lshlrev_b32 v44, 16, v190
    v_and_b32 v45, s57, v190
    v_pk_fma_f32 v[44:45], v[44:45], v[36:37], v[38:39] op_sel_hi:[1,0,0]
    v_cvt_pk_bf16_f32 v190, v44, v45
    v_lshlrev_b32 v46, 16, v191
    v_and_b32 v47, s57, v191
    v_pk_fma_f32 v[46:47], v[46:47], v[36:37], v[38:39] op_sel_hi:[1,0,0]
    v_cvt_pk_bf16_f32 v191, v46, v47
    v_lshlrev_b32 v40, 16, v192
    v_and_b32 v41, s57, v192
    v_pk_fma_f32 v[40:41], v[40:41], v[36:37], v[38:39] op_sel_hi:[1,0,0]
    v_cvt_pk_bf16_f32 v192, v40, v41
    v_lshlrev_b32 v42, 16, v193
    v_and_b32 v43, s57, v193
    v_pk_fma_f32 v[42:43], v[42:43], v[36:37], v[38:39] op_sel_hi:[1,0,0]
    v_cvt_pk_bf16_f32 v193, v42, v43
    v_lshlrev_b32 v44, 16, v194
    v_and_b32 v45, s57, v194
    v_pk_fma_f32 v[44:45], v[44:45], v[36:37], v[38:39] op_sel_hi:[1,0,0]
    v_cvt_pk_bf16_f32 v194, v44, v45
    v_lshlrev_b32 v46, 16, v195
    v_and_b32 v47, s57, v195
    v_pk_fma_f32 v[46:47], v[46:47], v[36:37], v[38:39] op_sel_hi:[1,0,0]
    v_cvt_pk_bf16_f32 v195, v46, v47
    v_lshlrev_b32 v40, 16, v196
    v_and_b32 v41, s57, v196
    v_pk_fma_f32 v[40:41], v[40:41], v[36:37], v[38:39] op_sel_hi:[1,0,0]
    v_cvt_pk_bf16_f32 v196, v40, v41
    v_lshlrev_b32 v42, 16, v197
    v_and_b32 v43, s57, v197
    v_pk_fma_f32 v[42:43], v[42:43], v[36:37], v[38:39] op_sel_hi:[1,0,0]
    v_cvt_pk_bf16_f32 v197, v42, v43
    v_lshlrev_b32 v44, 16, v198
    v_and_b32 v45, s57, v198
    v_pk_fma_f32 v[44:45], v[44:45], v[36:37], v[38:39] op_sel_hi:[1,0,0]
    v_cvt_pk_bf16_f32 v198, v44, v45
    v_lshlrev_b32 v46, 16, v199
    v_and_b32 v47, s57, v199
    v_pk_fma_f32 v[46:47], v[46:47], v[36:37], v[38:39] op_sel_hi:[1,0,0]
    v_cvt_pk_bf16_f32 v199, v46, v47
    v_lshlrev_b32 v40, 16, v200
    v_and_b32 v41, s57, v200
    v_pk_fma_f32 v[40:41], v[40:41], v[36:37], v[38:39] op_sel_hi:[1,0,0]
    v_cvt_pk_bf16_f32 v200, v40, v41
    v_lshlrev_b32 v42, 16, v201
    v_and_b32 v43, s57, v201
    v_pk_fma_f32 v[42:43], v[42:43], v[36:37], v[38:39] op_sel_hi:[1,0,0]
    v_cvt_pk_bf16_f32 v201, v42, v43
    v_lshlrev_b32 v44, 16, v202
    v_and_b32 v45, s57, v202
    v_pk_fma_f32 v[44:45], v[44:45], v[36:37], v[38:39] op_sel_hi:[1,0,0]
    v_cvt_pk_bf16_f32 v202, v44, v45
    v_lshlrev_b32 v46, 16, v203
    v_and_b32 v47, s57, v203
    v_pk_fma_f32 v[46:47], v[46:47], v[36:37], v[38:39] op_sel_hi:[1,0,0]
    v_cvt_pk_bf16_f32 v203, v46, v47
    v_lshlrev_b32 v40, 16, v204
    v_and_b32 v41, s57, v204
    v_pk_fma_f32 v[40:41], v[40:41], v[36:37], v[38:39] op_sel_hi:[1,0,0]
    v_cvt_pk_bf16_f32 v204, v40, v41
    v_lshlrev_b32 v42, 16, v205
    v_and_b32 v43, s57, v205
    v_pk_fma_f32 v[42:43], v[42:43], v[36:37], v[38:39] op_sel_hi:[1,0,0]
    v_cvt_pk_bf16_f32 v205, v42, v43
    v_lshlrev_b32 v44, 16, v206
    v_and_b32 v45, s57, v206
    v_pk_fma_f32 v[44:45], v[44:45], v[36:37], v[38:39] op_sel_hi:[1,0,0]
    v_cvt_pk_bf16_f32 v206, v44, v45
    v_lshlrev_b32 v46, 16, v207
    v_and_b32 v47, s57, v207
    v_pk_fma_f32 v[46:47], v[46:47], v[36:37], v[38:39] op_sel_hi:[1,0,0]
    v_cvt_pk_bf16_f32 v207, v46, v47
    v_lshlrev_b32 v40, 16, v208
    v_and_b32 v41, s57, v208
    v_pk_fma_f32 v[40:41], v[40:41], v[36:37], v[38:39] op_sel_hi:[1,0,0]
    v_cvt_pk_bf16_f32 v208, v40, v41
    v_lshlrev_b32 v42, 16, v209
    v_and_b32 v43, s57, v209
    v_pk_fma_f32 v[42:43], v[42:43], v[36:37], v[38:39] op_sel_hi:[1,0,0]
    v_cvt_pk_bf16_f32 v209, v42, v43
    v_lshlrev_b32 v44, 16, v210
    v_and_b32 v45, s57, v210
    v_pk_fma_f32 v[44:45], v[44:45], v[36:37], v[38:39] op_sel_hi:[1,0,0]
    v_cvt_pk_bf16_f32 v210, v44, v45
    v_lshlrev_b32 v46, 16, v211
    v_and_b32 v47, s57, v211
    v_pk_fma_f32 v[46:47], v[46:47], v[36:37], v[38:39] op_sel_hi:[1,0,0]
    v_cvt_pk_bf16_f32 v211, v46, v47
    v_lshlrev_b32 v40, 16, v212
    v_and_b32 v41, s57, v212
    v_pk_fma_f32 v[40:41], v[40:41], v[36:37], v[38:39] op_sel_hi:[1,0,0]
    v_cvt_pk_bf16_f32 v212, v40, v41
    v_lshlrev_b32 v42, 16, v213
    v_and_b32 v43, s57, v213
    v_pk_fma_f32 v[42:43], v[42:43], v[36:37], v[38:39] op_sel_hi:[1,0,0]
    v_cvt_pk_bf16_f32 v213, v42, v43
    v_lshlrev_b32 v44, 16, v214
    v_and_b32 v45, s57, v214
    v_pk_fma_f32 v[44:45], v[44:45], v[36:37], v[38:39] op_sel_hi:[1,0,0]
    v_cvt_pk_bf16_f32 v214, v44, v45
    v_lshlrev_b32 v46, 16, v215
    v_and_b32 v47, s57, v215
    v_pk_fma_f32 v[46:47], v[46:47], v[36:37], v[38:39] op_sel_hi:[1,0,0]
    v_cvt_pk_bf16_f32 v215, v46, v47
    v_lshlrev_b32 v40, 16, v216
    v_and_b32 v41, s57, v216
    v_pk_fma_f32 v[40:41], v[40:41], v[36:37], v[38:39] op_sel_hi:[1,0,0]
    v_cvt_pk_bf16_f32 v216, v40, v41
    v_lshlrev_b32 v42, 16, v217
    v_and_b32 v43, s57, v217
    v_pk_fma_f32 v[42:43], v[42:43], v[36:37], v[38:39] op_sel_hi:[1,0,0]
    v_cvt_pk_bf16_f32 v217, v42, v43
    v_lshlrev_b32 v44, 16, v218
    v_and_b32 v45, s57, v218
    v_pk_fma_f32 v[44:45], v[44:45], v[36:37], v[38:39] op_sel_hi:[1,0,0]
    v_cvt_pk_bf16_f32 v218, v44, v45
    v_lshlrev_b32 v46, 16, v219
    v_and_b32 v47, s57, v219
    v_pk_fma_f32 v[46:47], v[46:47], v[36:37], v[38:39] op_sel_hi:[1,0,0]
    v_cvt_pk_bf16_f32 v219, v46, v47
    v_lshlrev_b32 v40, 16, v220
    v_and_b32 v41, s57, v220
    v_pk_fma_f32 v[40:41], v[40:41], v[36:37], v[38:39] op_sel_hi:[1,0,0]
    v_cvt_pk_bf16_f32 v220, v40, v41
    v_lshlrev_b32 v42, 16, v221
    v_and_b32 v43, s57, v221
    v_pk_fma_f32 v[42:43], v[42:43], v[36:37], v[38:39] op_sel_hi:[1,0,0]
    v_cvt_pk_bf16_f32 v221, v42, v43
    v_lshlrev_b32 v44, 16, v222
    v_and_b32 v45, s57, v222
    v_pk_fma_f32 v[44:45], v[44:45], v[36:37], v[38:39] op_sel_hi:[1,0,0]
    v_cvt_pk_bf16_f32 v222, v44, v45
    v_lshlrev_b32 v46, 16, v223
    v_and_b32 v47, s57, v223
    v_pk_fma_f32 v[46:47], v[46:47], v[36:37], v[38:39] op_sel_hi:[1,0,0]
    v_cvt_pk_bf16_f32 v223, v46, v47
    v_lshlrev_b32 v40, 16, v224
    v_and_b32 v41, s57, v224
    v_pk_fma_f32 v[40:41], v[40:41], v[36:37], v[38:39] op_sel_hi:[1,0,0]
    v_cvt_pk_bf16_f32 v224, v40, v41
    v_lshlrev_b32 v42, 16, v225
    v_and_b32 v43, s57, v225
    v_pk_fma_f32 v[42:43], v[42:43], v[36:37], v[38:39] op_sel_hi:[1,0,0]
    v_cvt_pk_bf16_f32 v225, v42, v43
    v_lshlrev_b32 v44, 16, v226
    v_and_b32 v45, s57, v226
    v_pk_fma_f32 v[44:45], v[44:45], v[36:37], v[38:39] op_sel_hi:[1,0,0]
    v_cvt_pk_bf16_f32 v226, v44, v45
    v_lshlrev_b32 v46, 16, v227
    v_and_b32 v47, s57, v227
    v_pk_fma_f32 v[46:47], v[46:47], v[36:37], v[38:39] op_sel_hi:[1,0,0]
    v_cvt_pk_bf16_f32 v227, v46, v47
    v_lshlrev_b32 v40, 16, v228
    v_and_b32 v41, s57, v228
    v_pk_fma_f32 v[40:41], v[40:41], v[36:37], v[38:39] op_sel_hi:[1,0,0]
    v_cvt_pk_bf16_f32 v228, v40, v41
    v_lshlrev_b32 v42, 16, v229
    v_and_b32 v43, s57, v229
    v_pk_fma_f32 v[42:43], v[42:43], v[36:37], v[38:39] op_sel_hi:[1,0,0]
    v_cvt_pk_bf16_f32 v229, v42, v43
    v_lshlrev_b32 v44, 16, v230
    v_and_b32 v45, s57, v230
    v_pk_fma_f32 v[44:45], v[44:45], v[36:37], v[38:39] op_sel_hi:[1,0,0]
    v_cvt_pk_bf16_f32 v230, v44, v45
    v_lshlrev_b32 v46, 16, v231
    v_and_b32 v47, s57, v231
    v_pk_fma_f32 v[46:47], v[46:47], v[36:37], v[38:39] op_sel_hi:[1,0,0]
    v_cvt_pk_bf16_f32 v231, v46, v47
    v_lshlrev_b32 v40, 16, v232
    v_and_b32 v41, s57, v232
    v_pk_fma_f32 v[40:41], v[40:41], v[36:37], v[38:39] op_sel_hi:[1,0,0]
    v_cvt_pk_bf16_f32 v232, v40, v41
    v_lshlrev_b32 v42, 16, v233
    v_and_b32 v43, s57, v233
    v_pk_fma_f32 v[42:43], v[42:43], v[36:37], v[38:39] op_sel_hi:[1,0,0]
    v_cvt_pk_bf16_f32 v233, v42, v43
    v_lshlrev_b32 v44, 16, v234
    v_and_b32 v45, s57, v234
    v_pk_fma_f32 v[44:45], v[44:45], v[36:37], v[38:39] op_sel_hi:[1,0,0]
    v_cvt_pk_bf16_f32 v234, v44, v45
    v_lshlrev_b32 v46, 16, v235
    v_and_b32 v47, s57, v235
    v_pk_fma_f32 v[46:47], v[46:47], v[36:37], v[38:39] op_sel_hi:[1,0,0]
    v_cvt_pk_bf16_f32 v235, v46, v47
    v_lshlrev_b32 v40, 16, v236
    v_and_b32 v41, s57, v236
    v_pk_fma_f32 v[40:41], v[40:41], v[36:37], v[38:39] op_sel_hi:[1,0,0]
    v_cvt_pk_bf16_f32 v236, v40, v41
    v_lshlrev_b32 v42, 16, v237
    v_and_b32 v43, s57, v237
    v_pk_fma_f32 v[42:43], v[42:43], v[36:37], v[38:39] op_sel_hi:[1,0,0]
    v_cvt_pk_bf16_f32 v237, v42, v43
    v_lshlrev_b32 v44, 16, v238
    v_and_b32 v45, s57, v238
    v_pk_fma_f32 v[44:45], v[44:45], v[36:37], v[38:39] op_sel_hi:[1,0,0]
    v_cvt_pk_bf16_f32 v238, v44, v45
    v_lshlrev_b32 v46, 16, v239
    v_and_b32 v47, s57, v239
    v_pk_fma_f32 v[46:47], v[46:47], v[36:37], v[38:39] op_sel_hi:[1,0,0]
    v_cvt_pk_bf16_f32 v239, v46, v47
    v_lshlrev_b32 v40, 16, v240
    v_and_b32 v41, s57, v240
    v_pk_fma_f32 v[40:41], v[40:41], v[36:37], v[38:39] op_sel_hi:[1,0,0]
    v_cvt_pk_bf16_f32 v240, v40, v41
    v_lshlrev_b32 v42, 16, v241
    v_and_b32 v43, s57, v241
    v_pk_fma_f32 v[42:43], v[42:43], v[36:37], v[38:39] op_sel_hi:[1,0,0]
    v_cvt_pk_bf16_f32 v241, v42, v43
    v_lshlrev_b32 v44, 16, v242
    v_and_b32 v45, s57, v242
    v_pk_fma_f32 v[44:45], v[44:45], v[36:37], v[38:39] op_sel_hi:[1,0,0]
    v_cvt_pk_bf16_f32 v242, v44, v45
    v_lshlrev_b32 v46, 16, v243
    v_and_b32 v47, s57, v243
    v_pk_fma_f32 v[46:47], v[46:47], v[36:37], v[38:39] op_sel_hi:[1,0,0]
    v_cvt_pk_bf16_f32 v243, v46, v47
    v_lshlrev_b32 v40, 16, v244
    v_and_b32 v41, s57, v244
    v_pk_fma_f32 v[40:41], v[40:41], v[36:37], v[38:39] op_sel_hi:[1,0,0]
    v_cvt_pk_bf16_f32 v244, v40, v41
    v_lshlrev_b32 v42, 16, v245
    v_and_b32 v43, s57, v245
    v_pk_fma_f32 v[42:43], v[42:43], v[36:37], v[38:39] op_sel_hi:[1,0,0]
    v_cvt_pk_bf16_f32 v245, v42, v43
    v_lshlrev_b32 v44, 16, v246
    v_and_b32 v45, s57, v246
    v_pk_fma_f32 v[44:45], v[44:45], v[36:37], v[38:39] op_sel_hi:[1,0,0]
    v_cvt_pk_bf16_f32 v246, v44, v45
    v_lshlrev_b32 v46, 16, v247
    v_and_b32 v47, s57, v247
    v_pk_fma_f32 v[46:47], v[46:47], v[36:37], v[38:39] op_sel_hi:[1,0,0]
    v_cvt_pk_bf16_f32 v247, v46, v47
    v_lshlrev_b32 v40, 16, v248
    v_and_b32 v41, s57, v248
    v_pk_fma_f32 v[40:41], v[40:41], v[36:37], v[38:39] op_sel_hi:[1,0,0]
    v_cvt_pk_bf16_f32 v248, v40, v41
    v_lshlrev_b32 v42, 16, v249
    v_and_b32 v43, s57, v249
    v_pk_fma_f32 v[42:43], v[42:43], v[36:37], v[38:39] op_sel_hi:[1,0,0]
    v_cvt_pk_bf16_f32 v249, v42, v43
    v_lshlrev_b32 v44, 16, v250
    v_and_b32 v45, s57, v250
    v_pk_fma_f32 v[44:45], v[44:45], v[36:37], v[38:39] op_sel_hi:[1,0,0]
    v_cvt_pk_bf16_f32 v250, v44, v45
    v_lshlrev_b32 v46, 16, v251
    v_and_b32 v47, s57, v251
    v_pk_fma_f32 v[46:47], v[46:47], v[36:37], v[38:39] op_sel_hi:[1,0,0]
    v_cvt_pk_bf16_f32 v251, v46, v47
    v_lshlrev_b32 v40, 16, v252
    v_and_b32 v41, s57, v252
    v_pk_fma_f32 v[40:41], v[40:41], v[36:37], v[38:39] op_sel_hi:[1,0,0]
    v_cvt_pk_bf16_f32 v252, v40, v41
    v_lshlrev_b32 v42, 16, v253
    v_and_b32 v43, s57, v253
    v_pk_fma_f32 v[42:43], v[42:43], v[36:37], v[38:39] op_sel_hi:[1,0,0]
    v_cvt_pk_bf16_f32 v253, v42, v43
    v_lshlrev_b32 v44, 16, v254
    v_and_b32 v45, s57, v254
    v_pk_fma_f32 v[44:45], v[44:45], v[36:37], v[38:39] op_sel_hi:[1,0,0]
    v_cvt_pk_bf16_f32 v254, v44, v45
    v_lshlrev_b32 v46, 16, v255
    v_and_b32 v47, s57, v255
    v_pk_fma_f32 v[46:47], v[46:47], v[36:37], v[38:39] op_sel_hi:[1,0,0]
    v_cvt_pk_bf16_f32 v255, v46, v47
    s_barrier
    v_add_u32 v7, 0x4000, v7
    ds_read_b64_tr_b16 v[96:97], v7 offset:0
    ds_read_b64_tr_b16 v[98:99], v7 offset:1024
    v_add_u32 v13, 0x4000, v13
    ds_read_b64_tr_b16 v[100:101], v13 offset:0
    ds_read_b64_tr_b16 v[102:103], v13 offset:1024
    v_add_u32 v9, 0x4000, v9
    ds_read_b64_tr_b16 v[104:105], v9 offset:0
    ds_read_b64_tr_b16 v[106:107], v9 offset:1024
    s_cmp_lt_u32 s25, 10
    s_cbranch_scc0 parallel_sum__softmax_full_mha__dense_activation_relu__prompt_kernel_qB
    s_waitcnt lgkmcnt(4)
    v_mfma_f32_32x32x16_bf16 v[16:31], v[96:99], v[112:115], 0
    v_add_u32 v8, 0x4000, v8
    ds_read_b64_tr_b16 v[108:109], v8 offset:0
    ds_read_b64_tr_b16 v[110:111], v8 offset:1024
    s_waitcnt lgkmcnt(4)
    v_mfma_f32_32x32x16_bf16 v[32:47], v[100:103], v[112:115], 0
    ds_read_b64_tr_b16 v[96:97], v7 offset:4096
    ds_read_b64_tr_b16 v[98:99], v7 offset:5120
    s_waitcnt lgkmcnt(4)
    v_mfma_f32_32x32x16_bf16 v[48:63], v[104:107], v[112:115], 0
    ds_read_b64_tr_b16 v[100:101], v13 offset:4096
    ds_read_b64_tr_b16 v[102:103], v13 offset:5120
    s_waitcnt lgkmcnt(4)
    v_mfma_f32_32x32x16_bf16 v[64:79], v[112:115], v[108:111], 0
    ds_read_b64_tr_b16 v[104:105], v9 offset:4096
    ds_read_b64_tr_b16 v[106:107], v9 offset:5120
    s_waitcnt lgkmcnt(4)
    v_mfma_f32_32x32x16_bf16 v[16:31], v[96:99], v[116:119], v[16:31]
    ds_read_b64_tr_b16 v[108:109], v8 offset:4096
    ds_read_b64_tr_b16 v[110:111], v8 offset:5120
    s_waitcnt lgkmcnt(4)
    v_mfma_f32_32x32x16_bf16 v[32:47], v[100:103], v[116:119], v[32:47]
    ds_read_b64_tr_b16 v[96:97], v7 offset:8192
    ds_read_b64_tr_b16 v[98:99], v7 offset:9216
    s_waitcnt lgkmcnt(4)
    v_mfma_f32_32x32x16_bf16 v[48:63], v[104:107], v[116:119], v[48:63]
    ds_read_b64_tr_b16 v[100:101], v13 offset:8192
    ds_read_b64_tr_b16 v[102:103], v13 offset:9216
    s_waitcnt lgkmcnt(4)
    v_mfma_f32_32x32x16_bf16 v[64:79], v[116:119], v[108:111], v[64:79]
    ds_read_b64_tr_b16 v[104:105], v9 offset:8192
    ds_read_b64_tr_b16 v[106:107], v9 offset:9216
    s_waitcnt lgkmcnt(4)
    v_mfma_f32_32x32x16_bf16 v[16:31], v[96:99], v[120:123], v[16:31]
    ds_read_b64_tr_b16 v[108:109], v8 offset:8192
    ds_read_b64_tr_b16 v[110:111], v8 offset:9216
    s_waitcnt lgkmcnt(4)
    v_mfma_f32_32x32x16_bf16 v[32:47], v[100:103], v[120:123], v[32:47]
    ds_read_b64_tr_b16 v[96:97], v7 offset:12288
    ds_read_b64_tr_b16 v[98:99], v7 offset:13312
    s_waitcnt lgkmcnt(4)
    v_mfma_f32_32x32x16_bf16 v[48:63], v[104:107], v[120:123], v[48:63]
    ds_read_b64_tr_b16 v[100:101], v13 offset:12288
    ds_read_b64_tr_b16 v[102:103], v13 offset:13312
    s_waitcnt lgkmcnt(4)
    v_mfma_f32_32x32x16_bf16 v[64:79], v[120:123], v[108:111], v[64:79]
    ds_read_b64_tr_b16 v[104:105], v9 offset:12288
    ds_read_b64_tr_b16 v[106:107], v9 offset:13312
    s_waitcnt lgkmcnt(4)
    v_mfma_f32_32x32x16_bf16 v[16:31], v[96:99], v[124:127], v[16:31]
    ds_read_b64_tr_b16 v[108:109], v8 offset:12288
    ds_read_b64_tr_b16 v[110:111], v8 offset:13312
    s_waitcnt lgkmcnt(4)
    v_mfma_f32_32x32x16_bf16 v[32:47], v[100:103], v[124:127], v[32:47]
    ds_read_b64_tr_b16 v[96:97], v7 offset:16384
    ds_read_b64_tr_b16 v[98:99], v7 offset:17408
    s_waitcnt lgkmcnt(4)
    v_mfma_f32_32x32x16_bf16 v[48:63], v[104:107], v[124:127], v[48:63]
    ds_read_b64_tr_b16 v[100:101], v13 offset:16384
    ds_read_b64_tr_b16 v[102:103], v13 offset:17408
    s_waitcnt lgkmcnt(4)
    v_mfma_f32_32x32x16_bf16 v[64:79], v[124:127], v[108:111], v[64:79]
    ds_read_b64_tr_b16 v[104:105], v9 offset:16384
    ds_read_b64_tr_b16 v[106:107], v9 offset:17408
    s_waitcnt lgkmcnt(4)
    v_mfma_f32_32x32x16_bf16 v[16:31], v[96:99], v[128:131], v[16:31]
    ds_read_b64_tr_b16 v[108:109], v8 offset:16384
    ds_read_b64_tr_b16 v[110:111], v8 offset:17408
    s_waitcnt lgkmcnt(4)
    v_mfma_f32_32x32x16_bf16 v[32:47], v[100:103], v[128:131], v[32:47]
    ds_read_b64_tr_b16 v[96:97], v7 offset:20480
    ds_read_b64_tr_b16 v[98:99], v7 offset:21504
    s_waitcnt lgkmcnt(4)
    v_mfma_f32_32x32x16_bf16 v[48:63], v[104:107], v[128:131], v[48:63]
    ds_read_b64_tr_b16 v[100:101], v13 offset:20480
    ds_read_b64_tr_b16 v[102:103], v13 offset:21504
    s_waitcnt lgkmcnt(4)
    v_mfma_f32_32x32x16_bf16 v[64:79], v[128:131], v[108:111], v[64:79]
    ds_read_b64_tr_b16 v[104:105], v9 offset:20480
    ds_read_b64_tr_b16 v[106:107], v9 offset:21504
    s_waitcnt lgkmcnt(4)
    v_mfma_f32_32x32x16_bf16 v[16:31], v[96:99], v[132:135], v[16:31]
    ds_read_b64_tr_b16 v[108:109], v8 offset:20480
    ds_read_b64_tr_b16 v[110:111], v8 offset:21504
    s_waitcnt lgkmcnt(4)
    v_mfma_f32_32x32x16_bf16 v[32:47], v[100:103], v[132:135], v[32:47]
    ds_read_b64_tr_b16 v[96:97], v7 offset:24576
    ds_read_b64_tr_b16 v[98:99], v7 offset:25600
    s_waitcnt lgkmcnt(4)
    v_mfma_f32_32x32x16_bf16 v[48:63], v[104:107], v[132:135], v[48:63]
    ds_read_b64_tr_b16 v[100:101], v13 offset:24576
    ds_read_b64_tr_b16 v[102:103], v13 offset:25600
    s_waitcnt lgkmcnt(4)
    v_mfma_f32_32x32x16_bf16 v[64:79], v[132:135], v[108:111], v[64:79]
    ds_read_b64_tr_b16 v[104:105], v9 offset:24576
    ds_read_b64_tr_b16 v[106:107], v9 offset:25600
    s_waitcnt lgkmcnt(4)
    v_mfma_f32_32x32x16_bf16 v[16:31], v[96:99], v[136:139], v[16:31]
    ds_read_b64_tr_b16 v[108:109], v8 offset:24576
    ds_read_b64_tr_b16 v[110:111], v8 offset:25600
    s_waitcnt lgkmcnt(4)
    v_mfma_f32_32x32x16_bf16 v[32:47], v[100:103], v[136:139], v[32:47]
    ds_read_b64_tr_b16 v[96:97], v7 offset:28672
    ds_read_b64_tr_b16 v[98:99], v7 offset:29696
    s_waitcnt lgkmcnt(4)
    v_mfma_f32_32x32x16_bf16 v[48:63], v[104:107], v[136:139], v[48:63]
    ds_read_b64_tr_b16 v[100:101], v13 offset:28672
    ds_read_b64_tr_b16 v[102:103], v13 offset:29696
    s_waitcnt lgkmcnt(4)
    v_mfma_f32_32x32x16_bf16 v[64:79], v[136:139], v[108:111], v[64:79]
    ds_read_b64_tr_b16 v[104:105], v9 offset:28672
    ds_read_b64_tr_b16 v[106:107], v9 offset:29696
    s_waitcnt lgkmcnt(4)
    v_mfma_f32_32x32x16_bf16 v[16:31], v[96:99], v[140:143], v[16:31]
    ds_read_b64_tr_b16 v[108:109], v8 offset:28672
    ds_read_b64_tr_b16 v[110:111], v8 offset:29696
    s_waitcnt lgkmcnt(4)
    v_mfma_f32_32x32x16_bf16 v[32:47], v[100:103], v[140:143], v[32:47]
    ds_read_b64_tr_b16 v[96:97], v7 offset:32768
    ds_read_b64_tr_b16 v[98:99], v7 offset:33792
    s_waitcnt lgkmcnt(4)
    v_mfma_f32_32x32x16_bf16 v[48:63], v[104:107], v[140:143], v[48:63]
    ds_read_b64_tr_b16 v[100:101], v13 offset:32768
    ds_read_b64_tr_b16 v[102:103], v13 offset:33792
    s_waitcnt lgkmcnt(4)
    v_mfma_f32_32x32x16_bf16 v[64:79], v[140:143], v[108:111], v[64:79]
    ds_read_b64_tr_b16 v[104:105], v9 offset:32768
    ds_read_b64_tr_b16 v[106:107], v9 offset:33792
    s_waitcnt lgkmcnt(4)
    v_mfma_f32_32x32x16_bf16 v[16:31], v[96:99], v[144:147], v[16:31]
    s_barrier
    ds_read_b64_tr_b16 v[108:109], v8 offset:32768
    ds_read_b64_tr_b16 v[110:111], v8 offset:33792
    s_waitcnt lgkmcnt(4)
    v_mfma_f32_32x32x16_bf16 v[32:47], v[100:103], v[144:147], v[32:47]
    v_add_u32 v7, 0x9000, v7
    ds_read_b64_tr_b16 v[96:97], v7 offset:0
    ds_read_b64_tr_b16 v[98:99], v7 offset:1024
    s_waitcnt lgkmcnt(4)
    v_mfma_f32_32x32x16_bf16 v[48:63], v[104:107], v[144:147], v[48:63]
    v_add_u32 v13, 0x9000, v13
    ds_read_b64_tr_b16 v[100:101], v13 offset:0
    ds_read_b64_tr_b16 v[102:103], v13 offset:1024
    s_waitcnt lgkmcnt(4)
    v_mfma_f32_32x32x16_bf16 v[64:79], v[144:147], v[108:111], v[64:79]
    v_add_u32 v9, 0x9000, v9
    ds_read_b64_tr_b16 v[104:105], v9 offset:0
    ds_read_b64_tr_b16 v[106:107], v9 offset:1024
    s_waitcnt lgkmcnt(4)
    v_mfma_f32_32x32x16_bf16 v[16:31], v[96:99], v[148:151], v[16:31]
    v_add_u32 v8, 0x9000, v8
    ds_read_b64_tr_b16 v[108:109], v8 offset:0
    ds_read_b64_tr_b16 v[110:111], v8 offset:1024
    s_waitcnt lgkmcnt(4)
    v_mfma_f32_32x32x16_bf16 v[32:47], v[100:103], v[148:151], v[32:47]
    ds_read_b64_tr_b16 v[96:97], v7 offset:4096
    ds_read_b64_tr_b16 v[98:99], v7 offset:5120
    s_waitcnt lgkmcnt(4)
    v_mfma_f32_32x32x16_bf16 v[48:63], v[104:107], v[148:151], v[48:63]
    ds_read_b64_tr_b16 v[100:101], v13 offset:4096
    ds_read_b64_tr_b16 v[102:103], v13 offset:5120
    s_waitcnt lgkmcnt(4)
    v_mfma_f32_32x32x16_bf16 v[64:79], v[148:151], v[108:111], v[64:79]
    ds_read_b64_tr_b16 v[104:105], v9 offset:4096
    ds_read_b64_tr_b16 v[106:107], v9 offset:5120
    s_waitcnt lgkmcnt(4)
    v_mfma_f32_32x32x16_bf16 v[16:31], v[96:99], v[152:155], v[16:31]
    ds_read_b64_tr_b16 v[108:109], v8 offset:4096
    ds_read_b64_tr_b16 v[110:111], v8 offset:5120
    s_waitcnt lgkmcnt(4)
    v_mfma_f32_32x32x16_bf16 v[32:47], v[100:103], v[152:155], v[32:47]
    ds_read_b64_tr_b16 v[96:97], v7 offset:8192
    ds_read_b64_tr_b16 v[98:99], v7 offset:9216
    s_waitcnt lgkmcnt(4)
    v_mfma_f32_32x32x16_bf16 v[48:63], v[104:107], v[152:155], v[48:63]
    ds_read_b64_tr_b16 v[100:101], v13 offset:8192
    ds_read_b64_tr_b16 v[102:103], v13 offset:9216
    s_waitcnt lgkmcnt(4)
    v_mfma_f32_32x32x16_bf16 v[64:79], v[152:155], v[108:111], v[64:79]
    ds_read_b64_tr_b16 v[104:105], v9 offset:8192
    ds_read_b64_tr_b16 v[106:107], v9 offset:9216
    s_waitcnt lgkmcnt(4)
    v_mfma_f32_32x32x16_bf16 v[16:31], v[96:99], v[156:159], v[16:31]
    ds_read_b64_tr_b16 v[108:109], v8 offset:8192
    ds_read_b64_tr_b16 v[110:111], v8 offset:9216
    s_waitcnt lgkmcnt(4)
    v_mfma_f32_32x32x16_bf16 v[32:47], v[100:103], v[156:159], v[32:47]
    ds_read_b64_tr_b16 v[96:97], v7 offset:12288
    ds_read_b64_tr_b16 v[98:99], v7 offset:13312
    s_waitcnt lgkmcnt(4)
    v_mfma_f32_32x32x16_bf16 v[48:63], v[104:107], v[156:159], v[48:63]
    ds_read_b64_tr_b16 v[100:101], v13 offset:12288
    ds_read_b64_tr_b16 v[102:103], v13 offset:13312
    s_waitcnt lgkmcnt(4)
    v_mfma_f32_32x32x16_bf16 v[64:79], v[156:159], v[108:111], v[64:79]
    ds_read_b64_tr_b16 v[104:105], v9 offset:12288
    ds_read_b64_tr_b16 v[106:107], v9 offset:13312
    s_waitcnt lgkmcnt(4)
    v_mfma_f32_32x32x16_bf16 v[16:31], v[96:99], v[160:163], v[16:31]
    ds_read_b64_tr_b16 v[108:109], v8 offset:12288
    ds_read_b64_tr_b16 v[110:111], v8 offset:13312
    s_waitcnt lgkmcnt(4)
    v_mfma_f32_32x32x16_bf16 v[32:47], v[100:103], v[160:163], v[32:47]
    ds_read_b64_tr_b16 v[96:97], v7 offset:16384
    ds_read_b64_tr_b16 v[98:99], v7 offset:17408
    s_waitcnt lgkmcnt(4)
    v_mfma_f32_32x32x16_bf16 v[48:63], v[104:107], v[160:163], v[48:63]
    ds_read_b64_tr_b16 v[100:101], v13 offset:16384
    ds_read_b64_tr_b16 v[102:103], v13 offset:17408
    s_waitcnt lgkmcnt(4)
    v_mfma_f32_32x32x16_bf16 v[64:79], v[160:163], v[108:111], v[64:79]
    ds_read_b64_tr_b16 v[104:105], v9 offset:16384
    ds_read_b64_tr_b16 v[106:107], v9 offset:17408
    s_waitcnt lgkmcnt(4)
    v_mfma_f32_32x32x16_bf16 v[16:31], v[96:99], v[164:167], v[16:31]
    ds_read_b64_tr_b16 v[108:109], v8 offset:16384
    ds_read_b64_tr_b16 v[110:111], v8 offset:17408
    s_waitcnt lgkmcnt(4)
    v_mfma_f32_32x32x16_bf16 v[32:47], v[100:103], v[164:167], v[32:47]
    ds_read_b64_tr_b16 v[96:97], v7 offset:20480
    ds_read_b64_tr_b16 v[98:99], v7 offset:21504
    s_waitcnt lgkmcnt(4)
    v_mfma_f32_32x32x16_bf16 v[48:63], v[104:107], v[164:167], v[48:63]
    ds_read_b64_tr_b16 v[100:101], v13 offset:20480
    ds_read_b64_tr_b16 v[102:103], v13 offset:21504
    s_waitcnt lgkmcnt(4)
    v_mfma_f32_32x32x16_bf16 v[64:79], v[164:167], v[108:111], v[64:79]
    ds_read_b64_tr_b16 v[104:105], v9 offset:20480
    ds_read_b64_tr_b16 v[106:107], v9 offset:21504
    s_waitcnt lgkmcnt(4)
    v_mfma_f32_32x32x16_bf16 v[16:31], v[96:99], v[168:171], v[16:31]
    ds_read_b64_tr_b16 v[108:109], v8 offset:20480
    ds_read_b64_tr_b16 v[110:111], v8 offset:21504
    s_waitcnt lgkmcnt(4)
    v_mfma_f32_32x32x16_bf16 v[32:47], v[100:103], v[168:171], v[32:47]
    ds_read_b64_tr_b16 v[96:97], v7 offset:24576
    ds_read_b64_tr_b16 v[98:99], v7 offset:25600
    s_waitcnt lgkmcnt(4)
    v_mfma_f32_32x32x16_bf16 v[48:63], v[104:107], v[168:171], v[48:63]
    ds_read_b64_tr_b16 v[100:101], v13 offset:24576
    ds_read_b64_tr_b16 v[102:103], v13 offset:25600
    s_waitcnt lgkmcnt(4)
    v_mfma_f32_32x32x16_bf16 v[64:79], v[168:171], v[108:111], v[64:79]
    ds_read_b64_tr_b16 v[104:105], v9 offset:24576
    ds_read_b64_tr_b16 v[106:107], v9 offset:25600
    s_waitcnt lgkmcnt(4)
    v_mfma_f32_32x32x16_bf16 v[16:31], v[96:99], v[172:175], v[16:31]
    ds_read_b64_tr_b16 v[108:109], v8 offset:24576
    ds_read_b64_tr_b16 v[110:111], v8 offset:25600
    s_waitcnt lgkmcnt(4)
    v_mfma_f32_32x32x16_bf16 v[32:47], v[100:103], v[172:175], v[32:47]
    ds_read_b64_tr_b16 v[96:97], v7 offset:28672
    ds_read_b64_tr_b16 v[98:99], v7 offset:29696
    s_waitcnt lgkmcnt(4)
    v_mfma_f32_32x32x16_bf16 v[48:63], v[104:107], v[172:175], v[48:63]
    ds_read_b64_tr_b16 v[100:101], v13 offset:28672
    ds_read_b64_tr_b16 v[102:103], v13 offset:29696
    s_waitcnt lgkmcnt(4)
    v_mfma_f32_32x32x16_bf16 v[64:79], v[172:175], v[108:111], v[64:79]
    ds_read_b64_tr_b16 v[104:105], v9 offset:28672
    ds_read_b64_tr_b16 v[106:107], v9 offset:29696
    s_waitcnt lgkmcnt(4)
    v_mfma_f32_32x32x16_bf16 v[16:31], v[96:99], v[176:179], v[16:31]
    ds_read_b64_tr_b16 v[108:109], v8 offset:28672
    ds_read_b64_tr_b16 v[110:111], v8 offset:29696
    s_waitcnt lgkmcnt(4)
    v_mfma_f32_32x32x16_bf16 v[32:47], v[100:103], v[176:179], v[32:47]
    ds_read_b64_tr_b16 v[96:97], v7 offset:32768
    ds_read_b64_tr_b16 v[98:99], v7 offset:33792
    s_waitcnt lgkmcnt(4)
    v_mfma_f32_32x32x16_bf16 v[48:63], v[104:107], v[176:179], v[48:63]
    ds_read_b64_tr_b16 v[100:101], v13 offset:32768
    ds_read_b64_tr_b16 v[102:103], v13 offset:33792
    s_waitcnt lgkmcnt(4)
    v_mfma_f32_32x32x16_bf16 v[64:79], v[176:179], v[108:111], v[64:79]
    ds_read_b64_tr_b16 v[104:105], v9 offset:32768
    ds_read_b64_tr_b16 v[106:107], v9 offset:33792
    s_waitcnt lgkmcnt(4)
    v_mfma_f32_32x32x16_bf16 v[16:31], v[96:99], v[180:183], v[16:31]
    s_barrier
    ds_read_b64_tr_b16 v[108:109], v8 offset:32768
    ds_read_b64_tr_b16 v[110:111], v8 offset:33792
    s_waitcnt lgkmcnt(4)
    v_mfma_f32_32x32x16_bf16 v[32:47], v[100:103], v[180:183], v[32:47]
    v_add_u32 v7, 0x9000, v7
    ds_read_b64_tr_b16 v[96:97], v7 offset:0
    ds_read_b64_tr_b16 v[98:99], v7 offset:1024
    s_waitcnt lgkmcnt(4)
    v_mfma_f32_32x32x16_bf16 v[48:63], v[104:107], v[180:183], v[48:63]
    v_add_u32 v13, 0x9000, v13
    ds_read_b64_tr_b16 v[100:101], v13 offset:0
    ds_read_b64_tr_b16 v[102:103], v13 offset:1024
    s_waitcnt lgkmcnt(4)
    v_mfma_f32_32x32x16_bf16 v[64:79], v[180:183], v[108:111], v[64:79]
    v_add_u32 v9, 0x9000, v9
    ds_read_b64_tr_b16 v[104:105], v9 offset:0
    ds_read_b64_tr_b16 v[106:107], v9 offset:1024
    s_waitcnt lgkmcnt(4)
    v_mfma_f32_32x32x16_bf16 v[16:31], v[96:99], v[184:187], v[16:31]
    v_add_u32 v8, 0x9000, v8
    ds_read_b64_tr_b16 v[108:109], v8 offset:0
    ds_read_b64_tr_b16 v[110:111], v8 offset:1024
    s_waitcnt lgkmcnt(4)
    v_mfma_f32_32x32x16_bf16 v[32:47], v[100:103], v[184:187], v[32:47]
    ds_read_b64_tr_b16 v[96:97], v7 offset:4096
    ds_read_b64_tr_b16 v[98:99], v7 offset:5120
    s_waitcnt lgkmcnt(4)
    v_mfma_f32_32x32x16_bf16 v[48:63], v[104:107], v[184:187], v[48:63]
    ds_read_b64_tr_b16 v[100:101], v13 offset:4096
    ds_read_b64_tr_b16 v[102:103], v13 offset:5120
    s_waitcnt lgkmcnt(4)
    v_mfma_f32_32x32x16_bf16 v[64:79], v[184:187], v[108:111], v[64:79]
    ds_read_b64_tr_b16 v[104:105], v9 offset:4096
    ds_read_b64_tr_b16 v[106:107], v9 offset:5120
    s_waitcnt lgkmcnt(4)
    v_mfma_f32_32x32x16_bf16 v[16:31], v[96:99], v[188:191], v[16:31]
    ds_read_b64_tr_b16 v[108:109], v8 offset:4096
    ds_read_b64_tr_b16 v[110:111], v8 offset:5120
    s_waitcnt lgkmcnt(4)
    v_mfma_f32_32x32x16_bf16 v[32:47], v[100:103], v[188:191], v[32:47]
    ds_read_b64_tr_b16 v[96:97], v7 offset:8192
    ds_read_b64_tr_b16 v[98:99], v7 offset:9216
    s_waitcnt lgkmcnt(4)
    v_mfma_f32_32x32x16_bf16 v[48:63], v[104:107], v[188:191], v[48:63]
    ds_read_b64_tr_b16 v[100:101], v13 offset:8192
    ds_read_b64_tr_b16 v[102:103], v13 offset:9216
    s_waitcnt lgkmcnt(4)
    v_mfma_f32_32x32x16_bf16 v[64:79], v[188:191], v[108:111], v[64:79]
    ds_read_b64_tr_b16 v[104:105], v9 offset:8192
    ds_read_b64_tr_b16 v[106:107], v9 offset:9216
    s_waitcnt lgkmcnt(4)
    v_mfma_f32_32x32x16_bf16 v[16:31], v[96:99], v[192:195], v[16:31]
    ds_read_b64_tr_b16 v[108:109], v8 offset:8192
    ds_read_b64_tr_b16 v[110:111], v8 offset:9216
    s_waitcnt lgkmcnt(4)
    v_mfma_f32_32x32x16_bf16 v[32:47], v[100:103], v[192:195], v[32:47]
    ds_read_b64_tr_b16 v[96:97], v7 offset:12288
    ds_read_b64_tr_b16 v[98:99], v7 offset:13312
    s_waitcnt lgkmcnt(4)
    v_mfma_f32_32x32x16_bf16 v[48:63], v[104:107], v[192:195], v[48:63]
    ds_read_b64_tr_b16 v[100:101], v13 offset:12288
    ds_read_b64_tr_b16 v[102:103], v13 offset:13312
    s_waitcnt lgkmcnt(4)
    v_mfma_f32_32x32x16_bf16 v[64:79], v[192:195], v[108:111], v[64:79]
    ds_read_b64_tr_b16 v[104:105], v9 offset:12288
    ds_read_b64_tr_b16 v[106:107], v9 offset:13312
    s_waitcnt lgkmcnt(4)
    v_mfma_f32_32x32x16_bf16 v[16:31], v[96:99], v[196:199], v[16:31]
    ds_read_b64_tr_b16 v[108:109], v8 offset:12288
    ds_read_b64_tr_b16 v[110:111], v8 offset:13312
    s_waitcnt lgkmcnt(4)
    v_mfma_f32_32x32x16_bf16 v[32:47], v[100:103], v[196:199], v[32:47]
    ds_read_b64_tr_b16 v[96:97], v7 offset:16384
    ds_read_b64_tr_b16 v[98:99], v7 offset:17408
    s_waitcnt lgkmcnt(4)
    v_mfma_f32_32x32x16_bf16 v[48:63], v[104:107], v[196:199], v[48:63]
    ds_read_b64_tr_b16 v[100:101], v13 offset:16384
    ds_read_b64_tr_b16 v[102:103], v13 offset:17408
    s_waitcnt lgkmcnt(4)
    v_mfma_f32_32x32x16_bf16 v[64:79], v[196:199], v[108:111], v[64:79]
    ds_read_b64_tr_b16 v[104:105], v9 offset:16384
    ds_read_b64_tr_b16 v[106:107], v9 offset:17408
    s_waitcnt lgkmcnt(4)
    v_mfma_f32_32x32x16_bf16 v[16:31], v[96:99], v[200:203], v[16:31]
    ds_read_b64_tr_b16 v[108:109], v8 offset:16384
    ds_read_b64_tr_b16 v[110:111], v8 offset:17408
    s_waitcnt lgkmcnt(4)
    v_mfma_f32_32x32x16_bf16 v[32:47], v[100:103], v[200:203], v[32:47]
    ds_read_b64_tr_b16 v[96:97], v7 offset:20480
    ds_read_b64_tr_b16 v[98:99], v7 offset:21504
    s_waitcnt lgkmcnt(4)
    v_mfma_f32_32x32x16_bf16 v[48:63], v[104:107], v[200:203], v[48:63]
    ds_read_b64_tr_b16 v[100:101], v13 offset:20480
    ds_read_b64_tr_b16 v[102:103], v13 offset:21504
    s_waitcnt lgkmcnt(4)
    v_mfma_f32_32x32x16_bf16 v[64:79], v[200:203], v[108:111], v[64:79]
    ds_read_b64_tr_b16 v[104:105], v9 offset:20480
    ds_read_b64_tr_b16 v[106:107], v9 offset:21504
    s_waitcnt lgkmcnt(4)
    v_mfma_f32_32x32x16_bf16 v[16:31], v[96:99], v[204:207], v[16:31]
    ds_read_b64_tr_b16 v[108:109], v8 offset:20480
    ds_read_b64_tr_b16 v[110:111], v8 offset:21504
    s_waitcnt lgkmcnt(4)
    v_mfma_f32_32x32x16_bf16 v[32:47], v[100:103], v[204:207], v[32:47]
    ds_read_b64_tr_b16 v[96:97], v7 offset:24576
    ds_read_b64_tr_b16 v[98:99], v7 offset:25600
    s_waitcnt lgkmcnt(4)
    v_mfma_f32_32x32x16_bf16 v[48:63], v[104:107], v[204:207], v[48:63]
    ds_read_b64_tr_b16 v[100:101], v13 offset:24576
    ds_read_b64_tr_b16 v[102:103], v13 offset:25600
    s_waitcnt lgkmcnt(4)
    v_mfma_f32_32x32x16_bf16 v[64:79], v[204:207], v[108:111], v[64:79]
    ds_read_b64_tr_b16 v[104:105], v9 offset:24576
    ds_read_b64_tr_b16 v[106:107], v9 offset:25600
    s_waitcnt lgkmcnt(4)
    v_mfma_f32_32x32x16_bf16 v[16:31], v[96:99], v[208:211], v[16:31]
    ds_read_b64_tr_b16 v[108:109], v8 offset:24576
    ds_read_b64_tr_b16 v[110:111], v8 offset:25600
    s_waitcnt lgkmcnt(4)
    v_mfma_f32_32x32x16_bf16 v[32:47], v[100:103], v[208:211], v[32:47]
    ds_read_b64_tr_b16 v[96:97], v7 offset:28672
    ds_read_b64_tr_b16 v[98:99], v7 offset:29696
    s_waitcnt lgkmcnt(4)
    v_mfma_f32_32x32x16_bf16 v[48:63], v[104:107], v[208:211], v[48:63]
    ds_read_b64_tr_b16 v[100:101], v13 offset:28672
    ds_read_b64_tr_b16 v[102:103], v13 offset:29696
    s_waitcnt lgkmcnt(4)
    v_mfma_f32_32x32x16_bf16 v[64:79], v[208:211], v[108:111], v[64:79]
    ds_read_b64_tr_b16 v[104:105], v9 offset:28672
    ds_read_b64_tr_b16 v[106:107], v9 offset:29696
    s_waitcnt lgkmcnt(4)
    v_mfma_f32_32x32x16_bf16 v[16:31], v[96:99], v[212:215], v[16:31]
    ds_read_b64_tr_b16 v[108:109], v8 offset:28672
    ds_read_b64_tr_b16 v[110:111], v8 offset:29696
    s_waitcnt lgkmcnt(4)
    v_mfma_f32_32x32x16_bf16 v[32:47], v[100:103], v[212:215], v[32:47]
    ds_read_b64_tr_b16 v[96:97], v7 offset:32768
    ds_read_b64_tr_b16 v[98:99], v7 offset:33792
    s_waitcnt lgkmcnt(4)
    v_mfma_f32_32x32x16_bf16 v[48:63], v[104:107], v[212:215], v[48:63]
    ds_read_b64_tr_b16 v[100:101], v13 offset:32768
    ds_read_b64_tr_b16 v[102:103], v13 offset:33792
    s_waitcnt lgkmcnt(4)
    v_mfma_f32_32x32x16_bf16 v[64:79], v[212:215], v[108:111], v[64:79]
    ds_read_b64_tr_b16 v[104:105], v9 offset:32768
    ds_read_b64_tr_b16 v[106:107], v9 offset:33792
    s_waitcnt lgkmcnt(4)
    v_mfma_f32_32x32x16_bf16 v[16:31], v[96:99], v[216:219], v[16:31]
    s_barrier
    ds_read_b64_tr_b16 v[108:109], v8 offset:32768
    ds_read_b64_tr_b16 v[110:111], v8 offset:33792
    s_waitcnt lgkmcnt(4)
    v_mfma_f32_32x32x16_bf16 v[32:47], v[100:103], v[216:219], v[32:47]
    v_add_u32 v7, 0x9000, v7
    ds_read_b64_tr_b16 v[96:97], v7 offset:0
    ds_read_b64_tr_b16 v[98:99], v7 offset:1024
    s_waitcnt lgkmcnt(4)
    v_mfma_f32_32x32x16_bf16 v[48:63], v[104:107], v[216:219], v[48:63]
    v_add_u32 v13, 0x9000, v13
    ds_read_b64_tr_b16 v[100:101], v13 offset:0
    ds_read_b64_tr_b16 v[102:103], v13 offset:1024
    s_waitcnt lgkmcnt(4)
    v_mfma_f32_32x32x16_bf16 v[64:79], v[216:219], v[108:111], v[64:79]
    v_add_u32 v9, 0x9000, v9
    ds_read_b64_tr_b16 v[104:105], v9 offset:0
    ds_read_b64_tr_b16 v[106:107], v9 offset:1024
    s_waitcnt lgkmcnt(4)
    v_mfma_f32_32x32x16_bf16 v[16:31], v[96:99], v[220:223], v[16:31]
    v_add_u32 v8, 0x9000, v8
    ds_read_b64_tr_b16 v[108:109], v8 offset:0
    ds_read_b64_tr_b16 v[110:111], v8 offset:1024
    s_waitcnt lgkmcnt(4)
    v_mfma_f32_32x32x16_bf16 v[32:47], v[100:103], v[220:223], v[32:47]
    ds_read_b64_tr_b16 v[96:97], v7 offset:4096
    ds_read_b64_tr_b16 v[98:99], v7 offset:5120
    s_waitcnt lgkmcnt(4)
    v_mfma_f32_32x32x16_bf16 v[48:63], v[104:107], v[220:223], v[48:63]
    ds_read_b64_tr_b16 v[100:101], v13 offset:4096
    ds_read_b64_tr_b16 v[102:103], v13 offset:5120
    s_waitcnt lgkmcnt(4)
    v_mfma_f32_32x32x16_bf16 v[64:79], v[220:223], v[108:111], v[64:79]
    ds_read_b64_tr_b16 v[104:105], v9 offset:4096
    ds_read_b64_tr_b16 v[106:107], v9 offset:5120
    s_waitcnt lgkmcnt(4)
    v_mfma_f32_32x32x16_bf16 v[16:31], v[96:99], v[224:227], v[16:31]
    ds_read_b64_tr_b16 v[108:109], v8 offset:4096
    ds_read_b64_tr_b16 v[110:111], v8 offset:5120
    s_waitcnt lgkmcnt(4)
    v_mfma_f32_32x32x16_bf16 v[32:47], v[100:103], v[224:227], v[32:47]
    ds_read_b64_tr_b16 v[96:97], v7 offset:8192
    ds_read_b64_tr_b16 v[98:99], v7 offset:9216
    s_waitcnt lgkmcnt(4)
    v_mfma_f32_32x32x16_bf16 v[48:63], v[104:107], v[224:227], v[48:63]
    ds_read_b64_tr_b16 v[100:101], v13 offset:8192
    ds_read_b64_tr_b16 v[102:103], v13 offset:9216
    s_waitcnt lgkmcnt(4)
    v_mfma_f32_32x32x16_bf16 v[64:79], v[224:227], v[108:111], v[64:79]
    ds_read_b64_tr_b16 v[104:105], v9 offset:8192
    ds_read_b64_tr_b16 v[106:107], v9 offset:9216
    s_waitcnt lgkmcnt(4)
    v_mfma_f32_32x32x16_bf16 v[16:31], v[96:99], v[228:231], v[16:31]
    ds_read_b64_tr_b16 v[108:109], v8 offset:8192
    ds_read_b64_tr_b16 v[110:111], v8 offset:9216
    s_waitcnt lgkmcnt(4)
    v_mfma_f32_32x32x16_bf16 v[32:47], v[100:103], v[228:231], v[32:47]
    ds_read_b64_tr_b16 v[96:97], v7 offset:12288
    ds_read_b64_tr_b16 v[98:99], v7 offset:13312
    s_waitcnt lgkmcnt(4)
    v_mfma_f32_32x32x16_bf16 v[48:63], v[104:107], v[228:231], v[48:63]
    ds_read_b64_tr_b16 v[100:101], v13 offset:12288
    ds_read_b64_tr_b16 v[102:103], v13 offset:13312
    s_waitcnt lgkmcnt(4)
    v_mfma_f32_32x32x16_bf16 v[64:79], v[228:231], v[108:111], v[64:79]
    ds_read_b64_tr_b16 v[104:105], v9 offset:12288
    ds_read_b64_tr_b16 v[106:107], v9 offset:13312
    s_waitcnt lgkmcnt(4)
    v_mfma_f32_32x32x16_bf16 v[16:31], v[96:99], v[232:235], v[16:31]
    ds_read_b64_tr_b16 v[108:109], v8 offset:12288
    ds_read_b64_tr_b16 v[110:111], v8 offset:13312
    s_waitcnt lgkmcnt(4)
    v_mfma_f32_32x32x16_bf16 v[32:47], v[100:103], v[232:235], v[32:47]
    ds_read_b64_tr_b16 v[96:97], v7 offset:16384
    ds_read_b64_tr_b16 v[98:99], v7 offset:17408
    s_waitcnt lgkmcnt(4)
    v_mfma_f32_32x32x16_bf16 v[48:63], v[104:107], v[232:235], v[48:63]
    ds_read_b64_tr_b16 v[100:101], v13 offset:16384
    ds_read_b64_tr_b16 v[102:103], v13 offset:17408
    s_waitcnt lgkmcnt(4)
    v_mfma_f32_32x32x16_bf16 v[64:79], v[232:235], v[108:111], v[64:79]
    ds_read_b64_tr_b16 v[104:105], v9 offset:16384
    ds_read_b64_tr_b16 v[106:107], v9 offset:17408
    s_waitcnt lgkmcnt(4)
    v_mfma_f32_32x32x16_bf16 v[16:31], v[96:99], v[236:239], v[16:31]
    ds_read_b64_tr_b16 v[108:109], v8 offset:16384
    ds_read_b64_tr_b16 v[110:111], v8 offset:17408
    s_waitcnt lgkmcnt(4)
    v_mfma_f32_32x32x16_bf16 v[32:47], v[100:103], v[236:239], v[32:47]
    ds_read_b64_tr_b16 v[96:97], v7 offset:20480
    ds_read_b64_tr_b16 v[98:99], v7 offset:21504
    s_waitcnt lgkmcnt(4)
    v_mfma_f32_32x32x16_bf16 v[48:63], v[104:107], v[236:239], v[48:63]
    ds_read_b64_tr_b16 v[100:101], v13 offset:20480
    ds_read_b64_tr_b16 v[102:103], v13 offset:21504
    s_waitcnt lgkmcnt(4)
    v_mfma_f32_32x32x16_bf16 v[64:79], v[236:239], v[108:111], v[64:79]
    ds_read_b64_tr_b16 v[104:105], v9 offset:20480
    ds_read_b64_tr_b16 v[106:107], v9 offset:21504
    s_waitcnt lgkmcnt(4)
    v_mfma_f32_32x32x16_bf16 v[16:31], v[96:99], v[240:243], v[16:31]
    ds_read_b64_tr_b16 v[108:109], v8 offset:20480
    ds_read_b64_tr_b16 v[110:111], v8 offset:21504
    s_waitcnt lgkmcnt(4)
    v_mfma_f32_32x32x16_bf16 v[32:47], v[100:103], v[240:243], v[32:47]
    ds_read_b64_tr_b16 v[96:97], v7 offset:24576
    ds_read_b64_tr_b16 v[98:99], v7 offset:25600
    s_waitcnt lgkmcnt(4)
    v_mfma_f32_32x32x16_bf16 v[48:63], v[104:107], v[240:243], v[48:63]
    ds_read_b64_tr_b16 v[100:101], v13 offset:24576
    ds_read_b64_tr_b16 v[102:103], v13 offset:25600
    s_waitcnt lgkmcnt(4)
    v_mfma_f32_32x32x16_bf16 v[64:79], v[240:243], v[108:111], v[64:79]
    ds_read_b64_tr_b16 v[104:105], v9 offset:24576
    ds_read_b64_tr_b16 v[106:107], v9 offset:25600
    s_waitcnt lgkmcnt(4)
    v_mfma_f32_32x32x16_bf16 v[16:31], v[96:99], v[244:247], v[16:31]
    ds_read_b64_tr_b16 v[108:109], v8 offset:24576
    ds_read_b64_tr_b16 v[110:111], v8 offset:25600
    s_waitcnt lgkmcnt(4)
    v_mfma_f32_32x32x16_bf16 v[32:47], v[100:103], v[244:247], v[32:47]
    ds_read_b64_tr_b16 v[96:97], v7 offset:28672
    ds_read_b64_tr_b16 v[98:99], v7 offset:29696
    s_waitcnt lgkmcnt(4)
    v_mfma_f32_32x32x16_bf16 v[48:63], v[104:107], v[244:247], v[48:63]
    ds_read_b64_tr_b16 v[100:101], v13 offset:28672
    ds_read_b64_tr_b16 v[102:103], v13 offset:29696
    s_waitcnt lgkmcnt(4)
    v_mfma_f32_32x32x16_bf16 v[64:79], v[244:247], v[108:111], v[64:79]
    ds_read_b64_tr_b16 v[104:105], v9 offset:28672
    ds_read_b64_tr_b16 v[106:107], v9 offset:29696
    s_waitcnt lgkmcnt(4)
    v_mfma_f32_32x32x16_bf16 v[16:31], v[96:99], v[248:251], v[16:31]
    ds_read_b64_tr_b16 v[108:109], v8 offset:28672
    ds_read_b64_tr_b16 v[110:111], v8 offset:29696
    s_waitcnt lgkmcnt(4)
    v_mfma_f32_32x32x16_bf16 v[32:47], v[100:103], v[248:251], v[32:47]
    ds_read_b64_tr_b16 v[96:97], v7 offset:32768
    ds_read_b64_tr_b16 v[98:99], v7 offset:33792
    s_waitcnt lgkmcnt(4)
    v_mfma_f32_32x32x16_bf16 v[48:63], v[104:107], v[248:251], v[48:63]
    ds_read_b64_tr_b16 v[100:101], v13 offset:32768
    ds_read_b64_tr_b16 v[102:103], v13 offset:33792
    s_waitcnt lgkmcnt(4)
    v_mfma_f32_32x32x16_bf16 v[64:79], v[248:251], v[108:111], v[64:79]
    ds_read_b64_tr_b16 v[104:105], v9 offset:32768
    ds_read_b64_tr_b16 v[106:107], v9 offset:33792
    s_waitcnt lgkmcnt(4)
    v_mfma_f32_32x32x16_bf16 v[16:31], v[96:99], v[252:255], v[16:31]
    s_barrier
    ds_read_b64_tr_b16 v[108:109], v8 offset:32768
    ds_read_b64_tr_b16 v[110:111], v8 offset:33792
    s_waitcnt lgkmcnt(4)
    v_mfma_f32_32x32x16_bf16 v[32:47], v[100:103], v[252:255], v[32:47]
    v_add_u32 v10, 0x4000, v10
    ds_read_b64_tr_b16 v[96:97], v10 offset:0
    ds_read_b64_tr_b16 v[98:99], v10 offset:256
    s_waitcnt lgkmcnt(4)
    v_mfma_f32_32x32x16_bf16 v[48:63], v[104:107], v[252:255], v[48:63]
    ds_read_b64_tr_b16 v[100:101], v10 offset:1024
    ds_read_b64_tr_b16 v[102:103], v10 offset:1280
    s_waitcnt lgkmcnt(4)
    v_mfma_f32_32x32x16_bf16 v[64:79], v[252:255], v[108:111], v[64:79]
    ds_read_b64_tr_b16 v[104:105], v10 offset:2048
    ds_read_b64_tr_b16 v[106:107], v10 offset:2304
    s_waitcnt lgkmcnt(4)
    v_mfma_f32_32x32x16_bf16 v[80:95], v[96:99], v[112:115], 0
    ds_read_b64_tr_b16 v[108:109], v10 offset:3072
    ds_read_b64_tr_b16 v[110:111], v10 offset:3328
    s_waitcnt lgkmcnt(4)
    v_mfma_f32_32x32x16_bf16 v[80:95], v[100:103], v[116:119], v[80:95]
    ds_read_b64_tr_b16 v[96:97], v10 offset:4096
    ds_read_b64_tr_b16 v[98:99], v10 offset:4352
    s_waitcnt lgkmcnt(4)
    v_mfma_f32_32x32x16_bf16 v[80:95], v[104:107], v[120:123], v[80:95]
    ds_read_b64_tr_b16 v[100:101], v10 offset:5120
    ds_read_b64_tr_b16 v[102:103], v10 offset:5376
    s_waitcnt lgkmcnt(4)
    v_mfma_f32_32x32x16_bf16 v[80:95], v[108:111], v[124:127], v[80:95]
    ds_read_b64_tr_b16 v[104:105], v10 offset:6144
    ds_read_b64_tr_b16 v[106:107], v10 offset:6400
    s_waitcnt lgkmcnt(4)
    v_mfma_f32_32x32x16_bf16 v[80:95], v[96:99], v[128:131], v[80:95]
    ds_read_b64_tr_b16 v[108:109], v10 offset:7168
    ds_read_b64_tr_b16 v[110:111], v10 offset:7424
    s_waitcnt lgkmcnt(4)
    v_mfma_f32_32x32x16_bf16 v[80:95], v[100:103], v[132:135], v[80:95]
    ds_read_b64_tr_b16 v[96:97], v10 offset:8192
    ds_read_b64_tr_b16 v[98:99], v10 offset:8448
    s_waitcnt lgkmcnt(4)
    v_mfma_f32_32x32x16_bf16 v[80:95], v[104:107], v[136:139], v[80:95]
    ds_read_b64_tr_b16 v[100:101], v10 offset:9216
    ds_read_b64_tr_b16 v[102:103], v10 offset:9472
    v_mul_f32 v64, v5, v64
    v_mul_f32 v65, v5, v65
    v_mul_f32 v66, v5, v66
    v_mul_f32 v67, v5, v67
    v_mul_f32 v68, v5, v68
    s_waitcnt lgkmcnt(4)
    v_mfma_f32_32x32x16_bf16 v[80:95], v[108:111], v[140:143], v[80:95]
    ds_read_b64_tr_b16 v[104:105], v10 offset:10240
    ds_read_b64_tr_b16 v[106:107], v10 offset:10496
    v_mul_f32 v69, v5, v69
    v_mul_f32 v70, v5, v70
    v_mul_f32 v71, v5, v71
    v_mul_f32 v72, v5, v72
    v_mul_f32 v73, v5, v73
    s_waitcnt lgkmcnt(4)
    v_mfma_f32_32x32x16_bf16 v[80:95], v[96:99], v[144:147], v[80:95]
    ds_read_b64_tr_b16 v[108:109], v10 offset:11264
    ds_read_b64_tr_b16 v[110:111], v10 offset:11520
    v_mul_f32 v74, v5, v74
    v_mul_f32 v75, v5, v75
    v_mul_f32 v76, v5, v76
    v_mul_f32 v77, v5, v77
    v_mul_f32 v78, v5, v78
    s_waitcnt lgkmcnt(4)
    v_mfma_f32_32x32x16_bf16 v[80:95], v[100:103], v[148:151], v[80:95]
    ds_read_b64_tr_b16 v[96:97], v10 offset:12288
    ds_read_b64_tr_b16 v[98:99], v10 offset:12544
    v_mul_f32 v79, v5, v79
    v_mul_f32 v16, s63, v16
    v_mul_f32 v17, s63, v17
    v_mul_f32 v18, s63, v18
    v_mul_f32 v19, s63, v19
    s_waitcnt lgkmcnt(4)
    v_mfma_f32_32x32x16_bf16 v[80:95], v[104:107], v[152:155], v[80:95]
    ds_read_b64_tr_b16 v[100:101], v10 offset:13312
    ds_read_b64_tr_b16 v[102:103], v10 offset:13568
    v_mul_f32 v20, s63, v20
    v_mul_f32 v21, s63, v21
    v_mul_f32 v22, s63, v22
    v_mul_f32 v23, s63, v23
    v_mul_f32 v24, s63, v24
    s_waitcnt lgkmcnt(4)
    v_mfma_f32_32x32x16_bf16 v[80:95], v[108:111], v[156:159], v[80:95]
    ds_read_b64_tr_b16 v[104:105], v10 offset:14336
    ds_read_b64_tr_b16 v[106:107], v10 offset:14592
    v_mul_f32 v25, s63, v25
    v_mul_f32 v26, s63, v26
    v_mul_f32 v27, s63, v27
    v_mul_f32 v28, s63, v28
    v_mul_f32 v29, s63, v29
    s_waitcnt lgkmcnt(4)
    v_mfma_f32_32x32x16_bf16 v[80:95], v[96:99], v[160:163], v[80:95]
    ds_read_b64_tr_b16 v[108:109], v10 offset:15360
    ds_read_b64_tr_b16 v[110:111], v10 offset:15616
    v_mul_f32 v30, s63, v30
    v_mul_f32 v31, s63, v31
    v_cvt_pk_bf16_f32 v16, v16, v17
    v_cvt_pk_bf16_f32 v17, v18, v19
    v_cvt_pk_bf16_f32 v18, v20, v21
    s_waitcnt lgkmcnt(4)
    v_mfma_f32_32x32x16_bf16 v[80:95], v[100:103], v[164:167], v[80:95]
    ds_read_b64_tr_b16 v[96:97], v10 offset:16384
    ds_read_b64_tr_b16 v[98:99], v10 offset:16640
    v_cvt_pk_bf16_f32 v19, v22, v23
    s_mov_b32 s29, s45
    buffer_store_dwordx4 v[16:19], v1, s[12:15], s29 offen sc1
    v_cvt_pk_bf16_f32 v20, v24, v25
    v_cvt_pk_bf16_f32 v21, v26, v27
    v_cvt_pk_bf16_f32 v22, v28, v29
    s_waitcnt lgkmcnt(4)
    v_mfma_f32_32x32x16_bf16 v[80:95], v[104:107], v[168:171], v[80:95]
    ds_read_b64_tr_b16 v[100:101], v10 offset:17408
    ds_read_b64_tr_b16 v[102:103], v10 offset:17664
    v_cvt_pk_bf16_f32 v23, v30, v31
    s_add_u32 s29, s45, s60
    buffer_store_dwordx4 v[20:23], v1, s[12:15], s29 offen sc1
    v_mul_f32 v32, s64, v32
    v_mul_f32 v33, s64, v33
    v_mul_f32 v34, s64, v34
    s_waitcnt lgkmcnt(4)
    v_mfma_f32_32x32x16_bf16 v[80:95], v[108:111], v[172:175], v[80:95]
    ds_read_b64_tr_b16 v[104:105], v10 offset:18432
    ds_read_b64_tr_b16 v[106:107], v10 offset:18688
    v_mul_f32 v35, s64, v35
    v_mul_f32 v36, s64, v36
    v_mul_f32 v37, s64, v37
    v_mul_f32 v38, s64, v38
    v_mul_f32 v39, s64, v39
    s_waitcnt lgkmcnt(4)
    v_mfma_f32_32x32x16_bf16 v[80:95], v[96:99], v[176:179], v[80:95]
    ds_read_b64_tr_b16 v[108:109], v10 offset:19456
    ds_read_b64_tr_b16 v[110:111], v10 offset:19712
    v_mul_f32 v40, s64, v40
    v_mul_f32 v41, s64, v41
    v_mul_f32 v42, s64, v42
    v_mul_f32 v43, s64, v43
    s_waitcnt lgkmcnt(4)
    v_mfma_f32_32x32x16_bf16 v[80:95], v[100:103], v[180:183], v[80:95]
    ds_read_b64_tr_b16 v[96:97], v10 offset:20480
    ds_read_b64_tr_b16 v[98:99], v10 offset:20736
    v_mul_f32 v44, s64, v44
    v_mul_f32 v45, s64, v45
    v_mul_f32 v46, s64, v46
    v_mul_f32 v47, s64, v47
    s_waitcnt lgkmcnt(4)
    v_mfma_f32_32x32x16_bf16 v[80:95], v[104:107], v[184:187], v[80:95]
    ds_read_b64_tr_b16 v[100:101], v10 offset:21504
    ds_read_b64_tr_b16 v[102:103], v10 offset:21760
    v_cvt_pk_bf16_f32 v32, v32, v33
    v_cvt_pk_bf16_f32 v33, v34, v35
    v_cvt_pk_bf16_f32 v34, v36, v37
    v_cvt_pk_bf16_f32 v35, v38, v39
    s_waitcnt lgkmcnt(4)
    v_mfma_f32_32x32x16_bf16 v[80:95], v[108:111], v[188:191], v[80:95]
    ds_read_b64_tr_b16 v[104:105], v10 offset:22528
    ds_read_b64_tr_b16 v[106:107], v10 offset:22784
    s_mov_b32 s29, s46
    buffer_store_dwordx4 v[32:35], v1, s[12:15], s29 offen sc1
    v_cvt_pk_bf16_f32 v36, v40, v41
    v_cvt_pk_bf16_f32 v37, v42, v43
    v_cvt_pk_bf16_f32 v38, v44, v45
    s_waitcnt lgkmcnt(4)
    v_mfma_f32_32x32x16_bf16 v[80:95], v[96:99], v[192:195], v[80:95]
    ds_read_b64_tr_b16 v[108:109], v10 offset:23552
    ds_read_b64_tr_b16 v[110:111], v10 offset:23808
    v_cvt_pk_bf16_f32 v39, v46, v47
    s_add_u32 s29, s46, s61
    buffer_store_dwordx4 v[36:39], v1, s[12:15], s29 offen sc1
    v_mul_f32 v48, s65, v48
    v_mul_f32 v49, s65, v49
    s_waitcnt lgkmcnt(4)
    v_mfma_f32_32x32x16_bf16 v[80:95], v[100:103], v[196:199], v[80:95]
    ds_read_b64_tr_b16 v[96:97], v10 offset:24576
    ds_read_b64_tr_b16 v[98:99], v10 offset:24832
    v_mul_f32 v50, s65, v50
    v_mul_f32 v51, s65, v51
    v_mul_f32 v52, s65, v52
    v_mul_f32 v53, s65, v53
    s_waitcnt lgkmcnt(4)
    v_mfma_f32_32x32x16_bf16 v[80:95], v[104:107], v[200:203], v[80:95]
    ds_read_b64_tr_b16 v[100:101], v10 offset:25600
    ds_read_b64_tr_b16 v[102:103], v10 offset:25856
    v_mul_f32 v54, s65, v54
    v_mul_f32 v55, s65, v55
    v_mul_f32 v56, s65, v56
    v_mul_f32 v57, s65, v57
    s_waitcnt lgkmcnt(4)
    v_mfma_f32_32x32x16_bf16 v[80:95], v[108:111], v[204:207], v[80:95]
    ds_read_b64_tr_b16 v[104:105], v10 offset:26624
    ds_read_b64_tr_b16 v[106:107], v10 offset:26880
    v_mul_f32 v58, s65, v58
    v_mul_f32 v59, s65, v59
    v_mul_f32 v60, s65, v60
    v_mul_f32 v61, s65, v61
    s_waitcnt lgkmcnt(4)
    v_mfma_f32_32x32x16_bf16 v[80:95], v[96:99], v[208:211], v[80:95]
    ds_read_b64_tr_b16 v[108:109], v10 offset:27648
    ds_read_b64_tr_b16 v[110:111], v10 offset:27904
    v_mul_f32 v62, s65, v62
    v_mul_f32 v63, s65, v63
    v_cvt_pk_bf16_f32 v48, v48, v49
    v_cvt_pk_bf16_f32 v49, v50, v51
    s_waitcnt lgkmcnt(4)
    v_mfma_f32_32x32x16_bf16 v[80:95], v[100:103], v[212:215], v[80:95]
    ds_read_b64_tr_b16 v[96:97], v10 offset:28672
    ds_read_b64_tr_b16 v[98:99], v10 offset:28928
    v_cvt_pk_bf16_f32 v50, v52, v53
    v_cvt_pk_bf16_f32 v51, v54, v55
    s_mov_b32 s29, s47
    buffer_store_dwordx4 v[48:51], v1, s[12:15], s29 offen sc1
    v_cvt_pk_bf16_f32 v52, v56, v57
    s_waitcnt lgkmcnt(4)
    v_mfma_f32_32x32x16_bf16 v[80:95], v[104:107], v[216:219], v[80:95]
    ds_read_b64_tr_b16 v[100:101], v10 offset:29696
    ds_read_b64_tr_b16 v[102:103], v10 offset:29952
    v_cvt_pk_bf16_f32 v53, v58, v59
    v_cvt_pk_bf16_f32 v54, v60, v61
    v_cvt_pk_bf16_f32 v55, v62, v63
    s_add_u32 s29, s47, s62
    buffer_store_dwordx4 v[52:55], v1, s[12:15], s29 offen sc1
    s_waitcnt lgkmcnt(4)
    v_mfma_f32_32x32x16_bf16 v[80:95], v[108:111], v[220:223], v[80:95]
    ds_read_b64_tr_b16 v[104:105], v10 offset:30720
    ds_read_b64_tr_b16 v[106:107], v10 offset:30976
    v_mov_b32_dpp v40, v64 quad_perm:[1,0,3,2] row_mask:0xf bank_mask:0xf
    v_mov_b32_dpp v41, v65 quad_perm:[1,0,3,2] row_mask:0xf bank_mask:0xf
    v_mov_b32_dpp v42, v66 quad_perm:[1,0,3,2] row_mask:0xf bank_mask:0xf
    v_mov_b32_dpp v43, v67 quad_perm:[1,0,3,2] row_mask:0xf bank_mask:0xf
    s_waitcnt lgkmcnt(4)
    v_mfma_f32_32x32x16_bf16 v[80:95], v[96:99], v[224:227], v[80:95]
    ds_read_b64_tr_b16 v[108:109], v10 offset:31744
    ds_read_b64_tr_b16 v[110:111], v10 offset:32000
    v_mov_b32_dpp v44, v68 quad_perm:[1,0,3,2] row_mask:0xf bank_mask:0xf
    v_mov_b32_dpp v45, v69 quad_perm:[1,0,3,2] row_mask:0xf bank_mask:0xf
    v_mov_b32_dpp v46, v70 quad_perm:[1,0,3,2] row_mask:0xf bank_mask:0xf
    v_mov_b32_dpp v47, v71 quad_perm:[1,0,3,2] row_mask:0xf bank_mask:0xf
    s_waitcnt lgkmcnt(4)
    v_mfma_f32_32x32x16_bf16 v[80:95], v[100:103], v[228:231], v[80:95]
    ds_read_b64_tr_b16 v[96:97], v10 offset:32768
    ds_read_b64_tr_b16 v[98:99], v10 offset:33024
    v_cvt_pk_bf16_f32 v64, v64, v40
    v_cvt_pk_bf16_f32 v65, v65, v41
    v_cvt_pk_bf16_f32 v66, v66, v42
    v_cvt_pk_bf16_f32 v67, v67, v43
    s_waitcnt lgkmcnt(4)
    v_mfma_f32_32x32x16_bf16 v[80:95], v[104:107], v[232:235], v[80:95]
    ds_read_b64_tr_b16 v[100:101], v10 offset:33792
    ds_read_b64_tr_b16 v[102:103], v10 offset:34048
    v_cvt_pk_bf16_f32 v68, v68, v44
    v_cvt_pk_bf16_f32 v69, v69, v45
    v_cvt_pk_bf16_f32 v70, v70, v46
    v_cvt_pk_bf16_f32 v71, v71, v47
    s_waitcnt lgkmcnt(4)
    v_mfma_f32_32x32x16_bf16 v[80:95], v[108:111], v[236:239], v[80:95]
    ds_read_b64_tr_b16 v[104:105], v10 offset:34816
    ds_read_b64_tr_b16 v[106:107], v10 offset:35072
    s_mov_b64 exec, s[54:55]
    buffer_store_dwordx4 v[64:67], v4, s[12:15], 0 offen offset:0 sc1
    s_mov_b64 exec, -1
    s_mov_b64 exec, s[54:55]
    buffer_store_dwordx4 v[68:71], v4, s[12:15], 0 offen offset:32 sc1
    s_mov_b64 exec, -1
    v_mov_b32_dpp v40, v72 quad_perm:[1,0,3,2] row_mask:0xf bank_mask:0xf
    v_mov_b32_dpp v41, v73 quad_perm:[1,0,3,2] row_mask:0xf bank_mask:0xf
    s_waitcnt lgkmcnt(4)
    v_mfma_f32_32x32x16_bf16 v[80:95], v[96:99], v[240:243], v[80:95]
    s_barrier
    ds_read_b64_tr_b16 v[108:109], v10 offset:35840
    ds_read_b64_tr_b16 v[110:111], v10 offset:36096
    v_mov_b32_dpp v42, v74 quad_perm:[1,0,3,2] row_mask:0xf bank_mask:0xf
    v_mov_b32_dpp v43, v75 quad_perm:[1,0,3,2] row_mask:0xf bank_mask:0xf
    v_mov_b32_dpp v44, v76 quad_perm:[1,0,3,2] row_mask:0xf bank_mask:0xf
    v_mov_b32_dpp v45, v77 quad_perm:[1,0,3,2] row_mask:0xf bank_mask:0xf
    s_waitcnt lgkmcnt(4)
    v_mfma_f32_32x32x16_bf16 v[80:95], v[100:103], v[244:247], v[80:95]
    v_add_u32 v11, 0xd000, v11
    ds_read_b64_tr_b16 v[96:97], v11 offset:0
    ds_read_b64_tr_b16 v[98:99], v11 offset:512
    v_mov_b32_dpp v46, v78 quad_perm:[1,0,3,2] row_mask:0xf bank_mask:0xf
    v_mov_b32_dpp v47, v79 quad_perm:[1,0,3,2] row_mask:0xf bank_mask:0xf
    v_cvt_pk_bf16_f32 v72, v72, v40
    v_cvt_pk_bf16_f32 v73, v73, v41
    s_waitcnt lgkmcnt(4)
    v_mfma_f32_32x32x16_bf16 v[80:95], v[104:107], v[248:251], v[80:95]
    v_add_u32 v12, 0xd000, v12
    ds_read_b64_tr_b16 v[100:101], v12 offset:0
    ds_read_b64_tr_b16 v[102:103], v12 offset:512
    v_cvt_pk_bf16_f32 v74, v74, v42
    v_cvt_pk_bf16_f32 v75, v75, v43
    v_cvt_pk_bf16_f32 v76, v76, v44
    v_cvt_pk_bf16_f32 v77, v77, v45
    s_waitcnt lgkmcnt(4)
    v_mfma_f32_32x32x16_bf16 v[80:95], v[108:111], v[252:255], v[80:95]
    ds_read_b64_tr_b16 v[104:105], v11 offset:2048
    ds_read_b64_tr_b16 v[106:107], v11 offset:2560
    v_cvt_pk_bf16_f32 v78, v78, v46
    v_cvt_pk_bf16_f32 v79, v79, v47
    s_mov_b64 exec, s[54:55]
    buffer_store_dwordx4 v[72:75], v4, s[12:15], 0 offen offset:64 sc1
    s_mov_b64 exec, -1
    s_mov_b64 exec, s[54:55]
    buffer_store_dwordx4 v[76:79], v4, s[12:15], 0 offen offset:96 sc1
    s_mov_b64 exec, -1
    s_branch parallel_sum__softmax_full_mha__dense_activation_relu__prompt_kernel_qE
parallel_sum__softmax_full_mha__dense_activation_relu__prompt_kernel_qB:
    s_cmp_eq_u32 s25, 10
    s_cbranch_scc0 parallel_sum__softmax_full_mha__dense_activation_relu__prompt_kernel_qC
    s_waitcnt lgkmcnt(4)
    v_mfma_f32_32x32x16_bf16 v[16:31], v[96:99], v[112:115], 0
    v_add_u32 v8, 0x4000, v8
    ds_read_b64_tr_b16 v[108:109], v8 offset:0
    ds_read_b64_tr_b16 v[110:111], v8 offset:1024
    s_waitcnt lgkmcnt(4)
    v_mfma_f32_32x32x16_bf16 v[32:47], v[100:103], v[112:115], 0
    ds_read_b64_tr_b16 v[96:97], v7 offset:4096
    ds_read_b64_tr_b16 v[98:99], v7 offset:5120
    s_waitcnt lgkmcnt(4)
    v_mfma_f32_32x32x16_bf16 v[48:63], v[112:115], v[104:107], 0
    ds_read_b64_tr_b16 v[100:101], v13 offset:4096
    ds_read_b64_tr_b16 v[102:103], v13 offset:5120
    s_waitcnt lgkmcnt(4)
    v_mfma_f32_32x32x16_bf16 v[64:79], v[112:115], v[108:111], 0
    ds_read_b64_tr_b16 v[104:105], v9 offset:4096
    ds_read_b64_tr_b16 v[106:107], v9 offset:5120
    s_waitcnt lgkmcnt(4)
    v_mfma_f32_32x32x16_bf16 v[16:31], v[96:99], v[116:119], v[16:31]
    ds_read_b64_tr_b16 v[108:109], v8 offset:4096
    ds_read_b64_tr_b16 v[110:111], v8 offset:5120
    s_waitcnt lgkmcnt(4)
    v_mfma_f32_32x32x16_bf16 v[32:47], v[100:103], v[116:119], v[32:47]
    ds_read_b64_tr_b16 v[96:97], v7 offset:8192
    ds_read_b64_tr_b16 v[98:99], v7 offset:9216
    s_waitcnt lgkmcnt(4)
    v_mfma_f32_32x32x16_bf16 v[48:63], v[116:119], v[104:107], v[48:63]
    ds_read_b64_tr_b16 v[100:101], v13 offset:8192
    ds_read_b64_tr_b16 v[102:103], v13 offset:9216
    s_waitcnt lgkmcnt(4)
    v_mfma_f32_32x32x16_bf16 v[64:79], v[116:119], v[108:111], v[64:79]
    ds_read_b64_tr_b16 v[104:105], v9 offset:8192
    ds_read_b64_tr_b16 v[106:107], v9 offset:9216
    s_waitcnt lgkmcnt(4)
    v_mfma_f32_32x32x16_bf16 v[16:31], v[96:99], v[120:123], v[16:31]
    ds_read_b64_tr_b16 v[108:109], v8 offset:8192
    ds_read_b64_tr_b16 v[110:111], v8 offset:9216
    s_waitcnt lgkmcnt(4)
    v_mfma_f32_32x32x16_bf16 v[32:47], v[100:103], v[120:123], v[32:47]
    ds_read_b64_tr_b16 v[96:97], v7 offset:12288
    ds_read_b64_tr_b16 v[98:99], v7 offset:13312
    s_waitcnt lgkmcnt(4)
    v_mfma_f32_32x32x16_bf16 v[48:63], v[120:123], v[104:107], v[48:63]
    ds_read_b64_tr_b16 v[100:101], v13 offset:12288
    ds_read_b64_tr_b16 v[102:103], v13 offset:13312
    s_waitcnt lgkmcnt(4)
    v_mfma_f32_32x32x16_bf16 v[64:79], v[120:123], v[108:111], v[64:79]
    ds_read_b64_tr_b16 v[104:105], v9 offset:12288
    ds_read_b64_tr_b16 v[106:107], v9 offset:13312
    s_waitcnt lgkmcnt(4)
    v_mfma_f32_32x32x16_bf16 v[16:31], v[96:99], v[124:127], v[16:31]
    ds_read_b64_tr_b16 v[108:109], v8 offset:12288
    ds_read_b64_tr_b16 v[110:111], v8 offset:13312
    s_waitcnt lgkmcnt(4)
    v_mfma_f32_32x32x16_bf16 v[32:47], v[100:103], v[124:127], v[32:47]
    ds_read_b64_tr_b16 v[96:97], v7 offset:16384
    ds_read_b64_tr_b16 v[98:99], v7 offset:17408
    s_waitcnt lgkmcnt(4)
    v_mfma_f32_32x32x16_bf16 v[48:63], v[124:127], v[104:107], v[48:63]
    ds_read_b64_tr_b16 v[100:101], v13 offset:16384
    ds_read_b64_tr_b16 v[102:103], v13 offset:17408
    s_waitcnt lgkmcnt(4)
    v_mfma_f32_32x32x16_bf16 v[64:79], v[124:127], v[108:111], v[64:79]
    ds_read_b64_tr_b16 v[104:105], v9 offset:16384
    ds_read_b64_tr_b16 v[106:107], v9 offset:17408
    s_waitcnt lgkmcnt(4)
    v_mfma_f32_32x32x16_bf16 v[16:31], v[96:99], v[128:131], v[16:31]
    ds_read_b64_tr_b16 v[108:109], v8 offset:16384
    ds_read_b64_tr_b16 v[110:111], v8 offset:17408
    s_waitcnt lgkmcnt(4)
    v_mfma_f32_32x32x16_bf16 v[32:47], v[100:103], v[128:131], v[32:47]
    ds_read_b64_tr_b16 v[96:97], v7 offset:20480
    ds_read_b64_tr_b16 v[98:99], v7 offset:21504
    s_waitcnt lgkmcnt(4)
    v_mfma_f32_32x32x16_bf16 v[48:63], v[128:131], v[104:107], v[48:63]
    ds_read_b64_tr_b16 v[100:101], v13 offset:20480
    ds_read_b64_tr_b16 v[102:103], v13 offset:21504
    s_waitcnt lgkmcnt(4)
    v_mfma_f32_32x32x16_bf16 v[64:79], v[128:131], v[108:111], v[64:79]
    ds_read_b64_tr_b16 v[104:105], v9 offset:20480
    ds_read_b64_tr_b16 v[106:107], v9 offset:21504
    s_waitcnt lgkmcnt(4)
    v_mfma_f32_32x32x16_bf16 v[16:31], v[96:99], v[132:135], v[16:31]
    ds_read_b64_tr_b16 v[108:109], v8 offset:20480
    ds_read_b64_tr_b16 v[110:111], v8 offset:21504
    s_waitcnt lgkmcnt(4)
    v_mfma_f32_32x32x16_bf16 v[32:47], v[100:103], v[132:135], v[32:47]
    ds_read_b64_tr_b16 v[96:97], v7 offset:24576
    ds_read_b64_tr_b16 v[98:99], v7 offset:25600
    s_waitcnt lgkmcnt(4)
    v_mfma_f32_32x32x16_bf16 v[48:63], v[132:135], v[104:107], v[48:63]
    ds_read_b64_tr_b16 v[100:101], v13 offset:24576
    ds_read_b64_tr_b16 v[102:103], v13 offset:25600
    s_waitcnt lgkmcnt(4)
    v_mfma_f32_32x32x16_bf16 v[64:79], v[132:135], v[108:111], v[64:79]
    ds_read_b64_tr_b16 v[104:105], v9 offset:24576
    ds_read_b64_tr_b16 v[106:107], v9 offset:25600
    s_waitcnt lgkmcnt(4)
    v_mfma_f32_32x32x16_bf16 v[16:31], v[96:99], v[136:139], v[16:31]
    ds_read_b64_tr_b16 v[108:109], v8 offset:24576
    ds_read_b64_tr_b16 v[110:111], v8 offset:25600
    s_waitcnt lgkmcnt(4)
    v_mfma_f32_32x32x16_bf16 v[32:47], v[100:103], v[136:139], v[32:47]
    ds_read_b64_tr_b16 v[96:97], v7 offset:28672
    ds_read_b64_tr_b16 v[98:99], v7 offset:29696
    s_waitcnt lgkmcnt(4)
    v_mfma_f32_32x32x16_bf16 v[48:63], v[136:139], v[104:107], v[48:63]
    ds_read_b64_tr_b16 v[100:101], v13 offset:28672
    ds_read_b64_tr_b16 v[102:103], v13 offset:29696
    s_waitcnt lgkmcnt(4)
    v_mfma_f32_32x32x16_bf16 v[64:79], v[136:139], v[108:111], v[64:79]
    ds_read_b64_tr_b16 v[104:105], v9 offset:28672
    ds_read_b64_tr_b16 v[106:107], v9 offset:29696
    s_waitcnt lgkmcnt(4)
    v_mfma_f32_32x32x16_bf16 v[16:31], v[96:99], v[140:143], v[16:31]
    ds_read_b64_tr_b16 v[108:109], v8 offset:28672
    ds_read_b64_tr_b16 v[110:111], v8 offset:29696
    s_waitcnt lgkmcnt(4)
    v_mfma_f32_32x32x16_bf16 v[32:47], v[100:103], v[140:143], v[32:47]
    ds_read_b64_tr_b16 v[96:97], v7 offset:32768
    ds_read_b64_tr_b16 v[98:99], v7 offset:33792
    s_waitcnt lgkmcnt(4)
    v_mfma_f32_32x32x16_bf16 v[48:63], v[140:143], v[104:107], v[48:63]
    ds_read_b64_tr_b16 v[100:101], v13 offset:32768
    ds_read_b64_tr_b16 v[102:103], v13 offset:33792
    s_waitcnt lgkmcnt(4)
    v_mfma_f32_32x32x16_bf16 v[64:79], v[140:143], v[108:111], v[64:79]
    ds_read_b64_tr_b16 v[104:105], v9 offset:32768
    ds_read_b64_tr_b16 v[106:107], v9 offset:33792
    s_waitcnt lgkmcnt(4)
    v_mfma_f32_32x32x16_bf16 v[16:31], v[96:99], v[144:147], v[16:31]
    s_barrier
    ds_read_b64_tr_b16 v[108:109], v8 offset:32768
    ds_read_b64_tr_b16 v[110:111], v8 offset:33792
    s_waitcnt lgkmcnt(4)
    v_mfma_f32_32x32x16_bf16 v[32:47], v[100:103], v[144:147], v[32:47]
    v_add_u32 v7, 0x9000, v7
    ds_read_b64_tr_b16 v[96:97], v7 offset:0
    ds_read_b64_tr_b16 v[98:99], v7 offset:1024
    s_waitcnt lgkmcnt(4)
    v_mfma_f32_32x32x16_bf16 v[48:63], v[144:147], v[104:107], v[48:63]
    v_add_u32 v13, 0x9000, v13
    ds_read_b64_tr_b16 v[100:101], v13 offset:0
    ds_read_b64_tr_b16 v[102:103], v13 offset:1024
    s_waitcnt lgkmcnt(4)
    v_mfma_f32_32x32x16_bf16 v[64:79], v[144:147], v[108:111], v[64:79]
    v_add_u32 v9, 0x9000, v9
    ds_read_b64_tr_b16 v[104:105], v9 offset:0
    ds_read_b64_tr_b16 v[106:107], v9 offset:1024
    s_waitcnt lgkmcnt(4)
    v_mfma_f32_32x32x16_bf16 v[16:31], v[96:99], v[148:151], v[16:31]
    v_add_u32 v8, 0x9000, v8
    ds_read_b64_tr_b16 v[108:109], v8 offset:0
    ds_read_b64_tr_b16 v[110:111], v8 offset:1024
    s_waitcnt lgkmcnt(4)
    v_mfma_f32_32x32x16_bf16 v[32:47], v[100:103], v[148:151], v[32:47]
    ds_read_b64_tr_b16 v[96:97], v7 offset:4096
    ds_read_b64_tr_b16 v[98:99], v7 offset:5120
    s_waitcnt lgkmcnt(4)
    v_mfma_f32_32x32x16_bf16 v[48:63], v[148:151], v[104:107], v[48:63]
    ds_read_b64_tr_b16 v[100:101], v13 offset:4096
    ds_read_b64_tr_b16 v[102:103], v13 offset:5120
    s_waitcnt lgkmcnt(4)
    v_mfma_f32_32x32x16_bf16 v[64:79], v[148:151], v[108:111], v[64:79]
    ds_read_b64_tr_b16 v[104:105], v9 offset:4096
    ds_read_b64_tr_b16 v[106:107], v9 offset:5120
    s_waitcnt lgkmcnt(4)
    v_mfma_f32_32x32x16_bf16 v[16:31], v[96:99], v[152:155], v[16:31]
    ds_read_b64_tr_b16 v[108:109], v8 offset:4096
    ds_read_b64_tr_b16 v[110:111], v8 offset:5120
    s_waitcnt lgkmcnt(4)
    v_mfma_f32_32x32x16_bf16 v[32:47], v[100:103], v[152:155], v[32:47]
    ds_read_b64_tr_b16 v[96:97], v7 offset:8192
    ds_read_b64_tr_b16 v[98:99], v7 offset:9216
    s_waitcnt lgkmcnt(4)
    v_mfma_f32_32x32x16_bf16 v[48:63], v[152:155], v[104:107], v[48:63]
    ds_read_b64_tr_b16 v[100:101], v13 offset:8192
    ds_read_b64_tr_b16 v[102:103], v13 offset:9216
    s_waitcnt lgkmcnt(4)
    v_mfma_f32_32x32x16_bf16 v[64:79], v[152:155], v[108:111], v[64:79]
    ds_read_b64_tr_b16 v[104:105], v9 offset:8192
    ds_read_b64_tr_b16 v[106:107], v9 offset:9216
    s_waitcnt lgkmcnt(4)
    v_mfma_f32_32x32x16_bf16 v[16:31], v[96:99], v[156:159], v[16:31]
    ds_read_b64_tr_b16 v[108:109], v8 offset:8192
    ds_read_b64_tr_b16 v[110:111], v8 offset:9216
    s_waitcnt lgkmcnt(4)
    v_mfma_f32_32x32x16_bf16 v[32:47], v[100:103], v[156:159], v[32:47]
    ds_read_b64_tr_b16 v[96:97], v7 offset:12288
    ds_read_b64_tr_b16 v[98:99], v7 offset:13312
    s_waitcnt lgkmcnt(4)
    v_mfma_f32_32x32x16_bf16 v[48:63], v[156:159], v[104:107], v[48:63]
    ds_read_b64_tr_b16 v[100:101], v13 offset:12288
    ds_read_b64_tr_b16 v[102:103], v13 offset:13312
    s_waitcnt lgkmcnt(4)
    v_mfma_f32_32x32x16_bf16 v[64:79], v[156:159], v[108:111], v[64:79]
    ds_read_b64_tr_b16 v[104:105], v9 offset:12288
    ds_read_b64_tr_b16 v[106:107], v9 offset:13312
    s_waitcnt lgkmcnt(4)
    v_mfma_f32_32x32x16_bf16 v[16:31], v[96:99], v[160:163], v[16:31]
    ds_read_b64_tr_b16 v[108:109], v8 offset:12288
    ds_read_b64_tr_b16 v[110:111], v8 offset:13312
    s_waitcnt lgkmcnt(4)
    v_mfma_f32_32x32x16_bf16 v[32:47], v[100:103], v[160:163], v[32:47]
    ds_read_b64_tr_b16 v[96:97], v7 offset:16384
    ds_read_b64_tr_b16 v[98:99], v7 offset:17408
    s_waitcnt lgkmcnt(4)
    v_mfma_f32_32x32x16_bf16 v[48:63], v[160:163], v[104:107], v[48:63]
    ds_read_b64_tr_b16 v[100:101], v13 offset:16384
    ds_read_b64_tr_b16 v[102:103], v13 offset:17408
    s_waitcnt lgkmcnt(4)
    v_mfma_f32_32x32x16_bf16 v[64:79], v[160:163], v[108:111], v[64:79]
    ds_read_b64_tr_b16 v[104:105], v9 offset:16384
    ds_read_b64_tr_b16 v[106:107], v9 offset:17408
    s_waitcnt lgkmcnt(4)
    v_mfma_f32_32x32x16_bf16 v[16:31], v[96:99], v[164:167], v[16:31]
    ds_read_b64_tr_b16 v[108:109], v8 offset:16384
    ds_read_b64_tr_b16 v[110:111], v8 offset:17408
    s_waitcnt lgkmcnt(4)
    v_mfma_f32_32x32x16_bf16 v[32:47], v[100:103], v[164:167], v[32:47]
    ds_read_b64_tr_b16 v[96:97], v7 offset:20480
    ds_read_b64_tr_b16 v[98:99], v7 offset:21504
    s_waitcnt lgkmcnt(4)
    v_mfma_f32_32x32x16_bf16 v[48:63], v[164:167], v[104:107], v[48:63]
    ds_read_b64_tr_b16 v[100:101], v13 offset:20480
    ds_read_b64_tr_b16 v[102:103], v13 offset:21504
    s_waitcnt lgkmcnt(4)
    v_mfma_f32_32x32x16_bf16 v[64:79], v[164:167], v[108:111], v[64:79]
    ds_read_b64_tr_b16 v[104:105], v9 offset:20480
    ds_read_b64_tr_b16 v[106:107], v9 offset:21504
    s_waitcnt lgkmcnt(4)
    v_mfma_f32_32x32x16_bf16 v[16:31], v[96:99], v[168:171], v[16:31]
    ds_read_b64_tr_b16 v[108:109], v8 offset:20480
    ds_read_b64_tr_b16 v[110:111], v8 offset:21504
    s_waitcnt lgkmcnt(4)
    v_mfma_f32_32x32x16_bf16 v[32:47], v[100:103], v[168:171], v[32:47]
    ds_read_b64_tr_b16 v[96:97], v7 offset:24576
    ds_read_b64_tr_b16 v[98:99], v7 offset:25600
    s_waitcnt lgkmcnt(4)
    v_mfma_f32_32x32x16_bf16 v[48:63], v[168:171], v[104:107], v[48:63]
    ds_read_b64_tr_b16 v[100:101], v13 offset:24576
    ds_read_b64_tr_b16 v[102:103], v13 offset:25600
    s_waitcnt lgkmcnt(4)
    v_mfma_f32_32x32x16_bf16 v[64:79], v[168:171], v[108:111], v[64:79]
    ds_read_b64_tr_b16 v[104:105], v9 offset:24576
    ds_read_b64_tr_b16 v[106:107], v9 offset:25600
    s_waitcnt lgkmcnt(4)
    v_mfma_f32_32x32x16_bf16 v[16:31], v[96:99], v[172:175], v[16:31]
    ds_read_b64_tr_b16 v[108:109], v8 offset:24576
    ds_read_b64_tr_b16 v[110:111], v8 offset:25600
    s_waitcnt lgkmcnt(4)
    v_mfma_f32_32x32x16_bf16 v[32:47], v[100:103], v[172:175], v[32:47]
    ds_read_b64_tr_b16 v[96:97], v7 offset:28672
    ds_read_b64_tr_b16 v[98:99], v7 offset:29696
    s_waitcnt lgkmcnt(4)
    v_mfma_f32_32x32x16_bf16 v[48:63], v[172:175], v[104:107], v[48:63]
    ds_read_b64_tr_b16 v[100:101], v13 offset:28672
    ds_read_b64_tr_b16 v[102:103], v13 offset:29696
    s_waitcnt lgkmcnt(4)
    v_mfma_f32_32x32x16_bf16 v[64:79], v[172:175], v[108:111], v[64:79]
    ds_read_b64_tr_b16 v[104:105], v9 offset:28672
    ds_read_b64_tr_b16 v[106:107], v9 offset:29696
    s_waitcnt lgkmcnt(4)
    v_mfma_f32_32x32x16_bf16 v[16:31], v[96:99], v[176:179], v[16:31]
    ds_read_b64_tr_b16 v[108:109], v8 offset:28672
    ds_read_b64_tr_b16 v[110:111], v8 offset:29696
    s_waitcnt lgkmcnt(4)
    v_mfma_f32_32x32x16_bf16 v[32:47], v[100:103], v[176:179], v[32:47]
    ds_read_b64_tr_b16 v[96:97], v7 offset:32768
    ds_read_b64_tr_b16 v[98:99], v7 offset:33792
    s_waitcnt lgkmcnt(4)
    v_mfma_f32_32x32x16_bf16 v[48:63], v[176:179], v[104:107], v[48:63]
    ds_read_b64_tr_b16 v[100:101], v13 offset:32768
    ds_read_b64_tr_b16 v[102:103], v13 offset:33792
    s_waitcnt lgkmcnt(4)
    v_mfma_f32_32x32x16_bf16 v[64:79], v[176:179], v[108:111], v[64:79]
    ds_read_b64_tr_b16 v[104:105], v9 offset:32768
    ds_read_b64_tr_b16 v[106:107], v9 offset:33792
    s_waitcnt lgkmcnt(4)
    v_mfma_f32_32x32x16_bf16 v[16:31], v[96:99], v[180:183], v[16:31]
    s_barrier
    ds_read_b64_tr_b16 v[108:109], v8 offset:32768
    ds_read_b64_tr_b16 v[110:111], v8 offset:33792
    s_waitcnt lgkmcnt(4)
    v_mfma_f32_32x32x16_bf16 v[32:47], v[100:103], v[180:183], v[32:47]
    v_add_u32 v7, 0x9000, v7
    ds_read_b64_tr_b16 v[96:97], v7 offset:0
    ds_read_b64_tr_b16 v[98:99], v7 offset:1024
    s_waitcnt lgkmcnt(4)
    v_mfma_f32_32x32x16_bf16 v[48:63], v[180:183], v[104:107], v[48:63]
    v_add_u32 v13, 0x9000, v13
    ds_read_b64_tr_b16 v[100:101], v13 offset:0
    ds_read_b64_tr_b16 v[102:103], v13 offset:1024
    s_waitcnt lgkmcnt(4)
    v_mfma_f32_32x32x16_bf16 v[64:79], v[180:183], v[108:111], v[64:79]
    v_add_u32 v9, 0x9000, v9
    ds_read_b64_tr_b16 v[104:105], v9 offset:0
    ds_read_b64_tr_b16 v[106:107], v9 offset:1024
    s_waitcnt lgkmcnt(4)
    v_mfma_f32_32x32x16_bf16 v[16:31], v[96:99], v[184:187], v[16:31]
    v_add_u32 v8, 0x9000, v8
    ds_read_b64_tr_b16 v[108:109], v8 offset:0
    ds_read_b64_tr_b16 v[110:111], v8 offset:1024
    s_waitcnt lgkmcnt(4)
    v_mfma_f32_32x32x16_bf16 v[32:47], v[100:103], v[184:187], v[32:47]
    ds_read_b64_tr_b16 v[96:97], v7 offset:4096
    ds_read_b64_tr_b16 v[98:99], v7 offset:5120
    s_waitcnt lgkmcnt(4)
    v_mfma_f32_32x32x16_bf16 v[48:63], v[184:187], v[104:107], v[48:63]
    ds_read_b64_tr_b16 v[100:101], v13 offset:4096
    ds_read_b64_tr_b16 v[102:103], v13 offset:5120
    s_waitcnt lgkmcnt(4)
    v_mfma_f32_32x32x16_bf16 v[64:79], v[184:187], v[108:111], v[64:79]
    ds_read_b64_tr_b16 v[104:105], v9 offset:4096
    ds_read_b64_tr_b16 v[106:107], v9 offset:5120
    s_waitcnt lgkmcnt(4)
    v_mfma_f32_32x32x16_bf16 v[16:31], v[96:99], v[188:191], v[16:31]
    ds_read_b64_tr_b16 v[108:109], v8 offset:4096
    ds_read_b64_tr_b16 v[110:111], v8 offset:5120
    s_waitcnt lgkmcnt(4)
    v_mfma_f32_32x32x16_bf16 v[32:47], v[100:103], v[188:191], v[32:47]
    ds_read_b64_tr_b16 v[96:97], v7 offset:8192
    ds_read_b64_tr_b16 v[98:99], v7 offset:9216
    s_waitcnt lgkmcnt(4)
    v_mfma_f32_32x32x16_bf16 v[48:63], v[188:191], v[104:107], v[48:63]
    ds_read_b64_tr_b16 v[100:101], v13 offset:8192
    ds_read_b64_tr_b16 v[102:103], v13 offset:9216
    s_waitcnt lgkmcnt(4)
    v_mfma_f32_32x32x16_bf16 v[64:79], v[188:191], v[108:111], v[64:79]
    ds_read_b64_tr_b16 v[104:105], v9 offset:8192
    ds_read_b64_tr_b16 v[106:107], v9 offset:9216
    s_waitcnt lgkmcnt(4)
    v_mfma_f32_32x32x16_bf16 v[16:31], v[96:99], v[192:195], v[16:31]
    ds_read_b64_tr_b16 v[108:109], v8 offset:8192
    ds_read_b64_tr_b16 v[110:111], v8 offset:9216
    s_waitcnt lgkmcnt(4)
    v_mfma_f32_32x32x16_bf16 v[32:47], v[100:103], v[192:195], v[32:47]
    ds_read_b64_tr_b16 v[96:97], v7 offset:12288
    ds_read_b64_tr_b16 v[98:99], v7 offset:13312
    s_waitcnt lgkmcnt(4)
    v_mfma_f32_32x32x16_bf16 v[48:63], v[192:195], v[104:107], v[48:63]
    ds_read_b64_tr_b16 v[100:101], v13 offset:12288
    ds_read_b64_tr_b16 v[102:103], v13 offset:13312
    s_waitcnt lgkmcnt(4)
    v_mfma_f32_32x32x16_bf16 v[64:79], v[192:195], v[108:111], v[64:79]
    ds_read_b64_tr_b16 v[104:105], v9 offset:12288
    ds_read_b64_tr_b16 v[106:107], v9 offset:13312
    s_waitcnt lgkmcnt(4)
    v_mfma_f32_32x32x16_bf16 v[16:31], v[96:99], v[196:199], v[16:31]
    ds_read_b64_tr_b16 v[108:109], v8 offset:12288
    ds_read_b64_tr_b16 v[110:111], v8 offset:13312
    s_waitcnt lgkmcnt(4)
    v_mfma_f32_32x32x16_bf16 v[32:47], v[100:103], v[196:199], v[32:47]
    ds_read_b64_tr_b16 v[96:97], v7 offset:16384
    ds_read_b64_tr_b16 v[98:99], v7 offset:17408
    s_waitcnt lgkmcnt(4)
    v_mfma_f32_32x32x16_bf16 v[48:63], v[196:199], v[104:107], v[48:63]
    ds_read_b64_tr_b16 v[100:101], v13 offset:16384
    ds_read_b64_tr_b16 v[102:103], v13 offset:17408
    s_waitcnt lgkmcnt(4)
    v_mfma_f32_32x32x16_bf16 v[64:79], v[196:199], v[108:111], v[64:79]
    ds_read_b64_tr_b16 v[104:105], v9 offset:16384
    ds_read_b64_tr_b16 v[106:107], v9 offset:17408
    s_waitcnt lgkmcnt(4)
    v_mfma_f32_32x32x16_bf16 v[16:31], v[96:99], v[200:203], v[16:31]
    ds_read_b64_tr_b16 v[108:109], v8 offset:16384
    ds_read_b64_tr_b16 v[110:111], v8 offset:17408
    s_waitcnt lgkmcnt(4)
    v_mfma_f32_32x32x16_bf16 v[32:47], v[100:103], v[200:203], v[32:47]
    ds_read_b64_tr_b16 v[96:97], v7 offset:20480
    ds_read_b64_tr_b16 v[98:99], v7 offset:21504
    s_waitcnt lgkmcnt(4)
    v_mfma_f32_32x32x16_bf16 v[48:63], v[200:203], v[104:107], v[48:63]
    ds_read_b64_tr_b16 v[100:101], v13 offset:20480
    ds_read_b64_tr_b16 v[102:103], v13 offset:21504
    s_waitcnt lgkmcnt(4)
    v_mfma_f32_32x32x16_bf16 v[64:79], v[200:203], v[108:111], v[64:79]
    ds_read_b64_tr_b16 v[104:105], v9 offset:20480
    ds_read_b64_tr_b16 v[106:107], v9 offset:21504
    s_waitcnt lgkmcnt(4)
    v_mfma_f32_32x32x16_bf16 v[16:31], v[96:99], v[204:207], v[16:31]
    ds_read_b64_tr_b16 v[108:109], v8 offset:20480
    ds_read_b64_tr_b16 v[110:111], v8 offset:21504
    s_waitcnt lgkmcnt(4)
    v_mfma_f32_32x32x16_bf16 v[32:47], v[100:103], v[204:207], v[32:47]
    ds_read_b64_tr_b16 v[96:97], v7 offset:24576
    ds_read_b64_tr_b16 v[98:99], v7 offset:25600
    s_waitcnt lgkmcnt(4)
    v_mfma_f32_32x32x16_bf16 v[48:63], v[204:207], v[104:107], v[48:63]
    ds_read_b64_tr_b16 v[100:101], v13 offset:24576
    ds_read_b64_tr_b16 v[102:103], v13 offset:25600
    s_waitcnt lgkmcnt(4)
    v_mfma_f32_32x32x16_bf16 v[64:79], v[204:207], v[108:111], v[64:79]
    ds_read_b64_tr_b16 v[104:105], v9 offset:24576
    ds_read_b64_tr_b16 v[106:107], v9 offset:25600
    s_waitcnt lgkmcnt(4)
    v_mfma_f32_32x32x16_bf16 v[16:31], v[96:99], v[208:211], v[16:31]
    ds_read_b64_tr_b16 v[108:109], v8 offset:24576
    ds_read_b64_tr_b16 v[110:111], v8 offset:25600
    s_waitcnt lgkmcnt(4)
    v_mfma_f32_32x32x16_bf16 v[32:47], v[100:103], v[208:211], v[32:47]
    ds_read_b64_tr_b16 v[96:97], v7 offset:28672
    ds_read_b64_tr_b16 v[98:99], v7 offset:29696
    s_waitcnt lgkmcnt(4)
    v_mfma_f32_32x32x16_bf16 v[48:63], v[208:211], v[104:107], v[48:63]
    ds_read_b64_tr_b16 v[100:101], v13 offset:28672
    ds_read_b64_tr_b16 v[102:103], v13 offset:29696
    s_waitcnt lgkmcnt(4)
    v_mfma_f32_32x32x16_bf16 v[64:79], v[208:211], v[108:111], v[64:79]
    ds_read_b64_tr_b16 v[104:105], v9 offset:28672
    ds_read_b64_tr_b16 v[106:107], v9 offset:29696
    s_waitcnt lgkmcnt(4)
    v_mfma_f32_32x32x16_bf16 v[16:31], v[96:99], v[212:215], v[16:31]
    ds_read_b64_tr_b16 v[108:109], v8 offset:28672
    ds_read_b64_tr_b16 v[110:111], v8 offset:29696
    s_waitcnt lgkmcnt(4)
    v_mfma_f32_32x32x16_bf16 v[32:47], v[100:103], v[212:215], v[32:47]
    ds_read_b64_tr_b16 v[96:97], v7 offset:32768
    ds_read_b64_tr_b16 v[98:99], v7 offset:33792
    s_waitcnt lgkmcnt(4)
    v_mfma_f32_32x32x16_bf16 v[48:63], v[212:215], v[104:107], v[48:63]
    ds_read_b64_tr_b16 v[100:101], v13 offset:32768
    ds_read_b64_tr_b16 v[102:103], v13 offset:33792
    s_waitcnt lgkmcnt(4)
    v_mfma_f32_32x32x16_bf16 v[64:79], v[212:215], v[108:111], v[64:79]
    ds_read_b64_tr_b16 v[104:105], v9 offset:32768
    ds_read_b64_tr_b16 v[106:107], v9 offset:33792
    s_waitcnt lgkmcnt(4)
    v_mfma_f32_32x32x16_bf16 v[16:31], v[96:99], v[216:219], v[16:31]
    s_barrier
    ds_read_b64_tr_b16 v[108:109], v8 offset:32768
    ds_read_b64_tr_b16 v[110:111], v8 offset:33792
    s_waitcnt lgkmcnt(4)
    v_mfma_f32_32x32x16_bf16 v[32:47], v[100:103], v[216:219], v[32:47]
    v_add_u32 v7, 0x9000, v7
    ds_read_b64_tr_b16 v[96:97], v7 offset:0
    ds_read_b64_tr_b16 v[98:99], v7 offset:1024
    s_waitcnt lgkmcnt(4)
    v_mfma_f32_32x32x16_bf16 v[48:63], v[216:219], v[104:107], v[48:63]
    v_add_u32 v13, 0x9000, v13
    ds_read_b64_tr_b16 v[100:101], v13 offset:0
    ds_read_b64_tr_b16 v[102:103], v13 offset:1024
    s_waitcnt lgkmcnt(4)
    v_mfma_f32_32x32x16_bf16 v[64:79], v[216:219], v[108:111], v[64:79]
    v_add_u32 v9, 0x9000, v9
    ds_read_b64_tr_b16 v[104:105], v9 offset:0
    ds_read_b64_tr_b16 v[106:107], v9 offset:1024
    s_waitcnt lgkmcnt(4)
    v_mfma_f32_32x32x16_bf16 v[16:31], v[96:99], v[220:223], v[16:31]
    v_add_u32 v8, 0x9000, v8
    ds_read_b64_tr_b16 v[108:109], v8 offset:0
    ds_read_b64_tr_b16 v[110:111], v8 offset:1024
    s_waitcnt lgkmcnt(4)
    v_mfma_f32_32x32x16_bf16 v[32:47], v[100:103], v[220:223], v[32:47]
    ds_read_b64_tr_b16 v[96:97], v7 offset:4096
    ds_read_b64_tr_b16 v[98:99], v7 offset:5120
    s_waitcnt lgkmcnt(4)
    v_mfma_f32_32x32x16_bf16 v[48:63], v[220:223], v[104:107], v[48:63]
    ds_read_b64_tr_b16 v[100:101], v13 offset:4096
    ds_read_b64_tr_b16 v[102:103], v13 offset:5120
    s_waitcnt lgkmcnt(4)
    v_mfma_f32_32x32x16_bf16 v[64:79], v[220:223], v[108:111], v[64:79]
    ds_read_b64_tr_b16 v[104:105], v9 offset:4096
    ds_read_b64_tr_b16 v[106:107], v9 offset:5120
    s_waitcnt lgkmcnt(4)
    v_mfma_f32_32x32x16_bf16 v[16:31], v[96:99], v[224:227], v[16:31]
    ds_read_b64_tr_b16 v[108:109], v8 offset:4096
    ds_read_b64_tr_b16 v[110:111], v8 offset:5120
    s_waitcnt lgkmcnt(4)
    v_mfma_f32_32x32x16_bf16 v[32:47], v[100:103], v[224:227], v[32:47]
    ds_read_b64_tr_b16 v[96:97], v7 offset:8192
    ds_read_b64_tr_b16 v[98:99], v7 offset:9216
    s_waitcnt lgkmcnt(4)
    v_mfma_f32_32x32x16_bf16 v[48:63], v[224:227], v[104:107], v[48:63]
    ds_read_b64_tr_b16 v[100:101], v13 offset:8192
    ds_read_b64_tr_b16 v[102:103], v13 offset:9216
    s_waitcnt lgkmcnt(4)
    v_mfma_f32_32x32x16_bf16 v[64:79], v[224:227], v[108:111], v[64:79]
    ds_read_b64_tr_b16 v[104:105], v9 offset:8192
    ds_read_b64_tr_b16 v[106:107], v9 offset:9216
    s_waitcnt lgkmcnt(4)
    v_mfma_f32_32x32x16_bf16 v[16:31], v[96:99], v[228:231], v[16:31]
    ds_read_b64_tr_b16 v[108:109], v8 offset:8192
    ds_read_b64_tr_b16 v[110:111], v8 offset:9216
    s_waitcnt lgkmcnt(4)
    v_mfma_f32_32x32x16_bf16 v[32:47], v[100:103], v[228:231], v[32:47]
    ds_read_b64_tr_b16 v[96:97], v7 offset:12288
    ds_read_b64_tr_b16 v[98:99], v7 offset:13312
    s_waitcnt lgkmcnt(4)
    v_mfma_f32_32x32x16_bf16 v[48:63], v[228:231], v[104:107], v[48:63]
    ds_read_b64_tr_b16 v[100:101], v13 offset:12288
    ds_read_b64_tr_b16 v[102:103], v13 offset:13312
    s_waitcnt lgkmcnt(4)
    v_mfma_f32_32x32x16_bf16 v[64:79], v[228:231], v[108:111], v[64:79]
    ds_read_b64_tr_b16 v[104:105], v9 offset:12288
    ds_read_b64_tr_b16 v[106:107], v9 offset:13312
    s_waitcnt lgkmcnt(4)
    v_mfma_f32_32x32x16_bf16 v[16:31], v[96:99], v[232:235], v[16:31]
    ds_read_b64_tr_b16 v[108:109], v8 offset:12288
    ds_read_b64_tr_b16 v[110:111], v8 offset:13312
    s_waitcnt lgkmcnt(4)
    v_mfma_f32_32x32x16_bf16 v[32:47], v[100:103], v[232:235], v[32:47]
    ds_read_b64_tr_b16 v[96:97], v7 offset:16384
    ds_read_b64_tr_b16 v[98:99], v7 offset:17408
    s_waitcnt lgkmcnt(4)
    v_mfma_f32_32x32x16_bf16 v[48:63], v[232:235], v[104:107], v[48:63]
    ds_read_b64_tr_b16 v[100:101], v13 offset:16384
    ds_read_b64_tr_b16 v[102:103], v13 offset:17408
    s_waitcnt lgkmcnt(4)
    v_mfma_f32_32x32x16_bf16 v[64:79], v[232:235], v[108:111], v[64:79]
    ds_read_b64_tr_b16 v[104:105], v9 offset:16384
    ds_read_b64_tr_b16 v[106:107], v9 offset:17408
    s_waitcnt lgkmcnt(4)
    v_mfma_f32_32x32x16_bf16 v[16:31], v[96:99], v[236:239], v[16:31]
    ds_read_b64_tr_b16 v[108:109], v8 offset:16384
    ds_read_b64_tr_b16 v[110:111], v8 offset:17408
    s_waitcnt lgkmcnt(4)
    v_mfma_f32_32x32x16_bf16 v[32:47], v[100:103], v[236:239], v[32:47]
    ds_read_b64_tr_b16 v[96:97], v7 offset:20480
    ds_read_b64_tr_b16 v[98:99], v7 offset:21504
    s_waitcnt lgkmcnt(4)
    v_mfma_f32_32x32x16_bf16 v[48:63], v[236:239], v[104:107], v[48:63]
    ds_read_b64_tr_b16 v[100:101], v13 offset:20480
    ds_read_b64_tr_b16 v[102:103], v13 offset:21504
    s_waitcnt lgkmcnt(4)
    v_mfma_f32_32x32x16_bf16 v[64:79], v[236:239], v[108:111], v[64:79]
    ds_read_b64_tr_b16 v[104:105], v9 offset:20480
    ds_read_b64_tr_b16 v[106:107], v9 offset:21504
    s_waitcnt lgkmcnt(4)
    v_mfma_f32_32x32x16_bf16 v[16:31], v[96:99], v[240:243], v[16:31]
    ds_read_b64_tr_b16 v[108:109], v8 offset:20480
    ds_read_b64_tr_b16 v[110:111], v8 offset:21504
    s_waitcnt lgkmcnt(4)
    v_mfma_f32_32x32x16_bf16 v[32:47], v[100:103], v[240:243], v[32:47]
    ds_read_b64_tr_b16 v[96:97], v7 offset:24576
    ds_read_b64_tr_b16 v[98:99], v7 offset:25600
    s_waitcnt lgkmcnt(4)
    v_mfma_f32_32x32x16_bf16 v[48:63], v[240:243], v[104:107], v[48:63]
    ds_read_b64_tr_b16 v[100:101], v13 offset:24576
    ds_read_b64_tr_b16 v[102:103], v13 offset:25600
    s_waitcnt lgkmcnt(4)
    v_mfma_f32_32x32x16_bf16 v[64:79], v[240:243], v[108:111], v[64:79]
    ds_read_b64_tr_b16 v[104:105], v9 offset:24576
    ds_read_b64_tr_b16 v[106:107], v9 offset:25600
    s_waitcnt lgkmcnt(4)
    v_mfma_f32_32x32x16_bf16 v[16:31], v[96:99], v[244:247], v[16:31]
    ds_read_b64_tr_b16 v[108:109], v8 offset:24576
    ds_read_b64_tr_b16 v[110:111], v8 offset:25600
    s_waitcnt lgkmcnt(4)
    v_mfma_f32_32x32x16_bf16 v[32:47], v[100:103], v[244:247], v[32:47]
    ds_read_b64_tr_b16 v[96:97], v7 offset:28672
    ds_read_b64_tr_b16 v[98:99], v7 offset:29696
    s_waitcnt lgkmcnt(4)
    v_mfma_f32_32x32x16_bf16 v[48:63], v[244:247], v[104:107], v[48:63]
    ds_read_b64_tr_b16 v[100:101], v13 offset:28672
    ds_read_b64_tr_b16 v[102:103], v13 offset:29696
    s_waitcnt lgkmcnt(4)
    v_mfma_f32_32x32x16_bf16 v[64:79], v[244:247], v[108:111], v[64:79]
    ds_read_b64_tr_b16 v[104:105], v9 offset:28672
    ds_read_b64_tr_b16 v[106:107], v9 offset:29696
    s_waitcnt lgkmcnt(4)
    v_mfma_f32_32x32x16_bf16 v[16:31], v[96:99], v[248:251], v[16:31]
    ds_read_b64_tr_b16 v[108:109], v8 offset:28672
    ds_read_b64_tr_b16 v[110:111], v8 offset:29696
    s_waitcnt lgkmcnt(4)
    v_mfma_f32_32x32x16_bf16 v[32:47], v[100:103], v[248:251], v[32:47]
    ds_read_b64_tr_b16 v[96:97], v7 offset:32768
    ds_read_b64_tr_b16 v[98:99], v7 offset:33792
    s_waitcnt lgkmcnt(4)
    v_mfma_f32_32x32x16_bf16 v[48:63], v[248:251], v[104:107], v[48:63]
    ds_read_b64_tr_b16 v[100:101], v13 offset:32768
    ds_read_b64_tr_b16 v[102:103], v13 offset:33792
    s_waitcnt lgkmcnt(4)
    v_mfma_f32_32x32x16_bf16 v[64:79], v[248:251], v[108:111], v[64:79]
    ds_read_b64_tr_b16 v[104:105], v9 offset:32768
    ds_read_b64_tr_b16 v[106:107], v9 offset:33792
    s_waitcnt lgkmcnt(4)
    v_mfma_f32_32x32x16_bf16 v[16:31], v[96:99], v[252:255], v[16:31]
    s_barrier
    ds_read_b64_tr_b16 v[108:109], v8 offset:32768
    ds_read_b64_tr_b16 v[110:111], v8 offset:33792
    s_waitcnt lgkmcnt(4)
    v_mfma_f32_32x32x16_bf16 v[32:47], v[100:103], v[252:255], v[32:47]
    v_add_u32 v10, 0x4000, v10
    ds_read_b64_tr_b16 v[96:97], v10 offset:0
    ds_read_b64_tr_b16 v[98:99], v10 offset:256
    s_waitcnt lgkmcnt(4)
    v_mfma_f32_32x32x16_bf16 v[48:63], v[252:255], v[104:107], v[48:63]
    ds_read_b64_tr_b16 v[100:101], v10 offset:1024
    ds_read_b64_tr_b16 v[102:103], v10 offset:1280
    s_waitcnt lgkmcnt(4)
    v_mfma_f32_32x32x16_bf16 v[64:79], v[252:255], v[108:111], v[64:79]
    ds_read_b64_tr_b16 v[104:105], v10 offset:2048
    ds_read_b64_tr_b16 v[106:107], v10 offset:2304
    s_waitcnt lgkmcnt(4)
    v_mfma_f32_32x32x16_bf16 v[80:95], v[96:99], v[112:115], 0
    ds_read_b64_tr_b16 v[108:109], v10 offset:3072
    ds_read_b64_tr_b16 v[110:111], v10 offset:3328
    s_waitcnt lgkmcnt(4)
    v_mfma_f32_32x32x16_bf16 v[80:95], v[100:103], v[116:119], v[80:95]
    ds_read_b64_tr_b16 v[96:97], v10 offset:4096
    ds_read_b64_tr_b16 v[98:99], v10 offset:4352
    s_waitcnt lgkmcnt(4)
    v_mfma_f32_32x32x16_bf16 v[80:95], v[104:107], v[120:123], v[80:95]
    ds_read_b64_tr_b16 v[100:101], v10 offset:5120
    ds_read_b64_tr_b16 v[102:103], v10 offset:5376
    s_waitcnt lgkmcnt(4)
    v_mfma_f32_32x32x16_bf16 v[80:95], v[108:111], v[124:127], v[80:95]
    ds_read_b64_tr_b16 v[104:105], v10 offset:6144
    ds_read_b64_tr_b16 v[106:107], v10 offset:6400
    s_waitcnt lgkmcnt(4)
    v_mfma_f32_32x32x16_bf16 v[80:95], v[96:99], v[128:131], v[80:95]
    ds_read_b64_tr_b16 v[108:109], v10 offset:7168
    ds_read_b64_tr_b16 v[110:111], v10 offset:7424
    s_waitcnt lgkmcnt(4)
    v_mfma_f32_32x32x16_bf16 v[80:95], v[100:103], v[132:135], v[80:95]
    ds_read_b64_tr_b16 v[96:97], v10 offset:8192
    ds_read_b64_tr_b16 v[98:99], v10 offset:8448
    s_waitcnt lgkmcnt(4)
    v_mfma_f32_32x32x16_bf16 v[80:95], v[104:107], v[136:139], v[80:95]
    ds_read_b64_tr_b16 v[100:101], v10 offset:9216
    ds_read_b64_tr_b16 v[102:103], v10 offset:9472
    v_mul_f32 v16, s63, v16
    v_mul_f32 v17, s63, v17
    v_mul_f32 v18, s63, v18
    v_mul_f32 v19, s63, v19
    s_waitcnt lgkmcnt(4)
    v_mfma_f32_32x32x16_bf16 v[80:95], v[108:111], v[140:143], v[80:95]
    ds_read_b64_tr_b16 v[104:105], v10 offset:10240
    ds_read_b64_tr_b16 v[106:107], v10 offset:10496
    v_mul_f32 v20, s63, v20
    v_mul_f32 v21, s63, v21
    v_mul_f32 v22, s63, v22
    v_mul_f32 v23, s63, v23
    s_waitcnt lgkmcnt(4)
    v_mfma_f32_32x32x16_bf16 v[80:95], v[96:99], v[144:147], v[80:95]
    ds_read_b64_tr_b16 v[108:109], v10 offset:11264
    ds_read_b64_tr_b16 v[110:111], v10 offset:11520
    v_mul_f32 v24, s63, v24
    v_mul_f32 v25, s63, v25
    v_mul_f32 v26, s63, v26
    v_mul_f32 v27, s63, v27
    s_waitcnt lgkmcnt(4)
    v_mfma_f32_32x32x16_bf16 v[80:95], v[100:103], v[148:151], v[80:95]
    ds_read_b64_tr_b16 v[96:97], v10 offset:12288
    ds_read_b64_tr_b16 v[98:99], v10 offset:12544
    v_mul_f32 v28, s63, v28
    v_mul_f32 v29, s63, v29
    v_mul_f32 v30, s63, v30
    v_mul_f32 v31, s63, v31
    s_waitcnt lgkmcnt(4)
    v_mfma_f32_32x32x16_bf16 v[80:95], v[104:107], v[152:155], v[80:95]
    ds_read_b64_tr_b16 v[100:101], v10 offset:13312
    ds_read_b64_tr_b16 v[102:103], v10 offset:13568
    v_cvt_pk_bf16_f32 v16, v16, v17
    v_cvt_pk_bf16_f32 v17, v18, v19
    v_cvt_pk_bf16_f32 v18, v20, v21
    v_cvt_pk_bf16_f32 v19, v22, v23
    s_waitcnt lgkmcnt(4)
    v_mfma_f32_32x32x16_bf16 v[80:95], v[108:111], v[156:159], v[80:95]
    ds_read_b64_tr_b16 v[104:105], v10 offset:14336
    ds_read_b64_tr_b16 v[106:107], v10 offset:14592
    s_mov_b32 s29, s45
    buffer_store_dwordx4 v[16:19], v1, s[12:15], s29 offen sc1
    v_cvt_pk_bf16_f32 v20, v24, v25
    v_cvt_pk_bf16_f32 v21, v26, v27
    v_cvt_pk_bf16_f32 v22, v28, v29
    s_waitcnt lgkmcnt(4)
    v_mfma_f32_32x32x16_bf16 v[80:95], v[96:99], v[160:163], v[80:95]
    ds_read_b64_tr_b16 v[108:109], v10 offset:15360
    ds_read_b64_tr_b16 v[110:111], v10 offset:15616
    v_cvt_pk_bf16_f32 v23, v30, v31
    s_add_u32 s29, s45, s60
    buffer_store_dwordx4 v[20:23], v1, s[12:15], s29 offen sc1
    v_mul_f32 v32, s64, v32
    v_mul_f32 v33, s64, v33
    s_waitcnt lgkmcnt(4)
    v_mfma_f32_32x32x16_bf16 v[80:95], v[100:103], v[164:167], v[80:95]
    ds_read_b64_tr_b16 v[96:97], v10 offset:16384
    ds_read_b64_tr_b16 v[98:99], v10 offset:16640
    v_mul_f32 v34, s64, v34
    v_mul_f32 v35, s64, v35
    v_mul_f32 v36, s64, v36
    v_mul_f32 v37, s64, v37
    s_waitcnt lgkmcnt(4)
    v_mfma_f32_32x32x16_bf16 v[80:95], v[104:107], v[168:171], v[80:95]
    ds_read_b64_tr_b16 v[100:101], v10 offset:17408
    ds_read_b64_tr_b16 v[102:103], v10 offset:17664
    v_mul_f32 v38, s64, v38
    v_mul_f32 v39, s64, v39
    v_mul_f32 v40, s64, v40
    v_mul_f32 v41, s64, v41
    s_waitcnt lgkmcnt(4)
    v_mfma_f32_32x32x16_bf16 v[80:95], v[108:111], v[172:175], v[80:95]
    ds_read_b64_tr_b16 v[104:105], v10 offset:18432
    ds_read_b64_tr_b16 v[106:107], v10 offset:18688
    v_mul_f32 v42, s64, v42
    v_mul_f32 v43, s64, v43
    v_mul_f32 v44, s64, v44
    v_mul_f32 v45, s64, v45
    s_waitcnt lgkmcnt(4)
    v_mfma_f32_32x32x16_bf16 v[80:95], v[96:99], v[176:179], v[80:95]
    ds_read_b64_tr_b16 v[108:109], v10 offset:19456
    ds_read_b64_tr_b16 v[110:111], v10 offset:19712
    v_mul_f32 v46, s64, v46
    v_mul_f32 v47, s64, v47
    v_cvt_pk_bf16_f32 v32, v32, v33
    v_cvt_pk_bf16_f32 v33, v34, v35
    s_waitcnt lgkmcnt(4)
    v_mfma_f32_32x32x16_bf16 v[80:95], v[100:103], v[180:183], v[80:95]
    ds_read_b64_tr_b16 v[96:97], v10 offset:20480
    ds_read_b64_tr_b16 v[98:99], v10 offset:20736
    v_cvt_pk_bf16_f32 v34, v36, v37
    v_cvt_pk_bf16_f32 v35, v38, v39
    s_mov_b32 s29, s46
    buffer_store_dwordx4 v[32:35], v1, s[12:15], s29 offen sc1
    v_cvt_pk_bf16_f32 v36, v40, v41
    s_waitcnt lgkmcnt(4)
    v_mfma_f32_32x32x16_bf16 v[80:95], v[104:107], v[184:187], v[80:95]
    ds_read_b64_tr_b16 v[100:101], v10 offset:21504
    ds_read_b64_tr_b16 v[102:103], v10 offset:21760
    v_cvt_pk_bf16_f32 v37, v42, v43
    v_cvt_pk_bf16_f32 v38, v44, v45
    v_cvt_pk_bf16_f32 v39, v46, v47
    s_add_u32 s29, s46, s61
    buffer_store_dwordx4 v[36:39], v1, s[12:15], s29 offen sc1
    s_waitcnt lgkmcnt(4)
    v_mfma_f32_32x32x16_bf16 v[80:95], v[108:111], v[188:191], v[80:95]
    ds_read_b64_tr_b16 v[104:105], v10 offset:22528
    ds_read_b64_tr_b16 v[106:107], v10 offset:22784
    v_cvt_pk_bf16_f32 v48, v48, v49
    v_cvt_pk_bf16_f32 v49, v50, v51
    v_cvt_pk_bf16_f32 v50, v52, v53
    v_cvt_pk_bf16_f32 v51, v54, v55
    s_waitcnt lgkmcnt(4)
    v_mfma_f32_32x32x16_bf16 v[80:95], v[96:99], v[192:195], v[80:95]
    ds_read_b64_tr_b16 v[108:109], v10 offset:23552
    ds_read_b64_tr_b16 v[110:111], v10 offset:23808
    buffer_store_dwordx4 v[48:51], v2, s[12:15], s48 offen offset:0 sc1
    v_cvt_pk_bf16_f32 v52, v56, v57
    v_cvt_pk_bf16_f32 v53, v58, v59
    v_cvt_pk_bf16_f32 v54, v60, v61
    s_waitcnt lgkmcnt(4)
    v_mfma_f32_32x32x16_bf16 v[80:95], v[100:103], v[196:199], v[80:95]
    ds_read_b64_tr_b16 v[96:97], v10 offset:24576
    ds_read_b64_tr_b16 v[98:99], v10 offset:24832
    v_cvt_pk_bf16_f32 v55, v62, v63
    buffer_store_dwordx4 v[52:55], v2, s[12:15], s48 offen offset:640 sc1
    v_mov_b32_dpp v40, v64 quad_perm:[1,0,3,2] row_mask:0xf bank_mask:0xf
    v_mov_b32_dpp v41, v65 quad_perm:[1,0,3,2] row_mask:0xf bank_mask:0xf
    s_waitcnt lgkmcnt(4)
    v_mfma_f32_32x32x16_bf16 v[80:95], v[104:107], v[200:203], v[80:95]
    ds_read_b64_tr_b16 v[100:101], v10 offset:25600
    ds_read_b64_tr_b16 v[102:103], v10 offset:25856
    v_mov_b32_dpp v42, v66 quad_perm:[1,0,3,2] row_mask:0xf bank_mask:0xf
    v_mov_b32_dpp v43, v67 quad_perm:[1,0,3,2] row_mask:0xf bank_mask:0xf
    v_mov_b32_dpp v44, v68 quad_perm:[1,0,3,2] row_mask:0xf bank_mask:0xf
    v_mov_b32_dpp v45, v69 quad_perm:[1,0,3,2] row_mask:0xf bank_mask:0xf
    s_waitcnt lgkmcnt(4)
    v_mfma_f32_32x32x16_bf16 v[80:95], v[108:111], v[204:207], v[80:95]
    ds_read_b64_tr_b16 v[104:105], v10 offset:26624
    ds_read_b64_tr_b16 v[106:107], v10 offset:26880
    v_mov_b32_dpp v46, v70 quad_perm:[1,0,3,2] row_mask:0xf bank_mask:0xf
    v_mov_b32_dpp v47, v71 quad_perm:[1,0,3,2] row_mask:0xf bank_mask:0xf
    v_cvt_pk_bf16_f32 v24, v64, v65
    v_cvt_pk_bf16_f32 v25, v66, v67
    s_waitcnt lgkmcnt(4)
    v_mfma_f32_32x32x16_bf16 v[80:95], v[96:99], v[208:211], v[80:95]
    ds_read_b64_tr_b16 v[108:109], v10 offset:27648
    ds_read_b64_tr_b16 v[110:111], v10 offset:27904
    v_cvt_pk_bf16_f32 v26, v68, v69
    v_cvt_pk_bf16_f32 v27, v70, v71
    v_cvt_pk_bf16_f32 v64, v64, v40
    v_cvt_pk_bf16_f32 v65, v65, v41
    s_waitcnt lgkmcnt(4)
    v_mfma_f32_32x32x16_bf16 v[80:95], v[100:103], v[212:215], v[80:95]
    ds_read_b64_tr_b16 v[96:97], v10 offset:28672
    ds_read_b64_tr_b16 v[98:99], v10 offset:28928
    v_cvt_pk_bf16_f32 v66, v66, v42
    v_cvt_pk_bf16_f32 v67, v67, v43
    v_cvt_pk_bf16_f32 v68, v68, v44
    v_cvt_pk_bf16_f32 v69, v69, v45
    s_waitcnt lgkmcnt(4)
    v_mfma_f32_32x32x16_bf16 v[80:95], v[104:107], v[216:219], v[80:95]
    ds_read_b64_tr_b16 v[100:101], v10 offset:29696
    ds_read_b64_tr_b16 v[102:103], v10 offset:29952
    v_cvt_pk_bf16_f32 v70, v70, v46
    v_cvt_pk_bf16_f32 v71, v71, v47
    v_cndmask_b32 v24, v24, v6, s[50:51]
    v_cndmask_b32 v25, v25, v6, s[50:51]
    s_waitcnt lgkmcnt(4)
    v_mfma_f32_32x32x16_bf16 v[80:95], v[108:111], v[220:223], v[80:95]
    ds_read_b64_tr_b16 v[104:105], v10 offset:30720
    ds_read_b64_tr_b16 v[106:107], v10 offset:30976
    v_cndmask_b32 v26, v26, v6, s[50:51]
    v_cndmask_b32 v27, v27, v6, s[50:51]
    s_mov_b64 exec, s[52:53]
    buffer_store_dwordx4 v[24:27], v3, s[12:15], s48 offen offset:0 sc1
    s_mov_b64 exec, -1
    s_mov_b64 exec, s[54:55]
    buffer_store_dwordx4 v[64:67], v4, s[12:15], 0 offen offset:0 sc1
    s_mov_b64 exec, -1
    s_waitcnt lgkmcnt(4)
    v_mfma_f32_32x32x16_bf16 v[80:95], v[96:99], v[224:227], v[80:95]
    ds_read_b64_tr_b16 v[108:109], v10 offset:31744
    ds_read_b64_tr_b16 v[110:111], v10 offset:32000
    s_mov_b64 exec, s[54:55]
    buffer_store_dwordx4 v[68:71], v4, s[12:15], 0 offen offset:32 sc1
    s_mov_b64 exec, -1
    v_mov_b32_dpp v40, v72 quad_perm:[1,0,3,2] row_mask:0xf bank_mask:0xf
    v_mov_b32_dpp v41, v73 quad_perm:[1,0,3,2] row_mask:0xf bank_mask:0xf
    v_mov_b32_dpp v42, v74 quad_perm:[1,0,3,2] row_mask:0xf bank_mask:0xf
    s_waitcnt lgkmcnt(4)
    v_mfma_f32_32x32x16_bf16 v[80:95], v[100:103], v[228:231], v[80:95]
    ds_read_b64_tr_b16 v[96:97], v10 offset:32768
    ds_read_b64_tr_b16 v[98:99], v10 offset:33024
    v_mov_b32_dpp v43, v75 quad_perm:[1,0,3,2] row_mask:0xf bank_mask:0xf
    v_mov_b32_dpp v44, v76 quad_perm:[1,0,3,2] row_mask:0xf bank_mask:0xf
    v_mov_b32_dpp v45, v77 quad_perm:[1,0,3,2] row_mask:0xf bank_mask:0xf
    v_mov_b32_dpp v46, v78 quad_perm:[1,0,3,2] row_mask:0xf bank_mask:0xf
    s_waitcnt lgkmcnt(4)
    v_mfma_f32_32x32x16_bf16 v[80:95], v[104:107], v[232:235], v[80:95]
    ds_read_b64_tr_b16 v[100:101], v10 offset:33792
    ds_read_b64_tr_b16 v[102:103], v10 offset:34048
    v_mov_b32_dpp v47, v79 quad_perm:[1,0,3,2] row_mask:0xf bank_mask:0xf
    v_cvt_pk_bf16_f32 v28, v72, v73
    v_cvt_pk_bf16_f32 v29, v74, v75
    v_cvt_pk_bf16_f32 v30, v76, v77
    s_waitcnt lgkmcnt(4)
    v_mfma_f32_32x32x16_bf16 v[80:95], v[108:111], v[236:239], v[80:95]
    ds_read_b64_tr_b16 v[104:105], v10 offset:34816
    ds_read_b64_tr_b16 v[106:107], v10 offset:35072
    v_cvt_pk_bf16_f32 v31, v78, v79
    v_cvt_pk_bf16_f32 v72, v72, v40
    v_cvt_pk_bf16_f32 v73, v73, v41
    v_cvt_pk_bf16_f32 v74, v74, v42
    s_waitcnt lgkmcnt(4)
    v_mfma_f32_32x32x16_bf16 v[80:95], v[96:99], v[240:243], v[80:95]
    s_barrier
    ds_read_b64_tr_b16 v[108:109], v10 offset:35840
    ds_read_b64_tr_b16 v[110:111], v10 offset:36096
    v_cvt_pk_bf16_f32 v75, v75, v43
    v_cvt_pk_bf16_f32 v76, v76, v44
    v_cvt_pk_bf16_f32 v77, v77, v45
    s_waitcnt lgkmcnt(4)
    v_mfma_f32_32x32x16_bf16 v[80:95], v[100:103], v[244:247], v[80:95]
    v_add_u32 v11, 0xd000, v11
    ds_read_b64_tr_b16 v[96:97], v11 offset:0
    ds_read_b64_tr_b16 v[98:99], v11 offset:512
    v_cvt_pk_bf16_f32 v78, v78, v46
    v_cvt_pk_bf16_f32 v79, v79, v47
    v_cndmask_b32 v28, v28, v6, s[50:51]
    s_waitcnt lgkmcnt(4)
    v_mfma_f32_32x32x16_bf16 v[80:95], v[104:107], v[248:251], v[80:95]
    v_add_u32 v12, 0xd000, v12
    ds_read_b64_tr_b16 v[100:101], v12 offset:0
    ds_read_b64_tr_b16 v[102:103], v12 offset:512
    v_cndmask_b32 v29, v29, v6, s[50:51]
    v_cndmask_b32 v30, v30, v6, s[50:51]
    v_cndmask_b32 v31, v31, v6, s[50:51]
    s_waitcnt lgkmcnt(4)
    v_mfma_f32_32x32x16_bf16 v[80:95], v[108:111], v[252:255], v[80:95]
    ds_read_b64_tr_b16 v[104:105], v11 offset:2048
    ds_read_b64_tr_b16 v[106:107], v11 offset:2560
    s_mov_b64 exec, s[52:53]
    buffer_store_dwordx4 v[28:31], v3, s[12:15], s48 offen offset:640 sc1
    s_mov_b64 exec, -1
    s_mov_b64 exec, s[54:55]
    buffer_store_dwordx4 v[72:75], v4, s[12:15], 0 offen offset:64 sc1
    s_mov_b64 exec, -1
    s_mov_b64 exec, s[54:55]
    buffer_store_dwordx4 v[76:79], v4, s[12:15], 0 offen offset:96 sc1
    s_mov_b64 exec, -1
    s_branch parallel_sum__softmax_full_mha__dense_activation_relu__prompt_kernel_qE
parallel_sum__softmax_full_mha__dense_activation_relu__prompt_kernel_qC:
    s_waitcnt lgkmcnt(4)
    v_mfma_f32_32x32x16_bf16 v[16:31], v[112:115], v[96:99], 0
    v_add_u32 v8, 0x4000, v8
    ds_read_b64_tr_b16 v[108:109], v8 offset:0
    ds_read_b64_tr_b16 v[110:111], v8 offset:1024
    s_waitcnt lgkmcnt(4)
    v_mfma_f32_32x32x16_bf16 v[32:47], v[112:115], v[100:103], 0
    ds_read_b64_tr_b16 v[96:97], v7 offset:4096
    ds_read_b64_tr_b16 v[98:99], v7 offset:5120
    s_waitcnt lgkmcnt(4)
    v_mfma_f32_32x32x16_bf16 v[48:63], v[112:115], v[104:107], 0
    ds_read_b64_tr_b16 v[100:101], v13 offset:4096
    ds_read_b64_tr_b16 v[102:103], v13 offset:5120
    s_waitcnt lgkmcnt(4)
    v_mfma_f32_32x32x16_bf16 v[64:79], v[112:115], v[108:111], 0
    ds_read_b64_tr_b16 v[104:105], v9 offset:4096
    ds_read_b64_tr_b16 v[106:107], v9 offset:5120
    s_waitcnt lgkmcnt(4)
    v_mfma_f32_32x32x16_bf16 v[16:31], v[116:119], v[96:99], v[16:31]
    ds_read_b64_tr_b16 v[108:109], v8 offset:4096
    ds_read_b64_tr_b16 v[110:111], v8 offset:5120
    s_waitcnt lgkmcnt(4)
    v_mfma_f32_32x32x16_bf16 v[32:47], v[116:119], v[100:103], v[32:47]
    ds_read_b64_tr_b16 v[96:97], v7 offset:8192
    ds_read_b64_tr_b16 v[98:99], v7 offset:9216
    s_waitcnt lgkmcnt(4)
    v_mfma_f32_32x32x16_bf16 v[48:63], v[116:119], v[104:107], v[48:63]
    ds_read_b64_tr_b16 v[100:101], v13 offset:8192
    ds_read_b64_tr_b16 v[102:103], v13 offset:9216
    s_waitcnt lgkmcnt(4)
    v_mfma_f32_32x32x16_bf16 v[64:79], v[116:119], v[108:111], v[64:79]
    ds_read_b64_tr_b16 v[104:105], v9 offset:8192
    ds_read_b64_tr_b16 v[106:107], v9 offset:9216
    s_waitcnt lgkmcnt(4)
    v_mfma_f32_32x32x16_bf16 v[16:31], v[120:123], v[96:99], v[16:31]
    ds_read_b64_tr_b16 v[108:109], v8 offset:8192
    ds_read_b64_tr_b16 v[110:111], v8 offset:9216
    s_waitcnt lgkmcnt(4)
    v_mfma_f32_32x32x16_bf16 v[32:47], v[120:123], v[100:103], v[32:47]
    ds_read_b64_tr_b16 v[96:97], v7 offset:12288
    ds_read_b64_tr_b16 v[98:99], v7 offset:13312
    s_waitcnt lgkmcnt(4)
    v_mfma_f32_32x32x16_bf16 v[48:63], v[120:123], v[104:107], v[48:63]
    ds_read_b64_tr_b16 v[100:101], v13 offset:12288
    ds_read_b64_tr_b16 v[102:103], v13 offset:13312
    s_waitcnt lgkmcnt(4)
    v_mfma_f32_32x32x16_bf16 v[64:79], v[120:123], v[108:111], v[64:79]
    ds_read_b64_tr_b16 v[104:105], v9 offset:12288
    ds_read_b64_tr_b16 v[106:107], v9 offset:13312
    s_waitcnt lgkmcnt(4)
    v_mfma_f32_32x32x16_bf16 v[16:31], v[124:127], v[96:99], v[16:31]
    ds_read_b64_tr_b16 v[108:109], v8 offset:12288
    ds_read_b64_tr_b16 v[110:111], v8 offset:13312
    s_waitcnt lgkmcnt(4)
    v_mfma_f32_32x32x16_bf16 v[32:47], v[124:127], v[100:103], v[32:47]
    ds_read_b64_tr_b16 v[96:97], v7 offset:16384
    ds_read_b64_tr_b16 v[98:99], v7 offset:17408
    s_waitcnt lgkmcnt(4)
    v_mfma_f32_32x32x16_bf16 v[48:63], v[124:127], v[104:107], v[48:63]
    ds_read_b64_tr_b16 v[100:101], v13 offset:16384
    ds_read_b64_tr_b16 v[102:103], v13 offset:17408
    s_waitcnt lgkmcnt(4)
    v_mfma_f32_32x32x16_bf16 v[64:79], v[124:127], v[108:111], v[64:79]
    ds_read_b64_tr_b16 v[104:105], v9 offset:16384
    ds_read_b64_tr_b16 v[106:107], v9 offset:17408
    s_waitcnt lgkmcnt(4)
    v_mfma_f32_32x32x16_bf16 v[16:31], v[128:131], v[96:99], v[16:31]
    ds_read_b64_tr_b16 v[108:109], v8 offset:16384
    ds_read_b64_tr_b16 v[110:111], v8 offset:17408
    s_waitcnt lgkmcnt(4)
    v_mfma_f32_32x32x16_bf16 v[32:47], v[128:131], v[100:103], v[32:47]
    ds_read_b64_tr_b16 v[96:97], v7 offset:20480
    ds_read_b64_tr_b16 v[98:99], v7 offset:21504
    s_waitcnt lgkmcnt(4)
    v_mfma_f32_32x32x16_bf16 v[48:63], v[128:131], v[104:107], v[48:63]
    ds_read_b64_tr_b16 v[100:101], v13 offset:20480
    ds_read_b64_tr_b16 v[102:103], v13 offset:21504
    s_waitcnt lgkmcnt(4)
    v_mfma_f32_32x32x16_bf16 v[64:79], v[128:131], v[108:111], v[64:79]
    ds_read_b64_tr_b16 v[104:105], v9 offset:20480
    ds_read_b64_tr_b16 v[106:107], v9 offset:21504
    s_waitcnt lgkmcnt(4)
    v_mfma_f32_32x32x16_bf16 v[16:31], v[132:135], v[96:99], v[16:31]
    ds_read_b64_tr_b16 v[108:109], v8 offset:20480
    ds_read_b64_tr_b16 v[110:111], v8 offset:21504
    s_waitcnt lgkmcnt(4)
    v_mfma_f32_32x32x16_bf16 v[32:47], v[132:135], v[100:103], v[32:47]
    ds_read_b64_tr_b16 v[96:97], v7 offset:24576
    ds_read_b64_tr_b16 v[98:99], v7 offset:25600
    s_waitcnt lgkmcnt(4)
    v_mfma_f32_32x32x16_bf16 v[48:63], v[132:135], v[104:107], v[48:63]
    ds_read_b64_tr_b16 v[100:101], v13 offset:24576
    ds_read_b64_tr_b16 v[102:103], v13 offset:25600
    s_waitcnt lgkmcnt(4)
    v_mfma_f32_32x32x16_bf16 v[64:79], v[132:135], v[108:111], v[64:79]
    ds_read_b64_tr_b16 v[104:105], v9 offset:24576
    ds_read_b64_tr_b16 v[106:107], v9 offset:25600
    s_waitcnt lgkmcnt(4)
    v_mfma_f32_32x32x16_bf16 v[16:31], v[136:139], v[96:99], v[16:31]
    ds_read_b64_tr_b16 v[108:109], v8 offset:24576
    ds_read_b64_tr_b16 v[110:111], v8 offset:25600
    s_waitcnt lgkmcnt(4)
    v_mfma_f32_32x32x16_bf16 v[32:47], v[136:139], v[100:103], v[32:47]
    ds_read_b64_tr_b16 v[96:97], v7 offset:28672
    ds_read_b64_tr_b16 v[98:99], v7 offset:29696
    s_waitcnt lgkmcnt(4)
    v_mfma_f32_32x32x16_bf16 v[48:63], v[136:139], v[104:107], v[48:63]
    ds_read_b64_tr_b16 v[100:101], v13 offset:28672
    ds_read_b64_tr_b16 v[102:103], v13 offset:29696
    s_waitcnt lgkmcnt(4)
    v_mfma_f32_32x32x16_bf16 v[64:79], v[136:139], v[108:111], v[64:79]
    ds_read_b64_tr_b16 v[104:105], v9 offset:28672
    ds_read_b64_tr_b16 v[106:107], v9 offset:29696
    s_waitcnt lgkmcnt(4)
    v_mfma_f32_32x32x16_bf16 v[16:31], v[140:143], v[96:99], v[16:31]
    ds_read_b64_tr_b16 v[108:109], v8 offset:28672
    ds_read_b64_tr_b16 v[110:111], v8 offset:29696
    s_waitcnt lgkmcnt(4)
    v_mfma_f32_32x32x16_bf16 v[32:47], v[140:143], v[100:103], v[32:47]
    ds_read_b64_tr_b16 v[96:97], v7 offset:32768
    ds_read_b64_tr_b16 v[98:99], v7 offset:33792
    s_waitcnt lgkmcnt(4)
    v_mfma_f32_32x32x16_bf16 v[48:63], v[140:143], v[104:107], v[48:63]
    ds_read_b64_tr_b16 v[100:101], v13 offset:32768
    ds_read_b64_tr_b16 v[102:103], v13 offset:33792
    s_waitcnt lgkmcnt(4)
    v_mfma_f32_32x32x16_bf16 v[64:79], v[140:143], v[108:111], v[64:79]
    ds_read_b64_tr_b16 v[104:105], v9 offset:32768
    ds_read_b64_tr_b16 v[106:107], v9 offset:33792
    s_waitcnt lgkmcnt(4)
    v_mfma_f32_32x32x16_bf16 v[16:31], v[144:147], v[96:99], v[16:31]
    s_barrier
    ds_read_b64_tr_b16 v[108:109], v8 offset:32768
    ds_read_b64_tr_b16 v[110:111], v8 offset:33792
    s_waitcnt lgkmcnt(4)
    v_mfma_f32_32x32x16_bf16 v[32:47], v[144:147], v[100:103], v[32:47]
    v_add_u32 v7, 0x9000, v7
    ds_read_b64_tr_b16 v[96:97], v7 offset:0
    ds_read_b64_tr_b16 v[98:99], v7 offset:1024
    s_waitcnt lgkmcnt(4)
    v_mfma_f32_32x32x16_bf16 v[48:63], v[144:147], v[104:107], v[48:63]
    v_add_u32 v13, 0x9000, v13
    ds_read_b64_tr_b16 v[100:101], v13 offset:0
    ds_read_b64_tr_b16 v[102:103], v13 offset:1024
    s_waitcnt lgkmcnt(4)
    v_mfma_f32_32x32x16_bf16 v[64:79], v[144:147], v[108:111], v[64:79]
    v_add_u32 v9, 0x9000, v9
    ds_read_b64_tr_b16 v[104:105], v9 offset:0
    ds_read_b64_tr_b16 v[106:107], v9 offset:1024
    s_waitcnt lgkmcnt(4)
    v_mfma_f32_32x32x16_bf16 v[16:31], v[148:151], v[96:99], v[16:31]
    v_add_u32 v8, 0x9000, v8
    ds_read_b64_tr_b16 v[108:109], v8 offset:0
    ds_read_b64_tr_b16 v[110:111], v8 offset:1024
    s_waitcnt lgkmcnt(4)
    v_mfma_f32_32x32x16_bf16 v[32:47], v[148:151], v[100:103], v[32:47]
    ds_read_b64_tr_b16 v[96:97], v7 offset:4096
    ds_read_b64_tr_b16 v[98:99], v7 offset:5120
    s_waitcnt lgkmcnt(4)
    v_mfma_f32_32x32x16_bf16 v[48:63], v[148:151], v[104:107], v[48:63]
    ds_read_b64_tr_b16 v[100:101], v13 offset:4096
    ds_read_b64_tr_b16 v[102:103], v13 offset:5120
    s_waitcnt lgkmcnt(4)
    v_mfma_f32_32x32x16_bf16 v[64:79], v[148:151], v[108:111], v[64:79]
    ds_read_b64_tr_b16 v[104:105], v9 offset:4096
    ds_read_b64_tr_b16 v[106:107], v9 offset:5120
    s_waitcnt lgkmcnt(4)
    v_mfma_f32_32x32x16_bf16 v[16:31], v[152:155], v[96:99], v[16:31]
    ds_read_b64_tr_b16 v[108:109], v8 offset:4096
    ds_read_b64_tr_b16 v[110:111], v8 offset:5120
    s_waitcnt lgkmcnt(4)
    v_mfma_f32_32x32x16_bf16 v[32:47], v[152:155], v[100:103], v[32:47]
    ds_read_b64_tr_b16 v[96:97], v7 offset:8192
    ds_read_b64_tr_b16 v[98:99], v7 offset:9216
    s_waitcnt lgkmcnt(4)
    v_mfma_f32_32x32x16_bf16 v[48:63], v[152:155], v[104:107], v[48:63]
    ds_read_b64_tr_b16 v[100:101], v13 offset:8192
    ds_read_b64_tr_b16 v[102:103], v13 offset:9216
    s_waitcnt lgkmcnt(4)
    v_mfma_f32_32x32x16_bf16 v[64:79], v[152:155], v[108:111], v[64:79]
    ds_read_b64_tr_b16 v[104:105], v9 offset:8192
    ds_read_b64_tr_b16 v[106:107], v9 offset:9216
    s_waitcnt lgkmcnt(4)
    v_mfma_f32_32x32x16_bf16 v[16:31], v[156:159], v[96:99], v[16:31]
    ds_read_b64_tr_b16 v[108:109], v8 offset:8192
    ds_read_b64_tr_b16 v[110:111], v8 offset:9216
    s_waitcnt lgkmcnt(4)
    v_mfma_f32_32x32x16_bf16 v[32:47], v[156:159], v[100:103], v[32:47]
    ds_read_b64_tr_b16 v[96:97], v7 offset:12288
    ds_read_b64_tr_b16 v[98:99], v7 offset:13312
    s_waitcnt lgkmcnt(4)
    v_mfma_f32_32x32x16_bf16 v[48:63], v[156:159], v[104:107], v[48:63]
    ds_read_b64_tr_b16 v[100:101], v13 offset:12288
    ds_read_b64_tr_b16 v[102:103], v13 offset:13312
    s_waitcnt lgkmcnt(4)
    v_mfma_f32_32x32x16_bf16 v[64:79], v[156:159], v[108:111], v[64:79]
    ds_read_b64_tr_b16 v[104:105], v9 offset:12288
    ds_read_b64_tr_b16 v[106:107], v9 offset:13312
    s_waitcnt lgkmcnt(4)
    v_mfma_f32_32x32x16_bf16 v[16:31], v[160:163], v[96:99], v[16:31]
    ds_read_b64_tr_b16 v[108:109], v8 offset:12288
    ds_read_b64_tr_b16 v[110:111], v8 offset:13312
    s_waitcnt lgkmcnt(4)
    v_mfma_f32_32x32x16_bf16 v[32:47], v[160:163], v[100:103], v[32:47]
    ds_read_b64_tr_b16 v[96:97], v7 offset:16384
    ds_read_b64_tr_b16 v[98:99], v7 offset:17408
    s_waitcnt lgkmcnt(4)
    v_mfma_f32_32x32x16_bf16 v[48:63], v[160:163], v[104:107], v[48:63]
    ds_read_b64_tr_b16 v[100:101], v13 offset:16384
    ds_read_b64_tr_b16 v[102:103], v13 offset:17408
    s_waitcnt lgkmcnt(4)
    v_mfma_f32_32x32x16_bf16 v[64:79], v[160:163], v[108:111], v[64:79]
    ds_read_b64_tr_b16 v[104:105], v9 offset:16384
    ds_read_b64_tr_b16 v[106:107], v9 offset:17408
    s_waitcnt lgkmcnt(4)
    v_mfma_f32_32x32x16_bf16 v[16:31], v[164:167], v[96:99], v[16:31]
    ds_read_b64_tr_b16 v[108:109], v8 offset:16384
    ds_read_b64_tr_b16 v[110:111], v8 offset:17408
    s_waitcnt lgkmcnt(4)
    v_mfma_f32_32x32x16_bf16 v[32:47], v[164:167], v[100:103], v[32:47]
    ds_read_b64_tr_b16 v[96:97], v7 offset:20480
    ds_read_b64_tr_b16 v[98:99], v7 offset:21504
    s_waitcnt lgkmcnt(4)
    v_mfma_f32_32x32x16_bf16 v[48:63], v[164:167], v[104:107], v[48:63]
    ds_read_b64_tr_b16 v[100:101], v13 offset:20480
    ds_read_b64_tr_b16 v[102:103], v13 offset:21504
    s_waitcnt lgkmcnt(4)
    v_mfma_f32_32x32x16_bf16 v[64:79], v[164:167], v[108:111], v[64:79]
    ds_read_b64_tr_b16 v[104:105], v9 offset:20480
    ds_read_b64_tr_b16 v[106:107], v9 offset:21504
    s_waitcnt lgkmcnt(4)
    v_mfma_f32_32x32x16_bf16 v[16:31], v[168:171], v[96:99], v[16:31]
    ds_read_b64_tr_b16 v[108:109], v8 offset:20480
    ds_read_b64_tr_b16 v[110:111], v8 offset:21504
    s_waitcnt lgkmcnt(4)
    v_mfma_f32_32x32x16_bf16 v[32:47], v[168:171], v[100:103], v[32:47]
    ds_read_b64_tr_b16 v[96:97], v7 offset:24576
    ds_read_b64_tr_b16 v[98:99], v7 offset:25600
    s_waitcnt lgkmcnt(4)
    v_mfma_f32_32x32x16_bf16 v[48:63], v[168:171], v[104:107], v[48:63]
    ds_read_b64_tr_b16 v[100:101], v13 offset:24576
    ds_read_b64_tr_b16 v[102:103], v13 offset:25600
    s_waitcnt lgkmcnt(4)
    v_mfma_f32_32x32x16_bf16 v[64:79], v[168:171], v[108:111], v[64:79]
    ds_read_b64_tr_b16 v[104:105], v9 offset:24576
    ds_read_b64_tr_b16 v[106:107], v9 offset:25600
    s_waitcnt lgkmcnt(4)
    v_mfma_f32_32x32x16_bf16 v[16:31], v[172:175], v[96:99], v[16:31]
    ds_read_b64_tr_b16 v[108:109], v8 offset:24576
    ds_read_b64_tr_b16 v[110:111], v8 offset:25600
    s_waitcnt lgkmcnt(4)
    v_mfma_f32_32x32x16_bf16 v[32:47], v[172:175], v[100:103], v[32:47]
    ds_read_b64_tr_b16 v[96:97], v7 offset:28672
    ds_read_b64_tr_b16 v[98:99], v7 offset:29696
    s_waitcnt lgkmcnt(4)
    v_mfma_f32_32x32x16_bf16 v[48:63], v[172:175], v[104:107], v[48:63]
    ds_read_b64_tr_b16 v[100:101], v13 offset:28672
    ds_read_b64_tr_b16 v[102:103], v13 offset:29696
    s_waitcnt lgkmcnt(4)
    v_mfma_f32_32x32x16_bf16 v[64:79], v[172:175], v[108:111], v[64:79]
    ds_read_b64_tr_b16 v[104:105], v9 offset:28672
    ds_read_b64_tr_b16 v[106:107], v9 offset:29696
    s_waitcnt lgkmcnt(4)
    v_mfma_f32_32x32x16_bf16 v[16:31], v[176:179], v[96:99], v[16:31]
    ds_read_b64_tr_b16 v[108:109], v8 offset:28672
    ds_read_b64_tr_b16 v[110:111], v8 offset:29696
    s_waitcnt lgkmcnt(4)
    v_mfma_f32_32x32x16_bf16 v[32:47], v[176:179], v[100:103], v[32:47]
    ds_read_b64_tr_b16 v[96:97], v7 offset:32768
    ds_read_b64_tr_b16 v[98:99], v7 offset:33792
    s_waitcnt lgkmcnt(4)
    v_mfma_f32_32x32x16_bf16 v[48:63], v[176:179], v[104:107], v[48:63]
    ds_read_b64_tr_b16 v[100:101], v13 offset:32768
    ds_read_b64_tr_b16 v[102:103], v13 offset:33792
    s_waitcnt lgkmcnt(4)
    v_mfma_f32_32x32x16_bf16 v[64:79], v[176:179], v[108:111], v[64:79]
    ds_read_b64_tr_b16 v[104:105], v9 offset:32768
    ds_read_b64_tr_b16 v[106:107], v9 offset:33792
    s_waitcnt lgkmcnt(4)
    v_mfma_f32_32x32x16_bf16 v[16:31], v[180:183], v[96:99], v[16:31]
    s_barrier
    ds_read_b64_tr_b16 v[108:109], v8 offset:32768
    ds_read_b64_tr_b16 v[110:111], v8 offset:33792
    s_waitcnt lgkmcnt(4)
    v_mfma_f32_32x32x16_bf16 v[32:47], v[180:183], v[100:103], v[32:47]
    v_add_u32 v7, 0x9000, v7
    ds_read_b64_tr_b16 v[96:97], v7 offset:0
    ds_read_b64_tr_b16 v[98:99], v7 offset:1024
    s_waitcnt lgkmcnt(4)
    v_mfma_f32_32x32x16_bf16 v[48:63], v[180:183], v[104:107], v[48:63]
    v_add_u32 v13, 0x9000, v13
    ds_read_b64_tr_b16 v[100:101], v13 offset:0
    ds_read_b64_tr_b16 v[102:103], v13 offset:1024
    s_waitcnt lgkmcnt(4)
    v_mfma_f32_32x32x16_bf16 v[64:79], v[180:183], v[108:111], v[64:79]
    v_add_u32 v9, 0x9000, v9
    ds_read_b64_tr_b16 v[104:105], v9 offset:0
    ds_read_b64_tr_b16 v[106:107], v9 offset:1024
    s_waitcnt lgkmcnt(4)
    v_mfma_f32_32x32x16_bf16 v[16:31], v[184:187], v[96:99], v[16:31]
    v_add_u32 v8, 0x9000, v8
    ds_read_b64_tr_b16 v[108:109], v8 offset:0
    ds_read_b64_tr_b16 v[110:111], v8 offset:1024
    s_waitcnt lgkmcnt(4)
    v_mfma_f32_32x32x16_bf16 v[32:47], v[184:187], v[100:103], v[32:47]
    ds_read_b64_tr_b16 v[96:97], v7 offset:4096
    ds_read_b64_tr_b16 v[98:99], v7 offset:5120
    s_waitcnt lgkmcnt(4)
    v_mfma_f32_32x32x16_bf16 v[48:63], v[184:187], v[104:107], v[48:63]
    ds_read_b64_tr_b16 v[100:101], v13 offset:4096
    ds_read_b64_tr_b16 v[102:103], v13 offset:5120
    s_waitcnt lgkmcnt(4)
    v_mfma_f32_32x32x16_bf16 v[64:79], v[184:187], v[108:111], v[64:79]
    ds_read_b64_tr_b16 v[104:105], v9 offset:4096
    ds_read_b64_tr_b16 v[106:107], v9 offset:5120
    s_waitcnt lgkmcnt(4)
    v_mfma_f32_32x32x16_bf16 v[16:31], v[188:191], v[96:99], v[16:31]
    ds_read_b64_tr_b16 v[108:109], v8 offset:4096
    ds_read_b64_tr_b16 v[110:111], v8 offset:5120
    s_waitcnt lgkmcnt(4)
    v_mfma_f32_32x32x16_bf16 v[32:47], v[188:191], v[100:103], v[32:47]
    ds_read_b64_tr_b16 v[96:97], v7 offset:8192
    ds_read_b64_tr_b16 v[98:99], v7 offset:9216
    s_waitcnt lgkmcnt(4)
    v_mfma_f32_32x32x16_bf16 v[48:63], v[188:191], v[104:107], v[48:63]
    ds_read_b64_tr_b16 v[100:101], v13 offset:8192
    ds_read_b64_tr_b16 v[102:103], v13 offset:9216
    s_waitcnt lgkmcnt(4)
    v_mfma_f32_32x32x16_bf16 v[64:79], v[188:191], v[108:111], v[64:79]
    ds_read_b64_tr_b16 v[104:105], v9 offset:8192
    ds_read_b64_tr_b16 v[106:107], v9 offset:9216
    s_waitcnt lgkmcnt(4)
    v_mfma_f32_32x32x16_bf16 v[16:31], v[192:195], v[96:99], v[16:31]
    ds_read_b64_tr_b16 v[108:109], v8 offset:8192
    ds_read_b64_tr_b16 v[110:111], v8 offset:9216
    s_waitcnt lgkmcnt(4)
    v_mfma_f32_32x32x16_bf16 v[32:47], v[192:195], v[100:103], v[32:47]
    ds_read_b64_tr_b16 v[96:97], v7 offset:12288
    ds_read_b64_tr_b16 v[98:99], v7 offset:13312
    s_waitcnt lgkmcnt(4)
    v_mfma_f32_32x32x16_bf16 v[48:63], v[192:195], v[104:107], v[48:63]
    ds_read_b64_tr_b16 v[100:101], v13 offset:12288
    ds_read_b64_tr_b16 v[102:103], v13 offset:13312
    s_waitcnt lgkmcnt(4)
    v_mfma_f32_32x32x16_bf16 v[64:79], v[192:195], v[108:111], v[64:79]
    ds_read_b64_tr_b16 v[104:105], v9 offset:12288
    ds_read_b64_tr_b16 v[106:107], v9 offset:13312
    s_waitcnt lgkmcnt(4)
    v_mfma_f32_32x32x16_bf16 v[16:31], v[196:199], v[96:99], v[16:31]
    ds_read_b64_tr_b16 v[108:109], v8 offset:12288
    ds_read_b64_tr_b16 v[110:111], v8 offset:13312
    s_waitcnt lgkmcnt(4)
    v_mfma_f32_32x32x16_bf16 v[32:47], v[196:199], v[100:103], v[32:47]
    ds_read_b64_tr_b16 v[96:97], v7 offset:16384
    ds_read_b64_tr_b16 v[98:99], v7 offset:17408
    s_waitcnt lgkmcnt(4)
    v_mfma_f32_32x32x16_bf16 v[48:63], v[196:199], v[104:107], v[48:63]
    ds_read_b64_tr_b16 v[100:101], v13 offset:16384
    ds_read_b64_tr_b16 v[102:103], v13 offset:17408
    s_waitcnt lgkmcnt(4)
    v_mfma_f32_32x32x16_bf16 v[64:79], v[196:199], v[108:111], v[64:79]
    ds_read_b64_tr_b16 v[104:105], v9 offset:16384
    ds_read_b64_tr_b16 v[106:107], v9 offset:17408
    s_waitcnt lgkmcnt(4)
    v_mfma_f32_32x32x16_bf16 v[16:31], v[200:203], v[96:99], v[16:31]
    ds_read_b64_tr_b16 v[108:109], v8 offset:16384
    ds_read_b64_tr_b16 v[110:111], v8 offset:17408
    s_waitcnt lgkmcnt(4)
    v_mfma_f32_32x32x16_bf16 v[32:47], v[200:203], v[100:103], v[32:47]
    ds_read_b64_tr_b16 v[96:97], v7 offset:20480
    ds_read_b64_tr_b16 v[98:99], v7 offset:21504
    s_waitcnt lgkmcnt(4)
    v_mfma_f32_32x32x16_bf16 v[48:63], v[200:203], v[104:107], v[48:63]
    ds_read_b64_tr_b16 v[100:101], v13 offset:20480
    ds_read_b64_tr_b16 v[102:103], v13 offset:21504
    s_waitcnt lgkmcnt(4)
    v_mfma_f32_32x32x16_bf16 v[64:79], v[200:203], v[108:111], v[64:79]
    ds_read_b64_tr_b16 v[104:105], v9 offset:20480
    ds_read_b64_tr_b16 v[106:107], v9 offset:21504
    s_waitcnt lgkmcnt(4)
    v_mfma_f32_32x32x16_bf16 v[16:31], v[204:207], v[96:99], v[16:31]
    ds_read_b64_tr_b16 v[108:109], v8 offset:20480
    ds_read_b64_tr_b16 v[110:111], v8 offset:21504
    s_waitcnt lgkmcnt(4)
    v_mfma_f32_32x32x16_bf16 v[32:47], v[204:207], v[100:103], v[32:47]
    ds_read_b64_tr_b16 v[96:97], v7 offset:24576
    ds_read_b64_tr_b16 v[98:99], v7 offset:25600
    s_waitcnt lgkmcnt(4)
    v_mfma_f32_32x32x16_bf16 v[48:63], v[204:207], v[104:107], v[48:63]
    ds_read_b64_tr_b16 v[100:101], v13 offset:24576
    ds_read_b64_tr_b16 v[102:103], v13 offset:25600
    s_waitcnt lgkmcnt(4)
    v_mfma_f32_32x32x16_bf16 v[64:79], v[204:207], v[108:111], v[64:79]
    ds_read_b64_tr_b16 v[104:105], v9 offset:24576
    ds_read_b64_tr_b16 v[106:107], v9 offset:25600
    s_waitcnt lgkmcnt(4)
    v_mfma_f32_32x32x16_bf16 v[16:31], v[208:211], v[96:99], v[16:31]
    ds_read_b64_tr_b16 v[108:109], v8 offset:24576
    ds_read_b64_tr_b16 v[110:111], v8 offset:25600
    s_waitcnt lgkmcnt(4)
    v_mfma_f32_32x32x16_bf16 v[32:47], v[208:211], v[100:103], v[32:47]
    ds_read_b64_tr_b16 v[96:97], v7 offset:28672
    ds_read_b64_tr_b16 v[98:99], v7 offset:29696
    s_waitcnt lgkmcnt(4)
    v_mfma_f32_32x32x16_bf16 v[48:63], v[208:211], v[104:107], v[48:63]
    ds_read_b64_tr_b16 v[100:101], v13 offset:28672
    ds_read_b64_tr_b16 v[102:103], v13 offset:29696
    s_waitcnt lgkmcnt(4)
    v_mfma_f32_32x32x16_bf16 v[64:79], v[208:211], v[108:111], v[64:79]
    ds_read_b64_tr_b16 v[104:105], v9 offset:28672
    ds_read_b64_tr_b16 v[106:107], v9 offset:29696
    s_waitcnt lgkmcnt(4)
    v_mfma_f32_32x32x16_bf16 v[16:31], v[212:215], v[96:99], v[16:31]
    ds_read_b64_tr_b16 v[108:109], v8 offset:28672
    ds_read_b64_tr_b16 v[110:111], v8 offset:29696
    s_waitcnt lgkmcnt(4)
    v_mfma_f32_32x32x16_bf16 v[32:47], v[212:215], v[100:103], v[32:47]
    ds_read_b64_tr_b16 v[96:97], v7 offset:32768
    ds_read_b64_tr_b16 v[98:99], v7 offset:33792
    s_waitcnt lgkmcnt(4)
    v_mfma_f32_32x32x16_bf16 v[48:63], v[212:215], v[104:107], v[48:63]
    ds_read_b64_tr_b16 v[100:101], v13 offset:32768
    ds_read_b64_tr_b16 v[102:103], v13 offset:33792
    s_waitcnt lgkmcnt(4)
    v_mfma_f32_32x32x16_bf16 v[64:79], v[212:215], v[108:111], v[64:79]
    ds_read_b64_tr_b16 v[104:105], v9 offset:32768
    ds_read_b64_tr_b16 v[106:107], v9 offset:33792
    s_waitcnt lgkmcnt(4)
    v_mfma_f32_32x32x16_bf16 v[16:31], v[216:219], v[96:99], v[16:31]
    s_barrier
    ds_read_b64_tr_b16 v[108:109], v8 offset:32768
    ds_read_b64_tr_b16 v[110:111], v8 offset:33792
    s_waitcnt lgkmcnt(4)
    v_mfma_f32_32x32x16_bf16 v[32:47], v[216:219], v[100:103], v[32:47]
    v_add_u32 v7, 0x9000, v7
    ds_read_b64_tr_b16 v[96:97], v7 offset:0
    ds_read_b64_tr_b16 v[98:99], v7 offset:1024
    s_waitcnt lgkmcnt(4)
    v_mfma_f32_32x32x16_bf16 v[48:63], v[216:219], v[104:107], v[48:63]
    v_add_u32 v13, 0x9000, v13
    ds_read_b64_tr_b16 v[100:101], v13 offset:0
    ds_read_b64_tr_b16 v[102:103], v13 offset:1024
    s_waitcnt lgkmcnt(4)
    v_mfma_f32_32x32x16_bf16 v[64:79], v[216:219], v[108:111], v[64:79]
    v_add_u32 v9, 0x9000, v9
    ds_read_b64_tr_b16 v[104:105], v9 offset:0
    ds_read_b64_tr_b16 v[106:107], v9 offset:1024
    s_waitcnt lgkmcnt(4)
    v_mfma_f32_32x32x16_bf16 v[16:31], v[220:223], v[96:99], v[16:31]
    v_add_u32 v8, 0x9000, v8
    ds_read_b64_tr_b16 v[108:109], v8 offset:0
    ds_read_b64_tr_b16 v[110:111], v8 offset:1024
    s_waitcnt lgkmcnt(4)
    v_mfma_f32_32x32x16_bf16 v[32:47], v[220:223], v[100:103], v[32:47]
    ds_read_b64_tr_b16 v[96:97], v7 offset:4096
    ds_read_b64_tr_b16 v[98:99], v7 offset:5120
    s_waitcnt lgkmcnt(4)
    v_mfma_f32_32x32x16_bf16 v[48:63], v[220:223], v[104:107], v[48:63]
    ds_read_b64_tr_b16 v[100:101], v13 offset:4096
    ds_read_b64_tr_b16 v[102:103], v13 offset:5120
    s_waitcnt lgkmcnt(4)
    v_mfma_f32_32x32x16_bf16 v[64:79], v[220:223], v[108:111], v[64:79]
    ds_read_b64_tr_b16 v[104:105], v9 offset:4096
    ds_read_b64_tr_b16 v[106:107], v9 offset:5120
    s_waitcnt lgkmcnt(4)
    v_mfma_f32_32x32x16_bf16 v[16:31], v[224:227], v[96:99], v[16:31]
    ds_read_b64_tr_b16 v[108:109], v8 offset:4096
    ds_read_b64_tr_b16 v[110:111], v8 offset:5120
    s_waitcnt lgkmcnt(4)
    v_mfma_f32_32x32x16_bf16 v[32:47], v[224:227], v[100:103], v[32:47]
    ds_read_b64_tr_b16 v[96:97], v7 offset:8192
    ds_read_b64_tr_b16 v[98:99], v7 offset:9216
    s_waitcnt lgkmcnt(4)
    v_mfma_f32_32x32x16_bf16 v[48:63], v[224:227], v[104:107], v[48:63]
    ds_read_b64_tr_b16 v[100:101], v13 offset:8192
    ds_read_b64_tr_b16 v[102:103], v13 offset:9216
    s_waitcnt lgkmcnt(4)
    v_mfma_f32_32x32x16_bf16 v[64:79], v[224:227], v[108:111], v[64:79]
    ds_read_b64_tr_b16 v[104:105], v9 offset:8192
    ds_read_b64_tr_b16 v[106:107], v9 offset:9216
    s_waitcnt lgkmcnt(4)
    v_mfma_f32_32x32x16_bf16 v[16:31], v[228:231], v[96:99], v[16:31]
    ds_read_b64_tr_b16 v[108:109], v8 offset:8192
    ds_read_b64_tr_b16 v[110:111], v8 offset:9216
    s_waitcnt lgkmcnt(4)
    v_mfma_f32_32x32x16_bf16 v[32:47], v[228:231], v[100:103], v[32:47]
    ds_read_b64_tr_b16 v[96:97], v7 offset:12288
    ds_read_b64_tr_b16 v[98:99], v7 offset:13312
    s_waitcnt lgkmcnt(4)
    v_mfma_f32_32x32x16_bf16 v[48:63], v[228:231], v[104:107], v[48:63]
    ds_read_b64_tr_b16 v[100:101], v13 offset:12288
    ds_read_b64_tr_b16 v[102:103], v13 offset:13312
    s_waitcnt lgkmcnt(4)
    v_mfma_f32_32x32x16_bf16 v[64:79], v[228:231], v[108:111], v[64:79]
    ds_read_b64_tr_b16 v[104:105], v9 offset:12288
    ds_read_b64_tr_b16 v[106:107], v9 offset:13312
    s_waitcnt lgkmcnt(4)
    v_mfma_f32_32x32x16_bf16 v[16:31], v[232:235], v[96:99], v[16:31]
    ds_read_b64_tr_b16 v[108:109], v8 offset:12288
    ds_read_b64_tr_b16 v[110:111], v8 offset:13312
    s_waitcnt lgkmcnt(4)
    v_mfma_f32_32x32x16_bf16 v[32:47], v[232:235], v[100:103], v[32:47]
    ds_read_b64_tr_b16 v[96:97], v7 offset:16384
    ds_read_b64_tr_b16 v[98:99], v7 offset:17408
    s_waitcnt lgkmcnt(4)
    v_mfma_f32_32x32x16_bf16 v[48:63], v[232:235], v[104:107], v[48:63]
    ds_read_b64_tr_b16 v[100:101], v13 offset:16384
    ds_read_b64_tr_b16 v[102:103], v13 offset:17408
    s_waitcnt lgkmcnt(4)
    v_mfma_f32_32x32x16_bf16 v[64:79], v[232:235], v[108:111], v[64:79]
    ds_read_b64_tr_b16 v[104:105], v9 offset:16384
    ds_read_b64_tr_b16 v[106:107], v9 offset:17408
    s_waitcnt lgkmcnt(4)
    v_mfma_f32_32x32x16_bf16 v[16:31], v[236:239], v[96:99], v[16:31]
    ds_read_b64_tr_b16 v[108:109], v8 offset:16384
    ds_read_b64_tr_b16 v[110:111], v8 offset:17408
    s_waitcnt lgkmcnt(4)
    v_mfma_f32_32x32x16_bf16 v[32:47], v[236:239], v[100:103], v[32:47]
    ds_read_b64_tr_b16 v[96:97], v7 offset:20480
    ds_read_b64_tr_b16 v[98:99], v7 offset:21504
    s_waitcnt lgkmcnt(4)
    v_mfma_f32_32x32x16_bf16 v[48:63], v[236:239], v[104:107], v[48:63]
    ds_read_b64_tr_b16 v[100:101], v13 offset:20480
    ds_read_b64_tr_b16 v[102:103], v13 offset:21504
    s_waitcnt lgkmcnt(4)
    v_mfma_f32_32x32x16_bf16 v[64:79], v[236:239], v[108:111], v[64:79]
    ds_read_b64_tr_b16 v[104:105], v9 offset:20480
    ds_read_b64_tr_b16 v[106:107], v9 offset:21504
    s_waitcnt lgkmcnt(4)
    v_mfma_f32_32x32x16_bf16 v[16:31], v[240:243], v[96:99], v[16:31]
    ds_read_b64_tr_b16 v[108:109], v8 offset:20480
    ds_read_b64_tr_b16 v[110:111], v8 offset:21504
    s_waitcnt lgkmcnt(4)
    v_mfma_f32_32x32x16_bf16 v[32:47], v[240:243], v[100:103], v[32:47]
    ds_read_b64_tr_b16 v[96:97], v7 offset:24576
    ds_read_b64_tr_b16 v[98:99], v7 offset:25600
    s_waitcnt lgkmcnt(4)
    v_mfma_f32_32x32x16_bf16 v[48:63], v[240:243], v[104:107], v[48:63]
    ds_read_b64_tr_b16 v[100:101], v13 offset:24576
    ds_read_b64_tr_b16 v[102:103], v13 offset:25600
    s_waitcnt lgkmcnt(4)
    v_mfma_f32_32x32x16_bf16 v[64:79], v[240:243], v[108:111], v[64:79]
    ds_read_b64_tr_b16 v[104:105], v9 offset:24576
    ds_read_b64_tr_b16 v[106:107], v9 offset:25600
    s_waitcnt lgkmcnt(4)
    v_mfma_f32_32x32x16_bf16 v[16:31], v[244:247], v[96:99], v[16:31]
    ds_read_b64_tr_b16 v[108:109], v8 offset:24576
    ds_read_b64_tr_b16 v[110:111], v8 offset:25600
    s_waitcnt lgkmcnt(4)
    v_mfma_f32_32x32x16_bf16 v[32:47], v[244:247], v[100:103], v[32:47]
    ds_read_b64_tr_b16 v[96:97], v7 offset:28672
    ds_read_b64_tr_b16 v[98:99], v7 offset:29696
    s_waitcnt lgkmcnt(4)
    v_mfma_f32_32x32x16_bf16 v[48:63], v[244:247], v[104:107], v[48:63]
    ds_read_b64_tr_b16 v[100:101], v13 offset:28672
    ds_read_b64_tr_b16 v[102:103], v13 offset:29696
    s_waitcnt lgkmcnt(4)
    v_mfma_f32_32x32x16_bf16 v[64:79], v[244:247], v[108:111], v[64:79]
    ds_read_b64_tr_b16 v[104:105], v9 offset:28672
    ds_read_b64_tr_b16 v[106:107], v9 offset:29696
    s_waitcnt lgkmcnt(4)
    v_mfma_f32_32x32x16_bf16 v[16:31], v[248:251], v[96:99], v[16:31]
    ds_read_b64_tr_b16 v[108:109], v8 offset:28672
    ds_read_b64_tr_b16 v[110:111], v8 offset:29696
    s_waitcnt lgkmcnt(4)
    v_mfma_f32_32x32x16_bf16 v[32:47], v[248:251], v[100:103], v[32:47]
    ds_read_b64_tr_b16 v[96:97], v7 offset:32768
    ds_read_b64_tr_b16 v[98:99], v7 offset:33792
    s_waitcnt lgkmcnt(4)
    v_mfma_f32_32x32x16_bf16 v[48:63], v[248:251], v[104:107], v[48:63]
    ds_read_b64_tr_b16 v[100:101], v13 offset:32768
    ds_read_b64_tr_b16 v[102:103], v13 offset:33792
    s_waitcnt lgkmcnt(4)
    v_mfma_f32_32x32x16_bf16 v[64:79], v[248:251], v[108:111], v[64:79]
    ds_read_b64_tr_b16 v[104:105], v9 offset:32768
    ds_read_b64_tr_b16 v[106:107], v9 offset:33792
    s_waitcnt lgkmcnt(4)
    v_mfma_f32_32x32x16_bf16 v[16:31], v[252:255], v[96:99], v[16:31]
    s_barrier
    ds_read_b64_tr_b16 v[108:109], v8 offset:32768
    ds_read_b64_tr_b16 v[110:111], v8 offset:33792
    s_waitcnt lgkmcnt(4)
    v_mfma_f32_32x32x16_bf16 v[32:47], v[252:255], v[100:103], v[32:47]
    v_add_u32 v10, 0x4000, v10
    ds_read_b64_tr_b16 v[96:97], v10 offset:0
    ds_read_b64_tr_b16 v[98:99], v10 offset:256
    s_waitcnt lgkmcnt(4)
    v_mfma_f32_32x32x16_bf16 v[48:63], v[252:255], v[104:107], v[48:63]
    ds_read_b64_tr_b16 v[100:101], v10 offset:1024
    ds_read_b64_tr_b16 v[102:103], v10 offset:1280
    s_waitcnt lgkmcnt(4)
    v_mfma_f32_32x32x16_bf16 v[64:79], v[252:255], v[108:111], v[64:79]
    ds_read_b64_tr_b16 v[104:105], v10 offset:2048
    ds_read_b64_tr_b16 v[106:107], v10 offset:2304
    s_waitcnt lgkmcnt(4)
    v_mfma_f32_32x32x16_bf16 v[80:95], v[96:99], v[112:115], 0
    ds_read_b64_tr_b16 v[108:109], v10 offset:3072
    ds_read_b64_tr_b16 v[110:111], v10 offset:3328
    s_waitcnt lgkmcnt(4)
    v_mfma_f32_32x32x16_bf16 v[80:95], v[100:103], v[116:119], v[80:95]
    ds_read_b64_tr_b16 v[96:97], v10 offset:4096
    ds_read_b64_tr_b16 v[98:99], v10 offset:4352
    s_waitcnt lgkmcnt(4)
    v_mfma_f32_32x32x16_bf16 v[80:95], v[104:107], v[120:123], v[80:95]
    ds_read_b64_tr_b16 v[100:101], v10 offset:5120
    ds_read_b64_tr_b16 v[102:103], v10 offset:5376
    s_waitcnt lgkmcnt(4)
    v_mfma_f32_32x32x16_bf16 v[80:95], v[108:111], v[124:127], v[80:95]
    ds_read_b64_tr_b16 v[104:105], v10 offset:6144
    ds_read_b64_tr_b16 v[106:107], v10 offset:6400
    s_waitcnt lgkmcnt(4)
    v_mfma_f32_32x32x16_bf16 v[80:95], v[96:99], v[128:131], v[80:95]
    ds_read_b64_tr_b16 v[108:109], v10 offset:7168
    ds_read_b64_tr_b16 v[110:111], v10 offset:7424
    s_waitcnt lgkmcnt(4)
    v_mfma_f32_32x32x16_bf16 v[80:95], v[100:103], v[132:135], v[80:95]
    ds_read_b64_tr_b16 v[96:97], v10 offset:8192
    ds_read_b64_tr_b16 v[98:99], v10 offset:8448
    s_waitcnt lgkmcnt(4)
    v_mfma_f32_32x32x16_bf16 v[80:95], v[104:107], v[136:139], v[80:95]
    ds_read_b64_tr_b16 v[100:101], v10 offset:9216
    ds_read_b64_tr_b16 v[102:103], v10 offset:9472
    v_cvt_pk_bf16_f32 v16, v16, v17
    v_cvt_pk_bf16_f32 v17, v18, v19
    s_waitcnt lgkmcnt(4)
    v_mfma_f32_32x32x16_bf16 v[80:95], v[108:111], v[140:143], v[80:95]
    ds_read_b64_tr_b16 v[104:105], v10 offset:10240
    ds_read_b64_tr_b16 v[106:107], v10 offset:10496
    v_cvt_pk_bf16_f32 v18, v20, v21
    v_cvt_pk_bf16_f32 v19, v22, v23
    s_waitcnt lgkmcnt(4)
    v_mfma_f32_32x32x16_bf16 v[80:95], v[96:99], v[144:147], v[80:95]
    ds_read_b64_tr_b16 v[108:109], v10 offset:11264
    ds_read_b64_tr_b16 v[110:111], v10 offset:11520
    buffer_store_dwordx4 v[16:19], v2, s[12:15], s48 offen offset:0 sc1
    v_cvt_pk_bf16_f32 v20, v24, v25
    s_waitcnt lgkmcnt(4)
    v_mfma_f32_32x32x16_bf16 v[80:95], v[100:103], v[148:151], v[80:95]
    ds_read_b64_tr_b16 v[96:97], v10 offset:12288
    ds_read_b64_tr_b16 v[98:99], v10 offset:12544
    v_cvt_pk_bf16_f32 v21, v26, v27
    v_cvt_pk_bf16_f32 v22, v28, v29
    s_waitcnt lgkmcnt(4)
    v_mfma_f32_32x32x16_bf16 v[80:95], v[104:107], v[152:155], v[80:95]
    ds_read_b64_tr_b16 v[100:101], v10 offset:13312
    ds_read_b64_tr_b16 v[102:103], v10 offset:13568
    v_cvt_pk_bf16_f32 v23, v30, v31
    buffer_store_dwordx4 v[20:23], v2, s[12:15], s48 offen offset:640 sc1
    s_waitcnt lgkmcnt(4)
    v_mfma_f32_32x32x16_bf16 v[80:95], v[108:111], v[156:159], v[80:95]
    ds_read_b64_tr_b16 v[104:105], v10 offset:14336
    ds_read_b64_tr_b16 v[106:107], v10 offset:14592
    v_cvt_pk_bf16_f32 v32, v32, v33
    v_cvt_pk_bf16_f32 v33, v34, v35
    s_waitcnt lgkmcnt(4)
    v_mfma_f32_32x32x16_bf16 v[80:95], v[96:99], v[160:163], v[80:95]
    ds_read_b64_tr_b16 v[108:109], v10 offset:15360
    ds_read_b64_tr_b16 v[110:111], v10 offset:15616
    v_cvt_pk_bf16_f32 v34, v36, v37
    v_cvt_pk_bf16_f32 v35, v38, v39
    s_waitcnt lgkmcnt(4)
    v_mfma_f32_32x32x16_bf16 v[80:95], v[100:103], v[164:167], v[80:95]
    ds_read_b64_tr_b16 v[96:97], v10 offset:16384
    ds_read_b64_tr_b16 v[98:99], v10 offset:16640
    buffer_store_dwordx4 v[32:35], v3, s[12:15], s48 offen offset:0 sc1
    v_cvt_pk_bf16_f32 v36, v40, v41
    s_waitcnt lgkmcnt(4)
    v_mfma_f32_32x32x16_bf16 v[80:95], v[104:107], v[168:171], v[80:95]
    ds_read_b64_tr_b16 v[100:101], v10 offset:17408
    ds_read_b64_tr_b16 v[102:103], v10 offset:17664
    v_cvt_pk_bf16_f32 v37, v42, v43
    v_cvt_pk_bf16_f32 v38, v44, v45
    s_waitcnt lgkmcnt(4)
    v_mfma_f32_32x32x16_bf16 v[80:95], v[108:111], v[172:175], v[80:95]
    ds_read_b64_tr_b16 v[104:105], v10 offset:18432
    ds_read_b64_tr_b16 v[106:107], v10 offset:18688
    v_cvt_pk_bf16_f32 v39, v46, v47
    buffer_store_dwordx4 v[36:39], v3, s[12:15], s48 offen offset:640 sc1
    s_waitcnt lgkmcnt(4)
    v_mfma_f32_32x32x16_bf16 v[80:95], v[96:99], v[176:179], v[80:95]
    ds_read_b64_tr_b16 v[108:109], v10 offset:19456
    ds_read_b64_tr_b16 v[110:111], v10 offset:19712
    v_cvt_pk_bf16_f32 v48, v48, v49
    v_cvt_pk_bf16_f32 v49, v50, v51
    s_waitcnt lgkmcnt(4)
    v_mfma_f32_32x32x16_bf16 v[80:95], v[100:103], v[180:183], v[80:95]
    ds_read_b64_tr_b16 v[96:97], v10 offset:20480
    ds_read_b64_tr_b16 v[98:99], v10 offset:20736
    v_cvt_pk_bf16_f32 v50, v52, v53
    v_cvt_pk_bf16_f32 v51, v54, v55
    s_waitcnt lgkmcnt(4)
    v_mfma_f32_32x32x16_bf16 v[80:95], v[104:107], v[184:187], v[80:95]
    ds_read_b64_tr_b16 v[100:101], v10 offset:21504
    ds_read_b64_tr_b16 v[102:103], v10 offset:21760
    buffer_store_dwordx4 v[48:51], v4, s[12:15], s48 offen offset:0 sc1
    v_cvt_pk_bf16_f32 v52, v56, v57
    s_waitcnt lgkmcnt(4)
    v_mfma_f32_32x32x16_bf16 v[80:95], v[108:111], v[188:191], v[80:95]
    ds_read_b64_tr_b16 v[104:105], v10 offset:22528
    ds_read_b64_tr_b16 v[106:107], v10 offset:22784
    v_cvt_pk_bf16_f32 v53, v58, v59
    v_cvt_pk_bf16_f32 v54, v60, v61
    s_waitcnt lgkmcnt(4)
    v_mfma_f32_32x32x16_bf16 v[80:95], v[96:99], v[192:195], v[80:95]
    ds_read_b64_tr_b16 v[108:109], v10 offset:23552
    ds_read_b64_tr_b16 v[110:111], v10 offset:23808
    v_cvt_pk_bf16_f32 v55, v62, v63
    buffer_store_dwordx4 v[52:55], v4, s[12:15], s48 offen offset:640 sc1
    s_waitcnt lgkmcnt(4)
    v_mfma_f32_32x32x16_bf16 v[80:95], v[100:103], v[196:199], v[80:95]
    ds_read_b64_tr_b16 v[96:97], v10 offset:24576
    ds_read_b64_tr_b16 v[98:99], v10 offset:24832
    v_cvt_pk_bf16_f32 v64, v64, v65
    v_cvt_pk_bf16_f32 v65, v66, v67
    s_waitcnt lgkmcnt(4)
    v_mfma_f32_32x32x16_bf16 v[80:95], v[104:107], v[200:203], v[80:95]
    ds_read_b64_tr_b16 v[100:101], v10 offset:25600
    ds_read_b64_tr_b16 v[102:103], v10 offset:25856
    v_cvt_pk_bf16_f32 v66, v68, v69
    v_cvt_pk_bf16_f32 v67, v70, v71
    s_waitcnt lgkmcnt(4)
    v_mfma_f32_32x32x16_bf16 v[80:95], v[108:111], v[204:207], v[80:95]
    ds_read_b64_tr_b16 v[104:105], v10 offset:26624
    ds_read_b64_tr_b16 v[106:107], v10 offset:26880
    v_cndmask_b32 v64, v64, v6, s[50:51]
    v_cndmask_b32 v65, v65, v6, s[50:51]
    s_waitcnt lgkmcnt(4)
    v_mfma_f32_32x32x16_bf16 v[80:95], v[96:99], v[208:211], v[80:95]
    ds_read_b64_tr_b16 v[108:109], v10 offset:27648
    ds_read_b64_tr_b16 v[110:111], v10 offset:27904
    v_cndmask_b32 v66, v66, v6, s[50:51]
    s_waitcnt lgkmcnt(4)
    v_mfma_f32_32x32x16_bf16 v[80:95], v[100:103], v[212:215], v[80:95]
    ds_read_b64_tr_b16 v[96:97], v10 offset:28672
    ds_read_b64_tr_b16 v[98:99], v10 offset:28928
    v_cndmask_b32 v67, v67, v6, s[50:51]
    s_waitcnt lgkmcnt(4)
    v_mfma_f32_32x32x16_bf16 v[80:95], v[104:107], v[216:219], v[80:95]
    ds_read_b64_tr_b16 v[100:101], v10 offset:29696
    ds_read_b64_tr_b16 v[102:103], v10 offset:29952
    s_mov_b64 exec, s[52:53]
    buffer_store_dwordx4 v[64:67], v5, s[12:15], s48 offen offset:0 sc1
    s_mov_b64 exec, -1
    s_waitcnt lgkmcnt(4)
    v_mfma_f32_32x32x16_bf16 v[80:95], v[108:111], v[220:223], v[80:95]
    ds_read_b64_tr_b16 v[104:105], v10 offset:30720
    ds_read_b64_tr_b16 v[106:107], v10 offset:30976
    v_cvt_pk_bf16_f32 v68, v72, v73
    s_waitcnt lgkmcnt(4)
    v_mfma_f32_32x32x16_bf16 v[80:95], v[96:99], v[224:227], v[80:95]
    ds_read_b64_tr_b16 v[108:109], v10 offset:31744
    ds_read_b64_tr_b16 v[110:111], v10 offset:32000
    v_cvt_pk_bf16_f32 v69, v74, v75
    s_waitcnt lgkmcnt(4)
    v_mfma_f32_32x32x16_bf16 v[80:95], v[100:103], v[228:231], v[80:95]
    ds_read_b64_tr_b16 v[96:97], v10 offset:32768
    ds_read_b64_tr_b16 v[98:99], v10 offset:33024
    v_cvt_pk_bf16_f32 v70, v76, v77
    s_waitcnt lgkmcnt(4)
    v_mfma_f32_32x32x16_bf16 v[80:95], v[104:107], v[232:235], v[80:95]
    ds_read_b64_tr_b16 v[100:101], v10 offset:33792
    ds_read_b64_tr_b16 v[102:103], v10 offset:34048
    v_cvt_pk_bf16_f32 v71, v78, v79
    s_waitcnt lgkmcnt(4)
    v_mfma_f32_32x32x16_bf16 v[80:95], v[108:111], v[236:239], v[80:95]
    ds_read_b64_tr_b16 v[104:105], v10 offset:34816
    ds_read_b64_tr_b16 v[106:107], v10 offset:35072
    v_cndmask_b32 v68, v68, v6, s[50:51]
    s_waitcnt lgkmcnt(4)
    v_mfma_f32_32x32x16_bf16 v[80:95], v[96:99], v[240:243], v[80:95]
    s_barrier
    ds_read_b64_tr_b16 v[108:109], v10 offset:35840
    ds_read_b64_tr_b16 v[110:111], v10 offset:36096
    v_cndmask_b32 v69, v69, v6, s[50:51]
    s_waitcnt lgkmcnt(4)
    v_mfma_f32_32x32x16_bf16 v[80:95], v[100:103], v[244:247], v[80:95]
    v_add_u32 v11, 0xd000, v11
    ds_read_b64_tr_b16 v[96:97], v11 offset:0
    ds_read_b64_tr_b16 v[98:99], v11 offset:512
    v_cndmask_b32 v70, v70, v6, s[50:51]
    s_waitcnt lgkmcnt(4)
    v_mfma_f32_32x32x16_bf16 v[80:95], v[104:107], v[248:251], v[80:95]
    v_add_u32 v12, 0xd000, v12
    ds_read_b64_tr_b16 v[100:101], v12 offset:0
    ds_read_b64_tr_b16 v[102:103], v12 offset:512
    v_cndmask_b32 v71, v71, v6, s[50:51]
    s_waitcnt lgkmcnt(4)
    v_mfma_f32_32x32x16_bf16 v[80:95], v[108:111], v[252:255], v[80:95]
    ds_read_b64_tr_b16 v[104:105], v11 offset:2048
    ds_read_b64_tr_b16 v[106:107], v11 offset:2560
    s_mov_b64 exec, s[52:53]
    buffer_store_dwordx4 v[68:71], v5, s[12:15], s48 offen offset:640 sc1
    s_mov_b64 exec, -1
parallel_sum__softmax_full_mha__dense_activation_relu__prompt_kernel_qE:
    s_waitcnt lgkmcnt(4)
    v_mfma_f32_32x32x16_bf16 v[16:31], v[96:99], v[112:115], 0
    ds_read_b64_tr_b16 v[108:109], v12 offset:2048
    ds_read_b64_tr_b16 v[110:111], v12 offset:2560
    s_waitcnt lgkmcnt(4)
    v_mfma_f32_32x32x16_bf16 v[32:47], v[100:103], v[112:115], 0
    ds_read_b64_tr_b16 v[96:97], v11 offset:4096
    ds_read_b64_tr_b16 v[98:99], v11 offset:4608
    s_waitcnt lgkmcnt(4)
    v_mfma_f32_32x32x16_bf16 v[16:31], v[104:107], v[116:119], v[16:31]
    ds_read_b64_tr_b16 v[100:101], v12 offset:4096
    ds_read_b64_tr_b16 v[102:103], v12 offset:4608
    s_waitcnt lgkmcnt(4)
    v_mfma_f32_32x32x16_bf16 v[32:47], v[108:111], v[116:119], v[32:47]
    ds_read_b64_tr_b16 v[104:105], v11 offset:6144
    ds_read_b64_tr_b16 v[106:107], v11 offset:6656
    s_waitcnt lgkmcnt(4)
    v_mfma_f32_32x32x16_bf16 v[16:31], v[96:99], v[120:123], v[16:31]
    ds_read_b64_tr_b16 v[108:109], v12 offset:6144
    ds_read_b64_tr_b16 v[110:111], v12 offset:6656
    s_waitcnt lgkmcnt(4)
    v_mfma_f32_32x32x16_bf16 v[32:47], v[100:103], v[120:123], v[32:47]
    ds_read_b64_tr_b16 v[96:97], v11 offset:8192
    ds_read_b64_tr_b16 v[98:99], v11 offset:8704
    s_waitcnt lgkmcnt(4)
    v_mfma_f32_32x32x16_bf16 v[16:31], v[104:107], v[124:127], v[16:31]
    ds_read_b64_tr_b16 v[100:101], v12 offset:8192
    ds_read_b64_tr_b16 v[102:103], v12 offset:8704
    v_cvt_pk_bf16_f32 v80, v80, v81
    v_cvt_pk_bf16_f32 v81, v82, v83
    s_waitcnt lgkmcnt(4)
    v_mfma_f32_32x32x16_bf16 v[32:47], v[108:111], v[124:127], v[32:47]
    ds_read_b64_tr_b16 v[104:105], v11 offset:10240
    ds_read_b64_tr_b16 v[106:107], v11 offset:10752
    v_cvt_pk_bf16_f32 v82, v84, v85
    s_waitcnt lgkmcnt(4)
    v_mfma_f32_32x32x16_bf16 v[16:31], v[96:99], v[128:131], v[16:31]
    ds_read_b64_tr_b16 v[108:109], v12 offset:10240
    ds_read_b64_tr_b16 v[110:111], v12 offset:10752
    v_cvt_pk_bf16_f32 v83, v86, v87
    s_waitcnt lgkmcnt(4)
    v_mfma_f32_32x32x16_bf16 v[32:47], v[100:103], v[128:131], v[32:47]
    ds_read_b64_tr_b16 v[96:97], v11 offset:12288
    ds_read_b64_tr_b16 v[98:99], v11 offset:12800
    v_pk_max_i16 v80, v80, 0
    s_waitcnt lgkmcnt(4)
    v_mfma_f32_32x32x16_bf16 v[16:31], v[104:107], v[132:135], v[16:31]
    ds_read_b64_tr_b16 v[100:101], v12 offset:12288
    ds_read_b64_tr_b16 v[102:103], v12 offset:12800
    v_pk_max_i16 v81, v81, 0
    s_waitcnt lgkmcnt(4)
    v_mfma_f32_32x32x16_bf16 v[32:47], v[108:111], v[132:135], v[32:47]
    ds_read_b64_tr_b16 v[104:105], v11 offset:14336
    ds_read_b64_tr_b16 v[106:107], v11 offset:14848
    v_pk_max_i16 v82, v82, 0
    s_waitcnt lgkmcnt(4)
    v_mfma_f32_32x32x16_bf16 v[16:31], v[96:99], v[136:139], v[16:31]
    ds_read_b64_tr_b16 v[108:109], v12 offset:14336
    ds_read_b64_tr_b16 v[110:111], v12 offset:14848
    v_pk_max_i16 v83, v83, 0
    s_waitcnt lgkmcnt(4)
    v_mfma_f32_32x32x16_bf16 v[32:47], v[100:103], v[136:139], v[32:47]
    ds_read_b64_tr_b16 v[96:97], v11 offset:16384
    ds_read_b64_tr_b16 v[98:99], v11 offset:16896
    v_cvt_pk_bf16_f32 v84, v88, v89
    s_waitcnt lgkmcnt(4)
    v_mfma_f32_32x32x16_bf16 v[16:31], v[104:107], v[140:143], v[16:31]
    ds_read_b64_tr_b16 v[100:101], v12 offset:16384
    ds_read_b64_tr_b16 v[102:103], v12 offset:16896
    v_cvt_pk_bf16_f32 v85, v90, v91
    s_waitcnt lgkmcnt(4)
    v_mfma_f32_32x32x16_bf16 v[32:47], v[108:111], v[140:143], v[32:47]
    ds_read_b64_tr_b16 v[104:105], v11 offset:18432
    ds_read_b64_tr_b16 v[106:107], v11 offset:18944
    v_cvt_pk_bf16_f32 v86, v92, v93
    s_waitcnt lgkmcnt(4)
    v_mfma_f32_32x32x16_bf16 v[16:31], v[96:99], v[144:147], v[16:31]
    ds_read_b64_tr_b16 v[108:109], v12 offset:18432
    ds_read_b64_tr_b16 v[110:111], v12 offset:18944
    v_cvt_pk_bf16_f32 v87, v94, v95
    s_waitcnt lgkmcnt(4)
    v_mfma_f32_32x32x16_bf16 v[32:47], v[100:103], v[144:147], v[32:47]
    ds_read_b64_tr_b16 v[96:97], v11 offset:20480
    ds_read_b64_tr_b16 v[98:99], v11 offset:20992
    v_pk_max_i16 v84, v84, 0
    s_waitcnt lgkmcnt(4)
    v_mfma_f32_32x32x16_bf16 v[16:31], v[104:107], v[148:151], v[16:31]
    ds_read_b64_tr_b16 v[100:101], v12 offset:20480
    ds_read_b64_tr_b16 v[102:103], v12 offset:20992
    v_pk_max_i16 v85, v85, 0
    s_waitcnt lgkmcnt(4)
    v_mfma_f32_32x32x16_bf16 v[32:47], v[108:111], v[148:151], v[32:47]
    ds_read_b64_tr_b16 v[104:105], v11 offset:22528
    ds_read_b64_tr_b16 v[106:107], v11 offset:23040
    v_pk_max_i16 v86, v86, 0
    s_waitcnt lgkmcnt(4)
    v_mfma_f32_32x32x16_bf16 v[16:31], v[96:99], v[152:155], v[16:31]
    ds_read_b64_tr_b16 v[108:109], v12 offset:22528
    ds_read_b64_tr_b16 v[110:111], v12 offset:23040
    v_pk_max_i16 v87, v87, 0
    s_waitcnt lgkmcnt(4)
    v_mfma_f32_32x32x16_bf16 v[32:47], v[100:103], v[152:155], v[32:47]
    ds_read_b64_tr_b16 v[96:97], v11 offset:24576
    ds_read_b64_tr_b16 v[98:99], v11 offset:25088
    s_waitcnt lgkmcnt(4)
    v_mfma_f32_32x32x16_bf16 v[16:31], v[104:107], v[156:159], v[16:31]
    ds_read_b64_tr_b16 v[100:101], v12 offset:24576
    ds_read_b64_tr_b16 v[102:103], v12 offset:25088
    s_waitcnt lgkmcnt(4)
    v_mfma_f32_32x32x16_bf16 v[32:47], v[108:111], v[156:159], v[32:47]
    ds_read_b64_tr_b16 v[104:105], v11 offset:26624
    ds_read_b64_tr_b16 v[106:107], v11 offset:27136
    s_waitcnt lgkmcnt(4)
    v_mfma_f32_32x32x16_bf16 v[16:31], v[96:99], v[160:163], v[16:31]
    ds_read_b64_tr_b16 v[108:109], v12 offset:26624
    ds_read_b64_tr_b16 v[110:111], v12 offset:27136
    s_waitcnt lgkmcnt(4)
    v_mfma_f32_32x32x16_bf16 v[32:47], v[100:103], v[160:163], v[32:47]
    ds_read_b64_tr_b16 v[96:97], v11 offset:28672
    ds_read_b64_tr_b16 v[98:99], v11 offset:29184
    s_waitcnt lgkmcnt(4)
    v_mfma_f32_32x32x16_bf16 v[16:31], v[104:107], v[164:167], v[16:31]
    ds_read_b64_tr_b16 v[100:101], v12 offset:28672
    ds_read_b64_tr_b16 v[102:103], v12 offset:29184
    s_waitcnt lgkmcnt(4)
    v_mfma_f32_32x32x16_bf16 v[32:47], v[108:111], v[164:167], v[32:47]
    ds_read_b64_tr_b16 v[104:105], v11 offset:30720
    ds_read_b64_tr_b16 v[106:107], v11 offset:31232
    s_waitcnt lgkmcnt(4)
    v_mfma_f32_32x32x16_bf16 v[16:31], v[96:99], v[168:171], v[16:31]
    ds_read_b64_tr_b16 v[108:109], v12 offset:30720
    ds_read_b64_tr_b16 v[110:111], v12 offset:31232
    s_add_u32 s29, s42, 0
    buffer_store_dwordx4 v[80:83], v1, s[12:15], s29 offen sc1
    s_waitcnt lgkmcnt(4)
    v_mfma_f32_32x32x16_bf16 v[32:47], v[100:103], v[168:171], v[32:47]
    ds_read_b64_tr_b16 v[96:97], v11 offset:32768
    ds_read_b64_tr_b16 v[98:99], v11 offset:33280
    s_waitcnt lgkmcnt(4)
    v_mfma_f32_32x32x16_bf16 v[16:31], v[104:107], v[172:175], v[16:31]
    ds_read_b64_tr_b16 v[100:101], v12 offset:32768
    ds_read_b64_tr_b16 v[102:103], v12 offset:33280
    s_waitcnt lgkmcnt(4)
    v_mfma_f32_32x32x16_bf16 v[32:47], v[108:111], v[172:175], v[32:47]
    ds_read_b64_tr_b16 v[104:105], v11 offset:34816
    ds_read_b64_tr_b16 v[106:107], v11 offset:35328
    s_add_u32 s29, s42, 1024
    buffer_store_dwordx4 v[84:87], v1, s[12:15], s29 offen sc1
    s_waitcnt lgkmcnt(4)
    v_mfma_f32_32x32x16_bf16 v[16:31], v[96:99], v[176:179], v[16:31]
    s_barrier
    ds_read_b64_tr_b16 v[108:109], v12 offset:34816
    ds_read_b64_tr_b16 v[110:111], v12 offset:35328
    s_waitcnt lgkmcnt(4)
    v_mfma_f32_32x32x16_bf16 v[32:47], v[100:103], v[176:179], v[32:47]
    v_add_u32 v11, 0x9000, v11
    ds_read_b64_tr_b16 v[96:97], v11 offset:0
    ds_read_b64_tr_b16 v[98:99], v11 offset:512
    s_waitcnt lgkmcnt(4)
    v_mfma_f32_32x32x16_bf16 v[16:31], v[104:107], v[180:183], v[16:31]
    v_add_u32 v12, 0x9000, v12
    ds_read_b64_tr_b16 v[100:101], v12 offset:0
    ds_read_b64_tr_b16 v[102:103], v12 offset:512
    s_waitcnt lgkmcnt(4)
    v_mfma_f32_32x32x16_bf16 v[32:47], v[108:111], v[180:183], v[32:47]
    ds_read_b64_tr_b16 v[104:105], v11 offset:2048
    ds_read_b64_tr_b16 v[106:107], v11 offset:2560
    s_waitcnt vmcnt(2)
    s_waitcnt lgkmcnt(4)
    v_mfma_f32_32x32x16_bf16 v[16:31], v[96:99], v[184:187], v[16:31]
    ds_read_b64_tr_b16 v[108:109], v12 offset:2048
    ds_read_b64_tr_b16 v[110:111], v12 offset:2560
    s_waitcnt lgkmcnt(4)
    v_mfma_f32_32x32x16_bf16 v[32:47], v[100:103], v[184:187], v[32:47]
    ds_read_b64_tr_b16 v[96:97], v11 offset:4096
    ds_read_b64_tr_b16 v[98:99], v11 offset:4608
    s_waitcnt lgkmcnt(4)
    v_mfma_f32_32x32x16_bf16 v[16:31], v[104:107], v[188:191], v[16:31]
    ds_read_b64_tr_b16 v[100:101], v12 offset:4096
    ds_read_b64_tr_b16 v[102:103], v12 offset:4608
    s_waitcnt lgkmcnt(4)
    v_mfma_f32_32x32x16_bf16 v[32:47], v[108:111], v[188:191], v[32:47]
    ds_read_b64_tr_b16 v[104:105], v11 offset:6144
    ds_read_b64_tr_b16 v[106:107], v11 offset:6656
    s_waitcnt lgkmcnt(4)
    v_mfma_f32_32x32x16_bf16 v[16:31], v[96:99], v[192:195], v[16:31]
    ds_read_b64_tr_b16 v[108:109], v12 offset:6144
    ds_read_b64_tr_b16 v[110:111], v12 offset:6656
    s_waitcnt lgkmcnt(4)
    v_mfma_f32_32x32x16_bf16 v[32:47], v[100:103], v[192:195], v[32:47]
    ds_read_b64_tr_b16 v[96:97], v11 offset:8192
    ds_read_b64_tr_b16 v[98:99], v11 offset:8704
    s_waitcnt lgkmcnt(4)
    v_mfma_f32_32x32x16_bf16 v[16:31], v[104:107], v[196:199], v[16:31]
    ds_read_b64_tr_b16 v[100:101], v12 offset:8192
    ds_read_b64_tr_b16 v[102:103], v12 offset:8704
    s_waitcnt lgkmcnt(4)
    v_mfma_f32_32x32x16_bf16 v[32:47], v[108:111], v[196:199], v[32:47]
    ds_read_b64_tr_b16 v[104:105], v11 offset:10240
    ds_read_b64_tr_b16 v[106:107], v11 offset:10752
    s_waitcnt lgkmcnt(4)
    v_mfma_f32_32x32x16_bf16 v[16:31], v[96:99], v[200:203], v[16:31]
    ds_read_b64_tr_b16 v[108:109], v12 offset:10240
    ds_read_b64_tr_b16 v[110:111], v12 offset:10752
    s_waitcnt lgkmcnt(4)
    v_mfma_f32_32x32x16_bf16 v[32:47], v[100:103], v[200:203], v[32:47]
    ds_read_b64_tr_b16 v[96:97], v11 offset:12288
    ds_read_b64_tr_b16 v[98:99], v11 offset:12800
    s_waitcnt lgkmcnt(4)
    v_mfma_f32_32x32x16_bf16 v[16:31], v[104:107], v[204:207], v[16:31]
    ds_read_b64_tr_b16 v[100:101], v12 offset:12288
    ds_read_b64_tr_b16 v[102:103], v12 offset:12800
    s_waitcnt lgkmcnt(4)
    v_mfma_f32_32x32x16_bf16 v[32:47], v[108:111], v[204:207], v[32:47]
    ds_read_b64_tr_b16 v[104:105], v11 offset:14336
    ds_read_b64_tr_b16 v[106:107], v11 offset:14848
    s_waitcnt lgkmcnt(4)
    v_mfma_f32_32x32x16_bf16 v[16:31], v[96:99], v[208:211], v[16:31]
    ds_read_b64_tr_b16 v[108:109], v12 offset:14336
    ds_read_b64_tr_b16 v[110:111], v12 offset:14848
    s_waitcnt lgkmcnt(4)
    v_mfma_f32_32x32x16_bf16 v[32:47], v[100:103], v[208:211], v[32:47]
    ds_read_b64_tr_b16 v[96:97], v11 offset:16384
    ds_read_b64_tr_b16 v[98:99], v11 offset:16896
    s_waitcnt lgkmcnt(4)
    v_mfma_f32_32x32x16_bf16 v[16:31], v[104:107], v[212:215], v[16:31]
    ds_read_b64_tr_b16 v[100:101], v12 offset:16384
    ds_read_b64_tr_b16 v[102:103], v12 offset:16896
    s_waitcnt lgkmcnt(4)
    v_mfma_f32_32x32x16_bf16 v[32:47], v[108:111], v[212:215], v[32:47]
    ds_read_b64_tr_b16 v[104:105], v11 offset:18432
    ds_read_b64_tr_b16 v[106:107], v11 offset:18944
    s_waitcnt lgkmcnt(4)
    v_mfma_f32_32x32x16_bf16 v[16:31], v[96:99], v[216:219], v[16:31]
    ds_read_b64_tr_b16 v[108:109], v12 offset:18432
    ds_read_b64_tr_b16 v[110:111], v12 offset:18944
    s_waitcnt lgkmcnt(4)
    v_mfma_f32_32x32x16_bf16 v[32:47], v[100:103], v[216:219], v[32:47]
    ds_read_b64_tr_b16 v[96:97], v11 offset:20480
    ds_read_b64_tr_b16 v[98:99], v11 offset:20992
    s_waitcnt lgkmcnt(4)
    v_mfma_f32_32x32x16_bf16 v[16:31], v[104:107], v[220:223], v[16:31]
    ds_read_b64_tr_b16 v[100:101], v12 offset:20480
    ds_read_b64_tr_b16 v[102:103], v12 offset:20992
    s_waitcnt lgkmcnt(4)
    v_mfma_f32_32x32x16_bf16 v[32:47], v[108:111], v[220:223], v[32:47]
    ds_read_b64_tr_b16 v[104:105], v11 offset:22528
    ds_read_b64_tr_b16 v[106:107], v11 offset:23040
    s_waitcnt lgkmcnt(4)
    v_mfma_f32_32x32x16_bf16 v[16:31], v[96:99], v[224:227], v[16:31]
    ds_read_b64_tr_b16 v[108:109], v12 offset:22528
    ds_read_b64_tr_b16 v[110:111], v12 offset:23040
    s_waitcnt lgkmcnt(4)
    v_mfma_f32_32x32x16_bf16 v[32:47], v[100:103], v[224:227], v[32:47]
    ds_read_b64_tr_b16 v[96:97], v11 offset:24576
    ds_read_b64_tr_b16 v[98:99], v11 offset:25088
    s_waitcnt lgkmcnt(4)
    v_mfma_f32_32x32x16_bf16 v[16:31], v[104:107], v[228:231], v[16:31]
    ds_read_b64_tr_b16 v[100:101], v12 offset:24576
    ds_read_b64_tr_b16 v[102:103], v12 offset:25088
    s_waitcnt lgkmcnt(4)
    v_mfma_f32_32x32x16_bf16 v[32:47], v[108:111], v[228:231], v[32:47]
    ds_read_b64_tr_b16 v[104:105], v11 offset:26624
    ds_read_b64_tr_b16 v[106:107], v11 offset:27136
    s_waitcnt lgkmcnt(4)
    v_mfma_f32_32x32x16_bf16 v[16:31], v[96:99], v[232:235], v[16:31]
    ds_read_b64_tr_b16 v[108:109], v12 offset:26624
    ds_read_b64_tr_b16 v[110:111], v12 offset:27136
    s_waitcnt lgkmcnt(4)
    v_mfma_f32_32x32x16_bf16 v[32:47], v[100:103], v[232:235], v[32:47]
    ds_read_b64_tr_b16 v[96:97], v11 offset:28672
    ds_read_b64_tr_b16 v[98:99], v11 offset:29184
    s_waitcnt lgkmcnt(4)
    v_mfma_f32_32x32x16_bf16 v[16:31], v[104:107], v[236:239], v[16:31]
    ds_read_b64_tr_b16 v[100:101], v12 offset:28672
    ds_read_b64_tr_b16 v[102:103], v12 offset:29184
    s_waitcnt lgkmcnt(4)
    v_mfma_f32_32x32x16_bf16 v[32:47], v[108:111], v[236:239], v[32:47]
    ds_read_b64_tr_b16 v[104:105], v11 offset:30720
    ds_read_b64_tr_b16 v[106:107], v11 offset:31232
    s_waitcnt lgkmcnt(4)
    v_mfma_f32_32x32x16_bf16 v[16:31], v[96:99], v[240:243], v[16:31]
    ds_read_b64_tr_b16 v[108:109], v12 offset:30720
    ds_read_b64_tr_b16 v[110:111], v12 offset:31232
    s_waitcnt lgkmcnt(4)
    v_mfma_f32_32x32x16_bf16 v[32:47], v[100:103], v[240:243], v[32:47]
    ds_read_b64_tr_b16 v[96:97], v11 offset:32768
    ds_read_b64_tr_b16 v[98:99], v11 offset:33280
    s_waitcnt lgkmcnt(4)
    v_mfma_f32_32x32x16_bf16 v[16:31], v[104:107], v[244:247], v[16:31]
    ds_read_b64_tr_b16 v[100:101], v12 offset:32768
    ds_read_b64_tr_b16 v[102:103], v12 offset:33280
    s_waitcnt lgkmcnt(4)
    v_mfma_f32_32x32x16_bf16 v[32:47], v[108:111], v[244:247], v[32:47]
    ds_read_b64_tr_b16 v[104:105], v11 offset:34816
    ds_read_b64_tr_b16 v[106:107], v11 offset:35328
    s_waitcnt lgkmcnt(4)
    v_mfma_f32_32x32x16_bf16 v[16:31], v[96:99], v[248:251], v[16:31]
    s_barrier
    ds_read_b64_tr_b16 v[108:109], v12 offset:34816
    ds_read_b64_tr_b16 v[110:111], v12 offset:35328
    s_waitcnt lgkmcnt(4)
    v_mfma_f32_32x32x16_bf16 v[32:47], v[100:103], v[248:251], v[32:47]
    v_add_u32 v11, 0x9000, v11
    ds_read_b64_tr_b16 v[96:97], v11 offset:0
    ds_read_b64_tr_b16 v[98:99], v11 offset:512
    s_waitcnt lgkmcnt(4)
    v_mfma_f32_32x32x16_bf16 v[16:31], v[104:107], v[252:255], v[16:31]
    v_add_u32 v12, 0x9000, v12
    ds_read_b64_tr_b16 v[100:101], v12 offset:0
    ds_read_b64_tr_b16 v[102:103], v12 offset:512
    s_waitcnt lgkmcnt(4)
    v_mfma_f32_32x32x16_bf16 v[32:47], v[108:111], v[252:255], v[32:47]
    ds_read_b64_tr_b16 v[104:105], v11 offset:2048
    ds_read_b64_tr_b16 v[106:107], v11 offset:2560
    s_add_u32 s58, s43, 0
    s_add_u32 s59, s43, 2048
    s_waitcnt lgkmcnt(4)
    v_mfma_f32_32x32x16_bf16 v[48:63], v[96:99], v[112:115], 0
    ds_read_b64_tr_b16 v[108:109], v12 offset:2048
    ds_read_b64_tr_b16 v[110:111], v12 offset:2560
    s_waitcnt lgkmcnt(4)
    v_mfma_f32_32x32x16_bf16 v[64:79], v[100:103], v[112:115], 0
    ds_read_b64_tr_b16 v[96:97], v11 offset:4096
    ds_read_b64_tr_b16 v[98:99], v11 offset:4608
    s_waitcnt lgkmcnt(4)
    v_mfma_f32_32x32x16_bf16 v[48:63], v[104:107], v[116:119], v[48:63]
    ds_read_b64_tr_b16 v[100:101], v12 offset:4096
    ds_read_b64_tr_b16 v[102:103], v12 offset:4608
    s_waitcnt lgkmcnt(4)
    v_mfma_f32_32x32x16_bf16 v[64:79], v[108:111], v[116:119], v[64:79]
    ds_read_b64_tr_b16 v[104:105], v11 offset:6144
    ds_read_b64_tr_b16 v[106:107], v11 offset:6656
    s_waitcnt lgkmcnt(4)
    v_mfma_f32_32x32x16_bf16 v[48:63], v[96:99], v[120:123], v[48:63]
    ds_read_b64_tr_b16 v[108:109], v12 offset:6144
    ds_read_b64_tr_b16 v[110:111], v12 offset:6656
    s_waitcnt lgkmcnt(4)
    v_mfma_f32_32x32x16_bf16 v[64:79], v[100:103], v[120:123], v[64:79]
    ds_read_b64_tr_b16 v[96:97], v11 offset:8192
    ds_read_b64_tr_b16 v[98:99], v11 offset:8704
    s_waitcnt lgkmcnt(4)
    v_mfma_f32_32x32x16_bf16 v[48:63], v[104:107], v[124:127], v[48:63]
    ds_read_b64_tr_b16 v[100:101], v12 offset:8192
    ds_read_b64_tr_b16 v[102:103], v12 offset:8704
    v_cvt_pk_bf16_f32 v16, v16, v17
    v_cvt_pk_bf16_f32 v17, v18, v19
    v_cvt_pk_bf16_f32 v18, v20, v21
    s_waitcnt lgkmcnt(4)
    v_mfma_f32_32x32x16_bf16 v[64:79], v[108:111], v[124:127], v[64:79]
    ds_read_b64_tr_b16 v[104:105], v11 offset:10240
    ds_read_b64_tr_b16 v[106:107], v11 offset:10752
    v_cvt_pk_bf16_f32 v19, v22, v23
    v_pk_max_i16 v16, v16, 0
    v_pk_max_i16 v17, v17, 0
    s_waitcnt lgkmcnt(4)
    v_mfma_f32_32x32x16_bf16 v[48:63], v[96:99], v[128:131], v[48:63]
    ds_read_b64_tr_b16 v[108:109], v12 offset:10240
    ds_read_b64_tr_b16 v[110:111], v12 offset:10752
    v_pk_max_i16 v18, v18, 0
    v_pk_max_i16 v19, v19, 0
    s_waitcnt lgkmcnt(4)
    v_mfma_f32_32x32x16_bf16 v[64:79], v[100:103], v[128:131], v[64:79]
    ds_read_b64_tr_b16 v[96:97], v11 offset:12288
    ds_read_b64_tr_b16 v[98:99], v11 offset:12800
    v_cvt_pk_bf16_f32 v20, v24, v25
    v_cvt_pk_bf16_f32 v21, v26, v27
    s_waitcnt lgkmcnt(4)
    v_mfma_f32_32x32x16_bf16 v[48:63], v[104:107], v[132:135], v[48:63]
    ds_read_b64_tr_b16 v[100:101], v12 offset:12288
    ds_read_b64_tr_b16 v[102:103], v12 offset:12800
    v_cvt_pk_bf16_f32 v22, v28, v29
    v_cvt_pk_bf16_f32 v23, v30, v31
    s_waitcnt lgkmcnt(4)
    v_mfma_f32_32x32x16_bf16 v[64:79], v[108:111], v[132:135], v[64:79]
    ds_read_b64_tr_b16 v[104:105], v11 offset:14336
    ds_read_b64_tr_b16 v[106:107], v11 offset:14848
    v_pk_max_i16 v20, v20, 0
    v_pk_max_i16 v21, v21, 0
    s_waitcnt lgkmcnt(4)
    v_mfma_f32_32x32x16_bf16 v[48:63], v[96:99], v[136:139], v[48:63]
    ds_read_b64_tr_b16 v[108:109], v12 offset:14336
    ds_read_b64_tr_b16 v[110:111], v12 offset:14848
    v_pk_max_i16 v22, v22, 0
    v_pk_max_i16 v23, v23, 0
    s_waitcnt lgkmcnt(4)
    v_mfma_f32_32x32x16_bf16 v[64:79], v[100:103], v[136:139], v[64:79]
    ds_read_b64_tr_b16 v[96:97], v11 offset:16384
    ds_read_b64_tr_b16 v[98:99], v11 offset:16896
    v_cvt_pk_bf16_f32 v32, v32, v33
    v_cvt_pk_bf16_f32 v33, v34, v35
    s_waitcnt lgkmcnt(4)
    v_mfma_f32_32x32x16_bf16 v[48:63], v[104:107], v[140:143], v[48:63]
    ds_read_b64_tr_b16 v[100:101], v12 offset:16384
    ds_read_b64_tr_b16 v[102:103], v12 offset:16896
    v_cvt_pk_bf16_f32 v34, v36, v37
    v_cvt_pk_bf16_f32 v35, v38, v39
    s_waitcnt lgkmcnt(4)
    v_mfma_f32_32x32x16_bf16 v[64:79], v[108:111], v[140:143], v[64:79]
    ds_read_b64_tr_b16 v[104:105], v11 offset:18432
    ds_read_b64_tr_b16 v[106:107], v11 offset:18944
    v_pk_max_i16 v32, v32, 0
    v_pk_max_i16 v33, v33, 0
    s_waitcnt lgkmcnt(4)
    v_mfma_f32_32x32x16_bf16 v[48:63], v[96:99], v[144:147], v[48:63]
    ds_read_b64_tr_b16 v[108:109], v12 offset:18432
    ds_read_b64_tr_b16 v[110:111], v12 offset:18944
    v_pk_max_i16 v34, v34, 0
    v_pk_max_i16 v35, v35, 0
    s_waitcnt lgkmcnt(4)
    v_mfma_f32_32x32x16_bf16 v[64:79], v[100:103], v[144:147], v[64:79]
    ds_read_b64_tr_b16 v[96:97], v11 offset:20480
    ds_read_b64_tr_b16 v[98:99], v11 offset:20992
    v_cvt_pk_bf16_f32 v36, v40, v41
    v_cvt_pk_bf16_f32 v37, v42, v43
    s_waitcnt lgkmcnt(4)
    v_mfma_f32_32x32x16_bf16 v[48:63], v[104:107], v[148:151], v[48:63]
    ds_read_b64_tr_b16 v[100:101], v12 offset:20480
    ds_read_b64_tr_b16 v[102:103], v12 offset:20992
    v_cvt_pk_bf16_f32 v38, v44, v45
    v_cvt_pk_bf16_f32 v39, v46, v47
    s_waitcnt lgkmcnt(4)
    v_mfma_f32_32x32x16_bf16 v[64:79], v[108:111], v[148:151], v[64:79]
    ds_read_b64_tr_b16 v[104:105], v11 offset:22528
    ds_read_b64_tr_b16 v[106:107], v11 offset:23040
    v_pk_max_i16 v36, v36, 0
    v_pk_max_i16 v37, v37, 0
    s_waitcnt lgkmcnt(4)
    v_mfma_f32_32x32x16_bf16 v[48:63], v[96:99], v[152:155], v[48:63]
    ds_read_b64_tr_b16 v[108:109], v12 offset:22528
    ds_read_b64_tr_b16 v[110:111], v12 offset:23040
    v_pk_max_i16 v38, v38, 0
    v_pk_max_i16 v39, v39, 0
    s_waitcnt lgkmcnt(4)
    v_mfma_f32_32x32x16_bf16 v[64:79], v[100:103], v[152:155], v[64:79]
    ds_read_b64_tr_b16 v[96:97], v11 offset:24576
    ds_read_b64_tr_b16 v[98:99], v11 offset:25088
    s_waitcnt lgkmcnt(4)
    v_mfma_f32_32x32x16_bf16 v[48:63], v[104:107], v[156:159], v[48:63]
    ds_read_b64_tr_b16 v[100:101], v12 offset:24576
    ds_read_b64_tr_b16 v[102:103], v12 offset:25088
    s_waitcnt lgkmcnt(4)
    v_mfma_f32_32x32x16_bf16 v[64:79], v[108:111], v[156:159], v[64:79]
    ds_read_b64_tr_b16 v[104:105], v11 offset:26624
    ds_read_b64_tr_b16 v[106:107], v11 offset:27136
    s_waitcnt lgkmcnt(4)
    v_mfma_f32_32x32x16_bf16 v[48:63], v[96:99], v[160:163], v[48:63]
    ds_read_b64_tr_b16 v[108:109], v12 offset:26624
    ds_read_b64_tr_b16 v[110:111], v12 offset:27136
    s_waitcnt lgkmcnt(4)
    v_mfma_f32_32x32x16_bf16 v[64:79], v[100:103], v[160:163], v[64:79]
    ds_read_b64_tr_b16 v[96:97], v11 offset:28672
    ds_read_b64_tr_b16 v[98:99], v11 offset:29184
    s_waitcnt lgkmcnt(4)
    v_mfma_f32_32x32x16_bf16 v[48:63], v[104:107], v[164:167], v[48:63]
    ds_read_b64_tr_b16 v[100:101], v12 offset:28672
    ds_read_b64_tr_b16 v[102:103], v12 offset:29184
    s_waitcnt lgkmcnt(4)
    v_mfma_f32_32x32x16_bf16 v[64:79], v[108:111], v[164:167], v[64:79]
    ds_read_b64_tr_b16 v[104:105], v11 offset:30720
    ds_read_b64_tr_b16 v[106:107], v11 offset:31232
    s_waitcnt lgkmcnt(4)
    v_mfma_f32_32x32x16_bf16 v[48:63], v[96:99], v[168:171], v[48:63]
    ds_read_b64_tr_b16 v[108:109], v12 offset:30720
    ds_read_b64_tr_b16 v[110:111], v12 offset:31232
    s_add_u32 s29, s58, 0
    buffer_store_dwordx4 v[16:19], v1, s[12:15], s29 offen sc1
    s_waitcnt lgkmcnt(4)
    v_mfma_f32_32x32x16_bf16 v[64:79], v[100:103], v[168:171], v[64:79]
    ds_read_b64_tr_b16 v[96:97], v11 offset:32768
    ds_read_b64_tr_b16 v[98:99], v11 offset:33280
    s_waitcnt lgkmcnt(4)
    v_mfma_f32_32x32x16_bf16 v[48:63], v[104:107], v[172:175], v[48:63]
    ds_read_b64_tr_b16 v[100:101], v12 offset:32768
    ds_read_b64_tr_b16 v[102:103], v12 offset:33280
    s_waitcnt lgkmcnt(4)
    v_mfma_f32_32x32x16_bf16 v[64:79], v[108:111], v[172:175], v[64:79]
    ds_read_b64_tr_b16 v[104:105], v11 offset:34816
    ds_read_b64_tr_b16 v[106:107], v11 offset:35328
    s_add_u32 s29, s58, 1024
    buffer_store_dwordx4 v[20:23], v1, s[12:15], s29 offen sc1
    s_waitcnt lgkmcnt(4)
    v_mfma_f32_32x32x16_bf16 v[48:63], v[96:99], v[176:179], v[48:63]
    s_barrier
    ds_read_b64_tr_b16 v[108:109], v12 offset:34816
    ds_read_b64_tr_b16 v[110:111], v12 offset:35328
    s_waitcnt lgkmcnt(4)
    v_mfma_f32_32x32x16_bf16 v[64:79], v[100:103], v[176:179], v[64:79]
    v_add_u32 v11, 0xfffe5000, v11
    ds_read_b64_tr_b16 v[96:97], v11 offset:0
    ds_read_b64_tr_b16 v[98:99], v11 offset:512
    s_waitcnt lgkmcnt(4)
    v_mfma_f32_32x32x16_bf16 v[48:63], v[104:107], v[180:183], v[48:63]
    v_add_u32 v12, 0xfffe5000, v12
    ds_read_b64_tr_b16 v[100:101], v12 offset:0
    ds_read_b64_tr_b16 v[102:103], v12 offset:512
    s_waitcnt lgkmcnt(4)
    v_mfma_f32_32x32x16_bf16 v[64:79], v[108:111], v[180:183], v[64:79]
    ds_read_b64_tr_b16 v[104:105], v11 offset:2048
    ds_read_b64_tr_b16 v[106:107], v11 offset:2560
    s_waitcnt lgkmcnt(4)
    v_mfma_f32_32x32x16_bf16 v[48:63], v[96:99], v[184:187], v[48:63]
    ds_read_b64_tr_b16 v[108:109], v12 offset:2048
    ds_read_b64_tr_b16 v[110:111], v12 offset:2560
    s_waitcnt lgkmcnt(4)
    v_mfma_f32_32x32x16_bf16 v[64:79], v[100:103], v[184:187], v[64:79]
    ds_read_b64_tr_b16 v[96:97], v11 offset:4096
    ds_read_b64_tr_b16 v[98:99], v11 offset:4608
    s_waitcnt lgkmcnt(4)
    v_mfma_f32_32x32x16_bf16 v[48:63], v[104:107], v[188:191], v[48:63]
    ds_read_b64_tr_b16 v[100:101], v12 offset:4096
    ds_read_b64_tr_b16 v[102:103], v12 offset:4608
    s_waitcnt lgkmcnt(4)
    v_mfma_f32_32x32x16_bf16 v[64:79], v[108:111], v[188:191], v[64:79]
    ds_read_b64_tr_b16 v[104:105], v11 offset:6144
    ds_read_b64_tr_b16 v[106:107], v11 offset:6656
    s_waitcnt lgkmcnt(4)
    v_mfma_f32_32x32x16_bf16 v[48:63], v[96:99], v[192:195], v[48:63]
    ds_read_b64_tr_b16 v[108:109], v12 offset:6144
    ds_read_b64_tr_b16 v[110:111], v12 offset:6656
    s_waitcnt lgkmcnt(4)
    v_mfma_f32_32x32x16_bf16 v[64:79], v[100:103], v[192:195], v[64:79]
    ds_read_b64_tr_b16 v[96:97], v11 offset:8192
    ds_read_b64_tr_b16 v[98:99], v11 offset:8704
    s_waitcnt lgkmcnt(4)
    v_mfma_f32_32x32x16_bf16 v[48:63], v[104:107], v[196:199], v[48:63]
    ds_read_b64_tr_b16 v[100:101], v12 offset:8192
    ds_read_b64_tr_b16 v[102:103], v12 offset:8704
    v_lshlrev_b32 v15, 7, v0
    s_waitcnt lgkmcnt(4)
    v_mfma_f32_32x32x16_bf16 v[64:79], v[108:111], v[196:199], v[64:79]
    ds_read_b64_tr_b16 v[104:105], v11 offset:10240
    ds_read_b64_tr_b16 v[106:107], v11 offset:10752
    s_mov_b32 exec_hi, 0x1ff
    buffer_load_dword v14, v15, s[68:71], s78 offen
    s_mov_b64 exec, -1
    s_waitcnt lgkmcnt(4)
    v_mfma_f32_32x32x16_bf16 v[48:63], v[96:99], v[200:203], v[48:63]
    ds_read_b64_tr_b16 v[108:109], v12 offset:10240
    ds_read_b64_tr_b16 v[110:111], v12 offset:10752
    s_mov_b32 exec_hi, 0
    s_mov_b32 exec_lo, 0x3f
    buffer_load_dword v14, v15, s[72:75], s79 offen
    s_mov_b64 exec, -1
    s_waitcnt lgkmcnt(4)
    v_mfma_f32_32x32x16_bf16 v[64:79], v[100:103], v[200:203], v[64:79]
    ds_read_b64_tr_b16 v[96:97], v11 offset:12288
    ds_read_b64_tr_b16 v[98:99], v11 offset:12800
    s_waitcnt lgkmcnt(4)
    v_mfma_f32_32x32x16_bf16 v[48:63], v[104:107], v[204:207], v[48:63]
    ds_read_b64_tr_b16 v[100:101], v12 offset:12288
    ds_read_b64_tr_b16 v[102:103], v12 offset:12800
    s_waitcnt lgkmcnt(4)
    v_mfma_f32_32x32x16_bf16 v[64:79], v[108:111], v[204:207], v[64:79]
    ds_read_b64_tr_b16 v[104:105], v11 offset:14336
    ds_read_b64_tr_b16 v[106:107], v11 offset:14848
    s_waitcnt lgkmcnt(4)
    v_mfma_f32_32x32x16_bf16 v[48:63], v[96:99], v[208:211], v[48:63]
    ds_read_b64_tr_b16 v[108:109], v12 offset:14336
    ds_read_b64_tr_b16 v[110:111], v12 offset:14848
    s_waitcnt lgkmcnt(4)
    v_mfma_f32_32x32x16_bf16 v[64:79], v[100:103], v[208:211], v[64:79]
    ds_read_b64_tr_b16 v[96:97], v11 offset:16384
    ds_read_b64_tr_b16 v[98:99], v11 offset:16896
    s_waitcnt lgkmcnt(4)
    v_mfma_f32_32x32x16_bf16 v[48:63], v[104:107], v[212:215], v[48:63]
    ds_read_b64_tr_b16 v[100:101], v12 offset:16384
    ds_read_b64_tr_b16 v[102:103], v12 offset:16896
    s_waitcnt lgkmcnt(4)
    v_mfma_f32_32x32x16_bf16 v[64:79], v[108:111], v[212:215], v[64:79]
    ds_read_b64_tr_b16 v[104:105], v11 offset:18432
    ds_read_b64_tr_b16 v[106:107], v11 offset:18944
    s_waitcnt lgkmcnt(4)
    v_mfma_f32_32x32x16_bf16 v[48:63], v[96:99], v[216:219], v[48:63]
    ds_read_b64_tr_b16 v[108:109], v12 offset:18432
    ds_read_b64_tr_b16 v[110:111], v12 offset:18944
    s_waitcnt lgkmcnt(4)
    v_mfma_f32_32x32x16_bf16 v[64:79], v[100:103], v[216:219], v[64:79]
    ds_read_b64_tr_b16 v[96:97], v11 offset:20480
    ds_read_b64_tr_b16 v[98:99], v11 offset:20992
    s_waitcnt lgkmcnt(4)
    v_mfma_f32_32x32x16_bf16 v[48:63], v[104:107], v[220:223], v[48:63]
    ds_read_b64_tr_b16 v[100:101], v12 offset:20480
    ds_read_b64_tr_b16 v[102:103], v12 offset:20992
    s_waitcnt lgkmcnt(4)
    v_mfma_f32_32x32x16_bf16 v[64:79], v[108:111], v[220:223], v[64:79]
    ds_read_b64_tr_b16 v[104:105], v11 offset:22528
    ds_read_b64_tr_b16 v[106:107], v11 offset:23040
    s_waitcnt lgkmcnt(4)
    v_mfma_f32_32x32x16_bf16 v[48:63], v[96:99], v[224:227], v[48:63]
    ds_read_b64_tr_b16 v[108:109], v12 offset:22528
    ds_read_b64_tr_b16 v[110:111], v12 offset:23040
    s_waitcnt lgkmcnt(4)
    v_mfma_f32_32x32x16_bf16 v[64:79], v[100:103], v[224:227], v[64:79]
    ds_read_b64_tr_b16 v[96:97], v11 offset:24576
    ds_read_b64_tr_b16 v[98:99], v11 offset:25088
    s_waitcnt lgkmcnt(4)
    v_mfma_f32_32x32x16_bf16 v[48:63], v[104:107], v[228:231], v[48:63]
    ds_read_b64_tr_b16 v[100:101], v12 offset:24576
    ds_read_b64_tr_b16 v[102:103], v12 offset:25088
    s_waitcnt lgkmcnt(4)
    v_mfma_f32_32x32x16_bf16 v[64:79], v[108:111], v[228:231], v[64:79]
    ds_read_b64_tr_b16 v[104:105], v11 offset:26624
    ds_read_b64_tr_b16 v[106:107], v11 offset:27136
    s_waitcnt lgkmcnt(4)
    v_mfma_f32_32x32x16_bf16 v[48:63], v[96:99], v[232:235], v[48:63]
    ds_read_b64_tr_b16 v[108:109], v12 offset:26624
    ds_read_b64_tr_b16 v[110:111], v12 offset:27136
    s_waitcnt lgkmcnt(4)
    v_mfma_f32_32x32x16_bf16 v[64:79], v[100:103], v[232:235], v[64:79]
    ds_read_b64_tr_b16 v[96:97], v11 offset:28672
    ds_read_b64_tr_b16 v[98:99], v11 offset:29184
    s_waitcnt lgkmcnt(4)
    v_mfma_f32_32x32x16_bf16 v[48:63], v[104:107], v[236:239], v[48:63]
    ds_read_b64_tr_b16 v[100:101], v12 offset:28672
    ds_read_b64_tr_b16 v[102:103], v12 offset:29184
    s_waitcnt lgkmcnt(4)
    v_mfma_f32_32x32x16_bf16 v[64:79], v[108:111], v[236:239], v[64:79]
    ds_read_b64_tr_b16 v[104:105], v11 offset:30720
    ds_read_b64_tr_b16 v[106:107], v11 offset:31232
    s_waitcnt lgkmcnt(4)
    v_mfma_f32_32x32x16_bf16 v[48:63], v[96:99], v[240:243], v[48:63]
    ds_read_b64_tr_b16 v[108:109], v12 offset:30720
    ds_read_b64_tr_b16 v[110:111], v12 offset:31232
    s_add_u32 s29, s59, 0
    buffer_store_dwordx4 v[32:35], v1, s[12:15], s29 offen sc1
    s_waitcnt lgkmcnt(4)
    v_mfma_f32_32x32x16_bf16 v[64:79], v[100:103], v[240:243], v[64:79]
    ds_read_b64_tr_b16 v[96:97], v11 offset:32768
    ds_read_b64_tr_b16 v[98:99], v11 offset:33280
    s_waitcnt lgkmcnt(4)
    v_mfma_f32_32x32x16_bf16 v[48:63], v[104:107], v[244:247], v[48:63]
    ds_read_b64_tr_b16 v[100:101], v12 offset:32768
    ds_read_b64_tr_b16 v[102:103], v12 offset:33280
    s_waitcnt lgkmcnt(4)
    v_mfma_f32_32x32x16_bf16 v[64:79], v[108:111], v[244:247], v[64:79]
    ds_read_b64_tr_b16 v[104:105], v11 offset:34816
    ds_read_b64_tr_b16 v[106:107], v11 offset:35328
    s_add_u32 s29, s59, 1024
    buffer_store_dwordx4 v[36:39], v1, s[12:15], s29 offen sc1
    s_waitcnt lgkmcnt(4)
    v_mfma_f32_32x32x16_bf16 v[48:63], v[96:99], v[248:251], v[48:63]
    s_barrier
    ds_read_b64_tr_b16 v[108:109], v12 offset:34816
    ds_read_b64_tr_b16 v[110:111], v12 offset:35328
    s_waitcnt lgkmcnt(4)
    v_mfma_f32_32x32x16_bf16 v[64:79], v[100:103], v[248:251], v[64:79]
    v_add_u32 v11, 0x9000, v11
    ds_read_b64_tr_b16 v[96:97], v11 offset:0
    ds_read_b64_tr_b16 v[98:99], v11 offset:512
    s_waitcnt lgkmcnt(4)
    v_mfma_f32_32x32x16_bf16 v[48:63], v[104:107], v[252:255], v[48:63]
    v_add_u32 v12, 0x9000, v12
    ds_read_b64_tr_b16 v[100:101], v12 offset:0
    ds_read_b64_tr_b16 v[102:103], v12 offset:512
    s_waitcnt lgkmcnt(4)
    v_mfma_f32_32x32x16_bf16 v[64:79], v[108:111], v[252:255], v[64:79]
    ds_read_b64_tr_b16 v[104:105], v11 offset:2048
    ds_read_b64_tr_b16 v[106:107], v11 offset:2560
    s_add_u32 s58, s43, 4096
    s_add_u32 s59, s43, 6144
    s_waitcnt lgkmcnt(4)
    v_mfma_f32_32x32x16_bf16 v[16:31], v[96:99], v[112:115], 0
    ds_read_b64_tr_b16 v[108:109], v12 offset:2048
    ds_read_b64_tr_b16 v[110:111], v12 offset:2560
    s_waitcnt lgkmcnt(4)
    v_mfma_f32_32x32x16_bf16 v[32:47], v[100:103], v[112:115], 0
    ds_read_b64_tr_b16 v[96:97], v11 offset:4096
    ds_read_b64_tr_b16 v[98:99], v11 offset:4608
    s_waitcnt lgkmcnt(4)
    v_mfma_f32_32x32x16_bf16 v[16:31], v[104:107], v[116:119], v[16:31]
    ds_read_b64_tr_b16 v[100:101], v12 offset:4096
    ds_read_b64_tr_b16 v[102:103], v12 offset:4608
    s_waitcnt lgkmcnt(4)
    v_mfma_f32_32x32x16_bf16 v[32:47], v[108:111], v[116:119], v[32:47]
    ds_read_b64_tr_b16 v[104:105], v11 offset:6144
    ds_read_b64_tr_b16 v[106:107], v11 offset:6656
    s_waitcnt lgkmcnt(4)
    v_mfma_f32_32x32x16_bf16 v[16:31], v[96:99], v[120:123], v[16:31]
    ds_read_b64_tr_b16 v[108:109], v12 offset:6144
    ds_read_b64_tr_b16 v[110:111], v12 offset:6656
    s_waitcnt lgkmcnt(4)
    v_mfma_f32_32x32x16_bf16 v[32:47], v[100:103], v[120:123], v[32:47]
    ds_read_b64_tr_b16 v[96:97], v11 offset:8192
    ds_read_b64_tr_b16 v[98:99], v11 offset:8704
    s_waitcnt lgkmcnt(4)
    v_mfma_f32_32x32x16_bf16 v[16:31], v[104:107], v[124:127], v[16:31]
    ds_read_b64_tr_b16 v[100:101], v12 offset:8192
    ds_read_b64_tr_b16 v[102:103], v12 offset:8704
    v_cvt_pk_bf16_f32 v48, v48, v49
    v_cvt_pk_bf16_f32 v49, v50, v51
    v_cvt_pk_bf16_f32 v50, v52, v53
    s_waitcnt lgkmcnt(4)
    v_mfma_f32_32x32x16_bf16 v[32:47], v[108:111], v[124:127], v[32:47]
    ds_read_b64_tr_b16 v[104:105], v11 offset:10240
    ds_read_b64_tr_b16 v[106:107], v11 offset:10752
    v_cvt_pk_bf16_f32 v51, v54, v55
    v_pk_max_i16 v48, v48, 0
    v_pk_max_i16 v49, v49, 0
    s_waitcnt lgkmcnt(4)
    v_mfma_f32_32x32x16_bf16 v[16:31], v[96:99], v[128:131], v[16:31]
    ds_read_b64_tr_b16 v[108:109], v12 offset:10240
    ds_read_b64_tr_b16 v[110:111], v12 offset:10752
    v_pk_max_i16 v50, v50, 0
    v_pk_max_i16 v51, v51, 0
    s_waitcnt lgkmcnt(4)
    v_mfma_f32_32x32x16_bf16 v[32:47], v[100:103], v[128:131], v[32:47]
    ds_read_b64_tr_b16 v[96:97], v11 offset:12288
    ds_read_b64_tr_b16 v[98:99], v11 offset:12800
    v_cvt_pk_bf16_f32 v52, v56, v57
    v_cvt_pk_bf16_f32 v53, v58, v59
    s_waitcnt lgkmcnt(4)
    v_mfma_f32_32x32x16_bf16 v[16:31], v[104:107], v[132:135], v[16:31]
    ds_read_b64_tr_b16 v[100:101], v12 offset:12288
    ds_read_b64_tr_b16 v[102:103], v12 offset:12800
    v_cvt_pk_bf16_f32 v54, v60, v61
    v_cvt_pk_bf16_f32 v55, v62, v63
    s_waitcnt lgkmcnt(4)
    v_mfma_f32_32x32x16_bf16 v[32:47], v[108:111], v[132:135], v[32:47]
    ds_read_b64_tr_b16 v[104:105], v11 offset:14336
    ds_read_b64_tr_b16 v[106:107], v11 offset:14848
    v_pk_max_i16 v52, v52, 0
    v_pk_max_i16 v53, v53, 0
    s_waitcnt lgkmcnt(4)
    v_mfma_f32_32x32x16_bf16 v[16:31], v[96:99], v[136:139], v[16:31]
    ds_read_b64_tr_b16 v[108:109], v12 offset:14336
    ds_read_b64_tr_b16 v[110:111], v12 offset:14848
    v_pk_max_i16 v54, v54, 0
    v_pk_max_i16 v55, v55, 0
    s_waitcnt lgkmcnt(4)
    v_mfma_f32_32x32x16_bf16 v[32:47], v[100:103], v[136:139], v[32:47]
    ds_read_b64_tr_b16 v[96:97], v11 offset:16384
    ds_read_b64_tr_b16 v[98:99], v11 offset:16896
    v_cvt_pk_bf16_f32 v64, v64, v65
    v_cvt_pk_bf16_f32 v65, v66, v67
    s_waitcnt lgkmcnt(4)
    v_mfma_f32_32x32x16_bf16 v[16:31], v[104:107], v[140:143], v[16:31]
    ds_read_b64_tr_b16 v[100:101], v12 offset:16384
    ds_read_b64_tr_b16 v[102:103], v12 offset:16896
    v_cvt_pk_bf16_f32 v66, v68, v69
    v_cvt_pk_bf16_f32 v67, v70, v71
    s_waitcnt lgkmcnt(4)
    v_mfma_f32_32x32x16_bf16 v[32:47], v[108:111], v[140:143], v[32:47]
    ds_read_b64_tr_b16 v[104:105], v11 offset:18432
    ds_read_b64_tr_b16 v[106:107], v11 offset:18944
    v_pk_max_i16 v64, v64, 0
    v_pk_max_i16 v65, v65, 0
    s_waitcnt lgkmcnt(4)
    v_mfma_f32_32x32x16_bf16 v[16:31], v[96:99], v[144:147], v[16:31]
    ds_read_b64_tr_b16 v[108:109], v12 offset:18432
    ds_read_b64_tr_b16 v[110:111], v12 offset:18944
    v_pk_max_i16 v66, v66, 0
    v_pk_max_i16 v67, v67, 0
    s_waitcnt lgkmcnt(4)
    v_mfma_f32_32x32x16_bf16 v[32:47], v[100:103], v[144:147], v[32:47]
    ds_read_b64_tr_b16 v[96:97], v11 offset:20480
    ds_read_b64_tr_b16 v[98:99], v11 offset:20992
    v_cvt_pk_bf16_f32 v68, v72, v73
    v_cvt_pk_bf16_f32 v69, v74, v75
    s_waitcnt lgkmcnt(4)
    v_mfma_f32_32x32x16_bf16 v[16:31], v[104:107], v[148:151], v[16:31]
    ds_read_b64_tr_b16 v[100:101], v12 offset:20480
    ds_read_b64_tr_b16 v[102:103], v12 offset:20992
    v_cvt_pk_bf16_f32 v70, v76, v77
    v_cvt_pk_bf16_f32 v71, v78, v79
    s_waitcnt lgkmcnt(4)
    v_mfma_f32_32x32x16_bf16 v[32:47], v[108:111], v[148:151], v[32:47]
    ds_read_b64_tr_b16 v[104:105], v11 offset:22528
    ds_read_b64_tr_b16 v[106:107], v11 offset:23040
    v_pk_max_i16 v68, v68, 0
    v_pk_max_i16 v69, v69, 0
    s_waitcnt lgkmcnt(4)
    v_mfma_f32_32x32x16_bf16 v[16:31], v[96:99], v[152:155], v[16:31]
    ds_read_b64_tr_b16 v[108:109], v12 offset:22528
    ds_read_b64_tr_b16 v[110:111], v12 offset:23040
    v_pk_max_i16 v70, v70, 0
    v_pk_max_i16 v71, v71, 0
    s_waitcnt lgkmcnt(4)
    v_mfma_f32_32x32x16_bf16 v[32:47], v[100:103], v[152:155], v[32:47]
    ds_read_b64_tr_b16 v[96:97], v11 offset:24576
    ds_read_b64_tr_b16 v[98:99], v11 offset:25088
    s_waitcnt lgkmcnt(4)
    v_mfma_f32_32x32x16_bf16 v[16:31], v[104:107], v[156:159], v[16:31]
    ds_read_b64_tr_b16 v[100:101], v12 offset:24576
    ds_read_b64_tr_b16 v[102:103], v12 offset:25088
    s_waitcnt lgkmcnt(4)
    v_mfma_f32_32x32x16_bf16 v[32:47], v[108:111], v[156:159], v[32:47]
    ds_read_b64_tr_b16 v[104:105], v11 offset:26624
    ds_read_b64_tr_b16 v[106:107], v11 offset:27136
    s_waitcnt lgkmcnt(4)
    v_mfma_f32_32x32x16_bf16 v[16:31], v[96:99], v[160:163], v[16:31]
    ds_read_b64_tr_b16 v[108:109], v12 offset:26624
    ds_read_b64_tr_b16 v[110:111], v12 offset:27136
    s_waitcnt lgkmcnt(4)
    v_mfma_f32_32x32x16_bf16 v[32:47], v[100:103], v[160:163], v[32:47]
    ds_read_b64_tr_b16 v[96:97], v11 offset:28672
    ds_read_b64_tr_b16 v[98:99], v11 offset:29184
    s_waitcnt lgkmcnt(4)
    v_mfma_f32_32x32x16_bf16 v[16:31], v[104:107], v[164:167], v[16:31]
    ds_read_b64_tr_b16 v[100:101], v12 offset:28672
    ds_read_b64_tr_b16 v[102:103], v12 offset:29184
    s_waitcnt lgkmcnt(4)
    v_mfma_f32_32x32x16_bf16 v[32:47], v[108:111], v[164:167], v[32:47]
    ds_read_b64_tr_b16 v[104:105], v11 offset:30720
    ds_read_b64_tr_b16 v[106:107], v11 offset:31232
    s_waitcnt lgkmcnt(4)
    v_mfma_f32_32x32x16_bf16 v[16:31], v[96:99], v[168:171], v[16:31]
    ds_read_b64_tr_b16 v[108:109], v12 offset:30720
    ds_read_b64_tr_b16 v[110:111], v12 offset:31232
    s_add_u32 s29, s58, 0
    buffer_store_dwordx4 v[48:51], v1, s[12:15], s29 offen sc1
    s_waitcnt lgkmcnt(4)
    v_mfma_f32_32x32x16_bf16 v[32:47], v[100:103], v[168:171], v[32:47]
    ds_read_b64_tr_b16 v[96:97], v11 offset:32768
    ds_read_b64_tr_b16 v[98:99], v11 offset:33280
    s_waitcnt lgkmcnt(4)
    v_mfma_f32_32x32x16_bf16 v[16:31], v[104:107], v[172:175], v[16:31]
    ds_read_b64_tr_b16 v[100:101], v12 offset:32768
    ds_read_b64_tr_b16 v[102:103], v12 offset:33280
    s_waitcnt lgkmcnt(4)
    v_mfma_f32_32x32x16_bf16 v[32:47], v[108:111], v[172:175], v[32:47]
    ds_read_b64_tr_b16 v[104:105], v11 offset:34816
    ds_read_b64_tr_b16 v[106:107], v11 offset:35328
    s_add_u32 s29, s58, 1024
    buffer_store_dwordx4 v[52:55], v1, s[12:15], s29 offen sc1
    s_waitcnt lgkmcnt(4)
    v_mfma_f32_32x32x16_bf16 v[16:31], v[96:99], v[176:179], v[16:31]
    s_barrier
    ds_read_b64_tr_b16 v[108:109], v12 offset:34816
    ds_read_b64_tr_b16 v[110:111], v12 offset:35328
    s_waitcnt lgkmcnt(4)
    v_mfma_f32_32x32x16_bf16 v[32:47], v[100:103], v[176:179], v[32:47]
    v_add_u32 v11, 0x9000, v11
    ds_read_b64_tr_b16 v[96:97], v11 offset:0
    ds_read_b64_tr_b16 v[98:99], v11 offset:512
    s_waitcnt lgkmcnt(4)
    v_mfma_f32_32x32x16_bf16 v[16:31], v[104:107], v[180:183], v[16:31]
    v_add_u32 v12, 0x9000, v12
    ds_read_b64_tr_b16 v[100:101], v12 offset:0
    ds_read_b64_tr_b16 v[102:103], v12 offset:512
    s_waitcnt lgkmcnt(4)
    v_mfma_f32_32x32x16_bf16 v[32:47], v[108:111], v[180:183], v[32:47]
    ds_read_b64_tr_b16 v[104:105], v11 offset:2048
    ds_read_b64_tr_b16 v[106:107], v11 offset:2560
    s_waitcnt lgkmcnt(4)
    v_mfma_f32_32x32x16_bf16 v[16:31], v[96:99], v[184:187], v[16:31]
    ds_read_b64_tr_b16 v[108:109], v12 offset:2048
    ds_read_b64_tr_b16 v[110:111], v12 offset:2560
    s_waitcnt lgkmcnt(4)
    v_mfma_f32_32x32x16_bf16 v[32:47], v[100:103], v[184:187], v[32:47]
    ds_read_b64_tr_b16 v[96:97], v11 offset:4096
    ds_read_b64_tr_b16 v[98:99], v11 offset:4608
    s_waitcnt lgkmcnt(4)
    v_mfma_f32_32x32x16_bf16 v[16:31], v[104:107], v[188:191], v[16:31]
    ds_read_b64_tr_b16 v[100:101], v12 offset:4096
    ds_read_b64_tr_b16 v[102:103], v12 offset:4608
    s_waitcnt lgkmcnt(4)
    v_mfma_f32_32x32x16_bf16 v[32:47], v[108:111], v[188:191], v[32:47]
    ds_read_b64_tr_b16 v[104:105], v11 offset:6144
    ds_read_b64_tr_b16 v[106:107], v11 offset:6656
    s_waitcnt lgkmcnt(4)
    v_mfma_f32_32x32x16_bf16 v[16:31], v[96:99], v[192:195], v[16:31]
    ds_read_b64_tr_b16 v[108:109], v12 offset:6144
    ds_read_b64_tr_b16 v[110:111], v12 offset:6656
    s_waitcnt lgkmcnt(4)
    v_mfma_f32_32x32x16_bf16 v[32:47], v[100:103], v[192:195], v[32:47]
    ds_read_b64_tr_b16 v[96:97], v11 offset:8192
    ds_read_b64_tr_b16 v[98:99], v11 offset:8704
    s_waitcnt lgkmcnt(4)
    v_mfma_f32_32x32x16_bf16 v[16:31], v[104:107], v[196:199], v[16:31]
    ds_read_b64_tr_b16 v[100:101], v12 offset:8192
    ds_read_b64_tr_b16 v[102:103], v12 offset:8704
    s_waitcnt lgkmcnt(4)
    v_mfma_f32_32x32x16_bf16 v[32:47], v[108:111], v[196:199], v[32:47]
    ds_read_b64_tr_b16 v[104:105], v11 offset:10240
    ds_read_b64_tr_b16 v[106:107], v11 offset:10752
    s_waitcnt lgkmcnt(4)
    v_mfma_f32_32x32x16_bf16 v[16:31], v[96:99], v[200:203], v[16:31]
    ds_read_b64_tr_b16 v[108:109], v12 offset:10240
    ds_read_b64_tr_b16 v[110:111], v12 offset:10752
    s_waitcnt lgkmcnt(4)
    v_mfma_f32_32x32x16_bf16 v[32:47], v[100:103], v[200:203], v[32:47]
    ds_read_b64_tr_b16 v[96:97], v11 offset:12288
    ds_read_b64_tr_b16 v[98:99], v11 offset:12800
    s_waitcnt lgkmcnt(4)
    v_mfma_f32_32x32x16_bf16 v[16:31], v[104:107], v[204:207], v[16:31]
    ds_read_b64_tr_b16 v[100:101], v12 offset:12288
    ds_read_b64_tr_b16 v[102:103], v12 offset:12800
    s_waitcnt lgkmcnt(4)
    v_mfma_f32_32x32x16_bf16 v[32:47], v[108:111], v[204:207], v[32:47]
    ds_read_b64_tr_b16 v[104:105], v11 offset:14336
    ds_read_b64_tr_b16 v[106:107], v11 offset:14848
    s_waitcnt lgkmcnt(4)
    v_mfma_f32_32x32x16_bf16 v[16:31], v[96:99], v[208:211], v[16:31]
    ds_read_b64_tr_b16 v[108:109], v12 offset:14336
    ds_read_b64_tr_b16 v[110:111], v12 offset:14848
    s_waitcnt lgkmcnt(4)
    v_mfma_f32_32x32x16_bf16 v[32:47], v[100:103], v[208:211], v[32:47]
    ds_read_b64_tr_b16 v[96:97], v11 offset:16384
    ds_read_b64_tr_b16 v[98:99], v11 offset:16896
    s_waitcnt lgkmcnt(4)
    v_mfma_f32_32x32x16_bf16 v[16:31], v[104:107], v[212:215], v[16:31]
    ds_read_b64_tr_b16 v[100:101], v12 offset:16384
    ds_read_b64_tr_b16 v[102:103], v12 offset:16896
    s_waitcnt lgkmcnt(4)
    v_mfma_f32_32x32x16_bf16 v[32:47], v[108:111], v[212:215], v[32:47]
    ds_read_b64_tr_b16 v[104:105], v11 offset:18432
    ds_read_b64_tr_b16 v[106:107], v11 offset:18944
    s_waitcnt lgkmcnt(4)
    v_mfma_f32_32x32x16_bf16 v[16:31], v[96:99], v[216:219], v[16:31]
    ds_read_b64_tr_b16 v[108:109], v12 offset:18432
    ds_read_b64_tr_b16 v[110:111], v12 offset:18944
    s_waitcnt lgkmcnt(4)
    v_mfma_f32_32x32x16_bf16 v[32:47], v[100:103], v[216:219], v[32:47]
    ds_read_b64_tr_b16 v[96:97], v11 offset:20480
    ds_read_b64_tr_b16 v[98:99], v11 offset:20992
    s_waitcnt lgkmcnt(4)
    v_mfma_f32_32x32x16_bf16 v[16:31], v[104:107], v[220:223], v[16:31]
    ds_read_b64_tr_b16 v[100:101], v12 offset:20480
    ds_read_b64_tr_b16 v[102:103], v12 offset:20992
    s_waitcnt lgkmcnt(4)
    v_mfma_f32_32x32x16_bf16 v[32:47], v[108:111], v[220:223], v[32:47]
    ds_read_b64_tr_b16 v[104:105], v11 offset:22528
    ds_read_b64_tr_b16 v[106:107], v11 offset:23040
    s_waitcnt lgkmcnt(4)
    v_mfma_f32_32x32x16_bf16 v[16:31], v[96:99], v[224:227], v[16:31]
    ds_read_b64_tr_b16 v[108:109], v12 offset:22528
    ds_read_b64_tr_b16 v[110:111], v12 offset:23040
    s_waitcnt lgkmcnt(4)
    v_mfma_f32_32x32x16_bf16 v[32:47], v[100:103], v[224:227], v[32:47]
    ds_read_b64_tr_b16 v[96:97], v11 offset:24576
    ds_read_b64_tr_b16 v[98:99], v11 offset:25088
    s_waitcnt lgkmcnt(4)
    v_mfma_f32_32x32x16_bf16 v[16:31], v[104:107], v[228:231], v[16:31]
    ds_read_b64_tr_b16 v[100:101], v12 offset:24576
    ds_read_b64_tr_b16 v[102:103], v12 offset:25088
    s_waitcnt lgkmcnt(4)
    v_mfma_f32_32x32x16_bf16 v[32:47], v[108:111], v[228:231], v[32:47]
    ds_read_b64_tr_b16 v[104:105], v11 offset:26624
    ds_read_b64_tr_b16 v[106:107], v11 offset:27136
    s_waitcnt lgkmcnt(4)
    v_mfma_f32_32x32x16_bf16 v[16:31], v[96:99], v[232:235], v[16:31]
    ds_read_b64_tr_b16 v[108:109], v12 offset:26624
    ds_read_b64_tr_b16 v[110:111], v12 offset:27136
    s_waitcnt lgkmcnt(4)
    v_mfma_f32_32x32x16_bf16 v[32:47], v[100:103], v[232:235], v[32:47]
    ds_read_b64_tr_b16 v[96:97], v11 offset:28672
    ds_read_b64_tr_b16 v[98:99], v11 offset:29184
    s_waitcnt lgkmcnt(4)
    v_mfma_f32_32x32x16_bf16 v[16:31], v[104:107], v[236:239], v[16:31]
    ds_read_b64_tr_b16 v[100:101], v12 offset:28672
    ds_read_b64_tr_b16 v[102:103], v12 offset:29184
    s_waitcnt lgkmcnt(4)
    v_mfma_f32_32x32x16_bf16 v[32:47], v[108:111], v[236:239], v[32:47]
    ds_read_b64_tr_b16 v[104:105], v11 offset:30720
    ds_read_b64_tr_b16 v[106:107], v11 offset:31232
    s_waitcnt lgkmcnt(4)
    v_mfma_f32_32x32x16_bf16 v[16:31], v[96:99], v[240:243], v[16:31]
    ds_read_b64_tr_b16 v[108:109], v12 offset:30720
    ds_read_b64_tr_b16 v[110:111], v12 offset:31232
    s_add_u32 s29, s59, 0
    buffer_store_dwordx4 v[64:67], v1, s[12:15], s29 offen sc1
    s_waitcnt lgkmcnt(4)
    v_mfma_f32_32x32x16_bf16 v[32:47], v[100:103], v[240:243], v[32:47]
    ds_read_b64_tr_b16 v[96:97], v11 offset:32768
    ds_read_b64_tr_b16 v[98:99], v11 offset:33280
    s_waitcnt lgkmcnt(4)
    v_mfma_f32_32x32x16_bf16 v[16:31], v[104:107], v[244:247], v[16:31]
    ds_read_b64_tr_b16 v[100:101], v12 offset:32768
    ds_read_b64_tr_b16 v[102:103], v12 offset:33280
    s_waitcnt lgkmcnt(4)
    v_mfma_f32_32x32x16_bf16 v[32:47], v[108:111], v[244:247], v[32:47]
    ds_read_b64_tr_b16 v[104:105], v11 offset:34816
    ds_read_b64_tr_b16 v[106:107], v11 offset:35328
    s_add_u32 s29, s59, 1024
    buffer_store_dwordx4 v[68:71], v1, s[12:15], s29 offen sc1
    s_waitcnt lgkmcnt(4)
    v_mfma_f32_32x32x16_bf16 v[16:31], v[96:99], v[248:251], v[16:31]
    s_barrier
    ds_read_b64_tr_b16 v[108:109], v12 offset:34816
    ds_read_b64_tr_b16 v[110:111], v12 offset:35328
    s_waitcnt lgkmcnt(4)
    v_mfma_f32_32x32x16_bf16 v[32:47], v[100:103], v[248:251], v[32:47]
    v_add_u32 v11, 0x9000, v11
    ds_read_b64_tr_b16 v[96:97], v11 offset:0
    ds_read_b64_tr_b16 v[98:99], v11 offset:512
    s_waitcnt lgkmcnt(4)
    v_mfma_f32_32x32x16_bf16 v[16:31], v[104:107], v[252:255], v[16:31]
    v_add_u32 v12, 0x9000, v12
    ds_read_b64_tr_b16 v[100:101], v12 offset:0
    ds_read_b64_tr_b16 v[102:103], v12 offset:512
    s_waitcnt lgkmcnt(4)
    v_mfma_f32_32x32x16_bf16 v[32:47], v[108:111], v[252:255], v[32:47]
    ds_read_b64_tr_b16 v[104:105], v11 offset:2048
    ds_read_b64_tr_b16 v[106:107], v11 offset:2560
    s_add_u32 s58, s43, 8192
    s_add_u32 s59, s43, 10240
    s_waitcnt lgkmcnt(4)
    v_mfma_f32_32x32x16_bf16 v[48:63], v[96:99], v[112:115], 0
    ds_read_b64_tr_b16 v[108:109], v12 offset:2048
    ds_read_b64_tr_b16 v[110:111], v12 offset:2560
    s_waitcnt lgkmcnt(4)
    v_mfma_f32_32x32x16_bf16 v[64:79], v[100:103], v[112:115], 0
    ds_read_b64_tr_b16 v[96:97], v11 offset:4096
    ds_read_b64_tr_b16 v[98:99], v11 offset:4608
    s_waitcnt lgkmcnt(4)
    v_mfma_f32_32x32x16_bf16 v[48:63], v[104:107], v[116:119], v[48:63]
    ds_read_b64_tr_b16 v[100:101], v12 offset:4096
    ds_read_b64_tr_b16 v[102:103], v12 offset:4608
    s_waitcnt lgkmcnt(4)
    v_mfma_f32_32x32x16_bf16 v[64:79], v[108:111], v[116:119], v[64:79]
    ds_read_b64_tr_b16 v[104:105], v11 offset:6144
    ds_read_b64_tr_b16 v[106:107], v11 offset:6656
    s_waitcnt lgkmcnt(4)
    v_mfma_f32_32x32x16_bf16 v[48:63], v[96:99], v[120:123], v[48:63]
    ds_read_b64_tr_b16 v[108:109], v12 offset:6144
    ds_read_b64_tr_b16 v[110:111], v12 offset:6656
    s_waitcnt lgkmcnt(4)
    v_mfma_f32_32x32x16_bf16 v[64:79], v[100:103], v[120:123], v[64:79]
    ds_read_b64_tr_b16 v[96:97], v11 offset:8192
    ds_read_b64_tr_b16 v[98:99], v11 offset:8704
    s_waitcnt lgkmcnt(4)
    v_mfma_f32_32x32x16_bf16 v[48:63], v[104:107], v[124:127], v[48:63]
    ds_read_b64_tr_b16 v[100:101], v12 offset:8192
    ds_read_b64_tr_b16 v[102:103], v12 offset:8704
    v_cvt_pk_bf16_f32 v16, v16, v17
    v_cvt_pk_bf16_f32 v17, v18, v19
    v_cvt_pk_bf16_f32 v18, v20, v21
    s_waitcnt lgkmcnt(4)
    v_mfma_f32_32x32x16_bf16 v[64:79], v[108:111], v[124:127], v[64:79]
    ds_read_b64_tr_b16 v[104:105], v11 offset:10240
    ds_read_b64_tr_b16 v[106:107], v11 offset:10752
    v_cvt_pk_bf16_f32 v19, v22, v23
    v_pk_max_i16 v16, v16, 0
    v_pk_max_i16 v17, v17, 0
    s_waitcnt lgkmcnt(4)
    v_mfma_f32_32x32x16_bf16 v[48:63], v[96:99], v[128:131], v[48:63]
    ds_read_b64_tr_b16 v[108:109], v12 offset:10240
    ds_read_b64_tr_b16 v[110:111], v12 offset:10752
    v_pk_max_i16 v18, v18, 0
    v_pk_max_i16 v19, v19, 0
    s_waitcnt lgkmcnt(4)
    v_mfma_f32_32x32x16_bf16 v[64:79], v[100:103], v[128:131], v[64:79]
    ds_read_b64_tr_b16 v[96:97], v11 offset:12288
    ds_read_b64_tr_b16 v[98:99], v11 offset:12800
    v_cvt_pk_bf16_f32 v20, v24, v25
    v_cvt_pk_bf16_f32 v21, v26, v27
    s_waitcnt lgkmcnt(4)
    v_mfma_f32_32x32x16_bf16 v[48:63], v[104:107], v[132:135], v[48:63]
    ds_read_b64_tr_b16 v[100:101], v12 offset:12288
    ds_read_b64_tr_b16 v[102:103], v12 offset:12800
    v_cvt_pk_bf16_f32 v22, v28, v29
    v_cvt_pk_bf16_f32 v23, v30, v31
    s_waitcnt lgkmcnt(4)
    v_mfma_f32_32x32x16_bf16 v[64:79], v[108:111], v[132:135], v[64:79]
    ds_read_b64_tr_b16 v[104:105], v11 offset:14336
    ds_read_b64_tr_b16 v[106:107], v11 offset:14848
    v_pk_max_i16 v20, v20, 0
    v_pk_max_i16 v21, v21, 0
    s_waitcnt lgkmcnt(4)
    v_mfma_f32_32x32x16_bf16 v[48:63], v[96:99], v[136:139], v[48:63]
    ds_read_b64_tr_b16 v[108:109], v12 offset:14336
    ds_read_b64_tr_b16 v[110:111], v12 offset:14848
    v_pk_max_i16 v22, v22, 0
    v_pk_max_i16 v23, v23, 0
    s_waitcnt lgkmcnt(4)
    v_mfma_f32_32x32x16_bf16 v[64:79], v[100:103], v[136:139], v[64:79]
    ds_read_b64_tr_b16 v[96:97], v11 offset:16384
    ds_read_b64_tr_b16 v[98:99], v11 offset:16896
    v_cvt_pk_bf16_f32 v32, v32, v33
    v_cvt_pk_bf16_f32 v33, v34, v35
    s_waitcnt lgkmcnt(4)
    v_mfma_f32_32x32x16_bf16 v[48:63], v[104:107], v[140:143], v[48:63]
    ds_read_b64_tr_b16 v[100:101], v12 offset:16384
    ds_read_b64_tr_b16 v[102:103], v12 offset:16896
    v_cvt_pk_bf16_f32 v34, v36, v37
    v_cvt_pk_bf16_f32 v35, v38, v39
    s_waitcnt lgkmcnt(4)
    v_mfma_f32_32x32x16_bf16 v[64:79], v[108:111], v[140:143], v[64:79]
    ds_read_b64_tr_b16 v[104:105], v11 offset:18432
    ds_read_b64_tr_b16 v[106:107], v11 offset:18944
    v_pk_max_i16 v32, v32, 0
    v_pk_max_i16 v33, v33, 0
    s_waitcnt lgkmcnt(4)
    v_mfma_f32_32x32x16_bf16 v[48:63], v[96:99], v[144:147], v[48:63]
    ds_read_b64_tr_b16 v[108:109], v12 offset:18432
    ds_read_b64_tr_b16 v[110:111], v12 offset:18944
    v_pk_max_i16 v34, v34, 0
    v_pk_max_i16 v35, v35, 0
    s_waitcnt lgkmcnt(4)
    v_mfma_f32_32x32x16_bf16 v[64:79], v[100:103], v[144:147], v[64:79]
    ds_read_b64_tr_b16 v[96:97], v11 offset:20480
    ds_read_b64_tr_b16 v[98:99], v11 offset:20992
    v_cvt_pk_bf16_f32 v36, v40, v41
    v_cvt_pk_bf16_f32 v37, v42, v43
    s_waitcnt lgkmcnt(4)
    v_mfma_f32_32x32x16_bf16 v[48:63], v[104:107], v[148:151], v[48:63]
    ds_read_b64_tr_b16 v[100:101], v12 offset:20480
    ds_read_b64_tr_b16 v[102:103], v12 offset:20992
    v_cvt_pk_bf16_f32 v38, v44, v45
    v_cvt_pk_bf16_f32 v39, v46, v47
    s_waitcnt lgkmcnt(4)
    v_mfma_f32_32x32x16_bf16 v[64:79], v[108:111], v[148:151], v[64:79]
    ds_read_b64_tr_b16 v[104:105], v11 offset:22528
    ds_read_b64_tr_b16 v[106:107], v11 offset:23040
    v_pk_max_i16 v36, v36, 0
    v_pk_max_i16 v37, v37, 0
    s_waitcnt lgkmcnt(4)
    v_mfma_f32_32x32x16_bf16 v[48:63], v[96:99], v[152:155], v[48:63]
    ds_read_b64_tr_b16 v[108:109], v12 offset:22528
    ds_read_b64_tr_b16 v[110:111], v12 offset:23040
    v_pk_max_i16 v38, v38, 0
    v_pk_max_i16 v39, v39, 0
    s_waitcnt lgkmcnt(4)
    v_mfma_f32_32x32x16_bf16 v[64:79], v[100:103], v[152:155], v[64:79]
    ds_read_b64_tr_b16 v[96:97], v11 offset:24576
    ds_read_b64_tr_b16 v[98:99], v11 offset:25088
    s_waitcnt lgkmcnt(4)
    v_mfma_f32_32x32x16_bf16 v[48:63], v[104:107], v[156:159], v[48:63]
    ds_read_b64_tr_b16 v[100:101], v12 offset:24576
    ds_read_b64_tr_b16 v[102:103], v12 offset:25088
    s_add_u32 s29, s58, 0
    buffer_store_dwordx4 v[16:19], v1, s[12:15], s29 offen sc1
    s_waitcnt lgkmcnt(4)
    v_mfma_f32_32x32x16_bf16 v[64:79], v[108:111], v[156:159], v[64:79]
    ds_read_b64_tr_b16 v[104:105], v11 offset:26624
    ds_read_b64_tr_b16 v[106:107], v11 offset:27136
    s_waitcnt lgkmcnt(4)
    v_mfma_f32_32x32x16_bf16 v[48:63], v[96:99], v[160:163], v[48:63]
    ds_read_b64_tr_b16 v[108:109], v12 offset:26624
    ds_read_b64_tr_b16 v[110:111], v12 offset:27136
    s_waitcnt lgkmcnt(4)
    v_mfma_f32_32x32x16_bf16 v[64:79], v[100:103], v[160:163], v[64:79]
    ds_read_b64_tr_b16 v[96:97], v11 offset:28672
    ds_read_b64_tr_b16 v[98:99], v11 offset:29184
    s_add_u32 s29, s58, 1024
    buffer_store_dwordx4 v[20:23], v1, s[12:15], s29 offen sc1
    s_waitcnt lgkmcnt(4)
    v_mfma_f32_32x32x16_bf16 v[48:63], v[104:107], v[164:167], v[48:63]
    ds_read_b64_tr_b16 v[100:101], v12 offset:28672
    ds_read_b64_tr_b16 v[102:103], v12 offset:29184
    s_waitcnt lgkmcnt(4)
    v_mfma_f32_32x32x16_bf16 v[64:79], v[108:111], v[164:167], v[64:79]
    ds_read_b64_tr_b16 v[104:105], v11 offset:30720
    ds_read_b64_tr_b16 v[106:107], v11 offset:31232
    s_waitcnt lgkmcnt(4)
    v_mfma_f32_32x32x16_bf16 v[48:63], v[96:99], v[168:171], v[48:63]
    ds_read_b64_tr_b16 v[108:109], v12 offset:30720
    ds_read_b64_tr_b16 v[110:111], v12 offset:31232
    s_add_u32 s29, s59, 0
    buffer_store_dwordx4 v[32:35], v1, s[12:15], s29 offen sc1
    s_waitcnt lgkmcnt(4)
    v_mfma_f32_32x32x16_bf16 v[64:79], v[100:103], v[168:171], v[64:79]
    ds_read_b64_tr_b16 v[96:97], v11 offset:32768
    ds_read_b64_tr_b16 v[98:99], v11 offset:33280
    s_waitcnt lgkmcnt(4)
    v_mfma_f32_32x32x16_bf16 v[48:63], v[104:107], v[172:175], v[48:63]
    ds_read_b64_tr_b16 v[100:101], v12 offset:32768
    ds_read_b64_tr_b16 v[102:103], v12 offset:33280
    s_waitcnt lgkmcnt(4)
    v_mfma_f32_32x32x16_bf16 v[64:79], v[108:111], v[172:175], v[64:79]
    ds_read_b64_tr_b16 v[104:105], v11 offset:34816
    ds_read_b64_tr_b16 v[106:107], v11 offset:35328
    s_add_u32 s29, s59, 1024
    buffer_store_dwordx4 v[36:39], v1, s[12:15], s29 offen sc1
    s_waitcnt lgkmcnt(4)
    v_mfma_f32_32x32x16_bf16 v[48:63], v[96:99], v[176:179], v[48:63]
    s_barrier
    ds_read_b64_tr_b16 v[108:109], v12 offset:34816
    ds_read_b64_tr_b16 v[110:111], v12 offset:35328
    s_waitcnt lgkmcnt(4)
    v_mfma_f32_32x32x16_bf16 v[64:79], v[100:103], v[176:179], v[64:79]
    v_add_u32 v11, 0xfffe5000, v11
    ds_read_b64_tr_b16 v[96:97], v11 offset:0
    ds_read_b64_tr_b16 v[98:99], v11 offset:512
    s_waitcnt lgkmcnt(4)
    v_mfma_f32_32x32x16_bf16 v[48:63], v[104:107], v[180:183], v[48:63]
    v_add_u32 v12, 0xfffe5000, v12
    ds_read_b64_tr_b16 v[100:101], v12 offset:0
    ds_read_b64_tr_b16 v[102:103], v12 offset:512
    s_waitcnt lgkmcnt(4)
    v_mfma_f32_32x32x16_bf16 v[64:79], v[108:111], v[180:183], v[64:79]
    ds_read_b64_tr_b16 v[104:105], v11 offset:2048
    ds_read_b64_tr_b16 v[106:107], v11 offset:2560
    s_waitcnt lgkmcnt(4)
    v_mfma_f32_32x32x16_bf16 v[48:63], v[96:99], v[184:187], v[48:63]
    ds_read_b64_tr_b16 v[108:109], v12 offset:2048
    ds_read_b64_tr_b16 v[110:111], v12 offset:2560
    s_waitcnt lgkmcnt(4)
    v_mfma_f32_32x32x16_bf16 v[64:79], v[100:103], v[184:187], v[64:79]
    ds_read_b64_tr_b16 v[96:97], v11 offset:4096
    ds_read_b64_tr_b16 v[98:99], v11 offset:4608
    s_waitcnt lgkmcnt(4)
    v_mfma_f32_32x32x16_bf16 v[48:63], v[104:107], v[188:191], v[48:63]
    ds_read_b64_tr_b16 v[100:101], v12 offset:4096
    ds_read_b64_tr_b16 v[102:103], v12 offset:4608
    s_waitcnt lgkmcnt(4)
    v_mfma_f32_32x32x16_bf16 v[64:79], v[108:111], v[188:191], v[64:79]
    ds_read_b64_tr_b16 v[104:105], v11 offset:6144
    ds_read_b64_tr_b16 v[106:107], v11 offset:6656
    s_waitcnt lgkmcnt(4)
    v_mfma_f32_32x32x16_bf16 v[48:63], v[96:99], v[192:195], v[48:63]
    ds_read_b64_tr_b16 v[108:109], v12 offset:6144
    ds_read_b64_tr_b16 v[110:111], v12 offset:6656
    s_waitcnt lgkmcnt(4)
    v_mfma_f32_32x32x16_bf16 v[64:79], v[100:103], v[192:195], v[64:79]
    ds_read_b64_tr_b16 v[96:97], v11 offset:8192
    ds_read_b64_tr_b16 v[98:99], v11 offset:8704
    s_waitcnt lgkmcnt(4)
    v_mfma_f32_32x32x16_bf16 v[48:63], v[104:107], v[196:199], v[48:63]
    ds_read_b64_tr_b16 v[100:101], v12 offset:8192
    ds_read_b64_tr_b16 v[102:103], v12 offset:8704
    s_and_b32 s16, s2, 7
    s_lshr_b32 s17, s2, 3
    s_lshl_b32 s16, s16, 2
    s_and_b32 s18, s17, 3
    s_add_u32 s16, s16, s18
    s_lshr_b32 s17, s17, 2
    s_mov_b32 s20, s26
    s_lshl_b32 s18, s17, 3
    s_lshl_b32 s19, s20, 1
    s_add_u32 s18, s18, s19
    s_waitcnt lgkmcnt(4)
    v_mfma_f32_32x32x16_bf16 v[64:79], v[108:111], v[196:199], v[64:79]
    ds_read_b64_tr_b16 v[104:105], v11 offset:10240
    ds_read_b64_tr_b16 v[106:107], v11 offset:10752
    s_lshl_b32 s21, s16, 16
    s_lshl_b32 s22, s18, 10
    s_add_u32 s21, s21, s22
    buffer_load_dwordx4 v[16:19], v1, s[12:15], s21 offen sc1
    s_waitcnt lgkmcnt(4)
    v_mfma_f32_32x32x16_bf16 v[48:63], v[96:99], v[200:203], v[48:63]
    ds_read_b64_tr_b16 v[108:109], v12 offset:10240
    ds_read_b64_tr_b16 v[110:111], v12 offset:10752
    buffer_load_dwordx4 v[24:27], v1, s[12:15], s21 offen offset:1024 sc1
    s_waitcnt lgkmcnt(4)
    v_mfma_f32_32x32x16_bf16 v[64:79], v[100:103], v[200:203], v[64:79]
    ds_read_b64_tr_b16 v[96:97], v11 offset:12288
    ds_read_b64_tr_b16 v[98:99], v11 offset:12800
    v_and_b32 v5, 31, v0
    v_lshlrev_b32 v3, 2, v5
    s_waitcnt lgkmcnt(4)
    v_mfma_f32_32x32x16_bf16 v[48:63], v[104:107], v[204:207], v[48:63]
    ds_read_b64_tr_b16 v[100:101], v12 offset:12288
    ds_read_b64_tr_b16 v[102:103], v12 offset:12800
    v_mov_b32 v20, 0
    s_waitcnt lgkmcnt(4)
    v_mfma_f32_32x32x16_bf16 v[64:79], v[108:111], v[204:207], v[64:79]
    ds_read_b64_tr_b16 v[104:105], v11 offset:14336
    ds_read_b64_tr_b16 v[106:107], v11 offset:14848
    v_mov_b32 v21, 0
    s_waitcnt lgkmcnt(4)
    v_mfma_f32_32x32x16_bf16 v[48:63], v[96:99], v[208:211], v[48:63]
    ds_read_b64_tr_b16 v[108:109], v12 offset:14336
    ds_read_b64_tr_b16 v[110:111], v12 offset:14848
    v_mov_b32 v22, 0
    s_waitcnt lgkmcnt(4)
    v_mfma_f32_32x32x16_bf16 v[64:79], v[100:103], v[208:211], v[64:79]
    ds_read_b64_tr_b16 v[96:97], v11 offset:16384
    ds_read_b64_tr_b16 v[98:99], v11 offset:16896
    v_mov_b32 v23, 0
    s_waitcnt lgkmcnt(4)
    v_mfma_f32_32x32x16_bf16 v[48:63], v[104:107], v[212:215], v[48:63]
    ds_read_b64_tr_b16 v[100:101], v12 offset:16384
    ds_read_b64_tr_b16 v[102:103], v12 offset:16896
    v_mov_b32 v28, 0
    s_waitcnt lgkmcnt(4)
    v_mfma_f32_32x32x16_bf16 v[64:79], v[108:111], v[212:215], v[64:79]
    ds_read_b64_tr_b16 v[104:105], v11 offset:18432
    ds_read_b64_tr_b16 v[106:107], v11 offset:18944
    v_mov_b32 v29, 0
    s_waitcnt lgkmcnt(4)
    v_mfma_f32_32x32x16_bf16 v[48:63], v[96:99], v[216:219], v[48:63]
    ds_read_b64_tr_b16 v[108:109], v12 offset:18432
    ds_read_b64_tr_b16 v[110:111], v12 offset:18944
    v_mov_b32 v30, 0
    s_waitcnt lgkmcnt(4)
    v_mfma_f32_32x32x16_bf16 v[64:79], v[100:103], v[216:219], v[64:79]
    ds_read_b64_tr_b16 v[96:97], v11 offset:20480
    ds_read_b64_tr_b16 v[98:99], v11 offset:20992
    v_mov_b32 v31, 0
    s_waitcnt lgkmcnt(4)
    v_mfma_f32_32x32x16_bf16 v[48:63], v[104:107], v[220:223], v[48:63]
    ds_read_b64_tr_b16 v[100:101], v12 offset:20480
    ds_read_b64_tr_b16 v[102:103], v12 offset:20992
    s_lshl_b32 s21, s16, 13
    s_lshl_b32 s22, s18, 7
    s_add_u32 s21, s21, s22
    s_add_u32 s21, s21, 2097152
    s_mov_b32 exec_hi, 0
    buffer_load_dword v20, v3, s[12:15], s21 offen sc1
    buffer_load_dword v28, v3, s[12:15], s21 offen offset:128 sc1
    s_mov_b32 exec_hi, -1
    s_waitcnt lgkmcnt(4)
    v_mfma_f32_32x32x16_bf16 v[64:79], v[108:111], v[220:223], v[64:79]
    ds_read_b64_tr_b16 v[104:105], v11 offset:22528
    ds_read_b64_tr_b16 v[106:107], v11 offset:23040
    s_waitcnt lgkmcnt(4)
    v_mfma_f32_32x32x16_bf16 v[48:63], v[96:99], v[224:227], v[48:63]
    ds_read_b64_tr_b16 v[108:109], v12 offset:22528
    ds_read_b64_tr_b16 v[110:111], v12 offset:23040
    s_waitcnt lgkmcnt(4)
    v_mfma_f32_32x32x16_bf16 v[64:79], v[100:103], v[224:227], v[64:79]
    ds_read_b64_tr_b16 v[96:97], v11 offset:24576
    ds_read_b64_tr_b16 v[98:99], v11 offset:25088
    s_waitcnt lgkmcnt(4)
    v_mfma_f32_32x32x16_bf16 v[48:63], v[104:107], v[228:231], v[48:63]
    ds_read_b64_tr_b16 v[100:101], v12 offset:24576
    ds_read_b64_tr_b16 v[102:103], v12 offset:25088
    s_waitcnt lgkmcnt(4)
    v_mfma_f32_32x32x16_bf16 v[64:79], v[108:111], v[228:231], v[64:79]
    ds_read_b64_tr_b16 v[104:105], v11 offset:26624
    ds_read_b64_tr_b16 v[106:107], v11 offset:27136
    s_waitcnt lgkmcnt(4)
    v_mfma_f32_32x32x16_bf16 v[48:63], v[96:99], v[232:235], v[48:63]
    ds_read_b64_tr_b16 v[108:109], v12 offset:26624
    ds_read_b64_tr_b16 v[110:111], v12 offset:27136
    s_waitcnt lgkmcnt(4)
    v_mfma_f32_32x32x16_bf16 v[64:79], v[100:103], v[232:235], v[64:79]
    ds_read_b64_tr_b16 v[96:97], v11 offset:28672
    ds_read_b64_tr_b16 v[98:99], v11 offset:29184
    s_waitcnt lgkmcnt(4)
    v_mfma_f32_32x32x16_bf16 v[48:63], v[104:107], v[236:239], v[48:63]
    ds_read_b64_tr_b16 v[100:101], v12 offset:28672
    ds_read_b64_tr_b16 v[102:103], v12 offset:29184
    s_waitcnt lgkmcnt(4)
    v_mfma_f32_32x32x16_bf16 v[64:79], v[108:111], v[236:239], v[64:79]
    ds_read_b64_tr_b16 v[104:105], v11 offset:30720
    ds_read_b64_tr_b16 v[106:107], v11 offset:31232
    s_waitcnt lgkmcnt(4)
    v_mfma_f32_32x32x16_bf16 v[48:63], v[96:99], v[240:243], v[48:63]
    ds_read_b64_tr_b16 v[108:109], v12 offset:30720
    ds_read_b64_tr_b16 v[110:111], v12 offset:31232
    s_waitcnt lgkmcnt(4)
    v_mfma_f32_32x32x16_bf16 v[64:79], v[100:103], v[240:243], v[64:79]
    ds_read_b64_tr_b16 v[96:97], v11 offset:32768
    ds_read_b64_tr_b16 v[98:99], v11 offset:33280
    s_waitcnt lgkmcnt(4)
    v_mfma_f32_32x32x16_bf16 v[48:63], v[104:107], v[244:247], v[48:63]
    ds_read_b64_tr_b16 v[100:101], v12 offset:32768
    ds_read_b64_tr_b16 v[102:103], v12 offset:33280
    s_waitcnt lgkmcnt(4)
    v_mfma_f32_32x32x16_bf16 v[64:79], v[108:111], v[244:247], v[64:79]
    ds_read_b64_tr_b16 v[104:105], v11 offset:34816
    ds_read_b64_tr_b16 v[106:107], v11 offset:35328
    s_waitcnt lgkmcnt(4)
    v_mfma_f32_32x32x16_bf16 v[48:63], v[96:99], v[248:251], v[48:63]
    ds_read_b64_tr_b16 v[108:109], v12 offset:34816
    ds_read_b64_tr_b16 v[110:111], v12 offset:35328
    s_waitcnt lgkmcnt(4)
    v_mfma_f32_32x32x16_bf16 v[64:79], v[100:103], v[248:251], v[64:79]
    s_waitcnt lgkmcnt(2)
    v_mfma_f32_32x32x16_bf16 v[48:63], v[104:107], v[252:255], v[48:63]
    s_waitcnt lgkmcnt(0)
    v_mfma_f32_32x32x16_bf16 v[64:79], v[108:111], v[252:255], v[64:79]
    s_nop 7
    s_nop 7
    s_add_u32 s58, s43, 12288
    v_cvt_pk_bf16_f32 v48, v48, v49
    v_cvt_pk_bf16_f32 v49, v50, v51
    v_cvt_pk_bf16_f32 v50, v52, v53
    v_cvt_pk_bf16_f32 v51, v54, v55
    v_pk_max_i16 v48, v48, 0
    v_pk_max_i16 v49, v49, 0
    v_pk_max_i16 v50, v50, 0
    v_pk_max_i16 v51, v51, 0
    s_add_u32 s29, s58, 0
    buffer_store_dwordx4 v[48:51], v1, s[12:15], s29 offen sc1
    v_cvt_pk_bf16_f32 v52, v56, v57
    v_cvt_pk_bf16_f32 v53, v58, v59
    v_cvt_pk_bf16_f32 v54, v60, v61
    v_cvt_pk_bf16_f32 v55, v62, v63
    v_pk_max_i16 v52, v52, 0
    v_pk_max_i16 v53, v53, 0
    v_pk_max_i16 v54, v54, 0
    v_pk_max_i16 v55, v55, 0
    s_add_u32 s29, s58, 1024
    buffer_store_dwordx4 v[52:55], v1, s[12:15], s29 offen sc1
    s_add_u32 s58, s43, 14336
    v_cvt_pk_bf16_f32 v64, v64, v65
    v_cvt_pk_bf16_f32 v65, v66, v67
    v_cvt_pk_bf16_f32 v66, v68, v69
    v_cvt_pk_bf16_f32 v67, v70, v71
    v_pk_max_i16 v64, v64, 0
    v_pk_max_i16 v65, v65, 0
    v_pk_max_i16 v66, v66, 0
    v_pk_max_i16 v67, v67, 0
    s_add_u32 s29, s58, 0
    buffer_store_dwordx4 v[64:67], v1, s[12:15], s29 offen sc1
    v_cvt_pk_bf16_f32 v68, v72, v73
    v_cvt_pk_bf16_f32 v69, v74, v75
    v_cvt_pk_bf16_f32 v70, v76, v77
    v_cvt_pk_bf16_f32 v71, v78, v79
    v_pk_max_i16 v68, v68, 0
    v_pk_max_i16 v69, v69, 0
    v_pk_max_i16 v70, v70, 0
    v_pk_max_i16 v71, v71, 0
    s_add_u32 s29, s58, 1024
    buffer_store_dwordx4 v[68:71], v1, s[12:15], s29 offen sc1
parallel_sum__softmax_full_mha__dense_activation_relu__prompt_kernel_p2:
    s_mov_b32 s20, s26
    s_load_dwordx2 s[6:7], s[0:1], 64
    s_load_dwordx2 s[36:37], s[0:1], 40
    s_and_b32 s16, s2, 7
    s_lshr_b32 s17, s2, 3
    s_lshl_b32 s16, s16, 2
    s_and_b32 s18, s17, 3
    s_add_u32 s16, s16, s18
    s_lshr_b32 s17, s17, 2
    s_waitcnt lgkmcnt(0)
    s_cmp_lt_u32 s20, 4
    s_cbranch_scc1 parallel_sum__softmax_full_mha__dense_activation_relu__prompt_kernel_attn
    s_sub_u32 s21, s20, 4
    s_and_b32 s22, s2, 7
    s_lshr_b32 s23, s2, 3
    s_and_b32 s24, s22, 3
    s_lshr_b32 s22, s22, 2
    s_lshl_b32 s22, s22, 3
    s_lshr_b32 s25, s23, 2
    s_add_u32 s22, s22, s25
    s_and_b32 s23, s23, 3
    s_lshl_b32 s22, s22, 2
    s_add_u32 s22, s22, s21
    s_lshl_b32 s25, s23, 2
    s_lshr_b32 s26, s23, 1
    s_add_u32 s25, s25, s26
    s_add_u32 s8, s6, 2359296
    s_addc_u32 s9, s7, 0
    s_and_b32 s9, s9, 0xffff
    s_mov_b32 s10, 5242880
    s_mov_b32 s11, 0x20000
    s_add_u32 s12, s6, 9961472
    s_addc_u32 s13, s7, 0
    s_and_b32 s13, s13, 0xffff
    s_mov_b32 s14, 18874368
    s_mov_b32 s15, 0x20000
    s_mov_b32 s48, s36
    s_and_b32 s49, s37, 0xffff
    s_mov_b32 s50, 5308416
    s_mov_b32 s51, 0x20000
    s_add_u32 s32, s6, 28835840
    s_addc_u32 s33, s7, 0
    s_and_b32 s33, s33, 0xffff
    s_mov_b32 s34, 10485760
    s_mov_b32 s35, 0x20000
    v_lshlrev_b32 v1, 4, v0
    s_mul_i32 s38, s16, 163840
    s_mul_i32 s39, s21, 5120
    s_add_u32 s38, s38, s39
    s_mul_i32 s40, s24, 1327104
    s_lshl_b32 s41, s25, 6
    s_add_u32 s40, s40, s41
    s_mul_i32 s42, s22, 294912
    s_mul_i32 s43, s24, 73728
    s_add_u32 s42, s42, s43
    s_mul_i32 s54, s21, 18432
    s_add_u32 s54, s54, s40
    s_mul_i32 s55, s21, 5120
    s_mul_i32 s56, s21, 36864
    s_add_u32 s56, s56, s40
    s_mul_i32 s57, s21, 10240
    s_mul_i32 s58, s21, 46080
    s_add_u32 s58, s58, s40
    s_mul_i32 s59, s21, 12800
    s_movk_i32 s43, 3277
    s_movk_i32 s44, 1152
    v_add_u32 v10, 0, v0
    v_mul_u32_u24 v11, s43, v10
    v_lshrrev_b32 v11, 16, v11
    v_mul_u32_u24 v12, 20, v11
    v_sub_u32 v12, v10, v12
    v_bfe_u32 v13, v11, 2, 1
    v_lshlrev_b32 v13, 1, v13
    v_xor_b32 v12, v12, v13
    v_lshlrev_b32 v12, 4, v12
    v_mad_u32_u24 v4, v11, s44, v12
    v_add_u32 v10, 64, v0
    v_mul_u32_u24 v11, s43, v10
    v_lshrrev_b32 v11, 16, v11
    v_mul_u32_u24 v12, 20, v11
    v_sub_u32 v12, v10, v12
    v_bfe_u32 v13, v11, 2, 1
    v_lshlrev_b32 v13, 1, v13
    v_xor_b32 v12, v12, v13
    v_lshlrev_b32 v12, 4, v12
    v_mad_u32_u24 v5, v11, s44, v12
    v_add_u32 v10, 128, v0
    v_mul_u32_u24 v11, s43, v10
    v_lshrrev_b32 v11, 16, v11
    v_mul_u32_u24 v12, 20, v11
    v_sub_u32 v12, v10, v12
    v_bfe_u32 v13, v11, 2, 1
    v_lshlrev_b32 v13, 1, v13
    v_xor_b32 v12, v12, v13
    v_lshlrev_b32 v12, 4, v12
    v_mad_u32_u24 v6, v11, s44, v12
    v_add_u32 v10, 192, v0
    v_mul_u32_u24 v11, s43, v10
    v_lshrrev_b32 v11, 16, v11
    v_mul_u32_u24 v12, 20, v11
    v_sub_u32 v12, v10, v12
    v_bfe_u32 v13, v11, 2, 1
    v_lshlrev_b32 v13, 1, v13
    v_xor_b32 v12, v12, v13
    v_lshlrev_b32 v12, 4, v12
    v_mad_u32_u24 v7, v11, s44, v12
    v_add_u32 v10, 256, v0
    v_mul_u32_u24 v11, s43, v10
    v_lshrrev_b32 v11, 16, v11
    v_mul_u32_u24 v12, 20, v11
    v_sub_u32 v12, v10, v12
    v_bfe_u32 v13, v11, 2, 1
    v_lshlrev_b32 v13, 1, v13
    v_xor_b32 v12, v12, v13
    v_lshlrev_b32 v12, 4, v12
    v_mad_u32_u24 v8, v11, s44, v12
    s_and_b32 s62, s23, 1
    v_mov_b32 v16, 0
    v_mov_b32 v17, 0
    v_mov_b32 v18, 0
    v_mov_b32 v19, 0
    v_mov_b32 v20, 0
    v_mov_b32 v21, 0
    v_mov_b32 v22, 0
    v_mov_b32 v23, 0
    v_mov_b32 v24, 0
    v_mov_b32 v25, 0
    v_mov_b32 v26, 0
    v_mov_b32 v27, 0
    v_mov_b32 v28, 0
    v_mov_b32 v29, 0
    v_mov_b32 v30, 0
    v_mov_b32 v31, 0
    s_add_u32 m0, s39, 104448
    s_add_u32 s29, s38, 0
    buffer_load_dwordx4 v1, s[8:11], s29 offen sc1 lds
    s_add_u32 m0, s39, 105472
    s_add_u32 s29, s38, 1024
    buffer_load_dwordx4 v1, s[8:11], s29 offen sc1 lds
    s_add_u32 m0, s39, 106496
    s_add_u32 s29, s38, 2048
    buffer_load_dwordx4 v1, s[8:11], s29 offen sc1 lds
    s_add_u32 m0, s39, 107520
    s_add_u32 s29, s38, 3072
    buffer_load_dwordx4 v1, s[8:11], s29 offen sc1 lds
    s_add_u32 s45, s39, 108544
    s_cmp_eq_u32 s21, 3
    s_cselect_b32 m0, 8192, s45
    s_add_u32 s29, s38, 4096
    buffer_load_dwordx4 v1, s[8:11], s29 offen sc1 lds
    s_add_u32 m0, s55, 53248
    s_add_u32 s29, s54, 0
    buffer_load_dwordx4 v4, s[48:51], s29 offen lds
    s_add_u32 m0, s55, 54272
    s_add_u32 s29, s54, 0
    buffer_load_dwordx4 v5, s[48:51], s29 offen lds
    s_add_u32 m0, s55, 55296
    s_add_u32 s29, s54, 0
    buffer_load_dwordx4 v6, s[48:51], s29 offen lds
    s_add_u32 m0, s55, 56320
    s_add_u32 s29, s54, 0
    buffer_load_dwordx4 v7, s[48:51], s29 offen lds
    s_add_u32 m0, s55, 57344
    s_add_u32 s29, s54, 0
    buffer_load_dwordx4 v8, s[48:51], s29 offen lds
    v_mov_b32 v10, 0
    v_mov_b32 v11, 0
    v_mov_b32 v12, 0
    v_mov_b32 v13, 0
    ds_write_b64 v10, v[12:13]
    v_and_b32 v10, 15, v0
    v_lshrrev_b32 v11, 2, v10
    v_lshrrev_b32 v12, 5, v0
    v_lshlrev_b32 v12, 4, v12
    v_add_u32 v11, v11, v12
    v_bfe_u32 v13, v0, 4, 1
    v_lshl_add_u32 v11, v13, 2, v11
    v_mul_u32_u24 v11, 320, v11
    v_and_b32 v12, 3, v10
    v_lshl_add_u32 v11, v12, 3, v11
    v_lshlrev_b32 v13, 5, v13
    v_add_u32 v12, v11, v13
    v_xor_b32 v13, 32, v13
    v_add_u32 v11, v11, v13
    v_add_u32 v2, 53248, v12
    v_add_u32 v3, 1024, v12
    v_add_u32 v152, 53248, v11
    v_add_u32 v153, 1024, v11
    v_lshrrev_b32 v11, 5, v0
    v_bfe_u32 v12, v0, 4, 1
    v_lshlrev_b32 v13, 4, v10
    v_lshl_add_u32 v13, v12, 9, v13
    v_lshl_add_u32 v9, v11, 10, v13
    v_add_u32 v14, 256, v9
    v_lshl_add_u32 v15, v11, 3, v13
    s_waitcnt vmcnt(0)
    s_waitcnt lgkmcnt(0)
    s_barrier
    s_add_u32 s92, s6, 39321600
    s_addc_u32 s93, s7, 0
    s_lshr_b32 s73, s22, 2
    s_lshl_b32 s73, s73, 2
    s_add_u32 s73, s73, s24
    s_add_u32 s73, s73, 24
    s_lshl_b32 s73, s73, 7
    s_cmp_eq_u32 s21, 0
    s_cbranch_scc0 parallel_sum__softmax_full_mha__dense_activation_relu__prompt_kernel_nohs
    v_mov_b32 v12, s73
    v_mov_b32 v13, 1
    s_mov_b64 exec, 1
    global_atomic_add v12, v13, s[92:93] sc1
    s_mov_b64 exec, -1
parallel_sum__softmax_full_mha__dense_activation_relu__prompt_kernel_nohs:
    s_add_u32 m0, s39, 123904
    s_add_u32 s29, s38, 20480
    buffer_load_dwordx4 v1, s[8:11], s29 offen sc1 lds
    s_add_u32 m0, s39, 124928
    s_add_u32 s29, s38, 21504
    buffer_load_dwordx4 v1, s[8:11], s29 offen sc1 lds
    s_add_u32 m0, s39, 125952
    s_add_u32 s29, s38, 22528
    buffer_load_dwordx4 v1, s[8:11], s29 offen sc1 lds
    s_add_u32 m0, s39, 126976
    s_add_u32 s29, s38, 23552
    buffer_load_dwordx4 v1, s[8:11], s29 offen sc1 lds
    s_add_u32 s45, s39, 128000
    s_cmp_eq_u32 s21, 3
    s_cselect_b32 m0, 162816, s45
    s_add_u32 s29, s38, 24576
    buffer_load_dwordx4 v1, s[8:11], s29 offen sc1 lds
    s_add_u32 m0, s59, 1024
    s_add_u32 s29, s58, 73728
    buffer_load_dwordx4 v4, s[48:51], s29 offen lds
    s_add_u32 m0, s59, 2048
    s_add_u32 s29, s58, 73728
    buffer_load_dwordx4 v5, s[48:51], s29 offen lds
    s_add_u32 m0, s59, 3072
    s_add_u32 s29, s58, 73728
    buffer_load_dwordx4 v6, s[48:51], s29 offen lds
    s_add_u32 m0, s59, 4096
    s_add_u32 s29, s58, 73728
    buffer_load_dwordx4 v7, s[48:51], s29 offen lds
    s_add_u32 m0, s59, 5120
    s_add_u32 s29, s58, 73728
    buffer_load_dwordx4 v8, s[48:51], s29 offen lds
    s_add_u32 m0, s59, 6144
    s_add_u32 s29, s58, 92160
    buffer_load_dwordx4 v4, s[48:51], s29 offen lds
    s_add_u32 m0, s59, 7168
    s_add_u32 s29, s58, 92160
    buffer_load_dwordx4 v5, s[48:51], s29 offen lds
    s_add_u32 m0, s59, 8192
    s_add_u32 s29, s58, 92160
    buffer_load_dwordx4 v6, s[48:51], s29 offen lds
    s_add_u32 m0, s59, 9216
    s_add_u32 s29, s58, 92160
    buffer_load_dwordx4 v7, s[48:51], s29 offen lds
    s_add_u32 m0, s59, 10240
    s_add_u32 s29, s58, 92160
    buffer_load_dwordx4 v8, s[48:51], s29 offen lds
    s_add_u32 m0, s59, 11264
    s_add_u32 s29, s58, 110592
    buffer_load_dwordx4 v4, s[48:51], s29 offen lds
    s_add_u32 m0, s59, 12288
    s_add_u32 s29, s58, 110592
    buffer_load_dwordx4 v5, s[48:51], s29 offen lds
    s_add_u32 m0, s59, 13312
    s_add_u32 s29, s58, 110592
    s_mov_b32 exec_lo, 0xffffffff
    s_mov_b32 exec_hi, 0x0
    buffer_load_dwordx4 v6, s[48:51], s29 offen lds
    s_mov_b64 exec, -1
    s_cmp_eq_u32 s21, 0
    s_cbranch_scc0 parallel_sum__softmax_full_mha__dense_activation_relu__prompt_kernel_hspin
    s_mov_b32 s94, 65536
parallel_sum__softmax_full_mha__dense_activation_relu__prompt_kernel_poll_h:
    v_mov_b32 v12, s73
    global_load_dword v13, v12, s[92:93] sc1
    s_waitcnt vmcnt(0)
    v_readfirstlane_b32 s95, v13
    s_nop 0
    s_cmp_ge_u32 s95, 4
    s_cbranch_scc0 parallel_sum__softmax_full_mha__dense_activation_relu__prompt_kernel_again_h
    s_branch parallel_sum__softmax_full_mha__dense_activation_relu__prompt_kernel_ok_h
parallel_sum__softmax_full_mha__dense_activation_relu__prompt_kernel_again_h:
    s_sub_u32 s94, s94, 1
    s_cmp_eq_u32 s94, 0
    s_cbranch_scc1 parallel_sum__softmax_full_mha__dense_activation_relu__prompt_kernel_ok_h
    s_sleep 2
    s_branch parallel_sum__softmax_full_mha__dense_activation_relu__prompt_kernel_poll_h
parallel_sum__softmax_full_mha__dense_activation_relu__prompt_kernel_ok_h:
    v_mov_b32 v10, 0
    v_mov_b32 v11, 1
    ds_write_b32 v10, v11
    s_waitcnt lgkmcnt(0)
    s_branch parallel_sum__softmax_full_mha__dense_activation_relu__prompt_kernel_hok
parallel_sum__softmax_full_mha__dense_activation_relu__prompt_kernel_hspin:
    v_mov_b32 v10, 0
    s_mov_b32 s94, 1048576
parallel_sum__softmax_full_mha__dense_activation_relu__prompt_kernel_hspin2:
    ds_read_b32 v11, v10
    s_waitcnt lgkmcnt(0)
    v_readfirstlane_b32 s95, v11
    s_sub_u32 s94, s94, 1
    s_cmp_eq_u32 s94, 0
    s_cbranch_scc1 parallel_sum__softmax_full_mha__dense_activation_relu__prompt_kernel_hok
    s_cmp_eq_u32 s95, 1
    s_cbranch_scc1 parallel_sum__softmax_full_mha__dense_activation_relu__prompt_kernel_hok
    s_sleep 1
    s_branch parallel_sum__softmax_full_mha__dense_activation_relu__prompt_kernel_hspin2
parallel_sum__softmax_full_mha__dense_activation_relu__prompt_kernel_hok:
    s_add_u32 s29, s42, 0
    buffer_load_dwordx4 v[128:131], v9, s[12:15], s29 offen sc1
    s_add_u32 s29, s42, 0
    buffer_load_dwordx4 v[132:135], v14, s[12:15], s29 offen sc1
    s_add_u32 s29, s42, 2048
    buffer_load_dwordx4 v[136:139], v9, s[12:15], s29 offen sc1
    s_add_u32 s29, s42, 2048
    buffer_load_dwordx4 v[140:143], v14, s[12:15], s29 offen sc1
    ds_read_b64_tr_b16 v[96:97], v2 offset:0
    ds_read_b64_tr_b16 v[98:99], v2 offset:2560
    ds_read_b64_tr_b16 v[100:101], v152 offset:0
    ds_read_b64_tr_b16 v[102:103], v152 offset:2560
    ds_read_b64_tr_b16 v[104:105], v2 offset:64
    ds_read_b64_tr_b16 v[106:107], v2 offset:2624
    ds_read_b64_tr_b16 v[108:109], v152 offset:64
    ds_read_b64_tr_b16 v[110:111], v152 offset:2624
    s_waitcnt vmcnt(2)
    s_waitcnt lgkmcnt(6)
    s_cmp_eq_u32 s62, 1
    s_cbranch_scc1 parallel_sum__softmax_full_mha__dense_activation_relu__prompt_kernel_sk0_0
    v_mfma_f32_16x16x32_bf16 v[16:19], v[96:99], v[128:131], v[16:19]
    v_mfma_f32_16x16x32_bf16 v[20:23], v[96:99], v[132:135], v[20:23]
parallel_sum__softmax_full_mha__dense_activation_relu__prompt_kernel_sk0_0:
    ds_read_b64_tr_b16 v[112:113], v2 offset:128
    ds_read_b64_tr_b16 v[114:115], v2 offset:2688
    s_waitcnt lgkmcnt(6)
    s_cmp_eq_u32 s62, 1
    s_cbranch_scc1 parallel_sum__softmax_full_mha__dense_activation_relu__prompt_kernel_sk0_1
    v_mfma_f32_16x16x32_bf16 v[24:27], v[100:103], v[128:131], v[24:27]
    v_mfma_f32_16x16x32_bf16 v[28:31], v[100:103], v[132:135], v[28:31]
parallel_sum__softmax_full_mha__dense_activation_relu__prompt_kernel_sk0_1:
    ds_read_b64_tr_b16 v[116:117], v152 offset:128
    ds_read_b64_tr_b16 v[118:119], v152 offset:2688
    s_waitcnt lgkmcnt(6)
    v_mfma_f32_16x16x32_bf16 v[32:35], v[104:107], v[128:131], 0
    v_mfma_f32_16x16x32_bf16 v[36:39], v[104:107], v[132:135], 0
    ds_read_b64_tr_b16 v[120:121], v2 offset:192
    ds_read_b64_tr_b16 v[122:123], v2 offset:2752
    s_waitcnt lgkmcnt(6)
    v_mfma_f32_16x16x32_bf16 v[40:43], v[108:111], v[128:131], 0
    v_mfma_f32_16x16x32_bf16 v[44:47], v[108:111], v[132:135], 0
    ds_read_b64_tr_b16 v[124:125], v152 offset:192
    ds_read_b64_tr_b16 v[126:127], v152 offset:2752
    s_waitcnt lgkmcnt(6)
    v_mfma_f32_16x16x32_bf16 v[48:51], v[112:115], v[128:131], 0
    v_mfma_f32_16x16x32_bf16 v[52:55], v[112:115], v[132:135], 0
    ds_read_b64_tr_b16 v[96:97], v2 offset:256
    ds_read_b64_tr_b16 v[98:99], v2 offset:2816
    s_waitcnt lgkmcnt(6)
    v_mfma_f32_16x16x32_bf16 v[56:59], v[116:119], v[128:131], 0
    v_mfma_f32_16x16x32_bf16 v[60:63], v[116:119], v[132:135], 0
    ds_read_b64_tr_b16 v[100:101], v152 offset:256
    ds_read_b64_tr_b16 v[102:103], v152 offset:2816
    s_waitcnt lgkmcnt(6)
    v_mfma_f32_16x16x32_bf16 v[64:67], v[120:123], v[128:131], 0
    v_mfma_f32_16x16x32_bf16 v[68:71], v[120:123], v[132:135], 0
    ds_read_b64_tr_b16 v[104:105], v2 offset:10240
    ds_read_b64_tr_b16 v[106:107], v2 offset:12800
    s_waitcnt lgkmcnt(6)
    v_mfma_f32_16x16x32_bf16 v[72:75], v[124:127], v[128:131], 0
    v_mfma_f32_16x16x32_bf16 v[76:79], v[124:127], v[132:135], 0
    ds_read_b64_tr_b16 v[108:109], v152 offset:10240
    ds_read_b64_tr_b16 v[110:111], v152 offset:12800
    s_waitcnt lgkmcnt(6)
    v_mfma_f32_16x16x32_bf16 v[80:83], v[96:99], v[128:131], 0
    v_mfma_f32_16x16x32_bf16 v[84:87], v[96:99], v[132:135], 0
    ds_read_b64_tr_b16 v[112:113], v2 offset:10304
    ds_read_b64_tr_b16 v[114:115], v2 offset:12864
    s_waitcnt lgkmcnt(6)
    v_mfma_f32_16x16x32_bf16 v[88:91], v[100:103], v[128:131], 0
    v_mfma_f32_16x16x32_bf16 v[92:95], v[100:103], v[132:135], 0
    ds_read_b64_tr_b16 v[116:117], v152 offset:10304
    ds_read_b64_tr_b16 v[118:119], v152 offset:12864
    s_add_u32 s29, s42, 4096
    buffer_load_dwordx4 v[144:147], v9, s[12:15], s29 offen sc1
    s_add_u32 s29, s42, 4096
    buffer_load_dwordx4 v[148:151], v14, s[12:15], s29 offen sc1
    s_waitcnt vmcnt(2)
    s_waitcnt lgkmcnt(6)
    s_cmp_eq_u32 s62, 1
    s_cbranch_scc1 parallel_sum__softmax_full_mha__dense_activation_relu__prompt_kernel_sk1_0
    v_mfma_f32_16x16x32_bf16 v[16:19], v[104:107], v[136:139], v[16:19]
    v_mfma_f32_16x16x32_bf16 v[20:23], v[104:107], v[140:143], v[20:23]
parallel_sum__softmax_full_mha__dense_activation_relu__prompt_kernel_sk1_0:
    ds_read_b64_tr_b16 v[120:121], v2 offset:10368
    ds_read_b64_tr_b16 v[122:123], v2 offset:12928
    s_waitcnt lgkmcnt(6)
    s_cmp_eq_u32 s62, 1
    s_cbranch_scc1 parallel_sum__softmax_full_mha__dense_activation_relu__prompt_kernel_sk1_1
    v_mfma_f32_16x16x32_bf16 v[24:27], v[108:111], v[136:139], v[24:27]
    v_mfma_f32_16x16x32_bf16 v[28:31], v[108:111], v[140:143], v[28:31]
parallel_sum__softmax_full_mha__dense_activation_relu__prompt_kernel_sk1_1:
    ds_read_b64_tr_b16 v[124:125], v152 offset:10368
    ds_read_b64_tr_b16 v[126:127], v152 offset:12928
    s_waitcnt lgkmcnt(6)
    v_mfma_f32_16x16x32_bf16 v[32:35], v[112:115], v[136:139], v[32:35]
    v_mfma_f32_16x16x32_bf16 v[36:39], v[112:115], v[140:143], v[36:39]
    ds_read_b64_tr_b16 v[96:97], v2 offset:10432
    ds_read_b64_tr_b16 v[98:99], v2 offset:12992
    s_waitcnt lgkmcnt(6)
    v_mfma_f32_16x16x32_bf16 v[40:43], v[116:119], v[136:139], v[40:43]
    v_mfma_f32_16x16x32_bf16 v[44:47], v[116:119], v[140:143], v[44:47]
    ds_read_b64_tr_b16 v[100:101], v152 offset:10432
    ds_read_b64_tr_b16 v[102:103], v152 offset:12992
    s_waitcnt lgkmcnt(6)
    v_mfma_f32_16x16x32_bf16 v[48:51], v[120:123], v[136:139], v[48:51]
    v_mfma_f32_16x16x32_bf16 v[52:55], v[120:123], v[140:143], v[52:55]
    ds_read_b64_tr_b16 v[104:105], v2 offset:10496
    ds_read_b64_tr_b16 v[106:107], v2 offset:13056
    s_waitcnt lgkmcnt(6)
    v_mfma_f32_16x16x32_bf16 v[56:59], v[124:127], v[136:139], v[56:59]
    v_mfma_f32_16x16x32_bf16 v[60:63], v[124:127], v[140:143], v[60:63]
    ds_read_b64_tr_b16 v[108:109], v152 offset:10496
    ds_read_b64_tr_b16 v[110:111], v152 offset:13056
    s_waitcnt lgkmcnt(6)
    v_mfma_f32_16x16x32_bf16 v[64:67], v[96:99], v[136:139], v[64:67]
    v_mfma_f32_16x16x32_bf16 v[68:71], v[96:99], v[140:143], v[68:71]
    s_waitcnt lgkmcnt(4)
    v_mfma_f32_16x16x32_bf16 v[72:75], v[100:103], v[136:139], v[72:75]
    v_mfma_f32_16x16x32_bf16 v[76:79], v[100:103], v[140:143], v[76:79]
    s_waitcnt lgkmcnt(2)
    v_mfma_f32_16x16x32_bf16 v[80:83], v[104:107], v[136:139], v[80:83]
    v_mfma_f32_16x16x32_bf16 v[84:87], v[104:107], v[140:143], v[84:87]
    s_waitcnt lgkmcnt(0)
    v_mfma_f32_16x16x32_bf16 v[88:91], v[108:111], v[136:139], v[88:91]
    v_mfma_f32_16x16x32_bf16 v[92:95], v[108:111], v[140:143], v[92:95]
    s_add_u32 s29, s42, 6144
    buffer_load_dwordx4 v[128:131], v9, s[12:15], s29 offen sc1
    s_add_u32 s29, s42, 6144
    buffer_load_dwordx4 v[132:135], v14, s[12:15], s29 offen sc1
    s_waitcnt vmcnt(8)
    s_barrier
    ds_read_b64_tr_b16 v[112:113], v3 offset:0
    ds_read_b64_tr_b16 v[114:115], v3 offset:2560
    ds_read_b64_tr_b16 v[116:117], v153 offset:0
    ds_read_b64_tr_b16 v[118:119], v153 offset:2560
    ds_read_b64_tr_b16 v[120:121], v3 offset:64
    ds_read_b64_tr_b16 v[122:123], v3 offset:2624
    ds_read_b64_tr_b16 v[124:125], v153 offset:64
    ds_read_b64_tr_b16 v[126:127], v153 offset:2624
    s_waitcnt vmcnt(2)
    s_waitcnt lgkmcnt(6)
    s_cmp_eq_u32 s62, 1
    s_cbranch_scc1 parallel_sum__softmax_full_mha__dense_activation_relu__prompt_kernel_sk2_0
    v_mfma_f32_16x16x32_bf16 v[16:19], v[112:115], v[144:147], v[16:19]
    v_mfma_f32_16x16x32_bf16 v[20:23], v[112:115], v[148:151], v[20:23]
parallel_sum__softmax_full_mha__dense_activation_relu__prompt_kernel_sk2_0:
    ds_read_b64_tr_b16 v[96:97], v3 offset:128
    ds_read_b64_tr_b16 v[98:99], v3 offset:2688
    s_add_u32 m0, s39, 143360
    s_add_u32 s29, s38, 40960
    buffer_load_dwordx4 v1, s[8:11], s29 offen sc1 lds
    s_waitcnt lgkmcnt(6)
    s_cmp_eq_u32 s62, 1
    s_cbranch_scc1 parallel_sum__softmax_full_mha__dense_activation_relu__prompt_kernel_sk2_1
    v_mfma_f32_16x16x32_bf16 v[24:27], v[116:119], v[144:147], v[24:27]
    v_mfma_f32_16x16x32_bf16 v[28:31], v[116:119], v[148:151], v[28:31]
parallel_sum__softmax_full_mha__dense_activation_relu__prompt_kernel_sk2_1:
    ds_read_b64_tr_b16 v[100:101], v153 offset:128
    ds_read_b64_tr_b16 v[102:103], v153 offset:2688
    s_waitcnt lgkmcnt(6)
    v_mfma_f32_16x16x32_bf16 v[32:35], v[120:123], v[144:147], v[32:35]
    v_mfma_f32_16x16x32_bf16 v[36:39], v[120:123], v[148:151], v[36:39]
    ds_read_b64_tr_b16 v[104:105], v3 offset:192
    ds_read_b64_tr_b16 v[106:107], v3 offset:2752
    s_add_u32 m0, s39, 144384
    s_add_u32 s29, s38, 41984
    buffer_load_dwordx4 v1, s[8:11], s29 offen sc1 lds
    s_waitcnt lgkmcnt(6)
    v_mfma_f32_16x16x32_bf16 v[40:43], v[124:127], v[144:147], v[40:43]
    v_mfma_f32_16x16x32_bf16 v[44:47], v[124:127], v[148:151], v[44:47]
    ds_read_b64_tr_b16 v[108:109], v153 offset:192
    ds_read_b64_tr_b16 v[110:111], v153 offset:2752
    s_waitcnt lgkmcnt(6)
    v_mfma_f32_16x16x32_bf16 v[48:51], v[96:99], v[144:147], v[48:51]
    v_mfma_f32_16x16x32_bf16 v[52:55], v[96:99], v[148:151], v[52:55]
    ds_read_b64_tr_b16 v[112:113], v3 offset:256
    ds_read_b64_tr_b16 v[114:115], v3 offset:2816
    s_add_u32 m0, s39, 145408
    s_add_u32 s29, s38, 43008
    buffer_load_dwordx4 v1, s[8:11], s29 offen sc1 lds
    s_waitcnt lgkmcnt(6)
    v_mfma_f32_16x16x32_bf16 v[56:59], v[100:103], v[144:147], v[56:59]
    v_mfma_f32_16x16x32_bf16 v[60:63], v[100:103], v[148:151], v[60:63]
    ds_read_b64_tr_b16 v[116:117], v153 offset:256
    ds_read_b64_tr_b16 v[118:119], v153 offset:2816
    s_waitcnt lgkmcnt(6)
    v_mfma_f32_16x16x32_bf16 v[64:67], v[104:107], v[144:147], v[64:67]
    v_mfma_f32_16x16x32_bf16 v[68:71], v[104:107], v[148:151], v[68:71]
    ds_read_b64_tr_b16 v[120:121], v3 offset:10240
    ds_read_b64_tr_b16 v[122:123], v3 offset:12800
    s_add_u32 m0, s39, 146432
    s_add_u32 s29, s38, 44032
    buffer_load_dwordx4 v1, s[8:11], s29 offen sc1 lds
    s_waitcnt lgkmcnt(6)
    v_mfma_f32_16x16x32_bf16 v[72:75], v[108:111], v[144:147], v[72:75]
    v_mfma_f32_16x16x32_bf16 v[76:79], v[108:111], v[148:151], v[76:79]
    ds_read_b64_tr_b16 v[124:125], v153 offset:10240
    ds_read_b64_tr_b16 v[126:127], v153 offset:12800
    s_waitcnt lgkmcnt(6)
    v_mfma_f32_16x16x32_bf16 v[80:83], v[112:115], v[144:147], v[80:83]
    v_mfma_f32_16x16x32_bf16 v[84:87], v[112:115], v[148:151], v[84:87]
    ds_read_b64_tr_b16 v[96:97], v3 offset:10304
    ds_read_b64_tr_b16 v[98:99], v3 offset:12864
    s_waitcnt lgkmcnt(6)
    v_mfma_f32_16x16x32_bf16 v[88:91], v[116:119], v[144:147], v[88:91]
    v_mfma_f32_16x16x32_bf16 v[92:95], v[116:119], v[148:151], v[92:95]
    ds_read_b64_tr_b16 v[100:101], v153 offset:10304
    ds_read_b64_tr_b16 v[102:103], v153 offset:12864
    s_add_u32 s29, s42, 8192
    buffer_load_dwordx4 v[136:139], v9, s[12:15], s29 offen sc1
    s_add_u32 s29, s42, 8192
    buffer_load_dwordx4 v[140:143], v14, s[12:15], s29 offen sc1
    s_waitcnt vmcnt(6)
    s_waitcnt lgkmcnt(6)
    s_cmp_eq_u32 s62, 1
    s_cbranch_scc1 parallel_sum__softmax_full_mha__dense_activation_relu__prompt_kernel_sk3_0
    v_mfma_f32_16x16x32_bf16 v[16:19], v[120:123], v[128:131], v[16:19]
    v_mfma_f32_16x16x32_bf16 v[20:23], v[120:123], v[132:135], v[20:23]
parallel_sum__softmax_full_mha__dense_activation_relu__prompt_kernel_sk3_0:
    ds_read_b64_tr_b16 v[104:105], v3 offset:10368
    ds_read_b64_tr_b16 v[106:107], v3 offset:12928
    s_add_u32 s45, s39, 147456
    s_cmp_eq_u32 s21, 3
    s_cselect_b32 m0, 162816, s45
    s_add_u32 s29, s38, 45056
    buffer_load_dwordx4 v1, s[8:11], s29 offen sc1 lds
    s_waitcnt lgkmcnt(6)
    s_cmp_eq_u32 s62, 1
    s_cbranch_scc1 parallel_sum__softmax_full_mha__dense_activation_relu__prompt_kernel_sk3_1
    v_mfma_f32_16x16x32_bf16 v[24:27], v[124:127], v[128:131], v[24:27]
    v_mfma_f32_16x16x32_bf16 v[28:31], v[124:127], v[132:135], v[28:31]
parallel_sum__softmax_full_mha__dense_activation_relu__prompt_kernel_sk3_1:
    ds_read_b64_tr_b16 v[108:109], v153 offset:10368
    ds_read_b64_tr_b16 v[110:111], v153 offset:12928
    s_waitcnt lgkmcnt(6)
    v_mfma_f32_16x16x32_bf16 v[32:35], v[96:99], v[128:131], v[32:35]
    v_mfma_f32_16x16x32_bf16 v[36:39], v[96:99], v[132:135], v[36:39]
    ds_read_b64_tr_b16 v[112:113], v3 offset:10432
    ds_read_b64_tr_b16 v[114:115], v3 offset:12992
    s_add_u32 m0, s59, 53248
    s_add_u32 s29, s58, 258048
    buffer_load_dwordx4 v4, s[48:51], s29 offen lds
    s_waitcnt lgkmcnt(6)
    v_mfma_f32_16x16x32_bf16 v[40:43], v[100:103], v[128:131], v[40:43]
    v_mfma_f32_16x16x32_bf16 v[44:47], v[100:103], v[132:135], v[44:47]
    ds_read_b64_tr_b16 v[116:117], v153 offset:10432
    ds_read_b64_tr_b16 v[118:119], v153 offset:12992
    s_waitcnt lgkmcnt(6)
    v_mfma_f32_16x16x32_bf16 v[48:51], v[104:107], v[128:131], v[48:51]
    v_mfma_f32_16x16x32_bf16 v[52:55], v[104:107], v[132:135], v[52:55]
    ds_read_b64_tr_b16 v[120:121], v3 offset:10496
    ds_read_b64_tr_b16 v[122:123], v3 offset:13056
    s_add_u32 m0, s59, 54272
    s_add_u32 s29, s58, 258048
    buffer_load_dwordx4 v5, s[48:51], s29 offen lds
    s_waitcnt lgkmcnt(6)
    v_mfma_f32_16x16x32_bf16 v[56:59], v[108:111], v[128:131], v[56:59]
    v_mfma_f32_16x16x32_bf16 v[60:63], v[108:111], v[132:135], v[60:63]
    ds_read_b64_tr_b16 v[124:125], v153 offset:10496
    ds_read_b64_tr_b16 v[126:127], v153 offset:13056
    s_waitcnt lgkmcnt(6)
    v_mfma_f32_16x16x32_bf16 v[64:67], v[112:115], v[128:131], v[64:67]
    v_mfma_f32_16x16x32_bf16 v[68:71], v[112:115], v[132:135], v[68:71]
    ds_read_b64_tr_b16 v[96:97], v3 offset:20480
    ds_read_b64_tr_b16 v[98:99], v3 offset:23040
    s_add_u32 m0, s59, 55296
    s_add_u32 s29, s58, 258048
    buffer_load_dwordx4 v6, s[48:51], s29 offen lds
    s_waitcnt lgkmcnt(6)
    v_mfma_f32_16x16x32_bf16 v[72:75], v[116:119], v[128:131], v[72:75]
    v_mfma_f32_16x16x32_bf16 v[76:79], v[116:119], v[132:135], v[76:79]
    ds_read_b64_tr_b16 v[100:101], v153 offset:20480
    ds_read_b64_tr_b16 v[102:103], v153 offset:23040
    s_waitcnt lgkmcnt(6)
    v_mfma_f32_16x16x32_bf16 v[80:83], v[120:123], v[128:131], v[80:83]
    v_mfma_f32_16x16x32_bf16 v[84:87], v[120:123], v[132:135], v[84:87]
    ds_read_b64_tr_b16 v[104:105], v3 offset:20544
    ds_read_b64_tr_b16 v[106:107], v3 offset:23104
    s_waitcnt lgkmcnt(6)
    v_mfma_f32_16x16x32_bf16 v[88:91], v[124:127], v[128:131], v[88:91]
    v_mfma_f32_16x16x32_bf16 v[92:95], v[124:127], v[132:135], v[92:95]
    ds_read_b64_tr_b16 v[108:109], v153 offset:20544
    ds_read_b64_tr_b16 v[110:111], v153 offset:23104
    s_add_u32 s29, s42, 10240
    buffer_load_dwordx4 v[144:147], v9, s[12:15], s29 offen sc1
    s_add_u32 s29, s42, 10240
    buffer_load_dwordx4 v[148:151], v14, s[12:15], s29 offen sc1
    s_waitcnt vmcnt(6)
    s_waitcnt lgkmcnt(6)
    s_cmp_eq_u32 s62, 1
    s_cbranch_scc1 parallel_sum__softmax_full_mha__dense_activation_relu__prompt_kernel_sk4_0
    v_mfma_f32_16x16x32_bf16 v[16:19], v[96:99], v[136:139], v[16:19]
    v_mfma_f32_16x16x32_bf16 v[20:23], v[96:99], v[140:143], v[20:23]
parallel_sum__softmax_full_mha__dense_activation_relu__prompt_kernel_sk4_0:
    ds_read_b64_tr_b16 v[112:113], v3 offset:20608
    ds_read_b64_tr_b16 v[114:115], v3 offset:23168
    s_add_u32 m0, s59, 56320
    s_add_u32 s29, s58, 258048
    buffer_load_dwordx4 v7, s[48:51], s29 offen lds
    s_waitcnt lgkmcnt(6)
    s_cmp_eq_u32 s62, 1
    s_cbranch_scc1 parallel_sum__softmax_full_mha__dense_activation_relu__prompt_kernel_sk4_1
    v_mfma_f32_16x16x32_bf16 v[24:27], v[100:103], v[136:139], v[24:27]
    v_mfma_f32_16x16x32_bf16 v[28:31], v[100:103], v[140:143], v[28:31]
parallel_sum__softmax_full_mha__dense_activation_relu__prompt_kernel_sk4_1:
    ds_read_b64_tr_b16 v[116:117], v153 offset:20608
    ds_read_b64_tr_b16 v[118:119], v153 offset:23168
    s_waitcnt lgkmcnt(6)
    v_mfma_f32_16x16x32_bf16 v[32:35], v[104:107], v[136:139], v[32:35]
    v_mfma_f32_16x16x32_bf16 v[36:39], v[104:107], v[140:143], v[36:39]
    ds_read_b64_tr_b16 v[120:121], v3 offset:20672
    ds_read_b64_tr_b16 v[122:123], v3 offset:23232
    s_add_u32 m0, s59, 57344
    s_add_u32 s29, s58, 258048
    buffer_load_dwordx4 v8, s[48:51], s29 offen lds
    s_waitcnt lgkmcnt(6)
    v_mfma_f32_16x16x32_bf16 v[40:43], v[108:111], v[136:139], v[40:43]
    v_mfma_f32_16x16x32_bf16 v[44:47], v[108:111], v[140:143], v[44:47]
    ds_read_b64_tr_b16 v[124:125], v153 offset:20672
    ds_read_b64_tr_b16 v[126:127], v153 offset:23232
    s_waitcnt lgkmcnt(6)
    v_mfma_f32_16x16x32_bf16 v[48:51], v[112:115], v[136:139], v[48:51]
    v_mfma_f32_16x16x32_bf16 v[52:55], v[112:115], v[140:143], v[52:55]
    ds_read_b64_tr_b16 v[96:97], v3 offset:20736
    ds_read_b64_tr_b16 v[98:99], v3 offset:23296
    s_add_u32 m0, s59, 58368
    s_add_u32 s29, s58, 276480
    buffer_load_dwordx4 v4, s[48:51], s29 offen lds
    s_waitcnt lgkmcnt(6)
    v_mfma_f32_16x16x32_bf16 v[56:59], v[116:119], v[136:139], v[56:59]
    v_mfma_f32_16x16x32_bf16 v[60:63], v[116:119], v[140:143], v[60:63]
    ds_read_b64_tr_b16 v[100:101], v153 offset:20736
    ds_read_b64_tr_b16 v[102:103], v153 offset:23296
    s_waitcnt lgkmcnt(6)
    v_mfma_f32_16x16x32_bf16 v[64:67], v[120:123], v[136:139], v[64:67]
    v_mfma_f32_16x16x32_bf16 v[68:71], v[120:123], v[140:143], v[68:71]
    ds_read_b64_tr_b16 v[104:105], v3 offset:30720
    ds_read_b64_tr_b16 v[106:107], v3 offset:33280
    s_add_u32 m0, s59, 59392
    s_add_u32 s29, s58, 276480
    buffer_load_dwordx4 v5, s[48:51], s29 offen lds
    s_waitcnt lgkmcnt(6)
    v_mfma_f32_16x16x32_bf16 v[72:75], v[124:127], v[136:139], v[72:75]
    v_mfma_f32_16x16x32_bf16 v[76:79], v[124:127], v[140:143], v[76:79]
    ds_read_b64_tr_b16 v[108:109], v153 offset:30720
    ds_read_b64_tr_b16 v[110:111], v153 offset:33280
    s_waitcnt lgkmcnt(6)
    v_mfma_f32_16x16x32_bf16 v[80:83], v[96:99], v[136:139], v[80:83]
    v_mfma_f32_16x16x32_bf16 v[84:87], v[96:99], v[140:143], v[84:87]
    ds_read_b64_tr_b16 v[112:113], v3 offset:30784
    ds_read_b64_tr_b16 v[114:115], v3 offset:33344
    s_waitcnt lgkmcnt(6)
    v_mfma_f32_16x16x32_bf16 v[88:91], v[100:103], v[136:139], v[88:91]
    v_mfma_f32_16x16x32_bf16 v[92:95], v[100:103], v[140:143], v[92:95]
    ds_read_b64_tr_b16 v[116:117], v153 offset:30784
    ds_read_b64_tr_b16 v[118:119], v153 offset:33344
    s_add_u32 s29, s42, 12288
    buffer_load_dwordx4 v[128:131], v9, s[12:15], s29 offen sc1
    s_add_u32 s29, s42, 12288
    buffer_load_dwordx4 v[132:135], v14, s[12:15], s29 offen sc1
    s_waitcnt vmcnt(6)
    s_waitcnt lgkmcnt(6)
    s_cmp_eq_u32 s62, 1
    s_cbranch_scc1 parallel_sum__softmax_full_mha__dense_activation_relu__prompt_kernel_sk5_0
    v_mfma_f32_16x16x32_bf16 v[16:19], v[104:107], v[144:147], v[16:19]
    v_mfma_f32_16x16x32_bf16 v[20:23], v[104:107], v[148:151], v[20:23]
parallel_sum__softmax_full_mha__dense_activation_relu__prompt_kernel_sk5_0:
    ds_read_b64_tr_b16 v[120:121], v3 offset:30848
    ds_read_b64_tr_b16 v[122:123], v3 offset:33408
    s_add_u32 m0, s59, 60416
    s_add_u32 s29, s58, 276480
    buffer_load_dwordx4 v6, s[48:51], s29 offen lds
    s_waitcnt lgkmcnt(6)
    s_cmp_eq_u32 s62, 1
    s_cbranch_scc1 parallel_sum__softmax_full_mha__dense_activation_relu__prompt_kernel_sk5_1
    v_mfma_f32_16x16x32_bf16 v[24:27], v[108:111], v[144:147], v[24:27]
    v_mfma_f32_16x16x32_bf16 v[28:31], v[108:111], v[148:151], v[28:31]
parallel_sum__softmax_full_mha__dense_activation_relu__prompt_kernel_sk5_1:
    ds_read_b64_tr_b16 v[124:125], v153 offset:30848
    ds_read_b64_tr_b16 v[126:127], v153 offset:33408
    s_waitcnt lgkmcnt(6)
    v_mfma_f32_16x16x32_bf16 v[32:35], v[112:115], v[144:147], v[32:35]
    v_mfma_f32_16x16x32_bf16 v[36:39], v[112:115], v[148:151], v[36:39]
    ds_read_b64_tr_b16 v[96:97], v3 offset:30912
    ds_read_b64_tr_b16 v[98:99], v3 offset:33472
    s_add_u32 m0, s59, 61440
    s_add_u32 s29, s58, 276480
    buffer_load_dwordx4 v7, s[48:51], s29 offen lds
    s_waitcnt lgkmcnt(6)
    v_mfma_f32_16x16x32_bf16 v[40:43], v[116:119], v[144:147], v[40:43]
    v_mfma_f32_16x16x32_bf16 v[44:47], v[116:119], v[148:151], v[44:47]
    ds_read_b64_tr_b16 v[100:101], v153 offset:30912
    ds_read_b64_tr_b16 v[102:103], v153 offset:33472
    s_waitcnt lgkmcnt(6)
    v_mfma_f32_16x16x32_bf16 v[48:51], v[120:123], v[144:147], v[48:51]
    v_mfma_f32_16x16x32_bf16 v[52:55], v[120:123], v[148:151], v[52:55]
    ds_read_b64_tr_b16 v[104:105], v3 offset:30976
    ds_read_b64_tr_b16 v[106:107], v3 offset:33536
    s_add_u32 m0, s59, 62464
    s_add_u32 s29, s58, 276480
    buffer_load_dwordx4 v8, s[48:51], s29 offen lds
    s_waitcnt lgkmcnt(6)
    v_mfma_f32_16x16x32_bf16 v[56:59], v[124:127], v[144:147], v[56:59]
    v_mfma_f32_16x16x32_bf16 v[60:63], v[124:127], v[148:151], v[60:63]
    ds_read_b64_tr_b16 v[108:109], v153 offset:30976
    ds_read_b64_tr_b16 v[110:111], v153 offset:33536
    s_waitcnt lgkmcnt(6)
    v_mfma_f32_16x16x32_bf16 v[64:67], v[96:99], v[144:147], v[64:67]
    v_mfma_f32_16x16x32_bf16 v[68:71], v[96:99], v[148:151], v[68:71]
    ds_read_b64_tr_b16 v[112:113], v3 offset:40960
    ds_read_b64_tr_b16 v[114:115], v3 offset:43520
    s_add_u32 m0, s59, 63488
    s_add_u32 s29, s58, 294912
    buffer_load_dwordx4 v4, s[48:51], s29 offen lds
    s_waitcnt lgkmcnt(6)
    v_mfma_f32_16x16x32_bf16 v[72:75], v[100:103], v[144:147], v[72:75]
    v_mfma_f32_16x16x32_bf16 v[76:79], v[100:103], v[148:151], v[76:79]
    ds_read_b64_tr_b16 v[116:117], v153 offset:40960
    ds_read_b64_tr_b16 v[118:119], v153 offset:43520
    s_waitcnt lgkmcnt(6)
    v_mfma_f32_16x16x32_bf16 v[80:83], v[104:107], v[144:147], v[80:83]
    v_mfma_f32_16x16x32_bf16 v[84:87], v[104:107], v[148:151], v[84:87]
    ds_read_b64_tr_b16 v[120:121], v3 offset:41024
    ds_read_b64_tr_b16 v[122:123], v3 offset:43584
    s_waitcnt lgkmcnt(6)
    v_mfma_f32_16x16x32_bf16 v[88:91], v[108:111], v[144:147], v[88:91]
    v_mfma_f32_16x16x32_bf16 v[92:95], v[108:111], v[148:151], v[92:95]
    ds_read_b64_tr_b16 v[124:125], v153 offset:41024
    ds_read_b64_tr_b16 v[126:127], v153 offset:43584
    s_add_u32 s29, s42, 14336
    buffer_load_dwordx4 v[136:139], v9, s[12:15], s29 offen sc1
    s_add_u32 s29, s42, 14336
    buffer_load_dwordx4 v[140:143], v14, s[12:15], s29 offen sc1
    s_waitcnt vmcnt(6)
    s_waitcnt lgkmcnt(6)
    s_cmp_eq_u32 s62, 1
    s_cbranch_scc1 parallel_sum__softmax_full_mha__dense_activation_relu__prompt_kernel_sk6_0
    v_mfma_f32_16x16x32_bf16 v[16:19], v[112:115], v[128:131], v[16:19]
    v_mfma_f32_16x16x32_bf16 v[20:23], v[112:115], v[132:135], v[20:23]
parallel_sum__softmax_full_mha__dense_activation_relu__prompt_kernel_sk6_0:
    ds_read_b64_tr_b16 v[96:97], v3 offset:41088
    ds_read_b64_tr_b16 v[98:99], v3 offset:43648
    s_add_u32 m0, s59, 64512
    s_add_u32 s29, s58, 294912
    buffer_load_dwordx4 v5, s[48:51], s29 offen lds
    s_waitcnt lgkmcnt(6)
    s_cmp_eq_u32 s62, 1
    s_cbranch_scc1 parallel_sum__softmax_full_mha__dense_activation_relu__prompt_kernel_sk6_1
    v_mfma_f32_16x16x32_bf16 v[24:27], v[116:119], v[128:131], v[24:27]
    v_mfma_f32_16x16x32_bf16 v[28:31], v[116:119], v[132:135], v[28:31]
parallel_sum__softmax_full_mha__dense_activation_relu__prompt_kernel_sk6_1:
    ds_read_b64_tr_b16 v[100:101], v153 offset:41088
    ds_read_b64_tr_b16 v[102:103], v153 offset:43648
    s_waitcnt lgkmcnt(6)
    v_mfma_f32_16x16x32_bf16 v[32:35], v[120:123], v[128:131], v[32:35]
    v_mfma_f32_16x16x32_bf16 v[36:39], v[120:123], v[132:135], v[36:39]
    ds_read_b64_tr_b16 v[104:105], v3 offset:41152
    ds_read_b64_tr_b16 v[106:107], v3 offset:43712
    s_add_u32 m0, s59, 65536
    s_add_u32 s29, s58, 294912
    s_mov_b32 exec_lo, 0xffffffff
    s_mov_b32 exec_hi, 0x0
    buffer_load_dwordx4 v6, s[48:51], s29 offen lds
    s_mov_b64 exec, -1
    s_waitcnt lgkmcnt(6)
    v_mfma_f32_16x16x32_bf16 v[40:43], v[124:127], v[128:131], v[40:43]
    v_mfma_f32_16x16x32_bf16 v[44:47], v[124:127], v[132:135], v[44:47]
    ds_read_b64_tr_b16 v[108:109], v153 offset:41152
    ds_read_b64_tr_b16 v[110:111], v153 offset:43712
    s_waitcnt lgkmcnt(6)
    v_mfma_f32_16x16x32_bf16 v[48:51], v[96:99], v[128:131], v[48:51]
    v_mfma_f32_16x16x32_bf16 v[52:55], v[96:99], v[132:135], v[52:55]
    ds_read_b64_tr_b16 v[112:113], v3 offset:41216
    ds_read_b64_tr_b16 v[114:115], v3 offset:43776
    s_waitcnt lgkmcnt(6)
    v_mfma_f32_16x16x32_bf16 v[56:59], v[100:103], v[128:131], v[56:59]
    v_mfma_f32_16x16x32_bf16 v[60:63], v[100:103], v[132:135], v[60:63]
    ds_read_b64_tr_b16 v[116:117], v153 offset:41216
    ds_read_b64_tr_b16 v[118:119], v153 offset:43776
    s_waitcnt lgkmcnt(6)
    v_mfma_f32_16x16x32_bf16 v[64:67], v[104:107], v[128:131], v[64:67]
    v_mfma_f32_16x16x32_bf16 v[68:71], v[104:107], v[132:135], v[68:71]
    s_waitcnt lgkmcnt(4)
    v_mfma_f32_16x16x32_bf16 v[72:75], v[108:111], v[128:131], v[72:75]
    v_mfma_f32_16x16x32_bf16 v[76:79], v[108:111], v[132:135], v[76:79]
    s_waitcnt lgkmcnt(2)
    v_mfma_f32_16x16x32_bf16 v[80:83], v[112:115], v[128:131], v[80:83]
    v_mfma_f32_16x16x32_bf16 v[84:87], v[112:115], v[132:135], v[84:87]
    s_waitcnt lgkmcnt(0)
    v_mfma_f32_16x16x32_bf16 v[88:91], v[116:119], v[128:131], v[88:91]
    v_mfma_f32_16x16x32_bf16 v[92:95], v[116:119], v[132:135], v[92:95]
    s_add_u32 s29, s42, 16384
    buffer_load_dwordx4 v[144:147], v9, s[12:15], s29 offen sc1
    s_add_u32 s29, s42, 16384
    buffer_load_dwordx4 v[148:151], v14, s[12:15], s29 offen sc1
    s_waitcnt vmcnt(2)
    s_barrier
    ds_read_b64_tr_b16 v[120:121], v2 offset:0
    ds_read_b64_tr_b16 v[122:123], v2 offset:2560
    ds_read_b64_tr_b16 v[124:125], v152 offset:0
    ds_read_b64_tr_b16 v[126:127], v152 offset:2560
    ds_read_b64_tr_b16 v[96:97], v2 offset:64
    ds_read_b64_tr_b16 v[98:99], v2 offset:2624
    ds_read_b64_tr_b16 v[100:101], v152 offset:64
    ds_read_b64_tr_b16 v[102:103], v152 offset:2624
    s_waitcnt vmcnt(4)
    s_waitcnt lgkmcnt(6)
    s_cmp_eq_u32 s62, 1
    s_cbranch_scc1 parallel_sum__softmax_full_mha__dense_activation_relu__prompt_kernel_sk7_0
    v_mfma_f32_16x16x32_bf16 v[16:19], v[120:123], v[136:139], v[16:19]
    v_mfma_f32_16x16x32_bf16 v[20:23], v[120:123], v[140:143], v[20:23]
parallel_sum__softmax_full_mha__dense_activation_relu__prompt_kernel_sk7_0:
    ds_read_b64_tr_b16 v[104:105], v2 offset:128
    ds_read_b64_tr_b16 v[106:107], v2 offset:2688
    s_add_u32 m0, s39, 104448
    s_add_u32 s29, s38, 61440
    buffer_load_dwordx4 v1, s[8:11], s29 offen sc1 lds
    s_waitcnt lgkmcnt(6)
    s_cmp_eq_u32 s62, 1
    s_cbranch_scc1 parallel_sum__softmax_full_mha__dense_activation_relu__prompt_kernel_sk7_1
    v_mfma_f32_16x16x32_bf16 v[24:27], v[124:127], v[136:139], v[24:27]
    v_mfma_f32_16x16x32_bf16 v[28:31], v[124:127], v[140:143], v[28:31]
parallel_sum__softmax_full_mha__dense_activation_relu__prompt_kernel_sk7_1:
    ds_read_b64_tr_b16 v[108:109], v152 offset:128
    ds_read_b64_tr_b16 v[110:111], v152 offset:2688
    s_waitcnt lgkmcnt(6)
    v_mfma_f32_16x16x32_bf16 v[32:35], v[96:99], v[136:139], v[32:35]
    v_mfma_f32_16x16x32_bf16 v[36:39], v[96:99], v[140:143], v[36:39]
    ds_read_b64_tr_b16 v[112:113], v2 offset:192
    ds_read_b64_tr_b16 v[114:115], v2 offset:2752
    s_add_u32 m0, s39, 105472
    s_add_u32 s29, s38, 62464
    buffer_load_dwordx4 v1, s[8:11], s29 offen sc1 lds
    s_waitcnt lgkmcnt(6)
    v_mfma_f32_16x16x32_bf16 v[40:43], v[100:103], v[136:139], v[40:43]
    v_mfma_f32_16x16x32_bf16 v[44:47], v[100:103], v[140:143], v[44:47]
    ds_read_b64_tr_b16 v[116:117], v152 offset:192
    ds_read_b64_tr_b16 v[118:119], v152 offset:2752
    s_waitcnt lgkmcnt(6)
    v_mfma_f32_16x16x32_bf16 v[48:51], v[104:107], v[136:139], v[48:51]
    v_mfma_f32_16x16x32_bf16 v[52:55], v[104:107], v[140:143], v[52:55]
    ds_read_b64_tr_b16 v[120:121], v2 offset:256
    ds_read_b64_tr_b16 v[122:123], v2 offset:2816
    s_add_u32 m0, s39, 106496
    s_add_u32 s29, s38, 63488
    buffer_load_dwordx4 v1, s[8:11], s29 offen sc1 lds
    s_waitcnt lgkmcnt(6)
    v_mfma_f32_16x16x32_bf16 v[56:59], v[108:111], v[136:139], v[56:59]
    v_mfma_f32_16x16x32_bf16 v[60:63], v[108:111], v[140:143], v[60:63]
    ds_read_b64_tr_b16 v[124:125], v152 offset:256
    ds_read_b64_tr_b16 v[126:127], v152 offset:2816
    s_waitcnt lgkmcnt(6)
    v_mfma_f32_16x16x32_bf16 v[64:67], v[112:115], v[136:139], v[64:67]
    v_mfma_f32_16x16x32_bf16 v[68:71], v[112:115], v[140:143], v[68:71]
    ds_read_b64_tr_b16 v[96:97], v2 offset:10240
    ds_read_b64_tr_b16 v[98:99], v2 offset:12800
    s_add_u32 m0, s39, 107520
    s_add_u32 s29, s38, 64512
    buffer_load_dwordx4 v1, s[8:11], s29 offen sc1 lds
    s_waitcnt lgkmcnt(6)
    v_mfma_f32_16x16x32_bf16 v[72:75], v[116:119], v[136:139], v[72:75]
    v_mfma_f32_16x16x32_bf16 v[76:79], v[116:119], v[140:143], v[76:79]
    ds_read_b64_tr_b16 v[100:101], v152 offset:10240
    ds_read_b64_tr_b16 v[102:103], v152 offset:12800
    s_waitcnt lgkmcnt(6)
    v_mfma_f32_16x16x32_bf16 v[80:83], v[120:123], v[136:139], v[80:83]
    v_mfma_f32_16x16x32_bf16 v[84:87], v[120:123], v[140:143], v[84:87]
    ds_read_b64_tr_b16 v[104:105], v2 offset:10304
    ds_read_b64_tr_b16 v[106:107], v2 offset:12864
    s_waitcnt lgkmcnt(6)
    v_mfma_f32_16x16x32_bf16 v[88:91], v[124:127], v[136:139], v[88:91]
    v_mfma_f32_16x16x32_bf16 v[92:95], v[124:127], v[140:143], v[92:95]
    ds_read_b64_tr_b16 v[108:109], v152 offset:10304
    ds_read_b64_tr_b16 v[110:111], v152 offset:12864
    s_add_u32 s29, s42, 18432
    buffer_load_dwordx4 v[128:131], v9, s[12:15], s29 offen sc1
    s_add_u32 s29, s42, 18432
    buffer_load_dwordx4 v[132:135], v14, s[12:15], s29 offen sc1
    s_waitcnt vmcnt(6)
    s_waitcnt lgkmcnt(6)
    s_cmp_eq_u32 s62, 1
    s_cbranch_scc1 parallel_sum__softmax_full_mha__dense_activation_relu__prompt_kernel_sk8_0
    v_mfma_f32_16x16x32_bf16 v[16:19], v[96:99], v[144:147], v[16:19]
    v_mfma_f32_16x16x32_bf16 v[20:23], v[96:99], v[148:151], v[20:23]
parallel_sum__softmax_full_mha__dense_activation_relu__prompt_kernel_sk8_0:
    ds_read_b64_tr_b16 v[112:113], v2 offset:10368
    ds_read_b64_tr_b16 v[114:115], v2 offset:12928
    s_add_u32 s45, s39, 108544
    s_cmp_eq_u32 s21, 3
    s_cselect_b32 m0, 162816, s45
    s_add_u32 s29, s38, 65536
    buffer_load_dwordx4 v1, s[8:11], s29 offen sc1 lds
    s_waitcnt lgkmcnt(6)
    s_cmp_eq_u32 s62, 1
    s_cbranch_scc1 parallel_sum__softmax_full_mha__dense_activation_relu__prompt_kernel_sk8_1
    v_mfma_f32_16x16x32_bf16 v[24:27], v[100:103], v[144:147], v[24:27]
    v_mfma_f32_16x16x32_bf16 v[28:31], v[100:103], v[148:151], v[28:31]
parallel_sum__softmax_full_mha__dense_activation_relu__prompt_kernel_sk8_1:
    ds_read_b64_tr_b16 v[116:117], v152 offset:10368
    ds_read_b64_tr_b16 v[118:119], v152 offset:12928
    s_waitcnt lgkmcnt(6)
    v_mfma_f32_16x16x32_bf16 v[32:35], v[104:107], v[144:147], v[32:35]
    v_mfma_f32_16x16x32_bf16 v[36:39], v[104:107], v[148:151], v[36:39]
    ds_read_b64_tr_b16 v[120:121], v2 offset:10432
    ds_read_b64_tr_b16 v[122:123], v2 offset:12992
    s_add_u32 m0, s59, 1024
    s_add_u32 s29, s58, 442368
    buffer_load_dwordx4 v4, s[48:51], s29 offen lds
    s_waitcnt lgkmcnt(6)
    v_mfma_f32_16x16x32_bf16 v[40:43], v[108:111], v[144:147], v[40:43]
    v_mfma_f32_16x16x32_bf16 v[44:47], v[108:111], v[148:151], v[44:47]
    ds_read_b64_tr_b16 v[124:125], v152 offset:10432
    ds_read_b64_tr_b16 v[126:127], v152 offset:12992
    s_waitcnt lgkmcnt(6)
    v_mfma_f32_16x16x32_bf16 v[48:51], v[112:115], v[144:147], v[48:51]
    v_mfma_f32_16x16x32_bf16 v[52:55], v[112:115], v[148:151], v[52:55]
    ds_read_b64_tr_b16 v[96:97], v2 offset:10496
    ds_read_b64_tr_b16 v[98:99], v2 offset:13056
    s_add_u32 m0, s59, 2048
    s_add_u32 s29, s58, 442368
    buffer_load_dwordx4 v5, s[48:51], s29 offen lds
    s_waitcnt lgkmcnt(6)
    v_mfma_f32_16x16x32_bf16 v[56:59], v[116:119], v[144:147], v[56:59]
    v_mfma_f32_16x16x32_bf16 v[60:63], v[116:119], v[148:151], v[60:63]
    ds_read_b64_tr_b16 v[100:101], v152 offset:10496
    ds_read_b64_tr_b16 v[102:103], v152 offset:13056
    s_waitcnt lgkmcnt(6)
    v_mfma_f32_16x16x32_bf16 v[64:67], v[120:123], v[144:147], v[64:67]
    v_mfma_f32_16x16x32_bf16 v[68:71], v[120:123], v[148:151], v[68:71]
    ds_read_b64_tr_b16 v[104:105], v2 offset:20480
    ds_read_b64_tr_b16 v[106:107], v2 offset:23040
    s_add_u32 m0, s59, 3072
    s_add_u32 s29, s58, 442368
    buffer_load_dwordx4 v6, s[48:51], s29 offen lds
    s_waitcnt lgkmcnt(6)
    v_mfma_f32_16x16x32_bf16 v[72:75], v[124:127], v[144:147], v[72:75]
    v_mfma_f32_16x16x32_bf16 v[76:79], v[124:127], v[148:151], v[76:79]
    ds_read_b64_tr_b16 v[108:109], v152 offset:20480
    ds_read_b64_tr_b16 v[110:111], v152 offset:23040
    s_waitcnt lgkmcnt(6)
    v_mfma_f32_16x16x32_bf16 v[80:83], v[96:99], v[144:147], v[80:83]
    v_mfma_f32_16x16x32_bf16 v[84:87], v[96:99], v[148:151], v[84:87]
    ds_read_b64_tr_b16 v[112:113], v2 offset:20544
    ds_read_b64_tr_b16 v[114:115], v2 offset:23104
    s_waitcnt lgkmcnt(6)
    v_mfma_f32_16x16x32_bf16 v[88:91], v[100:103], v[144:147], v[88:91]
    v_mfma_f32_16x16x32_bf16 v[92:95], v[100:103], v[148:151], v[92:95]
    ds_read_b64_tr_b16 v[116:117], v152 offset:20544
    ds_read_b64_tr_b16 v[118:119], v152 offset:23104
    s_add_u32 s29, s42, 20480
    buffer_load_dwordx4 v[136:139], v9, s[12:15], s29 offen sc1
    s_add_u32 s29, s42, 20480
    buffer_load_dwordx4 v[140:143], v14, s[12:15], s29 offen sc1
    s_waitcnt vmcnt(6)
    s_waitcnt lgkmcnt(6)
    s_cmp_eq_u32 s62, 1
    s_cbranch_scc1 parallel_sum__softmax_full_mha__dense_activation_relu__prompt_kernel_sk9_0
    v_mfma_f32_16x16x32_bf16 v[16:19], v[104:107], v[128:131], v[16:19]
    v_mfma_f32_16x16x32_bf16 v[20:23], v[104:107], v[132:135], v[20:23]
parallel_sum__softmax_full_mha__dense_activation_relu__prompt_kernel_sk9_0:
    ds_read_b64_tr_b16 v[120:121], v2 offset:20608
    ds_read_b64_tr_b16 v[122:123], v2 offset:23168
    s_add_u32 m0, s59, 4096
    s_add_u32 s29, s58, 442368
    buffer_load_dwordx4 v7, s[48:51], s29 offen lds
    s_waitcnt lgkmcnt(6)
    s_cmp_eq_u32 s62, 1
    s_cbranch_scc1 parallel_sum__softmax_full_mha__dense_activation_relu__prompt_kernel_sk9_1
    v_mfma_f32_16x16x32_bf16 v[24:27], v[108:111], v[128:131], v[24:27]
    v_mfma_f32_16x16x32_bf16 v[28:31], v[108:111], v[132:135], v[28:31]
parallel_sum__softmax_full_mha__dense_activation_relu__prompt_kernel_sk9_1:
    ds_read_b64_tr_b16 v[124:125], v152 offset:20608
    ds_read_b64_tr_b16 v[126:127], v152 offset:23168
    s_waitcnt lgkmcnt(6)
    v_mfma_f32_16x16x32_bf16 v[32:35], v[112:115], v[128:131], v[32:35]
    v_mfma_f32_16x16x32_bf16 v[36:39], v[112:115], v[132:135], v[36:39]
    ds_read_b64_tr_b16 v[96:97], v2 offset:20672
    ds_read_b64_tr_b16 v[98:99], v2 offset:23232
    s_add_u32 m0, s59, 5120
    s_add_u32 s29, s58, 442368
    buffer_load_dwordx4 v8, s[48:51], s29 offen lds
    s_waitcnt lgkmcnt(6)
    v_mfma_f32_16x16x32_bf16 v[40:43], v[116:119], v[128:131], v[40:43]
    v_mfma_f32_16x16x32_bf16 v[44:47], v[116:119], v[132:135], v[44:47]
    ds_read_b64_tr_b16 v[100:101], v152 offset:20672
    ds_read_b64_tr_b16 v[102:103], v152 offset:23232
    s_waitcnt lgkmcnt(6)
    v_mfma_f32_16x16x32_bf16 v[48:51], v[120:123], v[128:131], v[48:51]
    v_mfma_f32_16x16x32_bf16 v[52:55], v[120:123], v[132:135], v[52:55]
    ds_read_b64_tr_b16 v[104:105], v2 offset:20736
    ds_read_b64_tr_b16 v[106:107], v2 offset:23296
    s_add_u32 m0, s59, 6144
    s_add_u32 s29, s58, 460800
    buffer_load_dwordx4 v4, s[48:51], s29 offen lds
    s_waitcnt lgkmcnt(6)
    v_mfma_f32_16x16x32_bf16 v[56:59], v[124:127], v[128:131], v[56:59]
    v_mfma_f32_16x16x32_bf16 v[60:63], v[124:127], v[132:135], v[60:63]
    ds_read_b64_tr_b16 v[108:109], v152 offset:20736
    ds_read_b64_tr_b16 v[110:111], v152 offset:23296
    s_waitcnt lgkmcnt(6)
    v_mfma_f32_16x16x32_bf16 v[64:67], v[96:99], v[128:131], v[64:67]
    v_mfma_f32_16x16x32_bf16 v[68:71], v[96:99], v[132:135], v[68:71]
    ds_read_b64_tr_b16 v[112:113], v2 offset:30720
    ds_read_b64_tr_b16 v[114:115], v2 offset:33280
    s_add_u32 m0, s59, 7168
    s_add_u32 s29, s58, 460800
    buffer_load_dwordx4 v5, s[48:51], s29 offen lds
    s_waitcnt lgkmcnt(6)
    v_mfma_f32_16x16x32_bf16 v[72:75], v[100:103], v[128:131], v[72:75]
    v_mfma_f32_16x16x32_bf16 v[76:79], v[100:103], v[132:135], v[76:79]
    ds_read_b64_tr_b16 v[116:117], v152 offset:30720
    ds_read_b64_tr_b16 v[118:119], v152 offset:33280
    s_waitcnt lgkmcnt(6)
    v_mfma_f32_16x16x32_bf16 v[80:83], v[104:107], v[128:131], v[80:83]
    v_mfma_f32_16x16x32_bf16 v[84:87], v[104:107], v[132:135], v[84:87]
    ds_read_b64_tr_b16 v[120:121], v2 offset:30784
    ds_read_b64_tr_b16 v[122:123], v2 offset:33344
    s_waitcnt lgkmcnt(6)
    v_mfma_f32_16x16x32_bf16 v[88:91], v[108:111], v[128:131], v[88:91]
    v_mfma_f32_16x16x32_bf16 v[92:95], v[108:111], v[132:135], v[92:95]
    ds_read_b64_tr_b16 v[124:125], v152 offset:30784
    ds_read_b64_tr_b16 v[126:127], v152 offset:33344
    s_add_u32 s29, s42, 22528
    buffer_load_dwordx4 v[144:147], v9, s[12:15], s29 offen sc1
    s_add_u32 s29, s42, 22528
    buffer_load_dwordx4 v[148:151], v14, s[12:15], s29 offen sc1
    s_waitcnt vmcnt(6)
    s_waitcnt lgkmcnt(6)
    s_cmp_eq_u32 s62, 1
    s_cbranch_scc1 parallel_sum__softmax_full_mha__dense_activation_relu__prompt_kernel_sk10_0
    v_mfma_f32_16x16x32_bf16 v[16:19], v[112:115], v[136:139], v[16:19]
    v_mfma_f32_16x16x32_bf16 v[20:23], v[112:115], v[140:143], v[20:23]
parallel_sum__softmax_full_mha__dense_activation_relu__prompt_kernel_sk10_0:
    ds_read_b64_tr_b16 v[96:97], v2 offset:30848
    ds_read_b64_tr_b16 v[98:99], v2 offset:33408
    s_add_u32 m0, s59, 8192
    s_add_u32 s29, s58, 460800
    buffer_load_dwordx4 v6, s[48:51], s29 offen lds
    s_waitcnt lgkmcnt(6)
    s_cmp_eq_u32 s62, 1
    s_cbranch_scc1 parallel_sum__softmax_full_mha__dense_activation_relu__prompt_kernel_sk10_1
    v_mfma_f32_16x16x32_bf16 v[24:27], v[116:119], v[136:139], v[24:27]
    v_mfma_f32_16x16x32_bf16 v[28:31], v[116:119], v[140:143], v[28:31]
parallel_sum__softmax_full_mha__dense_activation_relu__prompt_kernel_sk10_1:
    ds_read_b64_tr_b16 v[100:101], v152 offset:30848
    ds_read_b64_tr_b16 v[102:103], v152 offset:33408
    s_waitcnt lgkmcnt(6)
    v_mfma_f32_16x16x32_bf16 v[32:35], v[120:123], v[136:139], v[32:35]
    v_mfma_f32_16x16x32_bf16 v[36:39], v[120:123], v[140:143], v[36:39]
    ds_read_b64_tr_b16 v[104:105], v2 offset:30912
    ds_read_b64_tr_b16 v[106:107], v2 offset:33472
    s_add_u32 m0, s59, 9216
    s_add_u32 s29, s58, 460800
    buffer_load_dwordx4 v7, s[48:51], s29 offen lds
    s_waitcnt lgkmcnt(6)
    v_mfma_f32_16x16x32_bf16 v[40:43], v[124:127], v[136:139], v[40:43]
    v_mfma_f32_16x16x32_bf16 v[44:47], v[124:127], v[140:143], v[44:47]
    ds_read_b64_tr_b16 v[108:109], v152 offset:30912
    ds_read_b64_tr_b16 v[110:111], v152 offset:33472
    s_waitcnt lgkmcnt(6)
    v_mfma_f32_16x16x32_bf16 v[48:51], v[96:99], v[136:139], v[48:51]
    v_mfma_f32_16x16x32_bf16 v[52:55], v[96:99], v[140:143], v[52:55]
    ds_read_b64_tr_b16 v[112:113], v2 offset:30976
    ds_read_b64_tr_b16 v[114:115], v2 offset:33536
    s_add_u32 m0, s59, 10240
    s_add_u32 s29, s58, 460800
    buffer_load_dwordx4 v8, s[48:51], s29 offen lds
    s_waitcnt lgkmcnt(6)
    v_mfma_f32_16x16x32_bf16 v[56:59], v[100:103], v[136:139], v[56:59]
    v_mfma_f32_16x16x32_bf16 v[60:63], v[100:103], v[140:143], v[60:63]
    ds_read_b64_tr_b16 v[116:117], v152 offset:30976
    ds_read_b64_tr_b16 v[118:119], v152 offset:33536
    s_waitcnt lgkmcnt(6)
    v_mfma_f32_16x16x32_bf16 v[64:67], v[104:107], v[136:139], v[64:67]
    v_mfma_f32_16x16x32_bf16 v[68:71], v[104:107], v[140:143], v[68:71]
    ds_read_b64_tr_b16 v[120:121], v2 offset:40960
    ds_read_b64_tr_b16 v[122:123], v2 offset:43520
    s_add_u32 m0, s59, 11264
    s_add_u32 s29, s58, 479232
    buffer_load_dwordx4 v4, s[48:51], s29 offen lds
    s_waitcnt lgkmcnt(6)
    v_mfma_f32_16x16x32_bf16 v[72:75], v[108:111], v[136:139], v[72:75]
    v_mfma_f32_16x16x32_bf16 v[76:79], v[108:111], v[140:143], v[76:79]
    ds_read_b64_tr_b16 v[124:125], v152 offset:40960
    ds_read_b64_tr_b16 v[126:127], v152 offset:43520
    s_waitcnt lgkmcnt(6)
    v_mfma_f32_16x16x32_bf16 v[80:83], v[112:115], v[136:139], v[80:83]
    v_mfma_f32_16x16x32_bf16 v[84:87], v[112:115], v[140:143], v[84:87]
    ds_read_b64_tr_b16 v[96:97], v2 offset:41024
    ds_read_b64_tr_b16 v[98:99], v2 offset:43584
    s_waitcnt lgkmcnt(6)
    v_mfma_f32_16x16x32_bf16 v[88:91], v[116:119], v[136:139], v[88:91]
    v_mfma_f32_16x16x32_bf16 v[92:95], v[116:119], v[140:143], v[92:95]
    ds_read_b64_tr_b16 v[100:101], v152 offset:41024
    ds_read_b64_tr_b16 v[102:103], v152 offset:43584
    s_add_u32 s29, s42, 24576
    buffer_load_dwordx4 v[128:131], v9, s[12:15], s29 offen sc1
    s_add_u32 s29, s42, 24576
    buffer_load_dwordx4 v[132:135], v14, s[12:15], s29 offen sc1
    s_waitcnt vmcnt(6)
    s_waitcnt lgkmcnt(6)
    s_cmp_eq_u32 s62, 1
    s_cbranch_scc1 parallel_sum__softmax_full_mha__dense_activation_relu__prompt_kernel_sk11_0
    v_mfma_f32_16x16x32_bf16 v[16:19], v[120:123], v[144:147], v[16:19]
    v_mfma_f32_16x16x32_bf16 v[20:23], v[120:123], v[148:151], v[20:23]
parallel_sum__softmax_full_mha__dense_activation_relu__prompt_kernel_sk11_0:
    ds_read_b64_tr_b16 v[104:105], v2 offset:41088
    ds_read_b64_tr_b16 v[106:107], v2 offset:43648
    s_add_u32 m0, s59, 12288
    s_add_u32 s29, s58, 479232
    buffer_load_dwordx4 v5, s[48:51], s29 offen lds
    s_waitcnt lgkmcnt(6)
    s_cmp_eq_u32 s62, 1
    s_cbranch_scc1 parallel_sum__softmax_full_mha__dense_activation_relu__prompt_kernel_sk11_1
    v_mfma_f32_16x16x32_bf16 v[24:27], v[124:127], v[144:147], v[24:27]
    v_mfma_f32_16x16x32_bf16 v[28:31], v[124:127], v[148:151], v[28:31]
parallel_sum__softmax_full_mha__dense_activation_relu__prompt_kernel_sk11_1:
    ds_read_b64_tr_b16 v[108:109], v152 offset:41088
    ds_read_b64_tr_b16 v[110:111], v152 offset:43648
    s_waitcnt lgkmcnt(6)
    v_mfma_f32_16x16x32_bf16 v[32:35], v[96:99], v[144:147], v[32:35]
    v_mfma_f32_16x16x32_bf16 v[36:39], v[96:99], v[148:151], v[36:39]
    ds_read_b64_tr_b16 v[112:113], v2 offset:41152
    ds_read_b64_tr_b16 v[114:115], v2 offset:43712
    s_add_u32 m0, s59, 13312
    s_add_u32 s29, s58, 479232
    s_mov_b32 exec_lo, 0xffffffff
    s_mov_b32 exec_hi, 0x0
    buffer_load_dwordx4 v6, s[48:51], s29 offen lds
    s_mov_b64 exec, -1
    s_waitcnt lgkmcnt(6)
    v_mfma_f32_16x16x32_bf16 v[40:43], v[100:103], v[144:147], v[40:43]
    v_mfma_f32_16x16x32_bf16 v[44:47], v[100:103], v[148:151], v[44:47]
    ds_read_b64_tr_b16 v[116:117], v152 offset:41152
    ds_read_b64_tr_b16 v[118:119], v152 offset:43712
    s_waitcnt lgkmcnt(6)
    v_mfma_f32_16x16x32_bf16 v[48:51], v[104:107], v[144:147], v[48:51]
    v_mfma_f32_16x16x32_bf16 v[52:55], v[104:107], v[148:151], v[52:55]
    ds_read_b64_tr_b16 v[120:121], v2 offset:41216
    ds_read_b64_tr_b16 v[122:123], v2 offset:43776
    s_waitcnt lgkmcnt(6)
    v_mfma_f32_16x16x32_bf16 v[56:59], v[108:111], v[144:147], v[56:59]
    v_mfma_f32_16x16x32_bf16 v[60:63], v[108:111], v[148:151], v[60:63]
    ds_read_b64_tr_b16 v[124:125], v152 offset:41216
    ds_read_b64_tr_b16 v[126:127], v152 offset:43776
    s_waitcnt lgkmcnt(6)
    v_mfma_f32_16x16x32_bf16 v[64:67], v[112:115], v[144:147], v[64:67]
    v_mfma_f32_16x16x32_bf16 v[68:71], v[112:115], v[148:151], v[68:71]
    s_waitcnt lgkmcnt(4)
    v_mfma_f32_16x16x32_bf16 v[72:75], v[116:119], v[144:147], v[72:75]
    v_mfma_f32_16x16x32_bf16 v[76:79], v[116:119], v[148:151], v[76:79]
    s_waitcnt lgkmcnt(2)
    v_mfma_f32_16x16x32_bf16 v[80:83], v[120:123], v[144:147], v[80:83]
    v_mfma_f32_16x16x32_bf16 v[84:87], v[120:123], v[148:151], v[84:87]
    s_waitcnt lgkmcnt(0)
    v_mfma_f32_16x16x32_bf16 v[88:91], v[124:127], v[144:147], v[88:91]
    v_mfma_f32_16x16x32_bf16 v[92:95], v[124:127], v[148:151], v[92:95]
    s_add_u32 s29, s42, 26624
    buffer_load_dwordx4 v[136:139], v9, s[12:15], s29 offen sc1
    s_add_u32 s29, s42, 26624
    buffer_load_dwordx4 v[140:143], v14, s[12:15], s29 offen sc1
    s_waitcnt vmcnt(2)
    s_barrier
    ds_read_b64_tr_b16 v[96:97], v3 offset:0
    ds_read_b64_tr_b16 v[98:99], v3 offset:2560
    ds_read_b64_tr_b16 v[100:101], v153 offset:0
    ds_read_b64_tr_b16 v[102:103], v153 offset:2560
    ds_read_b64_tr_b16 v[104:105], v3 offset:64
    ds_read_b64_tr_b16 v[106:107], v3 offset:2624
    ds_read_b64_tr_b16 v[108:109], v153 offset:64
    ds_read_b64_tr_b16 v[110:111], v153 offset:2624
    s_waitcnt vmcnt(4)
    s_waitcnt lgkmcnt(6)
    s_cmp_eq_u32 s62, 1
    s_cbranch_scc1 parallel_sum__softmax_full_mha__dense_activation_relu__prompt_kernel_sk12_0
    v_mfma_f32_16x16x32_bf16 v[16:19], v[96:99], v[128:131], v[16:19]
    v_mfma_f32_16x16x32_bf16 v[20:23], v[96:99], v[132:135], v[20:23]
parallel_sum__softmax_full_mha__dense_activation_relu__prompt_kernel_sk12_0:
    ds_read_b64_tr_b16 v[112:113], v3 offset:128
    ds_read_b64_tr_b16 v[114:115], v3 offset:2688
    s_add_u32 m0, s39, 123904
    s_add_u32 s29, s38, 81920
    buffer_load_dwordx4 v1, s[8:11], s29 offen sc1 lds
    s_waitcnt lgkmcnt(6)
    s_cmp_eq_u32 s62, 1
    s_cbranch_scc1 parallel_sum__softmax_full_mha__dense_activation_relu__prompt_kernel_sk12_1
    v_mfma_f32_16x16x32_bf16 v[24:27], v[100:103], v[128:131], v[24:27]
    v_mfma_f32_16x16x32_bf16 v[28:31], v[100:103], v[132:135], v[28:31]
parallel_sum__softmax_full_mha__dense_activation_relu__prompt_kernel_sk12_1:
    ds_read_b64_tr_b16 v[116:117], v153 offset:128
    ds_read_b64_tr_b16 v[118:119], v153 offset:2688
    s_waitcnt lgkmcnt(6)
    v_mfma_f32_16x16x32_bf16 v[32:35], v[104:107], v[128:131], v[32:35]
    v_mfma_f32_16x16x32_bf16 v[36:39], v[104:107], v[132:135], v[36:39]
    ds_read_b64_tr_b16 v[120:121], v3 offset:192
    ds_read_b64_tr_b16 v[122:123], v3 offset:2752
    s_add_u32 m0, s39, 124928
    s_add_u32 s29, s38, 82944
    buffer_load_dwordx4 v1, s[8:11], s29 offen sc1 lds
    s_waitcnt lgkmcnt(6)
    v_mfma_f32_16x16x32_bf16 v[40:43], v[108:111], v[128:131], v[40:43]
    v_mfma_f32_16x16x32_bf16 v[44:47], v[108:111], v[132:135], v[44:47]
    ds_read_b64_tr_b16 v[124:125], v153 offset:192
    ds_read_b64_tr_b16 v[126:127], v153 offset:2752
    s_waitcnt lgkmcnt(6)
    v_mfma_f32_16x16x32_bf16 v[48:51], v[112:115], v[128:131], v[48:51]
    v_mfma_f32_16x16x32_bf16 v[52:55], v[112:115], v[132:135], v[52:55]
    ds_read_b64_tr_b16 v[96:97], v3 offset:256
    ds_read_b64_tr_b16 v[98:99], v3 offset:2816
    s_add_u32 m0, s39, 125952
    s_add_u32 s29, s38, 83968
    buffer_load_dwordx4 v1, s[8:11], s29 offen sc1 lds
    s_waitcnt lgkmcnt(6)
    v_mfma_f32_16x16x32_bf16 v[56:59], v[116:119], v[128:131], v[56:59]
    v_mfma_f32_16x16x32_bf16 v[60:63], v[116:119], v[132:135], v[60:63]
    ds_read_b64_tr_b16 v[100:101], v153 offset:256
    ds_read_b64_tr_b16 v[102:103], v153 offset:2816
    s_waitcnt lgkmcnt(6)
    v_mfma_f32_16x16x32_bf16 v[64:67], v[120:123], v[128:131], v[64:67]
    v_mfma_f32_16x16x32_bf16 v[68:71], v[120:123], v[132:135], v[68:71]
    ds_read_b64_tr_b16 v[104:105], v3 offset:10240
    ds_read_b64_tr_b16 v[106:107], v3 offset:12800
    s_add_u32 m0, s39, 126976
    s_add_u32 s29, s38, 84992
    buffer_load_dwordx4 v1, s[8:11], s29 offen sc1 lds
    s_waitcnt lgkmcnt(6)
    v_mfma_f32_16x16x32_bf16 v[72:75], v[124:127], v[128:131], v[72:75]
    v_mfma_f32_16x16x32_bf16 v[76:79], v[124:127], v[132:135], v[76:79]
    ds_read_b64_tr_b16 v[108:109], v153 offset:10240
    ds_read_b64_tr_b16 v[110:111], v153 offset:12800
    s_waitcnt lgkmcnt(6)
    v_mfma_f32_16x16x32_bf16 v[80:83], v[96:99], v[128:131], v[80:83]
    v_mfma_f32_16x16x32_bf16 v[84:87], v[96:99], v[132:135], v[84:87]
    ds_read_b64_tr_b16 v[112:113], v3 offset:10304
    ds_read_b64_tr_b16 v[114:115], v3 offset:12864
    s_waitcnt lgkmcnt(6)
    v_mfma_f32_16x16x32_bf16 v[88:91], v[100:103], v[128:131], v[88:91]
    v_mfma_f32_16x16x32_bf16 v[92:95], v[100:103], v[132:135], v[92:95]
    ds_read_b64_tr_b16 v[116:117], v153 offset:10304
    ds_read_b64_tr_b16 v[118:119], v153 offset:12864
    s_add_u32 s29, s42, 28672
    buffer_load_dwordx4 v[144:147], v9, s[12:15], s29 offen sc1
    s_add_u32 s29, s42, 28672
    buffer_load_dwordx4 v[148:151], v14, s[12:15], s29 offen sc1
    s_waitcnt vmcnt(6)
    s_waitcnt lgkmcnt(6)
    s_cmp_eq_u32 s62, 1
    s_cbranch_scc1 parallel_sum__softmax_full_mha__dense_activation_relu__prompt_kernel_sk13_0
    v_mfma_f32_16x16x32_bf16 v[16:19], v[104:107], v[136:139], v[16:19]
    v_mfma_f32_16x16x32_bf16 v[20:23], v[104:107], v[140:143], v[20:23]
parallel_sum__softmax_full_mha__dense_activation_relu__prompt_kernel_sk13_0:
    ds_read_b64_tr_b16 v[120:121], v3 offset:10368
    ds_read_b64_tr_b16 v[122:123], v3 offset:12928
    s_add_u32 s45, s39, 128000
    s_cmp_eq_u32 s21, 3
    s_cselect_b32 m0, 162816, s45
    s_add_u32 s29, s38, 86016
    buffer_load_dwordx4 v1, s[8:11], s29 offen sc1 lds
    s_waitcnt lgkmcnt(6)
    s_cmp_eq_u32 s62, 1
    s_cbranch_scc1 parallel_sum__softmax_full_mha__dense_activation_relu__prompt_kernel_sk13_1
    v_mfma_f32_16x16x32_bf16 v[24:27], v[108:111], v[136:139], v[24:27]
    v_mfma_f32_16x16x32_bf16 v[28:31], v[108:111], v[140:143], v[28:31]
parallel_sum__softmax_full_mha__dense_activation_relu__prompt_kernel_sk13_1:
    ds_read_b64_tr_b16 v[124:125], v153 offset:10368
    ds_read_b64_tr_b16 v[126:127], v153 offset:12928
    s_waitcnt lgkmcnt(6)
    v_mfma_f32_16x16x32_bf16 v[32:35], v[112:115], v[136:139], v[32:35]
    v_mfma_f32_16x16x32_bf16 v[36:39], v[112:115], v[140:143], v[36:39]
    ds_read_b64_tr_b16 v[96:97], v3 offset:10432
    ds_read_b64_tr_b16 v[98:99], v3 offset:12992
    s_add_u32 m0, s59, 53248
    s_add_u32 s29, s58, 626688
    buffer_load_dwordx4 v4, s[48:51], s29 offen lds
    s_waitcnt lgkmcnt(6)
    v_mfma_f32_16x16x32_bf16 v[40:43], v[116:119], v[136:139], v[40:43]
    v_mfma_f32_16x16x32_bf16 v[44:47], v[116:119], v[140:143], v[44:47]
    ds_read_b64_tr_b16 v[100:101], v153 offset:10432
    ds_read_b64_tr_b16 v[102:103], v153 offset:12992
    s_waitcnt lgkmcnt(6)
    v_mfma_f32_16x16x32_bf16 v[48:51], v[120:123], v[136:139], v[48:51]
    v_mfma_f32_16x16x32_bf16 v[52:55], v[120:123], v[140:143], v[52:55]
    ds_read_b64_tr_b16 v[104:105], v3 offset:10496
    ds_read_b64_tr_b16 v[106:107], v3 offset:13056
    s_add_u32 m0, s59, 54272
    s_add_u32 s29, s58, 626688
    buffer_load_dwordx4 v5, s[48:51], s29 offen lds
    s_waitcnt lgkmcnt(6)
    v_mfma_f32_16x16x32_bf16 v[56:59], v[124:127], v[136:139], v[56:59]
    v_mfma_f32_16x16x32_bf16 v[60:63], v[124:127], v[140:143], v[60:63]
    ds_read_b64_tr_b16 v[108:109], v153 offset:10496
    ds_read_b64_tr_b16 v[110:111], v153 offset:13056
    s_waitcnt lgkmcnt(6)
    v_mfma_f32_16x16x32_bf16 v[64:67], v[96:99], v[136:139], v[64:67]
    v_mfma_f32_16x16x32_bf16 v[68:71], v[96:99], v[140:143], v[68:71]
    ds_read_b64_tr_b16 v[112:113], v3 offset:20480
    ds_read_b64_tr_b16 v[114:115], v3 offset:23040
    s_add_u32 m0, s59, 55296
    s_add_u32 s29, s58, 626688
    buffer_load_dwordx4 v6, s[48:51], s29 offen lds
    s_waitcnt lgkmcnt(6)
    v_mfma_f32_16x16x32_bf16 v[72:75], v[100:103], v[136:139], v[72:75]
    v_mfma_f32_16x16x32_bf16 v[76:79], v[100:103], v[140:143], v[76:79]
    ds_read_b64_tr_b16 v[116:117], v153 offset:20480
    ds_read_b64_tr_b16 v[118:119], v153 offset:23040
    s_waitcnt lgkmcnt(6)
    v_mfma_f32_16x16x32_bf16 v[80:83], v[104:107], v[136:139], v[80:83]
    v_mfma_f32_16x16x32_bf16 v[84:87], v[104:107], v[140:143], v[84:87]
    ds_read_b64_tr_b16 v[120:121], v3 offset:20544
    ds_read_b64_tr_b16 v[122:123], v3 offset:23104
    s_waitcnt lgkmcnt(6)
    v_mfma_f32_16x16x32_bf16 v[88:91], v[108:111], v[136:139], v[88:91]
    v_mfma_f32_16x16x32_bf16 v[92:95], v[108:111], v[140:143], v[92:95]
    ds_read_b64_tr_b16 v[124:125], v153 offset:20544
    ds_read_b64_tr_b16 v[126:127], v153 offset:23104
    s_add_u32 s29, s42, 30720
    buffer_load_dwordx4 v[128:131], v9, s[12:15], s29 offen sc1
    s_add_u32 s29, s42, 30720
    buffer_load_dwordx4 v[132:135], v14, s[12:15], s29 offen sc1
    s_waitcnt vmcnt(6)
    s_waitcnt lgkmcnt(6)
    s_cmp_eq_u32 s62, 1
    s_cbranch_scc1 parallel_sum__softmax_full_mha__dense_activation_relu__prompt_kernel_sk14_0
    v_mfma_f32_16x16x32_bf16 v[16:19], v[112:115], v[144:147], v[16:19]
    v_mfma_f32_16x16x32_bf16 v[20:23], v[112:115], v[148:151], v[20:23]
parallel_sum__softmax_full_mha__dense_activation_relu__prompt_kernel_sk14_0:
    ds_read_b64_tr_b16 v[96:97], v3 offset:20608
    ds_read_b64_tr_b16 v[98:99], v3 offset:23168
    s_add_u32 m0, s59, 56320
    s_add_u32 s29, s58, 626688
    buffer_load_dwordx4 v7, s[48:51], s29 offen lds
    s_waitcnt lgkmcnt(6)
    s_cmp_eq_u32 s62, 1
    s_cbranch_scc1 parallel_sum__softmax_full_mha__dense_activation_relu__prompt_kernel_sk14_1
    v_mfma_f32_16x16x32_bf16 v[24:27], v[116:119], v[144:147], v[24:27]
    v_mfma_f32_16x16x32_bf16 v[28:31], v[116:119], v[148:151], v[28:31]
parallel_sum__softmax_full_mha__dense_activation_relu__prompt_kernel_sk14_1:
    ds_read_b64_tr_b16 v[100:101], v153 offset:20608
    ds_read_b64_tr_b16 v[102:103], v153 offset:23168
    s_waitcnt lgkmcnt(6)
    v_mfma_f32_16x16x32_bf16 v[32:35], v[120:123], v[144:147], v[32:35]
    v_mfma_f32_16x16x32_bf16 v[36:39], v[120:123], v[148:151], v[36:39]
    ds_read_b64_tr_b16 v[104:105], v3 offset:20672
    ds_read_b64_tr_b16 v[106:107], v3 offset:23232
    s_add_u32 m0, s59, 57344
    s_add_u32 s29, s58, 626688
    buffer_load_dwordx4 v8, s[48:51], s29 offen lds
    s_waitcnt lgkmcnt(6)
    v_mfma_f32_16x16x32_bf16 v[40:43], v[124:127], v[144:147], v[40:43]
    v_mfma_f32_16x16x32_bf16 v[44:47], v[124:127], v[148:151], v[44:47]
    ds_read_b64_tr_b16 v[108:109], v153 offset:20672
    ds_read_b64_tr_b16 v[110:111], v153 offset:23232
    s_waitcnt lgkmcnt(6)
    v_mfma_f32_16x16x32_bf16 v[48:51], v[96:99], v[144:147], v[48:51]
    v_mfma_f32_16x16x32_bf16 v[52:55], v[96:99], v[148:151], v[52:55]
    ds_read_b64_tr_b16 v[112:113], v3 offset:20736
    ds_read_b64_tr_b16 v[114:115], v3 offset:23296
    s_add_u32 m0, s59, 58368
    s_add_u32 s29, s58, 645120
    buffer_load_dwordx4 v4, s[48:51], s29 offen lds
    s_waitcnt lgkmcnt(6)
    v_mfma_f32_16x16x32_bf16 v[56:59], v[100:103], v[144:147], v[56:59]
    v_mfma_f32_16x16x32_bf16 v[60:63], v[100:103], v[148:151], v[60:63]
    ds_read_b64_tr_b16 v[116:117], v153 offset:20736
    ds_read_b64_tr_b16 v[118:119], v153 offset:23296
    s_waitcnt lgkmcnt(6)
    v_mfma_f32_16x16x32_bf16 v[64:67], v[104:107], v[144:147], v[64:67]
    v_mfma_f32_16x16x32_bf16 v[68:71], v[104:107], v[148:151], v[68:71]
    ds_read_b64_tr_b16 v[120:121], v3 offset:30720
    ds_read_b64_tr_b16 v[122:123], v3 offset:33280
    s_add_u32 m0, s59, 59392
    s_add_u32 s29, s58, 645120
    buffer_load_dwordx4 v5, s[48:51], s29 offen lds
    s_waitcnt lgkmcnt(6)
    v_mfma_f32_16x16x32_bf16 v[72:75], v[108:111], v[144:147], v[72:75]
    v_mfma_f32_16x16x32_bf16 v[76:79], v[108:111], v[148:151], v[76:79]
    ds_read_b64_tr_b16 v[124:125], v153 offset:30720
    ds_read_b64_tr_b16 v[126:127], v153 offset:33280
    s_waitcnt lgkmcnt(6)
    v_mfma_f32_16x16x32_bf16 v[80:83], v[112:115], v[144:147], v[80:83]
    v_mfma_f32_16x16x32_bf16 v[84:87], v[112:115], v[148:151], v[84:87]
    ds_read_b64_tr_b16 v[96:97], v3 offset:30784
    ds_read_b64_tr_b16 v[98:99], v3 offset:33344
    s_waitcnt lgkmcnt(6)
    v_mfma_f32_16x16x32_bf16 v[88:91], v[116:119], v[144:147], v[88:91]
    v_mfma_f32_16x16x32_bf16 v[92:95], v[116:119], v[148:151], v[92:95]
    ds_read_b64_tr_b16 v[100:101], v153 offset:30784
    ds_read_b64_tr_b16 v[102:103], v153 offset:33344
    s_add_u32 s29, s42, 32768
    buffer_load_dwordx4 v[136:139], v9, s[12:15], s29 offen sc1
    s_add_u32 s29, s42, 32768
    buffer_load_dwordx4 v[140:143], v14, s[12:15], s29 offen sc1
    s_waitcnt vmcnt(6)
    s_waitcnt lgkmcnt(6)
    s_cmp_eq_u32 s62, 1
    s_cbranch_scc1 parallel_sum__softmax_full_mha__dense_activation_relu__prompt_kernel_sk15_0
    v_mfma_f32_16x16x32_bf16 v[16:19], v[120:123], v[128:131], v[16:19]
    v_mfma_f32_16x16x32_bf16 v[20:23], v[120:123], v[132:135], v[20:23]
parallel_sum__softmax_full_mha__dense_activation_relu__prompt_kernel_sk15_0:
    ds_read_b64_tr_b16 v[104:105], v3 offset:30848
    ds_read_b64_tr_b16 v[106:107], v3 offset:33408
    s_add_u32 m0, s59, 60416
    s_add_u32 s29, s58, 645120
    buffer_load_dwordx4 v6, s[48:51], s29 offen lds
    s_waitcnt lgkmcnt(6)
    s_cmp_eq_u32 s62, 1
    s_cbranch_scc1 parallel_sum__softmax_full_mha__dense_activation_relu__prompt_kernel_sk15_1
    v_mfma_f32_16x16x32_bf16 v[24:27], v[124:127], v[128:131], v[24:27]
    v_mfma_f32_16x16x32_bf16 v[28:31], v[124:127], v[132:135], v[28:31]
parallel_sum__softmax_full_mha__dense_activation_relu__prompt_kernel_sk15_1:
    ds_read_b64_tr_b16 v[108:109], v153 offset:30848
    ds_read_b64_tr_b16 v[110:111], v153 offset:33408
    s_waitcnt lgkmcnt(6)
    v_mfma_f32_16x16x32_bf16 v[32:35], v[96:99], v[128:131], v[32:35]
    v_mfma_f32_16x16x32_bf16 v[36:39], v[96:99], v[132:135], v[36:39]
    ds_read_b64_tr_b16 v[112:113], v3 offset:30912
    ds_read_b64_tr_b16 v[114:115], v3 offset:33472
    s_add_u32 m0, s59, 61440
    s_add_u32 s29, s58, 645120
    buffer_load_dwordx4 v7, s[48:51], s29 offen lds
    s_waitcnt lgkmcnt(6)
    v_mfma_f32_16x16x32_bf16 v[40:43], v[100:103], v[128:131], v[40:43]
    v_mfma_f32_16x16x32_bf16 v[44:47], v[100:103], v[132:135], v[44:47]
    ds_read_b64_tr_b16 v[116:117], v153 offset:30912
    ds_read_b64_tr_b16 v[118:119], v153 offset:33472
    s_waitcnt lgkmcnt(6)
    v_mfma_f32_16x16x32_bf16 v[48:51], v[104:107], v[128:131], v[48:51]
    v_mfma_f32_16x16x32_bf16 v[52:55], v[104:107], v[132:135], v[52:55]
    ds_read_b64_tr_b16 v[120:121], v3 offset:30976
    ds_read_b64_tr_b16 v[122:123], v3 offset:33536
    s_add_u32 m0, s59, 62464
    s_add_u32 s29, s58, 645120
    buffer_load_dwordx4 v8, s[48:51], s29 offen lds
    s_waitcnt lgkmcnt(6)
    v_mfma_f32_16x16x32_bf16 v[56:59], v[108:111], v[128:131], v[56:59]
    v_mfma_f32_16x16x32_bf16 v[60:63], v[108:111], v[132:135], v[60:63]
    ds_read_b64_tr_b16 v[124:125], v153 offset:30976
    ds_read_b64_tr_b16 v[126:127], v153 offset:33536
    s_waitcnt lgkmcnt(6)
    v_mfma_f32_16x16x32_bf16 v[64:67], v[112:115], v[128:131], v[64:67]
    v_mfma_f32_16x16x32_bf16 v[68:71], v[112:115], v[132:135], v[68:71]
    ds_read_b64_tr_b16 v[96:97], v3 offset:40960
    ds_read_b64_tr_b16 v[98:99], v3 offset:43520
    s_add_u32 m0, s59, 63488
    s_add_u32 s29, s58, 663552
    buffer_load_dwordx4 v4, s[48:51], s29 offen lds
    s_waitcnt lgkmcnt(6)
    v_mfma_f32_16x16x32_bf16 v[72:75], v[116:119], v[128:131], v[72:75]
    v_mfma_f32_16x16x32_bf16 v[76:79], v[116:119], v[132:135], v[76:79]
    ds_read_b64_tr_b16 v[100:101], v153 offset:40960
    ds_read_b64_tr_b16 v[102:103], v153 offset:43520
    s_waitcnt lgkmcnt(6)
    v_mfma_f32_16x16x32_bf16 v[80:83], v[120:123], v[128:131], v[80:83]
    v_mfma_f32_16x16x32_bf16 v[84:87], v[120:123], v[132:135], v[84:87]
    ds_read_b64_tr_b16 v[104:105], v3 offset:41024
    ds_read_b64_tr_b16 v[106:107], v3 offset:43584
    s_waitcnt lgkmcnt(6)
    v_mfma_f32_16x16x32_bf16 v[88:91], v[124:127], v[128:131], v[88:91]
    v_mfma_f32_16x16x32_bf16 v[92:95], v[124:127], v[132:135], v[92:95]
    ds_read_b64_tr_b16 v[108:109], v153 offset:41024
    ds_read_b64_tr_b16 v[110:111], v153 offset:43584
    s_add_u32 s29, s42, 34816
    buffer_load_dwordx4 v[144:147], v9, s[12:15], s29 offen sc1
    s_add_u32 s29, s42, 34816
    buffer_load_dwordx4 v[148:151], v14, s[12:15], s29 offen sc1
    s_waitcnt vmcnt(6)
    s_waitcnt lgkmcnt(6)
    s_cmp_eq_u32 s62, 1
    s_cbranch_scc1 parallel_sum__softmax_full_mha__dense_activation_relu__prompt_kernel_sk16_0
    v_mfma_f32_16x16x32_bf16 v[16:19], v[96:99], v[136:139], v[16:19]
    v_mfma_f32_16x16x32_bf16 v[20:23], v[96:99], v[140:143], v[20:23]
parallel_sum__softmax_full_mha__dense_activation_relu__prompt_kernel_sk16_0:
    ds_read_b64_tr_b16 v[112:113], v3 offset:41088
    ds_read_b64_tr_b16 v[114:115], v3 offset:43648
    s_add_u32 m0, s59, 64512
    s_add_u32 s29, s58, 663552
    buffer_load_dwordx4 v5, s[48:51], s29 offen lds
    s_waitcnt lgkmcnt(6)
    s_cmp_eq_u32 s62, 1
    s_cbranch_scc1 parallel_sum__softmax_full_mha__dense_activation_relu__prompt_kernel_sk16_1
    v_mfma_f32_16x16x32_bf16 v[24:27], v[100:103], v[136:139], v[24:27]
    v_mfma_f32_16x16x32_bf16 v[28:31], v[100:103], v[140:143], v[28:31]
parallel_sum__softmax_full_mha__dense_activation_relu__prompt_kernel_sk16_1:
    ds_read_b64_tr_b16 v[116:117], v153 offset:41088
    ds_read_b64_tr_b16 v[118:119], v153 offset:43648
    s_waitcnt lgkmcnt(6)
    v_mfma_f32_16x16x32_bf16 v[32:35], v[104:107], v[136:139], v[32:35]
    v_mfma_f32_16x16x32_bf16 v[36:39], v[104:107], v[140:143], v[36:39]
    ds_read_b64_tr_b16 v[120:121], v3 offset:41152
    ds_read_b64_tr_b16 v[122:123], v3 offset:43712
    s_add_u32 m0, s59, 65536
    s_add_u32 s29, s58, 663552
    s_mov_b32 exec_lo, 0xffffffff
    s_mov_b32 exec_hi, 0x0
    buffer_load_dwordx4 v6, s[48:51], s29 offen lds
    s_mov_b64 exec, -1
    s_waitcnt lgkmcnt(6)
    v_mfma_f32_16x16x32_bf16 v[40:43], v[108:111], v[136:139], v[40:43]
    v_mfma_f32_16x16x32_bf16 v[44:47], v[108:111], v[140:143], v[44:47]
    ds_read_b64_tr_b16 v[124:125], v153 offset:41152
    ds_read_b64_tr_b16 v[126:127], v153 offset:43712
    s_waitcnt lgkmcnt(6)
    v_mfma_f32_16x16x32_bf16 v[48:51], v[112:115], v[136:139], v[48:51]
    v_mfma_f32_16x16x32_bf16 v[52:55], v[112:115], v[140:143], v[52:55]
    ds_read_b64_tr_b16 v[96:97], v3 offset:41216
    ds_read_b64_tr_b16 v[98:99], v3 offset:43776
    s_waitcnt lgkmcnt(6)
    v_mfma_f32_16x16x32_bf16 v[56:59], v[116:119], v[136:139], v[56:59]
    v_mfma_f32_16x16x32_bf16 v[60:63], v[116:119], v[140:143], v[60:63]
    ds_read_b64_tr_b16 v[100:101], v153 offset:41216
    ds_read_b64_tr_b16 v[102:103], v153 offset:43776
    s_waitcnt lgkmcnt(6)
    v_mfma_f32_16x16x32_bf16 v[64:67], v[120:123], v[136:139], v[64:67]
    v_mfma_f32_16x16x32_bf16 v[68:71], v[120:123], v[140:143], v[68:71]
    s_waitcnt lgkmcnt(4)
    v_mfma_f32_16x16x32_bf16 v[72:75], v[124:127], v[136:139], v[72:75]
    v_mfma_f32_16x16x32_bf16 v[76:79], v[124:127], v[140:143], v[76:79]
    s_waitcnt lgkmcnt(2)
    v_mfma_f32_16x16x32_bf16 v[80:83], v[96:99], v[136:139], v[80:83]
    v_mfma_f32_16x16x32_bf16 v[84:87], v[96:99], v[140:143], v[84:87]
    s_waitcnt lgkmcnt(0)
    v_mfma_f32_16x16x32_bf16 v[88:91], v[100:103], v[136:139], v[88:91]
    v_mfma_f32_16x16x32_bf16 v[92:95], v[100:103], v[140:143], v[92:95]
    s_add_u32 s29, s42, 36864
    buffer_load_dwordx4 v[128:131], v9, s[12:15], s29 offen sc1
    s_add_u32 s29, s42, 36864
    buffer_load_dwordx4 v[132:135], v14, s[12:15], s29 offen sc1
    s_waitcnt vmcnt(2)
    s_barrier
    ds_read_b64_tr_b16 v[104:105], v2 offset:0
    ds_read_b64_tr_b16 v[106:107], v2 offset:2560
    ds_read_b64_tr_b16 v[108:109], v152 offset:0
    ds_read_b64_tr_b16 v[110:111], v152 offset:2560
    ds_read_b64_tr_b16 v[112:113], v2 offset:64
    ds_read_b64_tr_b16 v[114:115], v2 offset:2624
    ds_read_b64_tr_b16 v[116:117], v152 offset:64
    ds_read_b64_tr_b16 v[118:119], v152 offset:2624
    s_waitcnt vmcnt(4)
    s_waitcnt lgkmcnt(6)
    s_cmp_eq_u32 s62, 1
    s_cbranch_scc1 parallel_sum__softmax_full_mha__dense_activation_relu__prompt_kernel_sk17_0
    v_mfma_f32_16x16x32_bf16 v[16:19], v[104:107], v[144:147], v[16:19]
    v_mfma_f32_16x16x32_bf16 v[20:23], v[104:107], v[148:151], v[20:23]
parallel_sum__softmax_full_mha__dense_activation_relu__prompt_kernel_sk17_0:
    ds_read_b64_tr_b16 v[120:121], v2 offset:128
    ds_read_b64_tr_b16 v[122:123], v2 offset:2688
    s_add_u32 m0, s39, 143360
    s_add_u32 s29, s38, 102400
    buffer_load_dwordx4 v1, s[8:11], s29 offen sc1 lds
    s_waitcnt lgkmcnt(6)
    s_cmp_eq_u32 s62, 1
    s_cbranch_scc1 parallel_sum__softmax_full_mha__dense_activation_relu__prompt_kernel_sk17_1
    v_mfma_f32_16x16x32_bf16 v[24:27], v[108:111], v[144:147], v[24:27]
    v_mfma_f32_16x16x32_bf16 v[28:31], v[108:111], v[148:151], v[28:31]
parallel_sum__softmax_full_mha__dense_activation_relu__prompt_kernel_sk17_1:
    ds_read_b64_tr_b16 v[124:125], v152 offset:128
    ds_read_b64_tr_b16 v[126:127], v152 offset:2688
    s_waitcnt lgkmcnt(6)
    v_mfma_f32_16x16x32_bf16 v[32:35], v[112:115], v[144:147], v[32:35]
    v_mfma_f32_16x16x32_bf16 v[36:39], v[112:115], v[148:151], v[36:39]
    ds_read_b64_tr_b16 v[96:97], v2 offset:192
    ds_read_b64_tr_b16 v[98:99], v2 offset:2752
    s_add_u32 m0, s39, 144384
    s_add_u32 s29, s38, 103424
    buffer_load_dwordx4 v1, s[8:11], s29 offen sc1 lds
    s_waitcnt lgkmcnt(6)
    v_mfma_f32_16x16x32_bf16 v[40:43], v[116:119], v[144:147], v[40:43]
    v_mfma_f32_16x16x32_bf16 v[44:47], v[116:119], v[148:151], v[44:47]
    ds_read_b64_tr_b16 v[100:101], v152 offset:192
    ds_read_b64_tr_b16 v[102:103], v152 offset:2752
    s_waitcnt lgkmcnt(6)
    v_mfma_f32_16x16x32_bf16 v[48:51], v[120:123], v[144:147], v[48:51]
    v_mfma_f32_16x16x32_bf16 v[52:55], v[120:123], v[148:151], v[52:55]
    ds_read_b64_tr_b16 v[104:105], v2 offset:256
    ds_read_b64_tr_b16 v[106:107], v2 offset:2816
    s_add_u32 m0, s39, 145408
    s_add_u32 s29, s38, 104448
    buffer_load_dwordx4 v1, s[8:11], s29 offen sc1 lds
    s_waitcnt lgkmcnt(6)
    v_mfma_f32_16x16x32_bf16 v[56:59], v[124:127], v[144:147], v[56:59]
    v_mfma_f32_16x16x32_bf16 v[60:63], v[124:127], v[148:151], v[60:63]
    ds_read_b64_tr_b16 v[108:109], v152 offset:256
    ds_read_b64_tr_b16 v[110:111], v152 offset:2816
    s_waitcnt lgkmcnt(6)
    v_mfma_f32_16x16x32_bf16 v[64:67], v[96:99], v[144:147], v[64:67]
    v_mfma_f32_16x16x32_bf16 v[68:71], v[96:99], v[148:151], v[68:71]
    ds_read_b64_tr_b16 v[112:113], v2 offset:10240
    ds_read_b64_tr_b16 v[114:115], v2 offset:12800
    s_add_u32 m0, s39, 146432
    s_add_u32 s29, s38, 105472
    buffer_load_dwordx4 v1, s[8:11], s29 offen sc1 lds
    s_waitcnt lgkmcnt(6)
    v_mfma_f32_16x16x32_bf16 v[72:75], v[100:103], v[144:147], v[72:75]
    v_mfma_f32_16x16x32_bf16 v[76:79], v[100:103], v[148:151], v[76:79]
    ds_read_b64_tr_b16 v[116:117], v152 offset:10240
    ds_read_b64_tr_b16 v[118:119], v152 offset:12800
    s_waitcnt lgkmcnt(6)
    v_mfma_f32_16x16x32_bf16 v[80:83], v[104:107], v[144:147], v[80:83]
    v_mfma_f32_16x16x32_bf16 v[84:87], v[104:107], v[148:151], v[84:87]
    ds_read_b64_tr_b16 v[120:121], v2 offset:10304
    ds_read_b64_tr_b16 v[122:123], v2 offset:12864
    s_waitcnt lgkmcnt(6)
    v_mfma_f32_16x16x32_bf16 v[88:91], v[108:111], v[144:147], v[88:91]
    v_mfma_f32_16x16x32_bf16 v[92:95], v[108:111], v[148:151], v[92:95]
    ds_read_b64_tr_b16 v[124:125], v152 offset:10304
    ds_read_b64_tr_b16 v[126:127], v152 offset:12864
    s_add_u32 s29, s42, 38912
    buffer_load_dwordx4 v[136:139], v9, s[12:15], s29 offen sc1
    s_add_u32 s29, s42, 38912
    buffer_load_dwordx4 v[140:143], v14, s[12:15], s29 offen sc1
    s_waitcnt vmcnt(6)
    s_waitcnt lgkmcnt(6)
    v_mfma_f32_16x16x32_bf16 v[16:19], v[112:115], v[128:131], v[16:19]
    v_mfma_f32_16x16x32_bf16 v[20:23], v[112:115], v[132:135], v[20:23]
    ds_read_b64_tr_b16 v[96:97], v2 offset:10368
    ds_read_b64_tr_b16 v[98:99], v2 offset:12928
    s_add_u32 s45, s39, 147456
    s_cmp_eq_u32 s21, 3
    s_cselect_b32 m0, 162816, s45
    s_add_u32 s29, s38, 106496
    buffer_load_dwordx4 v1, s[8:11], s29 offen sc1 lds
    s_waitcnt lgkmcnt(6)
    v_mfma_f32_16x16x32_bf16 v[24:27], v[116:119], v[128:131], v[24:27]
    v_mfma_f32_16x16x32_bf16 v[28:31], v[116:119], v[132:135], v[28:31]
    ds_read_b64_tr_b16 v[100:101], v152 offset:10368
    ds_read_b64_tr_b16 v[102:103], v152 offset:12928
    s_waitcnt lgkmcnt(6)
    v_mfma_f32_16x16x32_bf16 v[32:35], v[120:123], v[128:131], v[32:35]
    v_mfma_f32_16x16x32_bf16 v[36:39], v[120:123], v[132:135], v[36:39]
    ds_read_b64_tr_b16 v[104:105], v2 offset:10432
    ds_read_b64_tr_b16 v[106:107], v2 offset:12992
    s_add_u32 m0, s59, 1024
    s_add_u32 s29, s58, 811008
    buffer_load_dwordx4 v4, s[48:51], s29 offen lds
    s_waitcnt lgkmcnt(6)
    v_mfma_f32_16x16x32_bf16 v[40:43], v[124:127], v[128:131], v[40:43]
    v_mfma_f32_16x16x32_bf16 v[44:47], v[124:127], v[132:135], v[44:47]
    ds_read_b64_tr_b16 v[108:109], v152 offset:10432
    ds_read_b64_tr_b16 v[110:111], v152 offset:12992
    s_waitcnt lgkmcnt(6)
    v_mfma_f32_16x16x32_bf16 v[48:51], v[96:99], v[128:131], v[48:51]
    v_mfma_f32_16x16x32_bf16 v[52:55], v[96:99], v[132:135], v[52:55]
    ds_read_b64_tr_b16 v[112:113], v2 offset:10496
    ds_read_b64_tr_b16 v[114:115], v2 offset:13056
    s_add_u32 m0, s59, 2048
    s_add_u32 s29, s58, 811008
    buffer_load_dwordx4 v5, s[48:51], s29 offen lds
    s_waitcnt lgkmcnt(6)
    v_mfma_f32_16x16x32_bf16 v[56:59], v[100:103], v[128:131], v[56:59]
    v_mfma_f32_16x16x32_bf16 v[60:63], v[100:103], v[132:135], v[60:63]
    ds_read_b64_tr_b16 v[116:117], v152 offset:10496
    ds_read_b64_tr_b16 v[118:119], v152 offset:13056
    s_waitcnt lgkmcnt(6)
    v_mfma_f32_16x16x32_bf16 v[64:67], v[104:107], v[128:131], v[64:67]
    v_mfma_f32_16x16x32_bf16 v[68:71], v[104:107], v[132:135], v[68:71]
    ds_read_b64_tr_b16 v[120:121], v2 offset:20480
    ds_read_b64_tr_b16 v[122:123], v2 offset:23040
    s_add_u32 m0, s59, 3072
    s_add_u32 s29, s58, 811008
    buffer_load_dwordx4 v6, s[48:51], s29 offen lds
    s_waitcnt lgkmcnt(6)
    v_mfma_f32_16x16x32_bf16 v[72:75], v[108:111], v[128:131], v[72:75]
    v_mfma_f32_16x16x32_bf16 v[76:79], v[108:111], v[132:135], v[76:79]
    ds_read_b64_tr_b16 v[124:125], v152 offset:20480
    ds_read_b64_tr_b16 v[126:127], v152 offset:23040
    s_waitcnt lgkmcnt(6)
    s_cmp_eq_u32 s62, 0
    s_cbranch_scc1 parallel_sum__softmax_full_mha__dense_activation_relu__prompt_kernel_sk18_0
    v_mfma_f32_16x16x32_bf16 v[80:83], v[112:115], v[128:131], v[80:83]
    v_mfma_f32_16x16x32_bf16 v[84:87], v[112:115], v[132:135], v[84:87]
parallel_sum__softmax_full_mha__dense_activation_relu__prompt_kernel_sk18_0:
    ds_read_b64_tr_b16 v[96:97], v2 offset:20544
    ds_read_b64_tr_b16 v[98:99], v2 offset:23104
    s_waitcnt lgkmcnt(6)
    s_cmp_eq_u32 s62, 0
    s_cbranch_scc1 parallel_sum__softmax_full_mha__dense_activation_relu__prompt_kernel_sk18_1
    v_mfma_f32_16x16x32_bf16 v[88:91], v[116:119], v[128:131], v[88:91]
    v_mfma_f32_16x16x32_bf16 v[92:95], v[116:119], v[132:135], v[92:95]
parallel_sum__softmax_full_mha__dense_activation_relu__prompt_kernel_sk18_1:
    ds_read_b64_tr_b16 v[100:101], v152 offset:20544
    ds_read_b64_tr_b16 v[102:103], v152 offset:23104
    s_add_u32 s29, s42, 40960
    buffer_load_dwordx4 v[144:147], v9, s[12:15], s29 offen sc1
    s_add_u32 s29, s42, 40960
    buffer_load_dwordx4 v[148:151], v14, s[12:15], s29 offen sc1
    s_waitcnt vmcnt(6)
    s_waitcnt lgkmcnt(6)
    v_mfma_f32_16x16x32_bf16 v[16:19], v[120:123], v[136:139], v[16:19]
    v_mfma_f32_16x16x32_bf16 v[20:23], v[120:123], v[140:143], v[20:23]
    ds_read_b64_tr_b16 v[104:105], v2 offset:20608
    ds_read_b64_tr_b16 v[106:107], v2 offset:23168
    s_add_u32 m0, s59, 4096
    s_add_u32 s29, s58, 811008
    buffer_load_dwordx4 v7, s[48:51], s29 offen lds
    s_waitcnt lgkmcnt(6)
    v_mfma_f32_16x16x32_bf16 v[24:27], v[124:127], v[136:139], v[24:27]
    v_mfma_f32_16x16x32_bf16 v[28:31], v[124:127], v[140:143], v[28:31]
    ds_read_b64_tr_b16 v[108:109], v152 offset:20608
    ds_read_b64_tr_b16 v[110:111], v152 offset:23168
    s_waitcnt lgkmcnt(6)
    v_mfma_f32_16x16x32_bf16 v[32:35], v[96:99], v[136:139], v[32:35]
    v_mfma_f32_16x16x32_bf16 v[36:39], v[96:99], v[140:143], v[36:39]
    ds_read_b64_tr_b16 v[112:113], v2 offset:20672
    ds_read_b64_tr_b16 v[114:115], v2 offset:23232
    s_add_u32 m0, s59, 5120
    s_add_u32 s29, s58, 811008
    buffer_load_dwordx4 v8, s[48:51], s29 offen lds
    s_waitcnt lgkmcnt(6)
    v_mfma_f32_16x16x32_bf16 v[40:43], v[100:103], v[136:139], v[40:43]
    v_mfma_f32_16x16x32_bf16 v[44:47], v[100:103], v[140:143], v[44:47]
    ds_read_b64_tr_b16 v[116:117], v152 offset:20672
    ds_read_b64_tr_b16 v[118:119], v152 offset:23232
    s_waitcnt lgkmcnt(6)
    v_mfma_f32_16x16x32_bf16 v[48:51], v[104:107], v[136:139], v[48:51]
    v_mfma_f32_16x16x32_bf16 v[52:55], v[104:107], v[140:143], v[52:55]
    ds_read_b64_tr_b16 v[120:121], v2 offset:20736
    ds_read_b64_tr_b16 v[122:123], v2 offset:23296
    s_add_u32 m0, s59, 6144
    s_add_u32 s29, s58, 829440
    buffer_load_dwordx4 v4, s[48:51], s29 offen lds
    s_waitcnt lgkmcnt(6)
    v_mfma_f32_16x16x32_bf16 v[56:59], v[108:111], v[136:139], v[56:59]
    v_mfma_f32_16x16x32_bf16 v[60:63], v[108:111], v[140:143], v[60:63]
    ds_read_b64_tr_b16 v[124:125], v152 offset:20736
    ds_read_b64_tr_b16 v[126:127], v152 offset:23296
    s_waitcnt lgkmcnt(6)
    v_mfma_f32_16x16x32_bf16 v[64:67], v[112:115], v[136:139], v[64:67]
    v_mfma_f32_16x16x32_bf16 v[68:71], v[112:115], v[140:143], v[68:71]
    ds_read_b64_tr_b16 v[96:97], v2 offset:30720
    ds_read_b64_tr_b16 v[98:99], v2 offset:33280
    s_add_u32 m0, s59, 7168
    s_add_u32 s29, s58, 829440
    buffer_load_dwordx4 v5, s[48:51], s29 offen lds
    s_waitcnt lgkmcnt(6)
    v_mfma_f32_16x16x32_bf16 v[72:75], v[116:119], v[136:139], v[72:75]
    v_mfma_f32_16x16x32_bf16 v[76:79], v[116:119], v[140:143], v[76:79]
    ds_read_b64_tr_b16 v[100:101], v152 offset:30720
    ds_read_b64_tr_b16 v[102:103], v152 offset:33280
    s_waitcnt lgkmcnt(6)
    s_cmp_eq_u32 s62, 0
    s_cbranch_scc1 parallel_sum__softmax_full_mha__dense_activation_relu__prompt_kernel_sk19_0
    v_mfma_f32_16x16x32_bf16 v[80:83], v[120:123], v[136:139], v[80:83]
    v_mfma_f32_16x16x32_bf16 v[84:87], v[120:123], v[140:143], v[84:87]
parallel_sum__softmax_full_mha__dense_activation_relu__prompt_kernel_sk19_0:
    ds_read_b64_tr_b16 v[104:105], v2 offset:30784
    ds_read_b64_tr_b16 v[106:107], v2 offset:33344
    s_waitcnt lgkmcnt(6)
    s_cmp_eq_u32 s62, 0
    s_cbranch_scc1 parallel_sum__softmax_full_mha__dense_activation_relu__prompt_kernel_sk19_1
    v_mfma_f32_16x16x32_bf16 v[88:91], v[124:127], v[136:139], v[88:91]
    v_mfma_f32_16x16x32_bf16 v[92:95], v[124:127], v[140:143], v[92:95]
parallel_sum__softmax_full_mha__dense_activation_relu__prompt_kernel_sk19_1:
    ds_read_b64_tr_b16 v[108:109], v152 offset:30784
    ds_read_b64_tr_b16 v[110:111], v152 offset:33344
    s_add_u32 s29, s42, 43008
    buffer_load_dwordx4 v[128:131], v9, s[12:15], s29 offen sc1
    s_add_u32 s29, s42, 43008
    buffer_load_dwordx4 v[132:135], v14, s[12:15], s29 offen sc1
    s_waitcnt vmcnt(6)
    s_waitcnt lgkmcnt(6)
    v_mfma_f32_16x16x32_bf16 v[16:19], v[96:99], v[144:147], v[16:19]
    v_mfma_f32_16x16x32_bf16 v[20:23], v[96:99], v[148:151], v[20:23]
    ds_read_b64_tr_b16 v[112:113], v2 offset:30848
    ds_read_b64_tr_b16 v[114:115], v2 offset:33408
    s_add_u32 m0, s59, 8192
    s_add_u32 s29, s58, 829440
    buffer_load_dwordx4 v6, s[48:51], s29 offen lds
    s_waitcnt lgkmcnt(6)
    v_mfma_f32_16x16x32_bf16 v[24:27], v[100:103], v[144:147], v[24:27]
    v_mfma_f32_16x16x32_bf16 v[28:31], v[100:103], v[148:151], v[28:31]
    ds_read_b64_tr_b16 v[116:117], v152 offset:30848
    ds_read_b64_tr_b16 v[118:119], v152 offset:33408
    s_waitcnt lgkmcnt(6)
    v_mfma_f32_16x16x32_bf16 v[32:35], v[104:107], v[144:147], v[32:35]
    v_mfma_f32_16x16x32_bf16 v[36:39], v[104:107], v[148:151], v[36:39]
    ds_read_b64_tr_b16 v[120:121], v2 offset:30912
    ds_read_b64_tr_b16 v[122:123], v2 offset:33472
    s_add_u32 m0, s59, 9216
    s_add_u32 s29, s58, 829440
    buffer_load_dwordx4 v7, s[48:51], s29 offen lds
    s_waitcnt lgkmcnt(6)
    v_mfma_f32_16x16x32_bf16 v[40:43], v[108:111], v[144:147], v[40:43]
    v_mfma_f32_16x16x32_bf16 v[44:47], v[108:111], v[148:151], v[44:47]
    ds_read_b64_tr_b16 v[124:125], v152 offset:30912
    ds_read_b64_tr_b16 v[126:127], v152 offset:33472
    s_waitcnt lgkmcnt(6)
    v_mfma_f32_16x16x32_bf16 v[48:51], v[112:115], v[144:147], v[48:51]
    v_mfma_f32_16x16x32_bf16 v[52:55], v[112:115], v[148:151], v[52:55]
    ds_read_b64_tr_b16 v[96:97], v2 offset:30976
    ds_read_b64_tr_b16 v[98:99], v2 offset:33536
    s_add_u32 m0, s59, 10240
    s_add_u32 s29, s58, 829440
    buffer_load_dwordx4 v8, s[48:51], s29 offen lds
    s_waitcnt lgkmcnt(6)
    v_mfma_f32_16x16x32_bf16 v[56:59], v[116:119], v[144:147], v[56:59]
    v_mfma_f32_16x16x32_bf16 v[60:63], v[116:119], v[148:151], v[60:63]
    ds_read_b64_tr_b16 v[100:101], v152 offset:30976
    ds_read_b64_tr_b16 v[102:103], v152 offset:33536
    s_waitcnt lgkmcnt(6)
    v_mfma_f32_16x16x32_bf16 v[64:67], v[120:123], v[144:147], v[64:67]
    v_mfma_f32_16x16x32_bf16 v[68:71], v[120:123], v[148:151], v[68:71]
    ds_read_b64_tr_b16 v[104:105], v2 offset:40960
    ds_read_b64_tr_b16 v[106:107], v2 offset:43520
    s_add_u32 m0, s59, 11264
    s_add_u32 s29, s58, 847872
    buffer_load_dwordx4 v4, s[48:51], s29 offen lds
    s_waitcnt lgkmcnt(6)
    v_mfma_f32_16x16x32_bf16 v[72:75], v[124:127], v[144:147], v[72:75]
    v_mfma_f32_16x16x32_bf16 v[76:79], v[124:127], v[148:151], v[76:79]
    ds_read_b64_tr_b16 v[108:109], v152 offset:40960
    ds_read_b64_tr_b16 v[110:111], v152 offset:43520
    s_waitcnt lgkmcnt(6)
    s_cmp_eq_u32 s62, 0
    s_cbranch_scc1 parallel_sum__softmax_full_mha__dense_activation_relu__prompt_kernel_sk20_0
    v_mfma_f32_16x16x32_bf16 v[80:83], v[96:99], v[144:147], v[80:83]
    v_mfma_f32_16x16x32_bf16 v[84:87], v[96:99], v[148:151], v[84:87]
parallel_sum__softmax_full_mha__dense_activation_relu__prompt_kernel_sk20_0:
    ds_read_b64_tr_b16 v[112:113], v2 offset:41024
    ds_read_b64_tr_b16 v[114:115], v2 offset:43584
    s_waitcnt lgkmcnt(6)
    s_cmp_eq_u32 s62, 0
    s_cbranch_scc1 parallel_sum__softmax_full_mha__dense_activation_relu__prompt_kernel_sk20_1
    v_mfma_f32_16x16x32_bf16 v[88:91], v[100:103], v[144:147], v[88:91]
    v_mfma_f32_16x16x32_bf16 v[92:95], v[100:103], v[148:151], v[92:95]
parallel_sum__softmax_full_mha__dense_activation_relu__prompt_kernel_sk20_1:
    ds_read_b64_tr_b16 v[116:117], v152 offset:41024
    ds_read_b64_tr_b16 v[118:119], v152 offset:43584
    s_add_u32 s29, s42, 45056
    buffer_load_dwordx4 v[136:139], v9, s[12:15], s29 offen sc1
    s_add_u32 s29, s42, 45056
    buffer_load_dwordx4 v[140:143], v14, s[12:15], s29 offen sc1
    s_waitcnt vmcnt(6)
    s_waitcnt lgkmcnt(6)
    v_mfma_f32_16x16x32_bf16 v[16:19], v[104:107], v[128:131], v[16:19]
    v_mfma_f32_16x16x32_bf16 v[20:23], v[104:107], v[132:135], v[20:23]
    ds_read_b64_tr_b16 v[120:121], v2 offset:41088
    ds_read_b64_tr_b16 v[122:123], v2 offset:43648
    s_add_u32 m0, s59, 12288
    s_add_u32 s29, s58, 847872
    buffer_load_dwordx4 v5, s[48:51], s29 offen lds
    s_waitcnt lgkmcnt(6)
    v_mfma_f32_16x16x32_bf16 v[24:27], v[108:111], v[128:131], v[24:27]
    v_mfma_f32_16x16x32_bf16 v[28:31], v[108:111], v[132:135], v[28:31]
    ds_read_b64_tr_b16 v[124:125], v152 offset:41088
    ds_read_b64_tr_b16 v[126:127], v152 offset:43648
    s_waitcnt lgkmcnt(6)
    v_mfma_f32_16x16x32_bf16 v[32:35], v[112:115], v[128:131], v[32:35]
    v_mfma_f32_16x16x32_bf16 v[36:39], v[112:115], v[132:135], v[36:39]
    ds_read_b64_tr_b16 v[96:97], v2 offset:41152
    ds_read_b64_tr_b16 v[98:99], v2 offset:43712
    s_add_u32 m0, s59, 13312
    s_add_u32 s29, s58, 847872
    s_mov_b32 exec_lo, 0xffffffff
    s_mov_b32 exec_hi, 0x0
    buffer_load_dwordx4 v6, s[48:51], s29 offen lds
    s_mov_b64 exec, -1
    s_waitcnt lgkmcnt(6)
    v_mfma_f32_16x16x32_bf16 v[40:43], v[116:119], v[128:131], v[40:43]
    v_mfma_f32_16x16x32_bf16 v[44:47], v[116:119], v[132:135], v[44:47]
    ds_read_b64_tr_b16 v[100:101], v152 offset:41152
    ds_read_b64_tr_b16 v[102:103], v152 offset:43712
    s_waitcnt lgkmcnt(6)
    v_mfma_f32_16x16x32_bf16 v[48:51], v[120:123], v[128:131], v[48:51]
    v_mfma_f32_16x16x32_bf16 v[52:55], v[120:123], v[132:135], v[52:55]
    ds_read_b64_tr_b16 v[104:105], v2 offset:41216
    ds_read_b64_tr_b16 v[106:107], v2 offset:43776
    s_waitcnt lgkmcnt(6)
    v_mfma_f32_16x16x32_bf16 v[56:59], v[124:127], v[128:131], v[56:59]
    v_mfma_f32_16x16x32_bf16 v[60:63], v[124:127], v[132:135], v[60:63]
    ds_read_b64_tr_b16 v[108:109], v152 offset:41216
    ds_read_b64_tr_b16 v[110:111], v152 offset:43776
    s_waitcnt lgkmcnt(6)
    v_mfma_f32_16x16x32_bf16 v[64:67], v[96:99], v[128:131], v[64:67]
    v_mfma_f32_16x16x32_bf16 v[68:71], v[96:99], v[132:135], v[68:71]
    s_waitcnt lgkmcnt(4)
    v_mfma_f32_16x16x32_bf16 v[72:75], v[100:103], v[128:131], v[72:75]
    v_mfma_f32_16x16x32_bf16 v[76:79], v[100:103], v[132:135], v[76:79]
    s_waitcnt lgkmcnt(2)
    s_cmp_eq_u32 s62, 0
    s_cbranch_scc1 parallel_sum__softmax_full_mha__dense_activation_relu__prompt_kernel_sk21_0
    v_mfma_f32_16x16x32_bf16 v[80:83], v[104:107], v[128:131], v[80:83]
    v_mfma_f32_16x16x32_bf16 v[84:87], v[104:107], v[132:135], v[84:87]
parallel_sum__softmax_full_mha__dense_activation_relu__prompt_kernel_sk21_0:
    s_waitcnt lgkmcnt(0)
    s_cmp_eq_u32 s62, 0
    s_cbranch_scc1 parallel_sum__softmax_full_mha__dense_activation_relu__prompt_kernel_sk21_1
    v_mfma_f32_16x16x32_bf16 v[88:91], v[108:111], v[128:131], v[88:91]
    v_mfma_f32_16x16x32_bf16 v[92:95], v[108:111], v[132:135], v[92:95]
parallel_sum__softmax_full_mha__dense_activation_relu__prompt_kernel_sk21_1:
    s_add_u32 s29, s42, 47104
    buffer_load_dwordx4 v[144:147], v9, s[12:15], s29 offen sc1
    s_add_u32 s29, s42, 47104
    buffer_load_dwordx4 v[148:151], v14, s[12:15], s29 offen sc1
    s_waitcnt vmcnt(2)
    s_barrier
    ds_read_b64_tr_b16 v[112:113], v3 offset:0
    ds_read_b64_tr_b16 v[114:115], v3 offset:2560
    ds_read_b64_tr_b16 v[116:117], v153 offset:0
    ds_read_b64_tr_b16 v[118:119], v153 offset:2560
    ds_read_b64_tr_b16 v[120:121], v3 offset:64
    ds_read_b64_tr_b16 v[122:123], v3 offset:2624
    ds_read_b64_tr_b16 v[124:125], v153 offset:64
    ds_read_b64_tr_b16 v[126:127], v153 offset:2624
    s_waitcnt vmcnt(4)
    s_waitcnt lgkmcnt(6)
    v_mfma_f32_16x16x32_bf16 v[16:19], v[112:115], v[136:139], v[16:19]
    v_mfma_f32_16x16x32_bf16 v[20:23], v[112:115], v[140:143], v[20:23]
    ds_read_b64_tr_b16 v[96:97], v3 offset:128
    ds_read_b64_tr_b16 v[98:99], v3 offset:2688
    s_add_u32 m0, s39, 104448
    s_add_u32 s29, s38, 122880
    buffer_load_dwordx4 v1, s[8:11], s29 offen sc1 lds
    s_waitcnt lgkmcnt(6)
    v_mfma_f32_16x16x32_bf16 v[24:27], v[116:119], v[136:139], v[24:27]
    v_mfma_f32_16x16x32_bf16 v[28:31], v[116:119], v[140:143], v[28:31]
    ds_read_b64_tr_b16 v[100:101], v153 offset:128
    ds_read_b64_tr_b16 v[102:103], v153 offset:2688
    s_waitcnt lgkmcnt(6)
    v_mfma_f32_16x16x32_bf16 v[32:35], v[120:123], v[136:139], v[32:35]
    v_mfma_f32_16x16x32_bf16 v[36:39], v[120:123], v[140:143], v[36:39]
    ds_read_b64_tr_b16 v[104:105], v3 offset:192
    ds_read_b64_tr_b16 v[106:107], v3 offset:2752
    s_add_u32 m0, s39, 105472
    s_add_u32 s29, s38, 123904
    buffer_load_dwordx4 v1, s[8:11], s29 offen sc1 lds
    s_waitcnt lgkmcnt(6)
    v_mfma_f32_16x16x32_bf16 v[40:43], v[124:127], v[136:139], v[40:43]
    v_mfma_f32_16x16x32_bf16 v[44:47], v[124:127], v[140:143], v[44:47]
    ds_read_b64_tr_b16 v[108:109], v153 offset:192
    ds_read_b64_tr_b16 v[110:111], v153 offset:2752
    s_waitcnt lgkmcnt(6)
    v_mfma_f32_16x16x32_bf16 v[48:51], v[96:99], v[136:139], v[48:51]
    v_mfma_f32_16x16x32_bf16 v[52:55], v[96:99], v[140:143], v[52:55]
    ds_read_b64_tr_b16 v[112:113], v3 offset:256
    ds_read_b64_tr_b16 v[114:115], v3 offset:2816
    s_add_u32 m0, s39, 106496
    s_add_u32 s29, s38, 124928
    buffer_load_dwordx4 v1, s[8:11], s29 offen sc1 lds
    s_waitcnt lgkmcnt(6)
    v_mfma_f32_16x16x32_bf16 v[56:59], v[100:103], v[136:139], v[56:59]
    v_mfma_f32_16x16x32_bf16 v[60:63], v[100:103], v[140:143], v[60:63]
    ds_read_b64_tr_b16 v[116:117], v153 offset:256
    ds_read_b64_tr_b16 v[118:119], v153 offset:2816
    s_waitcnt lgkmcnt(6)
    v_mfma_f32_16x16x32_bf16 v[64:67], v[104:107], v[136:139], v[64:67]
    v_mfma_f32_16x16x32_bf16 v[68:71], v[104:107], v[140:143], v[68:71]
    ds_read_b64_tr_b16 v[120:121], v3 offset:10240
    ds_read_b64_tr_b16 v[122:123], v3 offset:12800
    s_add_u32 m0, s39, 107520
    s_add_u32 s29, s38, 125952
    buffer_load_dwordx4 v1, s[8:11], s29 offen sc1 lds
    s_waitcnt lgkmcnt(6)
    v_mfma_f32_16x16x32_bf16 v[72:75], v[108:111], v[136:139], v[72:75]
    v_mfma_f32_16x16x32_bf16 v[76:79], v[108:111], v[140:143], v[76:79]
    ds_read_b64_tr_b16 v[124:125], v153 offset:10240
    ds_read_b64_tr_b16 v[126:127], v153 offset:12800
    s_waitcnt lgkmcnt(6)
    s_cmp_eq_u32 s62, 0
    s_cbranch_scc1 parallel_sum__softmax_full_mha__dense_activation_relu__prompt_kernel_sk22_0
    v_mfma_f32_16x16x32_bf16 v[80:83], v[112:115], v[136:139], v[80:83]
    v_mfma_f32_16x16x32_bf16 v[84:87], v[112:115], v[140:143], v[84:87]
parallel_sum__softmax_full_mha__dense_activation_relu__prompt_kernel_sk22_0:
    ds_read_b64_tr_b16 v[96:97], v3 offset:10304
    ds_read_b64_tr_b16 v[98:99], v3 offset:12864
    s_waitcnt lgkmcnt(6)
    s_cmp_eq_u32 s62, 0
    s_cbranch_scc1 parallel_sum__softmax_full_mha__dense_activation_relu__prompt_kernel_sk22_1
    v_mfma_f32_16x16x32_bf16 v[88:91], v[116:119], v[136:139], v[88:91]
    v_mfma_f32_16x16x32_bf16 v[92:95], v[116:119], v[140:143], v[92:95]
parallel_sum__softmax_full_mha__dense_activation_relu__prompt_kernel_sk22_1:
    ds_read_b64_tr_b16 v[100:101], v153 offset:10304
    ds_read_b64_tr_b16 v[102:103], v153 offset:12864
    s_add_u32 s29, s42, 49152
    buffer_load_dwordx4 v[128:131], v9, s[12:15], s29 offen sc1
    s_add_u32 s29, s42, 49152
    buffer_load_dwordx4 v[132:135], v14, s[12:15], s29 offen sc1
    s_waitcnt vmcnt(6)
    s_waitcnt lgkmcnt(6)
    v_mfma_f32_16x16x32_bf16 v[16:19], v[120:123], v[144:147], v[16:19]
    v_mfma_f32_16x16x32_bf16 v[20:23], v[120:123], v[148:151], v[20:23]
    ds_read_b64_tr_b16 v[104:105], v3 offset:10368
    ds_read_b64_tr_b16 v[106:107], v3 offset:12928
    s_add_u32 s45, s39, 108544
    s_cmp_eq_u32 s21, 3
    s_cselect_b32 m0, 162816, s45
    s_add_u32 s29, s38, 126976
    buffer_load_dwordx4 v1, s[8:11], s29 offen sc1 lds
    s_waitcnt lgkmcnt(6)
    v_mfma_f32_16x16x32_bf16 v[24:27], v[124:127], v[144:147], v[24:27]
    v_mfma_f32_16x16x32_bf16 v[28:31], v[124:127], v[148:151], v[28:31]
    ds_read_b64_tr_b16 v[108:109], v153 offset:10368
    ds_read_b64_tr_b16 v[110:111], v153 offset:12928
    s_waitcnt lgkmcnt(6)
    v_mfma_f32_16x16x32_bf16 v[32:35], v[96:99], v[144:147], v[32:35]
    v_mfma_f32_16x16x32_bf16 v[36:39], v[96:99], v[148:151], v[36:39]
    ds_read_b64_tr_b16 v[112:113], v3 offset:10432
    ds_read_b64_tr_b16 v[114:115], v3 offset:12992
    s_add_u32 m0, s59, 53248
    s_add_u32 s29, s58, 995328
    buffer_load_dwordx4 v4, s[48:51], s29 offen lds
    s_waitcnt lgkmcnt(6)
    v_mfma_f32_16x16x32_bf16 v[40:43], v[100:103], v[144:147], v[40:43]
    v_mfma_f32_16x16x32_bf16 v[44:47], v[100:103], v[148:151], v[44:47]
    ds_read_b64_tr_b16 v[116:117], v153 offset:10432
    ds_read_b64_tr_b16 v[118:119], v153 offset:12992
    s_waitcnt lgkmcnt(6)
    v_mfma_f32_16x16x32_bf16 v[48:51], v[104:107], v[144:147], v[48:51]
    v_mfma_f32_16x16x32_bf16 v[52:55], v[104:107], v[148:151], v[52:55]
    ds_read_b64_tr_b16 v[120:121], v3 offset:10496
    ds_read_b64_tr_b16 v[122:123], v3 offset:13056
    s_add_u32 m0, s59, 54272
    s_add_u32 s29, s58, 995328
    buffer_load_dwordx4 v5, s[48:51], s29 offen lds
    s_waitcnt lgkmcnt(6)
    v_mfma_f32_16x16x32_bf16 v[56:59], v[108:111], v[144:147], v[56:59]
    v_mfma_f32_16x16x32_bf16 v[60:63], v[108:111], v[148:151], v[60:63]
    ds_read_b64_tr_b16 v[124:125], v153 offset:10496
    ds_read_b64_tr_b16 v[126:127], v153 offset:13056
    s_waitcnt lgkmcnt(6)
    v_mfma_f32_16x16x32_bf16 v[64:67], v[112:115], v[144:147], v[64:67]
    v_mfma_f32_16x16x32_bf16 v[68:71], v[112:115], v[148:151], v[68:71]
    ds_read_b64_tr_b16 v[96:97], v3 offset:20480
    ds_read_b64_tr_b16 v[98:99], v3 offset:23040
    s_add_u32 m0, s59, 55296
    s_add_u32 s29, s58, 995328
    buffer_load_dwordx4 v6, s[48:51], s29 offen lds
    s_waitcnt lgkmcnt(6)
    v_mfma_f32_16x16x32_bf16 v[72:75], v[116:119], v[144:147], v[72:75]
    v_mfma_f32_16x16x32_bf16 v[76:79], v[116:119], v[148:151], v[76:79]
    ds_read_b64_tr_b16 v[100:101], v153 offset:20480
    ds_read_b64_tr_b16 v[102:103], v153 offset:23040
    s_waitcnt lgkmcnt(6)
    s_cmp_eq_u32 s62, 0
    s_cbranch_scc1 parallel_sum__softmax_full_mha__dense_activation_relu__prompt_kernel_sk23_0
    v_mfma_f32_16x16x32_bf16 v[80:83], v[120:123], v[144:147], v[80:83]
    v_mfma_f32_16x16x32_bf16 v[84:87], v[120:123], v[148:151], v[84:87]
parallel_sum__softmax_full_mha__dense_activation_relu__prompt_kernel_sk23_0:
    ds_read_b64_tr_b16 v[104:105], v3 offset:20544
    ds_read_b64_tr_b16 v[106:107], v3 offset:23104
    s_waitcnt lgkmcnt(6)
    s_cmp_eq_u32 s62, 0
    s_cbranch_scc1 parallel_sum__softmax_full_mha__dense_activation_relu__prompt_kernel_sk23_1
    v_mfma_f32_16x16x32_bf16 v[88:91], v[124:127], v[144:147], v[88:91]
    v_mfma_f32_16x16x32_bf16 v[92:95], v[124:127], v[148:151], v[92:95]
parallel_sum__softmax_full_mha__dense_activation_relu__prompt_kernel_sk23_1:
    ds_read_b64_tr_b16 v[108:109], v153 offset:20544
    ds_read_b64_tr_b16 v[110:111], v153 offset:23104
    s_add_u32 s29, s42, 51200
    buffer_load_dwordx4 v[136:139], v9, s[12:15], s29 offen sc1
    s_add_u32 s29, s42, 51200
    buffer_load_dwordx4 v[140:143], v14, s[12:15], s29 offen sc1
    s_waitcnt vmcnt(6)
    s_waitcnt lgkmcnt(6)
    v_mfma_f32_16x16x32_bf16 v[16:19], v[96:99], v[128:131], v[16:19]
    v_mfma_f32_16x16x32_bf16 v[20:23], v[96:99], v[132:135], v[20:23]
    ds_read_b64_tr_b16 v[112:113], v3 offset:20608
    ds_read_b64_tr_b16 v[114:115], v3 offset:23168
    s_add_u32 m0, s59, 56320
    s_add_u32 s29, s58, 995328
    buffer_load_dwordx4 v7, s[48:51], s29 offen lds
    s_waitcnt lgkmcnt(6)
    v_mfma_f32_16x16x32_bf16 v[24:27], v[100:103], v[128:131], v[24:27]
    v_mfma_f32_16x16x32_bf16 v[28:31], v[100:103], v[132:135], v[28:31]
    ds_read_b64_tr_b16 v[116:117], v153 offset:20608
    ds_read_b64_tr_b16 v[118:119], v153 offset:23168
    s_waitcnt lgkmcnt(6)
    v_mfma_f32_16x16x32_bf16 v[32:35], v[104:107], v[128:131], v[32:35]
    v_mfma_f32_16x16x32_bf16 v[36:39], v[104:107], v[132:135], v[36:39]
    ds_read_b64_tr_b16 v[120:121], v3 offset:20672
    ds_read_b64_tr_b16 v[122:123], v3 offset:23232
    s_add_u32 m0, s59, 57344
    s_add_u32 s29, s58, 995328
    buffer_load_dwordx4 v8, s[48:51], s29 offen lds
    s_waitcnt lgkmcnt(6)
    v_mfma_f32_16x16x32_bf16 v[40:43], v[108:111], v[128:131], v[40:43]
    v_mfma_f32_16x16x32_bf16 v[44:47], v[108:111], v[132:135], v[44:47]
    ds_read_b64_tr_b16 v[124:125], v153 offset:20672
    ds_read_b64_tr_b16 v[126:127], v153 offset:23232
    s_waitcnt lgkmcnt(6)
    v_mfma_f32_16x16x32_bf16 v[48:51], v[112:115], v[128:131], v[48:51]
    v_mfma_f32_16x16x32_bf16 v[52:55], v[112:115], v[132:135], v[52:55]
    ds_read_b64_tr_b16 v[96:97], v3 offset:20736
    ds_read_b64_tr_b16 v[98:99], v3 offset:23296
    s_add_u32 m0, s59, 58368
    s_add_u32 s29, s58, 1013760
    buffer_load_dwordx4 v4, s[48:51], s29 offen lds
    s_waitcnt lgkmcnt(6)
    v_mfma_f32_16x16x32_bf16 v[56:59], v[116:119], v[128:131], v[56:59]
    v_mfma_f32_16x16x32_bf16 v[60:63], v[116:119], v[132:135], v[60:63]
    ds_read_b64_tr_b16 v[100:101], v153 offset:20736
    ds_read_b64_tr_b16 v[102:103], v153 offset:23296
    s_waitcnt lgkmcnt(6)
    v_mfma_f32_16x16x32_bf16 v[64:67], v[120:123], v[128:131], v[64:67]
    v_mfma_f32_16x16x32_bf16 v[68:71], v[120:123], v[132:135], v[68:71]
    ds_read_b64_tr_b16 v[104:105], v3 offset:30720
    ds_read_b64_tr_b16 v[106:107], v3 offset:33280
    s_add_u32 m0, s59, 59392
    s_add_u32 s29, s58, 1013760
    buffer_load_dwordx4 v5, s[48:51], s29 offen lds
    s_waitcnt lgkmcnt(6)
    v_mfma_f32_16x16x32_bf16 v[72:75], v[124:127], v[128:131], v[72:75]
    v_mfma_f32_16x16x32_bf16 v[76:79], v[124:127], v[132:135], v[76:79]
    ds_read_b64_tr_b16 v[108:109], v153 offset:30720
    ds_read_b64_tr_b16 v[110:111], v153 offset:33280
    s_waitcnt lgkmcnt(6)
    s_cmp_eq_u32 s62, 0
    s_cbranch_scc1 parallel_sum__softmax_full_mha__dense_activation_relu__prompt_kernel_sk24_0
    v_mfma_f32_16x16x32_bf16 v[80:83], v[96:99], v[128:131], v[80:83]
    v_mfma_f32_16x16x32_bf16 v[84:87], v[96:99], v[132:135], v[84:87]
parallel_sum__softmax_full_mha__dense_activation_relu__prompt_kernel_sk24_0:
    ds_read_b64_tr_b16 v[112:113], v3 offset:30784
    ds_read_b64_tr_b16 v[114:115], v3 offset:33344
    s_waitcnt lgkmcnt(6)
    s_cmp_eq_u32 s62, 0
    s_cbranch_scc1 parallel_sum__softmax_full_mha__dense_activation_relu__prompt_kernel_sk24_1
    v_mfma_f32_16x16x32_bf16 v[88:91], v[100:103], v[128:131], v[88:91]
    v_mfma_f32_16x16x32_bf16 v[92:95], v[100:103], v[132:135], v[92:95]
parallel_sum__softmax_full_mha__dense_activation_relu__prompt_kernel_sk24_1:
    ds_read_b64_tr_b16 v[116:117], v153 offset:30784
    ds_read_b64_tr_b16 v[118:119], v153 offset:33344
    s_add_u32 s29, s42, 53248
    buffer_load_dwordx4 v[144:147], v9, s[12:15], s29 offen sc1
    s_add_u32 s29, s42, 53248
    buffer_load_dwordx4 v[148:151], v14, s[12:15], s29 offen sc1
    s_waitcnt vmcnt(6)
    s_waitcnt lgkmcnt(6)
    v_mfma_f32_16x16x32_bf16 v[16:19], v[104:107], v[136:139], v[16:19]
    v_mfma_f32_16x16x32_bf16 v[20:23], v[104:107], v[140:143], v[20:23]
    ds_read_b64_tr_b16 v[120:121], v3 offset:30848
    ds_read_b64_tr_b16 v[122:123], v3 offset:33408
    s_add_u32 m0, s59, 60416
    s_add_u32 s29, s58, 1013760
    buffer_load_dwordx4 v6, s[48:51], s29 offen lds
    s_waitcnt lgkmcnt(6)
    v_mfma_f32_16x16x32_bf16 v[24:27], v[108:111], v[136:139], v[24:27]
    v_mfma_f32_16x16x32_bf16 v[28:31], v[108:111], v[140:143], v[28:31]
    ds_read_b64_tr_b16 v[124:125], v153 offset:30848
    ds_read_b64_tr_b16 v[126:127], v153 offset:33408
    s_waitcnt lgkmcnt(6)
    v_mfma_f32_16x16x32_bf16 v[32:35], v[112:115], v[136:139], v[32:35]
    v_mfma_f32_16x16x32_bf16 v[36:39], v[112:115], v[140:143], v[36:39]
    ds_read_b64_tr_b16 v[96:97], v3 offset:30912
    ds_read_b64_tr_b16 v[98:99], v3 offset:33472
    s_add_u32 m0, s59, 61440
    s_add_u32 s29, s58, 1013760
    buffer_load_dwordx4 v7, s[48:51], s29 offen lds
    s_waitcnt lgkmcnt(6)
    v_mfma_f32_16x16x32_bf16 v[40:43], v[116:119], v[136:139], v[40:43]
    v_mfma_f32_16x16x32_bf16 v[44:47], v[116:119], v[140:143], v[44:47]
    ds_read_b64_tr_b16 v[100:101], v153 offset:30912
    ds_read_b64_tr_b16 v[102:103], v153 offset:33472
    s_waitcnt lgkmcnt(6)
    v_mfma_f32_16x16x32_bf16 v[48:51], v[120:123], v[136:139], v[48:51]
    v_mfma_f32_16x16x32_bf16 v[52:55], v[120:123], v[140:143], v[52:55]
    ds_read_b64_tr_b16 v[104:105], v3 offset:30976
    ds_read_b64_tr_b16 v[106:107], v3 offset:33536
    s_add_u32 m0, s59, 62464
    s_add_u32 s29, s58, 1013760
    buffer_load_dwordx4 v8, s[48:51], s29 offen lds
    s_waitcnt lgkmcnt(6)
    v_mfma_f32_16x16x32_bf16 v[56:59], v[124:127], v[136:139], v[56:59]
    v_mfma_f32_16x16x32_bf16 v[60:63], v[124:127], v[140:143], v[60:63]
    ds_read_b64_tr_b16 v[108:109], v153 offset:30976
    ds_read_b64_tr_b16 v[110:111], v153 offset:33536
    s_waitcnt lgkmcnt(6)
    v_mfma_f32_16x16x32_bf16 v[64:67], v[96:99], v[136:139], v[64:67]
    v_mfma_f32_16x16x32_bf16 v[68:71], v[96:99], v[140:143], v[68:71]
    ds_read_b64_tr_b16 v[112:113], v3 offset:40960
    ds_read_b64_tr_b16 v[114:115], v3 offset:43520
    s_add_u32 m0, s59, 63488
    s_add_u32 s29, s58, 1032192
    buffer_load_dwordx4 v4, s[48:51], s29 offen lds
    s_waitcnt lgkmcnt(6)
    v_mfma_f32_16x16x32_bf16 v[72:75], v[100:103], v[136:139], v[72:75]
    v_mfma_f32_16x16x32_bf16 v[76:79], v[100:103], v[140:143], v[76:79]
    ds_read_b64_tr_b16 v[116:117], v153 offset:40960
    ds_read_b64_tr_b16 v[118:119], v153 offset:43520
    s_waitcnt lgkmcnt(6)
    s_cmp_eq_u32 s62, 0
    s_cbranch_scc1 parallel_sum__softmax_full_mha__dense_activation_relu__prompt_kernel_sk25_0
    v_mfma_f32_16x16x32_bf16 v[80:83], v[104:107], v[136:139], v[80:83]
    v_mfma_f32_16x16x32_bf16 v[84:87], v[104:107], v[140:143], v[84:87]
parallel_sum__softmax_full_mha__dense_activation_relu__prompt_kernel_sk25_0:
    ds_read_b64_tr_b16 v[120:121], v3 offset:41024
    ds_read_b64_tr_b16 v[122:123], v3 offset:43584
    s_waitcnt lgkmcnt(6)
    s_cmp_eq_u32 s62, 0
    s_cbranch_scc1 parallel_sum__softmax_full_mha__dense_activation_relu__prompt_kernel_sk25_1
    v_mfma_f32_16x16x32_bf16 v[88:91], v[108:111], v[136:139], v[88:91]
    v_mfma_f32_16x16x32_bf16 v[92:95], v[108:111], v[140:143], v[92:95]
parallel_sum__softmax_full_mha__dense_activation_relu__prompt_kernel_sk25_1:
    ds_read_b64_tr_b16 v[124:125], v153 offset:41024
    ds_read_b64_tr_b16 v[126:127], v153 offset:43584
    s_add_u32 s29, s42, 55296
    buffer_load_dwordx4 v[128:131], v9, s[12:15], s29 offen sc1
    s_add_u32 s29, s42, 55296
    buffer_load_dwordx4 v[132:135], v14, s[12:15], s29 offen sc1
    s_waitcnt vmcnt(6)
    s_waitcnt lgkmcnt(6)
    v_mfma_f32_16x16x32_bf16 v[16:19], v[112:115], v[144:147], v[16:19]
    v_mfma_f32_16x16x32_bf16 v[20:23], v[112:115], v[148:151], v[20:23]
    ds_read_b64_tr_b16 v[96:97], v3 offset:41088
    ds_read_b64_tr_b16 v[98:99], v3 offset:43648
    s_add_u32 m0, s59, 64512
    s_add_u32 s29, s58, 1032192
    buffer_load_dwordx4 v5, s[48:51], s29 offen lds
    s_waitcnt lgkmcnt(6)
    v_mfma_f32_16x16x32_bf16 v[24:27], v[116:119], v[144:147], v[24:27]
    v_mfma_f32_16x16x32_bf16 v[28:31], v[116:119], v[148:151], v[28:31]
    ds_read_b64_tr_b16 v[100:101], v153 offset:41088
    ds_read_b64_tr_b16 v[102:103], v153 offset:43648
    s_waitcnt lgkmcnt(6)
    v_mfma_f32_16x16x32_bf16 v[32:35], v[120:123], v[144:147], v[32:35]
    v_mfma_f32_16x16x32_bf16 v[36:39], v[120:123], v[148:151], v[36:39]
    ds_read_b64_tr_b16 v[104:105], v3 offset:41152
    ds_read_b64_tr_b16 v[106:107], v3 offset:43712
    s_add_u32 m0, s59, 65536
    s_add_u32 s29, s58, 1032192
    s_mov_b32 exec_lo, 0xffffffff
    s_mov_b32 exec_hi, 0x0
    buffer_load_dwordx4 v6, s[48:51], s29 offen lds
    s_mov_b64 exec, -1
    s_waitcnt lgkmcnt(6)
    v_mfma_f32_16x16x32_bf16 v[40:43], v[124:127], v[144:147], v[40:43]
    v_mfma_f32_16x16x32_bf16 v[44:47], v[124:127], v[148:151], v[44:47]
    ds_read_b64_tr_b16 v[108:109], v153 offset:41152
    ds_read_b64_tr_b16 v[110:111], v153 offset:43712
    s_waitcnt lgkmcnt(6)
    v_mfma_f32_16x16x32_bf16 v[48:51], v[96:99], v[144:147], v[48:51]
    v_mfma_f32_16x16x32_bf16 v[52:55], v[96:99], v[148:151], v[52:55]
    ds_read_b64_tr_b16 v[112:113], v3 offset:41216
    ds_read_b64_tr_b16 v[114:115], v3 offset:43776
    s_waitcnt lgkmcnt(6)
    v_mfma_f32_16x16x32_bf16 v[56:59], v[100:103], v[144:147], v[56:59]
    v_mfma_f32_16x16x32_bf16 v[60:63], v[100:103], v[148:151], v[60:63]
    ds_read_b64_tr_b16 v[116:117], v153 offset:41216
    ds_read_b64_tr_b16 v[118:119], v153 offset:43776
    s_waitcnt lgkmcnt(6)
    v_mfma_f32_16x16x32_bf16 v[64:67], v[104:107], v[144:147], v[64:67]
    v_mfma_f32_16x16x32_bf16 v[68:71], v[104:107], v[148:151], v[68:71]
    s_waitcnt lgkmcnt(4)
    v_mfma_f32_16x16x32_bf16 v[72:75], v[108:111], v[144:147], v[72:75]
    v_mfma_f32_16x16x32_bf16 v[76:79], v[108:111], v[148:151], v[76:79]
    s_waitcnt lgkmcnt(2)
    s_cmp_eq_u32 s62, 0
    s_cbranch_scc1 parallel_sum__softmax_full_mha__dense_activation_relu__prompt_kernel_sk26_0
    v_mfma_f32_16x16x32_bf16 v[80:83], v[112:115], v[144:147], v[80:83]
    v_mfma_f32_16x16x32_bf16 v[84:87], v[112:115], v[148:151], v[84:87]
parallel_sum__softmax_full_mha__dense_activation_relu__prompt_kernel_sk26_0:
    s_waitcnt lgkmcnt(0)
    s_cmp_eq_u32 s62, 0
    s_cbranch_scc1 parallel_sum__softmax_full_mha__dense_activation_relu__prompt_kernel_sk26_1
    v_mfma_f32_16x16x32_bf16 v[88:91], v[116:119], v[144:147], v[88:91]
    v_mfma_f32_16x16x32_bf16 v[92:95], v[116:119], v[148:151], v[92:95]
parallel_sum__softmax_full_mha__dense_activation_relu__prompt_kernel_sk26_1:
    s_add_u32 s29, s42, 57344
    buffer_load_dwordx4 v[136:139], v9, s[12:15], s29 offen sc1
    s_add_u32 s29, s42, 57344
    buffer_load_dwordx4 v[140:143], v14, s[12:15], s29 offen sc1
    s_waitcnt vmcnt(2)
    s_barrier
    ds_read_b64_tr_b16 v[120:121], v2 offset:0
    ds_read_b64_tr_b16 v[122:123], v2 offset:2560
    ds_read_b64_tr_b16 v[124:125], v152 offset:0
    ds_read_b64_tr_b16 v[126:127], v152 offset:2560
    ds_read_b64_tr_b16 v[96:97], v2 offset:64
    ds_read_b64_tr_b16 v[98:99], v2 offset:2624
    ds_read_b64_tr_b16 v[100:101], v152 offset:64
    ds_read_b64_tr_b16 v[102:103], v152 offset:2624
    s_waitcnt vmcnt(4)
    s_waitcnt lgkmcnt(6)
    v_mfma_f32_16x16x32_bf16 v[16:19], v[120:123], v[128:131], v[16:19]
    v_mfma_f32_16x16x32_bf16 v[20:23], v[120:123], v[132:135], v[20:23]
    ds_read_b64_tr_b16 v[104:105], v2 offset:128
    ds_read_b64_tr_b16 v[106:107], v2 offset:2688
    s_add_u32 m0, s39, 123904
    s_add_u32 s29, s38, 143360
    buffer_load_dwordx4 v1, s[8:11], s29 offen sc1 lds
    s_waitcnt lgkmcnt(6)
    v_mfma_f32_16x16x32_bf16 v[24:27], v[124:127], v[128:131], v[24:27]
    v_mfma_f32_16x16x32_bf16 v[28:31], v[124:127], v[132:135], v[28:31]
    ds_read_b64_tr_b16 v[108:109], v152 offset:128
    ds_read_b64_tr_b16 v[110:111], v152 offset:2688
    s_waitcnt lgkmcnt(6)
    v_mfma_f32_16x16x32_bf16 v[32:35], v[96:99], v[128:131], v[32:35]
    v_mfma_f32_16x16x32_bf16 v[36:39], v[96:99], v[132:135], v[36:39]
    ds_read_b64_tr_b16 v[112:113], v2 offset:192
    ds_read_b64_tr_b16 v[114:115], v2 offset:2752
    s_add_u32 m0, s39, 124928
    s_add_u32 s29, s38, 144384
    buffer_load_dwordx4 v1, s[8:11], s29 offen sc1 lds
    s_waitcnt lgkmcnt(6)
    v_mfma_f32_16x16x32_bf16 v[40:43], v[100:103], v[128:131], v[40:43]
    v_mfma_f32_16x16x32_bf16 v[44:47], v[100:103], v[132:135], v[44:47]
    ds_read_b64_tr_b16 v[116:117], v152 offset:192
    ds_read_b64_tr_b16 v[118:119], v152 offset:2752
    s_waitcnt lgkmcnt(6)
    v_mfma_f32_16x16x32_bf16 v[48:51], v[104:107], v[128:131], v[48:51]
    v_mfma_f32_16x16x32_bf16 v[52:55], v[104:107], v[132:135], v[52:55]
    ds_read_b64_tr_b16 v[120:121], v2 offset:256
    ds_read_b64_tr_b16 v[122:123], v2 offset:2816
    s_add_u32 m0, s39, 125952
    s_add_u32 s29, s38, 145408
    buffer_load_dwordx4 v1, s[8:11], s29 offen sc1 lds
    s_waitcnt lgkmcnt(6)
    v_mfma_f32_16x16x32_bf16 v[56:59], v[108:111], v[128:131], v[56:59]
    v_mfma_f32_16x16x32_bf16 v[60:63], v[108:111], v[132:135], v[60:63]
    ds_read_b64_tr_b16 v[124:125], v152 offset:256
    ds_read_b64_tr_b16 v[126:127], v152 offset:2816
    s_waitcnt lgkmcnt(6)
    v_mfma_f32_16x16x32_bf16 v[64:67], v[112:115], v[128:131], v[64:67]
    v_mfma_f32_16x16x32_bf16 v[68:71], v[112:115], v[132:135], v[68:71]
    ds_read_b64_tr_b16 v[96:97], v2 offset:10240
    ds_read_b64_tr_b16 v[98:99], v2 offset:12800
    s_add_u32 m0, s39, 126976
    s_add_u32 s29, s38, 146432
    buffer_load_dwordx4 v1, s[8:11], s29 offen sc1 lds
    s_waitcnt lgkmcnt(6)
    v_mfma_f32_16x16x32_bf16 v[72:75], v[116:119], v[128:131], v[72:75]
    v_mfma_f32_16x16x32_bf16 v[76:79], v[116:119], v[132:135], v[76:79]
    ds_read_b64_tr_b16 v[100:101], v152 offset:10240
    ds_read_b64_tr_b16 v[102:103], v152 offset:12800
    s_waitcnt lgkmcnt(6)
    s_cmp_eq_u32 s62, 0
    s_cbranch_scc1 parallel_sum__softmax_full_mha__dense_activation_relu__prompt_kernel_sk27_0
    v_mfma_f32_16x16x32_bf16 v[80:83], v[120:123], v[128:131], v[80:83]
    v_mfma_f32_16x16x32_bf16 v[84:87], v[120:123], v[132:135], v[84:87]
parallel_sum__softmax_full_mha__dense_activation_relu__prompt_kernel_sk27_0:
    ds_read_b64_tr_b16 v[104:105], v2 offset:10304
    ds_read_b64_tr_b16 v[106:107], v2 offset:12864
    s_waitcnt lgkmcnt(6)
    s_cmp_eq_u32 s62, 0
    s_cbranch_scc1 parallel_sum__softmax_full_mha__dense_activation_relu__prompt_kernel_sk27_1
    v_mfma_f32_16x16x32_bf16 v[88:91], v[124:127], v[128:131], v[88:91]
    v_mfma_f32_16x16x32_bf16 v[92:95], v[124:127], v[132:135], v[92:95]
parallel_sum__softmax_full_mha__dense_activation_relu__prompt_kernel_sk27_1:
    ds_read_b64_tr_b16 v[108:109], v152 offset:10304
    ds_read_b64_tr_b16 v[110:111], v152 offset:12864
    s_add_u32 s29, s42, 59392
    buffer_load_dwordx4 v[144:147], v9, s[12:15], s29 offen sc1
    s_add_u32 s29, s42, 59392
    buffer_load_dwordx4 v[148:151], v14, s[12:15], s29 offen sc1
    s_waitcnt vmcnt(6)
    s_waitcnt lgkmcnt(6)
    v_mfma_f32_16x16x32_bf16 v[16:19], v[96:99], v[136:139], v[16:19]
    v_mfma_f32_16x16x32_bf16 v[20:23], v[96:99], v[140:143], v[20:23]
    ds_read_b64_tr_b16 v[112:113], v2 offset:10368
    ds_read_b64_tr_b16 v[114:115], v2 offset:12928
    s_add_u32 s45, s39, 128000
    s_cmp_eq_u32 s21, 3
    s_cselect_b32 m0, 162816, s45
    s_add_u32 s29, s38, 147456
    buffer_load_dwordx4 v1, s[8:11], s29 offen sc1 lds
    s_waitcnt lgkmcnt(6)
    v_mfma_f32_16x16x32_bf16 v[24:27], v[100:103], v[136:139], v[24:27]
    v_mfma_f32_16x16x32_bf16 v[28:31], v[100:103], v[140:143], v[28:31]
    ds_read_b64_tr_b16 v[116:117], v152 offset:10368
    ds_read_b64_tr_b16 v[118:119], v152 offset:12928
    s_waitcnt lgkmcnt(6)
    v_mfma_f32_16x16x32_bf16 v[32:35], v[104:107], v[136:139], v[32:35]
    v_mfma_f32_16x16x32_bf16 v[36:39], v[104:107], v[140:143], v[36:39]
    ds_read_b64_tr_b16 v[120:121], v2 offset:10432
    ds_read_b64_tr_b16 v[122:123], v2 offset:12992
    s_add_u32 m0, s57, 1024
    s_add_u32 s29, s56, 1179648
    buffer_load_dwordx4 v4, s[48:51], s29 offen lds
    s_waitcnt lgkmcnt(6)
    v_mfma_f32_16x16x32_bf16 v[40:43], v[108:111], v[136:139], v[40:43]
    v_mfma_f32_16x16x32_bf16 v[44:47], v[108:111], v[140:143], v[44:47]
    ds_read_b64_tr_b16 v[124:125], v152 offset:10432
    ds_read_b64_tr_b16 v[126:127], v152 offset:12992
    s_waitcnt lgkmcnt(6)
    v_mfma_f32_16x16x32_bf16 v[48:51], v[112:115], v[136:139], v[48:51]
    v_mfma_f32_16x16x32_bf16 v[52:55], v[112:115], v[140:143], v[52:55]
    ds_read_b64_tr_b16 v[96:97], v2 offset:10496
    ds_read_b64_tr_b16 v[98:99], v2 offset:13056
    s_add_u32 m0, s57, 2048
    s_add_u32 s29, s56, 1179648
    buffer_load_dwordx4 v5, s[48:51], s29 offen lds
    s_waitcnt lgkmcnt(6)
    v_mfma_f32_16x16x32_bf16 v[56:59], v[116:119], v[136:139], v[56:59]
    v_mfma_f32_16x16x32_bf16 v[60:63], v[116:119], v[140:143], v[60:63]
    ds_read_b64_tr_b16 v[100:101], v152 offset:10496
    ds_read_b64_tr_b16 v[102:103], v152 offset:13056
    s_waitcnt lgkmcnt(6)
    v_mfma_f32_16x16x32_bf16 v[64:67], v[120:123], v[136:139], v[64:67]
    v_mfma_f32_16x16x32_bf16 v[68:71], v[120:123], v[140:143], v[68:71]
    ds_read_b64_tr_b16 v[104:105], v2 offset:20480
    ds_read_b64_tr_b16 v[106:107], v2 offset:23040
    s_add_u32 m0, s57, 3072
    s_add_u32 s29, s56, 1179648
    buffer_load_dwordx4 v6, s[48:51], s29 offen lds
    s_waitcnt lgkmcnt(6)
    v_mfma_f32_16x16x32_bf16 v[72:75], v[124:127], v[136:139], v[72:75]
    v_mfma_f32_16x16x32_bf16 v[76:79], v[124:127], v[140:143], v[76:79]
    ds_read_b64_tr_b16 v[108:109], v152 offset:20480
    ds_read_b64_tr_b16 v[110:111], v152 offset:23040
    s_waitcnt lgkmcnt(6)
    s_cmp_eq_u32 s62, 0
    s_cbranch_scc1 parallel_sum__softmax_full_mha__dense_activation_relu__prompt_kernel_sk28_0
    v_mfma_f32_16x16x32_bf16 v[80:83], v[96:99], v[136:139], v[80:83]
    v_mfma_f32_16x16x32_bf16 v[84:87], v[96:99], v[140:143], v[84:87]
parallel_sum__softmax_full_mha__dense_activation_relu__prompt_kernel_sk28_0:
    ds_read_b64_tr_b16 v[112:113], v2 offset:20544
    ds_read_b64_tr_b16 v[114:115], v2 offset:23104
    s_waitcnt lgkmcnt(6)
    s_cmp_eq_u32 s62, 0
    s_cbranch_scc1 parallel_sum__softmax_full_mha__dense_activation_relu__prompt_kernel_sk28_1
    v_mfma_f32_16x16x32_bf16 v[88:91], v[100:103], v[136:139], v[88:91]
    v_mfma_f32_16x16x32_bf16 v[92:95], v[100:103], v[140:143], v[92:95]
parallel_sum__softmax_full_mha__dense_activation_relu__prompt_kernel_sk28_1:
    ds_read_b64_tr_b16 v[116:117], v152 offset:20544
    ds_read_b64_tr_b16 v[118:119], v152 offset:23104
    s_add_u32 s29, s42, 61440
    buffer_load_dwordx4 v[128:131], v9, s[12:15], s29 offen sc1
    s_add_u32 s29, s42, 61440
    buffer_load_dwordx4 v[132:135], v14, s[12:15], s29 offen sc1
    s_waitcnt vmcnt(6)
    s_waitcnt lgkmcnt(6)
    v_mfma_f32_16x16x32_bf16 v[16:19], v[104:107], v[144:147], v[16:19]
    v_mfma_f32_16x16x32_bf16 v[20:23], v[104:107], v[148:151], v[20:23]
    ds_read_b64_tr_b16 v[120:121], v2 offset:20608
    ds_read_b64_tr_b16 v[122:123], v2 offset:23168
    s_add_u32 m0, s57, 4096
    s_add_u32 s29, s56, 1179648
    buffer_load_dwordx4 v7, s[48:51], s29 offen lds
    s_waitcnt lgkmcnt(6)
    v_mfma_f32_16x16x32_bf16 v[24:27], v[108:111], v[144:147], v[24:27]
    v_mfma_f32_16x16x32_bf16 v[28:31], v[108:111], v[148:151], v[28:31]
    ds_read_b64_tr_b16 v[124:125], v152 offset:20608
    ds_read_b64_tr_b16 v[126:127], v152 offset:23168
    s_waitcnt lgkmcnt(6)
    v_mfma_f32_16x16x32_bf16 v[32:35], v[112:115], v[144:147], v[32:35]
    v_mfma_f32_16x16x32_bf16 v[36:39], v[112:115], v[148:151], v[36:39]
    ds_read_b64_tr_b16 v[96:97], v2 offset:20672
    ds_read_b64_tr_b16 v[98:99], v2 offset:23232
    s_add_u32 m0, s57, 5120
    s_add_u32 s29, s56, 1179648
    buffer_load_dwordx4 v8, s[48:51], s29 offen lds
    s_waitcnt lgkmcnt(6)
    v_mfma_f32_16x16x32_bf16 v[40:43], v[116:119], v[144:147], v[40:43]
    v_mfma_f32_16x16x32_bf16 v[44:47], v[116:119], v[148:151], v[44:47]
    ds_read_b64_tr_b16 v[100:101], v152 offset:20672
    ds_read_b64_tr_b16 v[102:103], v152 offset:23232
    s_waitcnt lgkmcnt(6)
    v_mfma_f32_16x16x32_bf16 v[48:51], v[120:123], v[144:147], v[48:51]
    v_mfma_f32_16x16x32_bf16 v[52:55], v[120:123], v[148:151], v[52:55]
    ds_read_b64_tr_b16 v[104:105], v2 offset:20736
    ds_read_b64_tr_b16 v[106:107], v2 offset:23296
    s_add_u32 m0, s57, 6144
    s_add_u32 s29, s56, 1198080
    buffer_load_dwordx4 v4, s[48:51], s29 offen lds
    s_waitcnt lgkmcnt(6)
    v_mfma_f32_16x16x32_bf16 v[56:59], v[124:127], v[144:147], v[56:59]
    v_mfma_f32_16x16x32_bf16 v[60:63], v[124:127], v[148:151], v[60:63]
    ds_read_b64_tr_b16 v[108:109], v152 offset:20736
    ds_read_b64_tr_b16 v[110:111], v152 offset:23296
    s_waitcnt lgkmcnt(6)
    v_mfma_f32_16x16x32_bf16 v[64:67], v[96:99], v[144:147], v[64:67]
    v_mfma_f32_16x16x32_bf16 v[68:71], v[96:99], v[148:151], v[68:71]
    ds_read_b64_tr_b16 v[112:113], v2 offset:30720
    ds_read_b64_tr_b16 v[114:115], v2 offset:33280
    s_add_u32 m0, s57, 7168
    s_add_u32 s29, s56, 1198080
    buffer_load_dwordx4 v5, s[48:51], s29 offen lds
    s_waitcnt lgkmcnt(6)
    v_mfma_f32_16x16x32_bf16 v[72:75], v[100:103], v[144:147], v[72:75]
    v_mfma_f32_16x16x32_bf16 v[76:79], v[100:103], v[148:151], v[76:79]
    ds_read_b64_tr_b16 v[116:117], v152 offset:30720
    ds_read_b64_tr_b16 v[118:119], v152 offset:33280
    s_waitcnt lgkmcnt(6)
    s_cmp_eq_u32 s62, 0
    s_cbranch_scc1 parallel_sum__softmax_full_mha__dense_activation_relu__prompt_kernel_sk29_0
    v_mfma_f32_16x16x32_bf16 v[80:83], v[104:107], v[144:147], v[80:83]
    v_mfma_f32_16x16x32_bf16 v[84:87], v[104:107], v[148:151], v[84:87]
parallel_sum__softmax_full_mha__dense_activation_relu__prompt_kernel_sk29_0:
    ds_read_b64_tr_b16 v[120:121], v2 offset:30784
    ds_read_b64_tr_b16 v[122:123], v2 offset:33344
    s_waitcnt lgkmcnt(6)
    s_cmp_eq_u32 s62, 0
    s_cbranch_scc1 parallel_sum__softmax_full_mha__dense_activation_relu__prompt_kernel_sk29_1
    v_mfma_f32_16x16x32_bf16 v[88:91], v[108:111], v[144:147], v[88:91]
    v_mfma_f32_16x16x32_bf16 v[92:95], v[108:111], v[148:151], v[92:95]
parallel_sum__softmax_full_mha__dense_activation_relu__prompt_kernel_sk29_1:
    ds_read_b64_tr_b16 v[124:125], v152 offset:30784
    ds_read_b64_tr_b16 v[126:127], v152 offset:33344
    s_add_u32 s29, s42, 63488
    buffer_load_dwordx4 v[136:139], v9, s[12:15], s29 offen sc1
    s_add_u32 s29, s42, 63488
    buffer_load_dwordx4 v[140:143], v14, s[12:15], s29 offen sc1
    s_waitcnt vmcnt(6)
    s_waitcnt lgkmcnt(6)
    v_mfma_f32_16x16x32_bf16 v[16:19], v[112:115], v[128:131], v[16:19]
    v_mfma_f32_16x16x32_bf16 v[20:23], v[112:115], v[132:135], v[20:23]
    ds_read_b64_tr_b16 v[96:97], v2 offset:30848
    ds_read_b64_tr_b16 v[98:99], v2 offset:33408
    s_add_u32 m0, s57, 8192
    s_add_u32 s29, s56, 1198080
    buffer_load_dwordx4 v6, s[48:51], s29 offen lds
    s_waitcnt lgkmcnt(6)
    v_mfma_f32_16x16x32_bf16 v[24:27], v[116:119], v[128:131], v[24:27]
    v_mfma_f32_16x16x32_bf16 v[28:31], v[116:119], v[132:135], v[28:31]
    ds_read_b64_tr_b16 v[100:101], v152 offset:30848
    ds_read_b64_tr_b16 v[102:103], v152 offset:33408
    s_waitcnt lgkmcnt(6)
    v_mfma_f32_16x16x32_bf16 v[32:35], v[120:123], v[128:131], v[32:35]
    v_mfma_f32_16x16x32_bf16 v[36:39], v[120:123], v[132:135], v[36:39]
    ds_read_b64_tr_b16 v[104:105], v2 offset:30912
    ds_read_b64_tr_b16 v[106:107], v2 offset:33472
    s_add_u32 m0, s57, 9216
    s_add_u32 s29, s56, 1198080
    buffer_load_dwordx4 v7, s[48:51], s29 offen lds
    s_waitcnt lgkmcnt(6)
    v_mfma_f32_16x16x32_bf16 v[40:43], v[124:127], v[128:131], v[40:43]
    v_mfma_f32_16x16x32_bf16 v[44:47], v[124:127], v[132:135], v[44:47]
    ds_read_b64_tr_b16 v[108:109], v152 offset:30912
    ds_read_b64_tr_b16 v[110:111], v152 offset:33472
    s_waitcnt lgkmcnt(6)
    v_mfma_f32_16x16x32_bf16 v[48:51], v[96:99], v[128:131], v[48:51]
    v_mfma_f32_16x16x32_bf16 v[52:55], v[96:99], v[132:135], v[52:55]
    ds_read_b64_tr_b16 v[112:113], v2 offset:30976
    ds_read_b64_tr_b16 v[114:115], v2 offset:33536
    s_add_u32 m0, s57, 10240
    s_add_u32 s29, s56, 1198080
    buffer_load_dwordx4 v8, s[48:51], s29 offen lds
    s_waitcnt lgkmcnt(6)
    v_mfma_f32_16x16x32_bf16 v[56:59], v[100:103], v[128:131], v[56:59]
    v_mfma_f32_16x16x32_bf16 v[60:63], v[100:103], v[132:135], v[60:63]
    ds_read_b64_tr_b16 v[116:117], v152 offset:30976
    ds_read_b64_tr_b16 v[118:119], v152 offset:33536
    s_waitcnt lgkmcnt(6)
    v_mfma_f32_16x16x32_bf16 v[64:67], v[104:107], v[128:131], v[64:67]
    v_mfma_f32_16x16x32_bf16 v[68:71], v[104:107], v[132:135], v[68:71]
    ds_read_b64_tr_b16 v[120:121], v2 offset:40960
    ds_read_b64_tr_b16 v[122:123], v2 offset:43520
    s_waitcnt lgkmcnt(6)
    v_mfma_f32_16x16x32_bf16 v[72:75], v[108:111], v[128:131], v[72:75]
    v_mfma_f32_16x16x32_bf16 v[76:79], v[108:111], v[132:135], v[76:79]
    ds_read_b64_tr_b16 v[124:125], v152 offset:40960
    ds_read_b64_tr_b16 v[126:127], v152 offset:43520
    s_waitcnt lgkmcnt(6)
    s_cmp_eq_u32 s62, 0
    s_cbranch_scc1 parallel_sum__softmax_full_mha__dense_activation_relu__prompt_kernel_sk30_0
    v_mfma_f32_16x16x32_bf16 v[80:83], v[112:115], v[128:131], v[80:83]
    v_mfma_f32_16x16x32_bf16 v[84:87], v[112:115], v[132:135], v[84:87]
parallel_sum__softmax_full_mha__dense_activation_relu__prompt_kernel_sk30_0:
    ds_read_b64_tr_b16 v[96:97], v2 offset:41024
    ds_read_b64_tr_b16 v[98:99], v2 offset:43584
    s_waitcnt lgkmcnt(6)
    s_cmp_eq_u32 s62, 0
    s_cbranch_scc1 parallel_sum__softmax_full_mha__dense_activation_relu__prompt_kernel_sk30_1
    v_mfma_f32_16x16x32_bf16 v[88:91], v[116:119], v[128:131], v[88:91]
    v_mfma_f32_16x16x32_bf16 v[92:95], v[116:119], v[132:135], v[92:95]
parallel_sum__softmax_full_mha__dense_activation_relu__prompt_kernel_sk30_1:
    ds_read_b64_tr_b16 v[100:101], v152 offset:41024
    ds_read_b64_tr_b16 v[102:103], v152 offset:43584
    s_add_u32 s29, s42, 65536
    buffer_load_dwordx4 v[144:147], v9, s[12:15], s29 offen sc1
    s_add_u32 s29, s42, 65536
    buffer_load_dwordx4 v[148:151], v14, s[12:15], s29 offen sc1
    s_waitcnt vmcnt(5)
    s_waitcnt lgkmcnt(6)
    v_mfma_f32_16x16x32_bf16 v[16:19], v[120:123], v[136:139], v[16:19]
    v_mfma_f32_16x16x32_bf16 v[20:23], v[120:123], v[140:143], v[20:23]
    ds_read_b64_tr_b16 v[104:105], v2 offset:41088
    ds_read_b64_tr_b16 v[106:107], v2 offset:43648
    s_waitcnt lgkmcnt(6)
    v_mfma_f32_16x16x32_bf16 v[24:27], v[124:127], v[136:139], v[24:27]
    v_mfma_f32_16x16x32_bf16 v[28:31], v[124:127], v[140:143], v[28:31]
    ds_read_b64_tr_b16 v[108:109], v152 offset:41088
    ds_read_b64_tr_b16 v[110:111], v152 offset:43648
    s_waitcnt lgkmcnt(6)
    v_mfma_f32_16x16x32_bf16 v[32:35], v[96:99], v[136:139], v[32:35]
    v_mfma_f32_16x16x32_bf16 v[36:39], v[96:99], v[140:143], v[36:39]
    ds_read_b64_tr_b16 v[112:113], v2 offset:41152
    ds_read_b64_tr_b16 v[114:115], v2 offset:43712
    s_waitcnt lgkmcnt(6)
    v_mfma_f32_16x16x32_bf16 v[40:43], v[100:103], v[136:139], v[40:43]
    v_mfma_f32_16x16x32_bf16 v[44:47], v[100:103], v[140:143], v[44:47]
    ds_read_b64_tr_b16 v[116:117], v152 offset:41152
    ds_read_b64_tr_b16 v[118:119], v152 offset:43712
    s_waitcnt lgkmcnt(6)
    v_mfma_f32_16x16x32_bf16 v[48:51], v[104:107], v[136:139], v[48:51]
    v_mfma_f32_16x16x32_bf16 v[52:55], v[104:107], v[140:143], v[52:55]
    ds_read_b64_tr_b16 v[120:121], v2 offset:41216
    ds_read_b64_tr_b16 v[122:123], v2 offset:43776
    s_waitcnt lgkmcnt(6)
    v_mfma_f32_16x16x32_bf16 v[56:59], v[108:111], v[136:139], v[56:59]
    v_mfma_f32_16x16x32_bf16 v[60:63], v[108:111], v[140:143], v[60:63]
    ds_read_b64_tr_b16 v[124:125], v152 offset:41216
    ds_read_b64_tr_b16 v[126:127], v152 offset:43776
    s_waitcnt lgkmcnt(6)
    v_mfma_f32_16x16x32_bf16 v[64:67], v[112:115], v[136:139], v[64:67]
    v_mfma_f32_16x16x32_bf16 v[68:71], v[112:115], v[140:143], v[68:71]
    s_waitcnt lgkmcnt(4)
    v_mfma_f32_16x16x32_bf16 v[72:75], v[116:119], v[136:139], v[72:75]
    v_mfma_f32_16x16x32_bf16 v[76:79], v[116:119], v[140:143], v[76:79]
    s_waitcnt lgkmcnt(2)
    s_cmp_eq_u32 s62, 0
    s_cbranch_scc1 parallel_sum__softmax_full_mha__dense_activation_relu__prompt_kernel_sk31_0
    v_mfma_f32_16x16x32_bf16 v[80:83], v[120:123], v[136:139], v[80:83]
    v_mfma_f32_16x16x32_bf16 v[84:87], v[120:123], v[140:143], v[84:87]
parallel_sum__softmax_full_mha__dense_activation_relu__prompt_kernel_sk31_0:
    s_waitcnt lgkmcnt(0)
    s_cmp_eq_u32 s62, 0
    s_cbranch_scc1 parallel_sum__softmax_full_mha__dense_activation_relu__prompt_kernel_sk31_1
    v_mfma_f32_16x16x32_bf16 v[88:91], v[124:127], v[136:139], v[88:91]
    v_mfma_f32_16x16x32_bf16 v[92:95], v[124:127], v[140:143], v[92:95]
parallel_sum__softmax_full_mha__dense_activation_relu__prompt_kernel_sk31_1:
    s_add_u32 s29, s42, 67584
    buffer_load_dwordx4 v[128:131], v9, s[12:15], s29 offen sc1
    s_add_u32 s29, s42, 67584
    buffer_load_dwordx4 v[132:135], v14, s[12:15], s29 offen sc1
    s_waitcnt vmcnt(4)
    s_barrier
    ds_read_b64_tr_b16 v[96:97], v3 offset:0
    ds_read_b64_tr_b16 v[98:99], v3 offset:2560
    ds_read_b64_tr_b16 v[100:101], v153 offset:0
    ds_read_b64_tr_b16 v[102:103], v153 offset:2560
    ds_read_b64_tr_b16 v[104:105], v3 offset:64
    ds_read_b64_tr_b16 v[106:107], v3 offset:2624
    ds_read_b64_tr_b16 v[108:109], v153 offset:64
    ds_read_b64_tr_b16 v[110:111], v153 offset:2624
    s_waitcnt vmcnt(2)
    s_waitcnt lgkmcnt(6)
    v_mfma_f32_16x16x32_bf16 v[16:19], v[96:99], v[144:147], v[16:19]
    v_mfma_f32_16x16x32_bf16 v[20:23], v[96:99], v[148:151], v[20:23]
    ds_read_b64_tr_b16 v[112:113], v3 offset:128
    ds_read_b64_tr_b16 v[114:115], v3 offset:2688
    s_waitcnt lgkmcnt(6)
    v_mfma_f32_16x16x32_bf16 v[24:27], v[100:103], v[144:147], v[24:27]
    v_mfma_f32_16x16x32_bf16 v[28:31], v[100:103], v[148:151], v[28:31]
    ds_read_b64_tr_b16 v[116:117], v153 offset:128
    ds_read_b64_tr_b16 v[118:119], v153 offset:2688
    s_waitcnt lgkmcnt(6)
    v_mfma_f32_16x16x32_bf16 v[32:35], v[104:107], v[144:147], v[32:35]
    v_mfma_f32_16x16x32_bf16 v[36:39], v[104:107], v[148:151], v[36:39]
    ds_read_b64_tr_b16 v[120:121], v3 offset:192
    ds_read_b64_tr_b16 v[122:123], v3 offset:2752
    s_waitcnt lgkmcnt(6)
    v_mfma_f32_16x16x32_bf16 v[40:43], v[108:111], v[144:147], v[40:43]
    v_mfma_f32_16x16x32_bf16 v[44:47], v[108:111], v[148:151], v[44:47]
    ds_read_b64_tr_b16 v[124:125], v153 offset:192
    ds_read_b64_tr_b16 v[126:127], v153 offset:2752
    s_waitcnt lgkmcnt(6)
    v_mfma_f32_16x16x32_bf16 v[48:51], v[112:115], v[144:147], v[48:51]
    v_mfma_f32_16x16x32_bf16 v[52:55], v[112:115], v[148:151], v[52:55]
    ds_read_b64_tr_b16 v[96:97], v3 offset:256
    ds_read_b64_tr_b16 v[98:99], v3 offset:2816
    s_waitcnt lgkmcnt(6)
    v_mfma_f32_16x16x32_bf16 v[56:59], v[116:119], v[144:147], v[56:59]
    v_mfma_f32_16x16x32_bf16 v[60:63], v[116:119], v[148:151], v[60:63]
    ds_read_b64_tr_b16 v[100:101], v153 offset:256
    ds_read_b64_tr_b16 v[102:103], v153 offset:2816
    s_waitcnt lgkmcnt(6)
    v_mfma_f32_16x16x32_bf16 v[64:67], v[120:123], v[144:147], v[64:67]
    v_mfma_f32_16x16x32_bf16 v[68:71], v[120:123], v[148:151], v[68:71]
    ds_read_b64_tr_b16 v[104:105], v3 offset:10240
    ds_read_b64_tr_b16 v[106:107], v3 offset:12800
    s_waitcnt lgkmcnt(6)
    v_mfma_f32_16x16x32_bf16 v[72:75], v[124:127], v[144:147], v[72:75]
    v_mfma_f32_16x16x32_bf16 v[76:79], v[124:127], v[148:151], v[76:79]
    ds_read_b64_tr_b16 v[108:109], v153 offset:10240
    ds_read_b64_tr_b16 v[110:111], v153 offset:12800
    s_waitcnt lgkmcnt(6)
    s_cmp_eq_u32 s62, 0
    s_cbranch_scc1 parallel_sum__softmax_full_mha__dense_activation_relu__prompt_kernel_sk32_0
    v_mfma_f32_16x16x32_bf16 v[80:83], v[96:99], v[144:147], v[80:83]
    v_mfma_f32_16x16x32_bf16 v[84:87], v[96:99], v[148:151], v[84:87]
parallel_sum__softmax_full_mha__dense_activation_relu__prompt_kernel_sk32_0:
    ds_read_b64_tr_b16 v[112:113], v3 offset:10304
    ds_read_b64_tr_b16 v[114:115], v3 offset:12864
    s_waitcnt lgkmcnt(6)
    s_cmp_eq_u32 s62, 0
    s_cbranch_scc1 parallel_sum__softmax_full_mha__dense_activation_relu__prompt_kernel_sk32_1
    v_mfma_f32_16x16x32_bf16 v[88:91], v[100:103], v[144:147], v[88:91]
    v_mfma_f32_16x16x32_bf16 v[92:95], v[100:103], v[148:151], v[92:95]
parallel_sum__softmax_full_mha__dense_activation_relu__prompt_kernel_sk32_1:
    ds_read_b64_tr_b16 v[116:117], v153 offset:10304
    ds_read_b64_tr_b16 v[118:119], v153 offset:12864
    s_add_u32 s29, s42, 69632
    buffer_load_dwordx4 v[136:139], v9, s[12:15], s29 offen sc1
    s_add_u32 s29, s42, 69632
    buffer_load_dwordx4 v[140:143], v14, s[12:15], s29 offen sc1
    s_waitcnt vmcnt(2)
    s_waitcnt lgkmcnt(6)
    v_mfma_f32_16x16x32_bf16 v[16:19], v[104:107], v[128:131], v[16:19]
    v_mfma_f32_16x16x32_bf16 v[20:23], v[104:107], v[132:135], v[20:23]
    ds_read_b64_tr_b16 v[120:121], v3 offset:10368
    ds_read_b64_tr_b16 v[122:123], v3 offset:12928
    s_waitcnt lgkmcnt(6)
    v_mfma_f32_16x16x32_bf16 v[24:27], v[108:111], v[128:131], v[24:27]
    v_mfma_f32_16x16x32_bf16 v[28:31], v[108:111], v[132:135], v[28:31]
    ds_read_b64_tr_b16 v[124:125], v153 offset:10368
    ds_read_b64_tr_b16 v[126:127], v153 offset:12928
    s_waitcnt lgkmcnt(6)
    v_mfma_f32_16x16x32_bf16 v[32:35], v[112:115], v[128:131], v[32:35]
    v_mfma_f32_16x16x32_bf16 v[36:39], v[112:115], v[132:135], v[36:39]
    ds_read_b64_tr_b16 v[96:97], v3 offset:10432
    ds_read_b64_tr_b16 v[98:99], v3 offset:12992
    s_waitcnt lgkmcnt(6)
    v_mfma_f32_16x16x32_bf16 v[40:43], v[116:119], v[128:131], v[40:43]
    v_mfma_f32_16x16x32_bf16 v[44:47], v[116:119], v[132:135], v[44:47]
    ds_read_b64_tr_b16 v[100:101], v153 offset:10432
    ds_read_b64_tr_b16 v[102:103], v153 offset:12992
    s_waitcnt lgkmcnt(6)
    v_mfma_f32_16x16x32_bf16 v[48:51], v[120:123], v[128:131], v[48:51]
    v_mfma_f32_16x16x32_bf16 v[52:55], v[120:123], v[132:135], v[52:55]
    ds_read_b64_tr_b16 v[104:105], v3 offset:10496
    ds_read_b64_tr_b16 v[106:107], v3 offset:13056
    s_waitcnt lgkmcnt(6)
    v_mfma_f32_16x16x32_bf16 v[56:59], v[124:127], v[128:131], v[56:59]
    v_mfma_f32_16x16x32_bf16 v[60:63], v[124:127], v[132:135], v[60:63]
    ds_read_b64_tr_b16 v[108:109], v153 offset:10496
    ds_read_b64_tr_b16 v[110:111], v153 offset:13056
    s_waitcnt lgkmcnt(6)
    v_mfma_f32_16x16x32_bf16 v[64:67], v[96:99], v[128:131], v[64:67]
    v_mfma_f32_16x16x32_bf16 v[68:71], v[96:99], v[132:135], v[68:71]
    ds_read_b64_tr_b16 v[112:113], v3 offset:20480
    ds_read_b64_tr_b16 v[114:115], v3 offset:23040
    s_waitcnt lgkmcnt(6)
    v_mfma_f32_16x16x32_bf16 v[72:75], v[100:103], v[128:131], v[72:75]
    v_mfma_f32_16x16x32_bf16 v[76:79], v[100:103], v[132:135], v[76:79]
    ds_read_b64_tr_b16 v[116:117], v153 offset:20480
    ds_read_b64_tr_b16 v[118:119], v153 offset:23040
    s_waitcnt lgkmcnt(6)
    s_cmp_eq_u32 s62, 0
    s_cbranch_scc1 parallel_sum__softmax_full_mha__dense_activation_relu__prompt_kernel_sk33_0
    v_mfma_f32_16x16x32_bf16 v[80:83], v[104:107], v[128:131], v[80:83]
    v_mfma_f32_16x16x32_bf16 v[84:87], v[104:107], v[132:135], v[84:87]
parallel_sum__softmax_full_mha__dense_activation_relu__prompt_kernel_sk33_0:
    ds_read_b64_tr_b16 v[120:121], v3 offset:20544
    ds_read_b64_tr_b16 v[122:123], v3 offset:23104
    s_waitcnt lgkmcnt(6)
    s_cmp_eq_u32 s62, 0
    s_cbranch_scc1 parallel_sum__softmax_full_mha__dense_activation_relu__prompt_kernel_sk33_1
    v_mfma_f32_16x16x32_bf16 v[88:91], v[108:111], v[128:131], v[88:91]
    v_mfma_f32_16x16x32_bf16 v[92:95], v[108:111], v[132:135], v[92:95]
parallel_sum__softmax_full_mha__dense_activation_relu__prompt_kernel_sk33_1:
    ds_read_b64_tr_b16 v[124:125], v153 offset:20544
    ds_read_b64_tr_b16 v[126:127], v153 offset:23104
    s_add_u32 s29, s42, 71680
    buffer_load_dwordx4 v[144:147], v9, s[12:15], s29 offen sc1
    s_add_u32 s29, s42, 71680
    buffer_load_dwordx4 v[148:151], v14, s[12:15], s29 offen sc1
    s_waitcnt vmcnt(2)
    s_waitcnt lgkmcnt(6)
    v_mfma_f32_16x16x32_bf16 v[16:19], v[112:115], v[136:139], v[16:19]
    v_mfma_f32_16x16x32_bf16 v[20:23], v[112:115], v[140:143], v[20:23]
    ds_read_b64_tr_b16 v[96:97], v3 offset:20608
    ds_read_b64_tr_b16 v[98:99], v3 offset:23168
    s_waitcnt lgkmcnt(6)
    v_mfma_f32_16x16x32_bf16 v[24:27], v[116:119], v[136:139], v[24:27]
    v_mfma_f32_16x16x32_bf16 v[28:31], v[116:119], v[140:143], v[28:31]
    ds_read_b64_tr_b16 v[100:101], v153 offset:20608
    ds_read_b64_tr_b16 v[102:103], v153 offset:23168
    s_waitcnt lgkmcnt(6)
    v_mfma_f32_16x16x32_bf16 v[32:35], v[120:123], v[136:139], v[32:35]
    v_mfma_f32_16x16x32_bf16 v[36:39], v[120:123], v[140:143], v[36:39]
    ds_read_b64_tr_b16 v[104:105], v3 offset:20672
    ds_read_b64_tr_b16 v[106:107], v3 offset:23232
    s_waitcnt lgkmcnt(6)
    v_mfma_f32_16x16x32_bf16 v[40:43], v[124:127], v[136:139], v[40:43]
    v_mfma_f32_16x16x32_bf16 v[44:47], v[124:127], v[140:143], v[44:47]
    ds_read_b64_tr_b16 v[108:109], v153 offset:20672
    ds_read_b64_tr_b16 v[110:111], v153 offset:23232
    s_waitcnt lgkmcnt(6)
    v_mfma_f32_16x16x32_bf16 v[48:51], v[96:99], v[136:139], v[48:51]
    v_mfma_f32_16x16x32_bf16 v[52:55], v[96:99], v[140:143], v[52:55]
    ds_read_b64_tr_b16 v[112:113], v3 offset:20736
    ds_read_b64_tr_b16 v[114:115], v3 offset:23296
    s_waitcnt lgkmcnt(6)
    v_mfma_f32_16x16x32_bf16 v[56:59], v[100:103], v[136:139], v[56:59]
    v_mfma_f32_16x16x32_bf16 v[60:63], v[100:103], v[140:143], v[60:63]
    ds_read_b64_tr_b16 v[116:117], v153 offset:20736
    ds_read_b64_tr_b16 v[118:119], v153 offset:23296
    s_waitcnt lgkmcnt(6)
    v_mfma_f32_16x16x32_bf16 v[64:67], v[104:107], v[136:139], v[64:67]
    v_mfma_f32_16x16x32_bf16 v[68:71], v[104:107], v[140:143], v[68:71]
    ds_read_b64_tr_b16 v[120:121], v3 offset:30720
    ds_read_b64_tr_b16 v[122:123], v3 offset:33280
    s_waitcnt lgkmcnt(6)
    v_mfma_f32_16x16x32_bf16 v[72:75], v[108:111], v[136:139], v[72:75]
    v_mfma_f32_16x16x32_bf16 v[76:79], v[108:111], v[140:143], v[76:79]
    ds_read_b64_tr_b16 v[124:125], v153 offset:30720
    ds_read_b64_tr_b16 v[126:127], v153 offset:33280
    s_waitcnt lgkmcnt(6)
    s_cmp_eq_u32 s62, 0
    s_cbranch_scc1 parallel_sum__softmax_full_mha__dense_activation_relu__prompt_kernel_sk34_0
    v_mfma_f32_16x16x32_bf16 v[80:83], v[112:115], v[136:139], v[80:83]
    v_mfma_f32_16x16x32_bf16 v[84:87], v[112:115], v[140:143], v[84:87]
parallel_sum__softmax_full_mha__dense_activation_relu__prompt_kernel_sk34_0:
    ds_read_b64_tr_b16 v[96:97], v3 offset:30784
    ds_read_b64_tr_b16 v[98:99], v3 offset:33344
    s_waitcnt lgkmcnt(6)
    s_cmp_eq_u32 s62, 0
    s_cbranch_scc1 parallel_sum__softmax_full_mha__dense_activation_relu__prompt_kernel_sk34_1
    v_mfma_f32_16x16x32_bf16 v[88:91], v[116:119], v[136:139], v[88:91]
    v_mfma_f32_16x16x32_bf16 v[92:95], v[116:119], v[140:143], v[92:95]
parallel_sum__softmax_full_mha__dense_activation_relu__prompt_kernel_sk34_1:
    ds_read_b64_tr_b16 v[100:101], v153 offset:30784
    ds_read_b64_tr_b16 v[102:103], v153 offset:33344
    s_waitcnt vmcnt(0)
    s_waitcnt lgkmcnt(6)
    v_mfma_f32_16x16x32_bf16 v[16:19], v[120:123], v[144:147], v[16:19]
    v_mfma_f32_16x16x32_bf16 v[20:23], v[120:123], v[148:151], v[20:23]
    ds_read_b64_tr_b16 v[104:105], v3 offset:30848
    ds_read_b64_tr_b16 v[106:107], v3 offset:33408
    s_waitcnt lgkmcnt(6)
    v_mfma_f32_16x16x32_bf16 v[24:27], v[124:127], v[144:147], v[24:27]
    v_mfma_f32_16x16x32_bf16 v[28:31], v[124:127], v[148:151], v[28:31]
    ds_read_b64_tr_b16 v[108:109], v153 offset:30848
    ds_read_b64_tr_b16 v[110:111], v153 offset:33408
    s_waitcnt lgkmcnt(6)
    v_mfma_f32_16x16x32_bf16 v[32:35], v[96:99], v[144:147], v[32:35]
    v_mfma_f32_16x16x32_bf16 v[36:39], v[96:99], v[148:151], v[36:39]
    ds_read_b64_tr_b16 v[112:113], v3 offset:30912
    ds_read_b64_tr_b16 v[114:115], v3 offset:33472
    s_waitcnt lgkmcnt(6)
    v_mfma_f32_16x16x32_bf16 v[40:43], v[100:103], v[144:147], v[40:43]
    v_mfma_f32_16x16x32_bf16 v[44:47], v[100:103], v[148:151], v[44:47]
    ds_read_b64_tr_b16 v[116:117], v153 offset:30912
    ds_read_b64_tr_b16 v[118:119], v153 offset:33472
    s_waitcnt lgkmcnt(6)
    v_mfma_f32_16x16x32_bf16 v[48:51], v[104:107], v[144:147], v[48:51]
    v_mfma_f32_16x16x32_bf16 v[52:55], v[104:107], v[148:151], v[52:55]
    ds_read_b64_tr_b16 v[120:121], v3 offset:30976
    ds_read_b64_tr_b16 v[122:123], v3 offset:33536
    s_waitcnt lgkmcnt(6)
    v_mfma_f32_16x16x32_bf16 v[56:59], v[108:111], v[144:147], v[56:59]
    v_mfma_f32_16x16x32_bf16 v[60:63], v[108:111], v[148:151], v[60:63]
    ds_read_b64_tr_b16 v[124:125], v153 offset:30976
    ds_read_b64_tr_b16 v[126:127], v153 offset:33536
    s_waitcnt lgkmcnt(6)
    v_mfma_f32_16x16x32_bf16 v[64:67], v[112:115], v[144:147], v[64:67]
    v_mfma_f32_16x16x32_bf16 v[68:71], v[112:115], v[148:151], v[68:71]
    s_waitcnt lgkmcnt(4)
    v_mfma_f32_16x16x32_bf16 v[72:75], v[116:119], v[144:147], v[72:75]
    v_mfma_f32_16x16x32_bf16 v[76:79], v[116:119], v[148:151], v[76:79]
    s_waitcnt lgkmcnt(2)
    s_cmp_eq_u32 s62, 0
    s_cbranch_scc1 parallel_sum__softmax_full_mha__dense_activation_relu__prompt_kernel_sk35_0
    v_mfma_f32_16x16x32_bf16 v[80:83], v[120:123], v[144:147], v[80:83]
    v_mfma_f32_16x16x32_bf16 v[84:87], v[120:123], v[148:151], v[84:87]
parallel_sum__softmax_full_mha__dense_activation_relu__prompt_kernel_sk35_0:
    s_waitcnt lgkmcnt(0)
    s_cmp_eq_u32 s62, 0
    s_cbranch_scc1 parallel_sum__softmax_full_mha__dense_activation_relu__prompt_kernel_sk35_1
    v_mfma_f32_16x16x32_bf16 v[88:91], v[124:127], v[144:147], v[88:91]
    v_mfma_f32_16x16x32_bf16 v[92:95], v[124:127], v[148:151], v[92:95]
parallel_sum__softmax_full_mha__dense_activation_relu__prompt_kernel_sk35_1:
    s_nop 7
    s_nop 7
    s_mul_i32 s43, s24, 2359296
    s_mul_i32 s44, s22, 36864
    s_add_u32 s43, s43, s44
    s_lshl_b32 s44, s25, 11
    s_add_u32 s43, s43, s44
    s_and_b32 s44, s23, 1
    s_mul_i32 s45, s24, 262144
    s_lshl_b32 s63, s22, 12
    s_add_u32 s45, s45, s63
    s_lshr_b32 s63, s23, 1
    s_lshl_b32 s63, s63, 11
    s_add_u32 s45, s45, s63
    s_add_u32 s45, s45, 9437184
    s_cmp_eq_u32 s44, 1
    s_cselect_b32 s45, s45, s43
    s_add_u32 s29, s45, 0
    v_cvt_pk_bf16_f32 v16, v16, v17
    v_cvt_pk_bf16_f32 v17, v18, v19
    buffer_store_dwordx2 v[16:17], v15, s[32:35], s29 offen offset:0 sc1
    v_cvt_pk_bf16_f32 v20, v20, v21
    v_cvt_pk_bf16_f32 v21, v22, v23
    buffer_store_dwordx2 v[20:21], v15, s[32:35], s29 offen offset:256 sc1
    s_add_u32 s29, s45, 1024
    v_cvt_pk_bf16_f32 v24, v24, v25
    v_cvt_pk_bf16_f32 v25, v26, v27
    buffer_store_dwordx2 v[24:25], v15, s[32:35], s29 offen offset:0 sc1
    v_cvt_pk_bf16_f32 v28, v28, v29
    v_cvt_pk_bf16_f32 v29, v30, v31
    buffer_store_dwordx2 v[28:29], v15, s[32:35], s29 offen offset:256 sc1
    s_add_u32 s29, s43, 2048
    v_cvt_pk_bf16_f32 v32, v32, v33
    v_cvt_pk_bf16_f32 v33, v34, v35
    buffer_store_dwordx2 v[32:33], v15, s[32:35], s29 offen offset:0 sc1
    v_cvt_pk_bf16_f32 v36, v36, v37
    v_cvt_pk_bf16_f32 v37, v38, v39
    buffer_store_dwordx2 v[36:37], v15, s[32:35], s29 offen offset:256 sc1
    s_add_u32 s29, s43, 3072
    v_cvt_pk_bf16_f32 v40, v40, v41
    v_cvt_pk_bf16_f32 v41, v42, v43
    buffer_store_dwordx2 v[40:41], v15, s[32:35], s29 offen offset:0 sc1
    v_cvt_pk_bf16_f32 v44, v44, v45
    v_cvt_pk_bf16_f32 v45, v46, v47
    buffer_store_dwordx2 v[44:45], v15, s[32:35], s29 offen offset:256 sc1
    s_add_u32 s29, s43, 4096
    v_cvt_pk_bf16_f32 v48, v48, v49
    v_cvt_pk_bf16_f32 v49, v50, v51
    buffer_store_dwordx2 v[48:49], v15, s[32:35], s29 offen offset:0 sc1
    v_cvt_pk_bf16_f32 v52, v52, v53
    v_cvt_pk_bf16_f32 v53, v54, v55
    buffer_store_dwordx2 v[52:53], v15, s[32:35], s29 offen offset:256 sc1
    s_add_u32 s29, s43, 5120
    v_cvt_pk_bf16_f32 v56, v56, v57
    v_cvt_pk_bf16_f32 v57, v58, v59
    buffer_store_dwordx2 v[56:57], v15, s[32:35], s29 offen offset:0 sc1
    v_cvt_pk_bf16_f32 v60, v60, v61
    v_cvt_pk_bf16_f32 v61, v62, v63
    buffer_store_dwordx2 v[60:61], v15, s[32:35], s29 offen offset:256 sc1
    s_add_u32 s29, s43, 6144
    v_cvt_pk_bf16_f32 v64, v64, v65
    v_cvt_pk_bf16_f32 v65, v66, v67
    buffer_store_dwordx2 v[64:65], v15, s[32:35], s29 offen offset:0 sc1
    v_cvt_pk_bf16_f32 v68, v68, v69
    v_cvt_pk_bf16_f32 v69, v70, v71
    buffer_store_dwordx2 v[68:69], v15, s[32:35], s29 offen offset:256 sc1
    s_add_u32 s29, s43, 7168
    v_cvt_pk_bf16_f32 v72, v72, v73
    v_cvt_pk_bf16_f32 v73, v74, v75
    buffer_store_dwordx2 v[72:73], v15, s[32:35], s29 offen offset:0 sc1
    v_cvt_pk_bf16_f32 v76, v76, v77
    v_cvt_pk_bf16_f32 v77, v78, v79
    buffer_store_dwordx2 v[76:77], v15, s[32:35], s29 offen offset:256 sc1
    s_add_u32 s29, s43, 8192
    v_cvt_pk_bf16_f32 v80, v80, v81
    v_cvt_pk_bf16_f32 v81, v82, v83
    buffer_store_dwordx2 v[80:81], v15, s[32:35], s29 offen offset:0 sc1
    v_cvt_pk_bf16_f32 v84, v84, v85
    v_cvt_pk_bf16_f32 v85, v86, v87
    buffer_store_dwordx2 v[84:85], v15, s[32:35], s29 offen offset:256 sc1
    s_add_u32 s29, s43, 9216
    v_cvt_pk_bf16_f32 v88, v88, v89
    v_cvt_pk_bf16_f32 v89, v90, v91
    buffer_store_dwordx2 v[88:89], v15, s[32:35], s29 offen offset:0 sc1
    v_cvt_pk_bf16_f32 v92, v92, v93
    v_cvt_pk_bf16_f32 v93, v94, v95
    buffer_store_dwordx2 v[92:93], v15, s[32:35], s29 offen offset:256 sc1
    s_barrier
    s_waitcnt vmcnt(0)
    s_branch parallel_sum__softmax_full_mha__dense_activation_relu__prompt_kernel_fin
parallel_sum__softmax_full_mha__dense_activation_relu__prompt_kernel_attn:
    v_lshlrev_b32 v1, 4, v0
    s_lshl_b32 s18, s17, 3
    s_lshl_b32 s19, s20, 1
    s_add_u32 s18, s18, s19
    s_mov_b32 s12, s6
    s_and_b32 s13, s7, 0xffff
    s_mov_b32 s14, 2359296
    s_mov_b32 s15, 0x20000
    s_add_u32 s32, s6, 7602176
    s_addc_u32 s33, s7, 0
    s_and_b32 s33, s33, 0xffff
    s_mov_b32 s34, 2359296
    s_mov_b32 s35, 0x20000
    v_and_b32 v5, 31, v0
    v_add_u32 v2, 104448, v1
    v_add_u32 v3, 112640, v3
    v_lshrrev_b32 v6, 5, v0
    v_mul_u32_u24 v6, 320, v6
    v_min_u32 v7, 19, v5
    v_lshlrev_b32 v7, 4, v7
    v_add_u32 v4, v6, v7
    v_add_u32 v4, 113664, v4
    v_mov_b32 v37, 0x3f80
    v_mov_b32 v38, 0
    v_mov_b32 v39, 0
    v_mov_b32 v45, 0x3f80
    v_mov_b32 v46, 0
    v_mov_b32 v47, 0
    v_mov_b32 v48, 0
    v_mov_b32 v49, 0
    v_mov_b32 v50, 0
    v_mov_b32 v51, 0
    v_mov_b32 v52, 0
    v_mov_b32 v53, 0
    v_mov_b32 v54, 0
    v_mov_b32 v55, 0
    v_mov_b32 v56, 0
    v_mov_b32 v57, 0
    v_mov_b32 v58, 0
    v_mov_b32 v59, 0
    v_mov_b32 v60, 0
    v_mov_b32 v61, 0
    v_mov_b32 v62, 0
    v_mov_b32 v63, 0
    v_mov_b32 v72, 0
    v_mov_b32 v73, 0
    v_mov_b32 v74, 0
    v_mov_b32 v75, 0
    v_mov_b32 v76, 0
    v_mov_b32 v77, 0
    v_mov_b32 v78, 0
    v_mov_b32 v79, 0
    v_mov_b32 v112, 0
    v_mov_b32 v128, 0
    v_mov_b32 v113, 0
    v_mov_b32 v129, 0
    v_mov_b32 v114, 0
    v_mov_b32 v130, 0
    v_mov_b32 v115, 0
    v_mov_b32 v131, 0
    v_mov_b32 v116, 0
    v_mov_b32 v132, 0
    v_mov_b32 v117, 0
    v_mov_b32 v133, 0
    v_mov_b32 v118, 0
    v_mov_b32 v134, 0
    v_mov_b32 v119, 0
    v_mov_b32 v135, 0
    v_mov_b32 v120, 0
    v_mov_b32 v136, 0
    v_mov_b32 v121, 0
    v_mov_b32 v137, 0
    v_mov_b32 v122, 0
    v_mov_b32 v138, 0
    v_mov_b32 v123, 0
    v_mov_b32 v139, 0
    v_mov_b32 v124, 0
    v_mov_b32 v140, 0
    v_mov_b32 v125, 0
    v_mov_b32 v141, 0
    v_mov_b32 v126, 0
    v_mov_b32 v142, 0
    v_mov_b32 v127, 0
    v_mov_b32 v143, 0
    s_waitcnt vmcnt(0)
    s_barrier
    ds_read_b128 v[32:35], v2
    ds_read_b32 v36, v3
    s_waitcnt lgkmcnt(0)
    v_mfma_f32_32x32x16_bf16 v[80:95], v[32:35], v[16:19], 0
    v_mfma_f32_32x32x16_bf16 v[96:111], v[32:35], v[24:27], 0
    v_mfma_f32_32x32x8_bf16 v[80:95], v[36:37], v[20:21], v[80:95]
    v_mfma_f32_32x32x8_bf16 v[96:111], v[36:37], v[28:29], v[96:111]
    s_nop 7
    s_nop 7
    v_max3_f32 v144, v80, v81, v82
    v_max3_f32 v144, v144, v83, v84
    v_max3_f32 v144, v144, v85, v86
    v_max3_f32 v144, v144, v87, v88
    v_max3_f32 v144, v144, v89, v90
    v_max3_f32 v144, v144, v91, v92
    v_max3_f32 v144, v144, v93, v94
    v_max_f32 v144, v144, v95
    v_mov_b32 v145, v144
    s_nop 1
    v_permlane32_swap_b32 v144, v145
    s_nop 1
    v_max_f32 v144, v144, v145
    v_add_f32 v144, 0x42be0000, v144
    s_mov_b32 exec_hi, 0
    v_cvt_pk_bf16_f32 v21, -v144, 0
    s_mov_b32 exec_hi, -1
    v_max3_f32 v146, v96, v97, v98
    v_max3_f32 v146, v146, v99, v100
    v_max3_f32 v146, v146, v101, v102
    v_max3_f32 v146, v146, v103, v104
    v_max3_f32 v146, v146, v105, v106
    v_max3_f32 v146, v146, v107, v108
    v_max3_f32 v146, v146, v109, v110
    v_max_f32 v146, v146, v111
    v_mov_b32 v147, v146
    s_nop 1
    v_permlane32_swap_b32 v146, v147
    s_nop 1
    v_max_f32 v146, v146, v147
    v_add_f32 v146, 0x42be0000, v146
    s_mov_b32 exec_hi, 0
    v_cvt_pk_bf16_f32 v29, -v146, 0
    s_mov_b32 exec_hi, -1
    s_nop 1
    v_mfma_f32_32x32x16_bf16 v[80:95], v[32:35], v[16:19], 0
    v_mfma_f32_32x32x8_bf16 v[80:95], v[36:37], v[20:21], v[80:95]
    s_mov_b32 s30, 0
    s_mov_b32 s27, 0
    s_nop 7
    s_nop 3
    .p2align 6
parallel_sum__softmax_full_mha__dense_activation_relu__prompt_kernel_loop:
    v_mfma_f32_32x32x16_bf16 v[128:143], v[56:59], v[72:75], v[128:143]
    ds_read_b128 v[40:43], v2 offset:1024
    ds_read_b32 v44, v3 offset:128
    v_cvt_pk_bf16_f32 v79, v110, v111
    v_exp_f32 v80, v80
    v_exp_f32 v81, v81
    v_mfma_f32_32x32x16_bf16 v[128:143], v[60:63], v[76:79], v[128:143]
    ds_read_b128 v[48:51], v4 offset:0
    ds_read_b128 v[52:55], v4 offset:640
    v_exp_f32 v82, v82
    v_exp_f32 v83, v83
    v_cvt_pk_bf16_f32 v64, v80, v81
    v_exp_f32 v84, v84
    v_cvt_pk_bf16_f32 v65, v82, v83
    v_exp_f32 v85, v85
    v_mfma_f32_32x32x16_bf16 v[96:111], v[32:35], v[24:27], 0
    v_exp_f32 v86, v86
    v_cvt_pk_bf16_f32 v66, v84, v85
    v_exp_f32 v87, v87
    v_exp_f32 v88, v88
    v_cvt_pk_bf16_f32 v67, v86, v87
    v_exp_f32 v89, v89
    v_exp_f32 v90, v90
    v_mfma_f32_32x32x8_bf16 v[96:111], v[36:37], v[28:29], v[96:111]
    v_cvt_pk_bf16_f32 v68, v88, v89
    v_exp_f32 v91, v91
    v_exp_f32 v92, v92
    v_cvt_pk_bf16_f32 v69, v90, v91
    v_exp_f32 v93, v93
    v_exp_f32 v94, v94
    v_cvt_pk_bf16_f32 v70, v92, v93
    v_exp_f32 v95, v95
    s_waitcnt lgkmcnt(0)
    v_mfma_f32_32x32x16_bf16 v[112:127], v[48:51], v[64:67], v[112:127]
    s_nop 0
    v_cvt_pk_bf16_f32 v71, v94, v95
    v_exp_f32 v96, v96
    v_exp_f32 v97, v97
    v_mfma_f32_32x32x16_bf16 v[112:127], v[52:55], v[68:71], v[112:127]
    v_exp_f32 v98, v98
    v_exp_f32 v99, v99
    v_cvt_pk_bf16_f32 v72, v96, v97
    v_exp_f32 v100, v100
    v_cvt_pk_bf16_f32 v73, v98, v99
    v_exp_f32 v101, v101
    v_mfma_f32_32x32x16_bf16 v[80:95], v[40:43], v[16:19], 0
    v_exp_f32 v102, v102
    v_cvt_pk_bf16_f32 v74, v100, v101
    v_exp_f32 v103, v103
    v_exp_f32 v104, v104
    v_cvt_pk_bf16_f32 v75, v102, v103
    v_exp_f32 v105, v105
    v_exp_f32 v106, v106
    v_mfma_f32_32x32x8_bf16 v[80:95], v[44:45], v[20:21], v[80:95]
    v_cvt_pk_bf16_f32 v76, v104, v105
    v_exp_f32 v107, v107
    v_exp_f32 v108, v108
    v_cvt_pk_bf16_f32 v77, v106, v107
    v_exp_f32 v109, v109
    v_exp_f32 v110, v110
    v_cvt_pk_bf16_f32 v78, v108, v109
    v_exp_f32 v111, v111
    v_mfma_f32_32x32x16_bf16 v[128:143], v[48:51], v[72:75], v[128:143]
    ds_read_b128 v[32:35], v2 offset:2048
    ds_read_b32 v36, v3 offset:256
    v_cvt_pk_bf16_f32 v79, v110, v111
    v_exp_f32 v80, v80
    v_exp_f32 v81, v81
    v_mfma_f32_32x32x16_bf16 v[128:143], v[52:55], v[76:79], v[128:143]
    ds_read_b128 v[56:59], v4 offset:1280
    ds_read_b128 v[60:63], v4 offset:1920
    v_exp_f32 v82, v82
    v_exp_f32 v83, v83
    v_cvt_pk_bf16_f32 v64, v80, v81
    v_exp_f32 v84, v84
    v_cvt_pk_bf16_f32 v65, v82, v83
    v_exp_f32 v85, v85
    v_mfma_f32_32x32x16_bf16 v[96:111], v[40:43], v[24:27], 0
    v_exp_f32 v86, v86
    v_cvt_pk_bf16_f32 v66, v84, v85
    v_exp_f32 v87, v87
    v_exp_f32 v88, v88
    v_cvt_pk_bf16_f32 v67, v86, v87
    v_exp_f32 v89, v89
    v_exp_f32 v90, v90
    v_mfma_f32_32x32x8_bf16 v[96:111], v[44:45], v[28:29], v[96:111]
    v_cvt_pk_bf16_f32 v68, v88, v89
    v_exp_f32 v91, v91
    v_exp_f32 v92, v92
    v_cvt_pk_bf16_f32 v69, v90, v91
    v_exp_f32 v93, v93
    v_exp_f32 v94, v94
    v_cvt_pk_bf16_f32 v70, v92, v93
    v_exp_f32 v95, v95
    s_waitcnt lgkmcnt(0)
    v_mfma_f32_32x32x16_bf16 v[112:127], v[56:59], v[64:67], v[112:127]
    s_nop 0
    v_cvt_pk_bf16_f32 v71, v94, v95
    v_exp_f32 v96, v96
    v_exp_f32 v97, v97
    v_mfma_f32_32x32x16_bf16 v[112:127], v[60:63], v[68:71], v[112:127]
    v_exp_f32 v98, v98
    v_exp_f32 v99, v99
    v_cvt_pk_bf16_f32 v72, v96, v97
    v_exp_f32 v100, v100
    v_cvt_pk_bf16_f32 v73, v98, v99
    v_exp_f32 v101, v101
    v_mfma_f32_32x32x16_bf16 v[80:95], v[32:35], v[16:19], 0
    v_exp_f32 v102, v102
    v_cvt_pk_bf16_f32 v74, v100, v101
    v_exp_f32 v103, v103
    v_exp_f32 v104, v104
    v_cvt_pk_bf16_f32 v75, v102, v103
    v_exp_f32 v105, v105
    v_exp_f32 v106, v106
    v_mfma_f32_32x32x8_bf16 v[80:95], v[36:37], v[20:21], v[80:95]
    v_cvt_pk_bf16_f32 v76, v104, v105
    v_exp_f32 v107, v107
    v_exp_f32 v108, v108
    v_cvt_pk_bf16_f32 v77, v106, v107
    v_exp_f32 v109, v109
    v_exp_f32 v110, v110
    v_cvt_pk_bf16_f32 v78, v108, v109
    v_exp_f32 v111, v111
    v_mfma_f32_32x32x16_bf16 v[128:143], v[56:59], v[72:75], v[128:143]
    ds_read_b128 v[40:43], v2 offset:3072
    ds_read_b32 v44, v3 offset:384
    v_cvt_pk_bf16_f32 v79, v110, v111
    v_exp_f32 v80, v80
    v_exp_f32 v81, v81
    v_mfma_f32_32x32x16_bf16 v[128:143], v[60:63], v[76:79], v[128:143]
    ds_read_b128 v[48:51], v4 offset:2560
    ds_read_b128 v[52:55], v4 offset:3200
    v_exp_f32 v82, v82
    v_exp_f32 v83, v83
    v_cvt_pk_bf16_f32 v64, v80, v81
    v_exp_f32 v84, v84
    v_cvt_pk_bf16_f32 v65, v82, v83
    v_exp_f32 v85, v85
    v_mfma_f32_32x32x16_bf16 v[96:111], v[32:35], v[24:27], 0
    v_exp_f32 v86, v86
    v_cvt_pk_bf16_f32 v66, v84, v85
    v_exp_f32 v87, v87
    v_exp_f32 v88, v88
    v_cvt_pk_bf16_f32 v67, v86, v87
    v_exp_f32 v89, v89
    v_exp_f32 v90, v90
    v_mfma_f32_32x32x8_bf16 v[96:111], v[36:37], v[28:29], v[96:111]
    v_cvt_pk_bf16_f32 v68, v88, v89
    v_exp_f32 v91, v91
    v_exp_f32 v92, v92
    v_cvt_pk_bf16_f32 v69, v90, v91
    v_exp_f32 v93, v93
    v_exp_f32 v94, v94
    v_cvt_pk_bf16_f32 v70, v92, v93
    v_exp_f32 v95, v95
    s_waitcnt lgkmcnt(0)
    v_mfma_f32_32x32x16_bf16 v[112:127], v[48:51], v[64:67], v[112:127]
    s_nop 0
    v_cvt_pk_bf16_f32 v71, v94, v95
    v_exp_f32 v96, v96
    v_exp_f32 v97, v97
    v_mfma_f32_32x32x16_bf16 v[112:127], v[52:55], v[68:71], v[112:127]
    v_exp_f32 v98, v98
    v_exp_f32 v99, v99
    v_cvt_pk_bf16_f32 v72, v96, v97
    v_exp_f32 v100, v100
    v_cvt_pk_bf16_f32 v73, v98, v99
    v_exp_f32 v101, v101
    v_mfma_f32_32x32x16_bf16 v[80:95], v[40:43], v[16:19], 0
    v_exp_f32 v102, v102
    v_cvt_pk_bf16_f32 v74, v100, v101
    v_exp_f32 v103, v103
    v_exp_f32 v104, v104
    v_cvt_pk_bf16_f32 v75, v102, v103
    v_exp_f32 v105, v105
    v_exp_f32 v106, v106
    v_mfma_f32_32x32x8_bf16 v[80:95], v[44:45], v[20:21], v[80:95]
    v_cvt_pk_bf16_f32 v76, v104, v105
    v_exp_f32 v107, v107
    v_exp_f32 v108, v108
    v_cvt_pk_bf16_f32 v77, v106, v107
    v_exp_f32 v109, v109
    v_exp_f32 v110, v110
    v_cvt_pk_bf16_f32 v78, v108, v109
    v_exp_f32 v111, v111
    v_mfma_f32_32x32x16_bf16 v[128:143], v[48:51], v[72:75], v[128:143]
    ds_read_b128 v[32:35], v2 offset:4096
    ds_read_b32 v36, v3 offset:512
    v_cvt_pk_bf16_f32 v79, v110, v111
    v_exp_f32 v80, v80
    v_exp_f32 v81, v81
    v_mfma_f32_32x32x16_bf16 v[128:143], v[52:55], v[76:79], v[128:143]
    ds_read_b128 v[56:59], v4 offset:3840
    ds_read_b128 v[60:63], v4 offset:4480
    v_exp_f32 v82, v82
    v_exp_f32 v83, v83
    v_cvt_pk_bf16_f32 v64, v80, v81
    v_exp_f32 v84, v84
    v_cvt_pk_bf16_f32 v65, v82, v83
    v_exp_f32 v85, v85
    v_mfma_f32_32x32x16_bf16 v[96:111], v[40:43], v[24:27], 0
    v_exp_f32 v86, v86
    v_cvt_pk_bf16_f32 v66, v84, v85
    v_exp_f32 v87, v87
    v_exp_f32 v88, v88
    v_cvt_pk_bf16_f32 v67, v86, v87
    v_exp_f32 v89, v89
    v_exp_f32 v90, v90
    v_mfma_f32_32x32x8_bf16 v[96:111], v[44:45], v[28:29], v[96:111]
    v_cvt_pk_bf16_f32 v68, v88, v89
    v_exp_f32 v91, v91
    v_exp_f32 v92, v92
    v_cvt_pk_bf16_f32 v69, v90, v91
    v_exp_f32 v93, v93
    v_exp_f32 v94, v94
    v_cvt_pk_bf16_f32 v70, v92, v93
    v_exp_f32 v95, v95
    s_waitcnt lgkmcnt(0)
    v_mfma_f32_32x32x16_bf16 v[112:127], v[56:59], v[64:67], v[112:127]
    s_nop 0
    v_cvt_pk_bf16_f32 v71, v94, v95
    v_exp_f32 v96, v96
    v_exp_f32 v97, v97
    v_mfma_f32_32x32x16_bf16 v[112:127], v[60:63], v[68:71], v[112:127]
    v_exp_f32 v98, v98
    v_exp_f32 v99, v99
    v_cvt_pk_bf16_f32 v72, v96, v97
    v_exp_f32 v100, v100
    v_cvt_pk_bf16_f32 v73, v98, v99
    v_exp_f32 v101, v101
    v_mfma_f32_32x32x16_bf16 v[80:95], v[32:35], v[16:19], 0
    v_exp_f32 v102, v102
    v_cvt_pk_bf16_f32 v74, v100, v101
    v_exp_f32 v103, v103
    v_exp_f32 v104, v104
    v_cvt_pk_bf16_f32 v75, v102, v103
    v_exp_f32 v105, v105
    v_exp_f32 v106, v106
    v_mfma_f32_32x32x8_bf16 v[80:95], v[36:37], v[20:21], v[80:95]
    v_cvt_pk_bf16_f32 v76, v104, v105
    v_exp_f32 v107, v107
    v_exp_f32 v108, v108
    v_cvt_pk_bf16_f32 v77, v106, v107
    v_exp_f32 v109, v109
    v_exp_f32 v110, v110
    v_cvt_pk_bf16_f32 v78, v108, v109
    v_exp_f32 v111, v111
    v_mfma_f32_32x32x16_bf16 v[128:143], v[56:59], v[72:75], v[128:143]
    ds_read_b128 v[40:43], v2 offset:5120
    ds_read_b32 v44, v3 offset:640
    v_cvt_pk_bf16_f32 v79, v110, v111
    v_exp_f32 v80, v80
    v_exp_f32 v81, v81
    v_mfma_f32_32x32x16_bf16 v[128:143], v[60:63], v[76:79], v[128:143]
    ds_read_b128 v[48:51], v4 offset:5120
    ds_read_b128 v[52:55], v4 offset:5760
    v_exp_f32 v82, v82
    v_exp_f32 v83, v83
    v_cvt_pk_bf16_f32 v64, v80, v81
    v_exp_f32 v84, v84
    v_cvt_pk_bf16_f32 v65, v82, v83
    v_exp_f32 v85, v85
    v_mfma_f32_32x32x16_bf16 v[96:111], v[32:35], v[24:27], 0
    v_exp_f32 v86, v86
    v_cvt_pk_bf16_f32 v66, v84, v85
    v_exp_f32 v87, v87
    v_exp_f32 v88, v88
    v_cvt_pk_bf16_f32 v67, v86, v87
    v_exp_f32 v89, v89
    v_exp_f32 v90, v90
    v_mfma_f32_32x32x8_bf16 v[96:111], v[36:37], v[28:29], v[96:111]
    v_cvt_pk_bf16_f32 v68, v88, v89
    v_exp_f32 v91, v91
    v_exp_f32 v92, v92
    v_cvt_pk_bf16_f32 v69, v90, v91
    v_exp_f32 v93, v93
    v_exp_f32 v94, v94
    v_cvt_pk_bf16_f32 v70, v92, v93
    v_exp_f32 v95, v95
    s_waitcnt lgkmcnt(0)
    v_mfma_f32_32x32x16_bf16 v[112:127], v[48:51], v[64:67], v[112:127]
    s_nop 0
    v_cvt_pk_bf16_f32 v71, v94, v95
    v_exp_f32 v96, v96
    v_exp_f32 v97, v97
    v_mfma_f32_32x32x16_bf16 v[112:127], v[52:55], v[68:71], v[112:127]
    v_exp_f32 v98, v98
    v_exp_f32 v99, v99
    v_cvt_pk_bf16_f32 v72, v96, v97
    v_exp_f32 v100, v100
    v_cvt_pk_bf16_f32 v73, v98, v99
    v_exp_f32 v101, v101
    v_mfma_f32_32x32x16_bf16 v[80:95], v[40:43], v[16:19], 0
    v_exp_f32 v102, v102
    v_cvt_pk_bf16_f32 v74, v100, v101
    v_exp_f32 v103, v103
    v_exp_f32 v104, v104
    v_cvt_pk_bf16_f32 v75, v102, v103
    v_exp_f32 v105, v105
    v_exp_f32 v106, v106
    v_mfma_f32_32x32x8_bf16 v[80:95], v[44:45], v[20:21], v[80:95]
    v_cvt_pk_bf16_f32 v76, v104, v105
    v_exp_f32 v107, v107
    v_exp_f32 v108, v108
    v_cvt_pk_bf16_f32 v77, v106, v107
    v_exp_f32 v109, v109
    v_exp_f32 v110, v110
    v_cvt_pk_bf16_f32 v78, v108, v109
    v_exp_f32 v111, v111
    v_mfma_f32_32x32x16_bf16 v[128:143], v[48:51], v[72:75], v[128:143]
    ds_read_b128 v[32:35], v2 offset:6144
    ds_read_b32 v36, v3 offset:768
    v_cvt_pk_bf16_f32 v79, v110, v111
    v_exp_f32 v80, v80
    v_exp_f32 v81, v81
    v_mfma_f32_32x32x16_bf16 v[128:143], v[52:55], v[76:79], v[128:143]
    ds_read_b128 v[56:59], v4 offset:6400
    ds_read_b128 v[60:63], v4 offset:7040
    v_exp_f32 v82, v82
    v_exp_f32 v83, v83
    v_cvt_pk_bf16_f32 v64, v80, v81
    v_exp_f32 v84, v84
    v_cvt_pk_bf16_f32 v65, v82, v83
    v_exp_f32 v85, v85
    v_mfma_f32_32x32x16_bf16 v[96:111], v[40:43], v[24:27], 0
    v_exp_f32 v86, v86
    v_cvt_pk_bf16_f32 v66, v84, v85
    v_exp_f32 v87, v87
    v_exp_f32 v88, v88
    v_cvt_pk_bf16_f32 v67, v86, v87
    v_exp_f32 v89, v89
    v_exp_f32 v90, v90
    v_mfma_f32_32x32x8_bf16 v[96:111], v[44:45], v[28:29], v[96:111]
    v_cvt_pk_bf16_f32 v68, v88, v89
    v_exp_f32 v91, v91
    v_exp_f32 v92, v92
    v_cvt_pk_bf16_f32 v69, v90, v91
    v_exp_f32 v93, v93
    v_exp_f32 v94, v94
    v_cvt_pk_bf16_f32 v70, v92, v93
    v_exp_f32 v95, v95
    s_waitcnt lgkmcnt(0)
    v_mfma_f32_32x32x16_bf16 v[112:127], v[56:59], v[64:67], v[112:127]
    s_nop 0
    v_cvt_pk_bf16_f32 v71, v94, v95
    v_exp_f32 v96, v96
    v_exp_f32 v97, v97
    v_mfma_f32_32x32x16_bf16 v[112:127], v[60:63], v[68:71], v[112:127]
    v_exp_f32 v98, v98
    v_exp_f32 v99, v99
    v_cvt_pk_bf16_f32 v72, v96, v97
    v_exp_f32 v100, v100
    v_cvt_pk_bf16_f32 v73, v98, v99
    v_exp_f32 v101, v101
    v_mfma_f32_32x32x16_bf16 v[80:95], v[32:35], v[16:19], 0
    v_exp_f32 v102, v102
    v_cvt_pk_bf16_f32 v74, v100, v101
    v_exp_f32 v103, v103
    v_exp_f32 v104, v104
    v_cvt_pk_bf16_f32 v75, v102, v103
    v_exp_f32 v105, v105
    v_exp_f32 v106, v106
    v_mfma_f32_32x32x8_bf16 v[80:95], v[36:37], v[20:21], v[80:95]
    v_cvt_pk_bf16_f32 v76, v104, v105
    v_exp_f32 v107, v107
    v_exp_f32 v108, v108
    v_cvt_pk_bf16_f32 v77, v106, v107
    v_exp_f32 v109, v109
    v_exp_f32 v110, v110
    v_cvt_pk_bf16_f32 v78, v108, v109
    v_exp_f32 v111, v111
    v_mfma_f32_32x32x16_bf16 v[128:143], v[56:59], v[72:75], v[128:143]
    ds_read_b128 v[40:43], v2 offset:7168
    ds_read_b32 v44, v3 offset:896
    v_cvt_pk_bf16_f32 v79, v110, v111
    v_exp_f32 v80, v80
    v_exp_f32 v81, v81
    v_mfma_f32_32x32x16_bf16 v[128:143], v[60:63], v[76:79], v[128:143]
    ds_read_b128 v[48:51], v4 offset:7680
    ds_read_b128 v[52:55], v4 offset:8320
    v_exp_f32 v82, v82
    v_exp_f32 v83, v83
    v_cvt_pk_bf16_f32 v64, v80, v81
    v_exp_f32 v84, v84
    v_cvt_pk_bf16_f32 v65, v82, v83
    v_exp_f32 v85, v85
    v_mfma_f32_32x32x16_bf16 v[96:111], v[32:35], v[24:27], 0
    v_exp_f32 v86, v86
    v_cvt_pk_bf16_f32 v66, v84, v85
    v_exp_f32 v87, v87
    v_exp_f32 v88, v88
    v_cvt_pk_bf16_f32 v67, v86, v87
    v_exp_f32 v89, v89
    v_exp_f32 v90, v90
    v_mfma_f32_32x32x8_bf16 v[96:111], v[36:37], v[28:29], v[96:111]
    v_cvt_pk_bf16_f32 v68, v88, v89
    v_exp_f32 v91, v91
    v_exp_f32 v92, v92
    v_cvt_pk_bf16_f32 v69, v90, v91
    v_exp_f32 v93, v93
    v_exp_f32 v94, v94
    v_cvt_pk_bf16_f32 v70, v92, v93
    v_exp_f32 v95, v95
    s_waitcnt lgkmcnt(0)
    v_mfma_f32_32x32x16_bf16 v[112:127], v[48:51], v[64:67], v[112:127]
    s_nop 0
    v_cvt_pk_bf16_f32 v71, v94, v95
    v_exp_f32 v96, v96
    v_exp_f32 v97, v97
    v_mfma_f32_32x32x16_bf16 v[112:127], v[52:55], v[68:71], v[112:127]
    v_exp_f32 v98, v98
    v_exp_f32 v99, v99
    v_cvt_pk_bf16_f32 v72, v96, v97
    v_exp_f32 v100, v100
    v_cvt_pk_bf16_f32 v73, v98, v99
    v_exp_f32 v101, v101
    v_mfma_f32_32x32x16_bf16 v[80:95], v[40:43], v[16:19], 0
    v_exp_f32 v102, v102
    v_cvt_pk_bf16_f32 v74, v100, v101
    v_exp_f32 v103, v103
    v_exp_f32 v104, v104
    v_cvt_pk_bf16_f32 v75, v102, v103
    v_exp_f32 v105, v105
    v_exp_f32 v106, v106
    v_mfma_f32_32x32x8_bf16 v[80:95], v[44:45], v[20:21], v[80:95]
    v_cvt_pk_bf16_f32 v76, v104, v105
    v_exp_f32 v107, v107
    v_exp_f32 v108, v108
    v_cvt_pk_bf16_f32 v77, v106, v107
    v_exp_f32 v109, v109
    v_exp_f32 v110, v110
    v_cvt_pk_bf16_f32 v78, v108, v109
    v_exp_f32 v111, v111
    s_barrier
    s_add_u32 s26, s27, 19456
    s_cmp_eq_u32 s26, 58368
    s_cselect_b32 s26, 0, s26
    s_sub_u32 s25, s26, s27
    v_add_u32 v2, s25, v2
    v_add_u32 v3, s25, v3
    v_mfma_f32_32x32x16_bf16 v[128:143], v[48:51], v[72:75], v[128:143]
    ds_read_b128 v[32:35], v2 offset:0
    ds_read_b32 v36, v3 offset:0
    v_cvt_pk_bf16_f32 v79, v110, v111
    v_exp_f32 v80, v80
    v_exp_f32 v81, v81
    v_mfma_f32_32x32x16_bf16 v[128:143], v[52:55], v[76:79], v[128:143]
    ds_read_b128 v[56:59], v4 offset:8960
    ds_read_b128 v[60:63], v4 offset:9600
    v_exp_f32 v82, v82
    v_exp_f32 v83, v83
    v_cvt_pk_bf16_f32 v64, v80, v81
    v_exp_f32 v84, v84
    v_cvt_pk_bf16_f32 v65, v82, v83
    v_exp_f32 v85, v85
    v_mfma_f32_32x32x16_bf16 v[96:111], v[40:43], v[24:27], 0
    v_exp_f32 v86, v86
    v_cvt_pk_bf16_f32 v66, v84, v85
    v_exp_f32 v87, v87
    v_exp_f32 v88, v88
    v_cvt_pk_bf16_f32 v67, v86, v87
    v_exp_f32 v89, v89
    v_exp_f32 v90, v90
    v_mfma_f32_32x32x8_bf16 v[96:111], v[44:45], v[28:29], v[96:111]
    v_cvt_pk_bf16_f32 v68, v88, v89
    v_exp_f32 v91, v91
    v_exp_f32 v92, v92
    v_cvt_pk_bf16_f32 v69, v90, v91
    v_exp_f32 v93, v93
    v_exp_f32 v94, v94
    v_cvt_pk_bf16_f32 v70, v92, v93
    v_exp_f32 v95, v95
    v_add_u32 v4, s25, v4
    s_mov_b32 s27, s26
    s_waitcnt lgkmcnt(0)
    v_mfma_f32_32x32x16_bf16 v[112:127], v[56:59], v[64:67], v[112:127]
    s_nop 0
    v_cvt_pk_bf16_f32 v71, v94, v95
    v_exp_f32 v96, v96
    v_exp_f32 v97, v97
    v_mfma_f32_32x32x16_bf16 v[112:127], v[60:63], v[68:71], v[112:127]
    v_exp_f32 v98, v98
    v_exp_f32 v99, v99
    v_cvt_pk_bf16_f32 v72, v96, v97
    v_exp_f32 v100, v100
    v_cvt_pk_bf16_f32 v73, v98, v99
    v_exp_f32 v101, v101
    v_mfma_f32_32x32x16_bf16 v[80:95], v[32:35], v[16:19], 0
    v_exp_f32 v102, v102
    v_cvt_pk_bf16_f32 v74, v100, v101
    v_exp_f32 v103, v103
    v_exp_f32 v104, v104
    v_cvt_pk_bf16_f32 v75, v102, v103
    v_exp_f32 v105, v105
    v_exp_f32 v106, v106
    v_mfma_f32_32x32x8_bf16 v[80:95], v[36:37], v[20:21], v[80:95]
    v_cvt_pk_bf16_f32 v76, v104, v105
    v_exp_f32 v107, v107
    v_exp_f32 v108, v108
    v_cvt_pk_bf16_f32 v77, v106, v107
    v_exp_f32 v109, v109
    v_exp_f32 v110, v110
    v_cvt_pk_bf16_f32 v78, v108, v109
    v_exp_f32 v111, v111
    s_add_u32 s30, s30, 1
    s_cmp_lt_u32 s30, 8
    s_cbranch_scc1 parallel_sum__softmax_full_mha__dense_activation_relu__prompt_kernel_loop
    s_nop 0
    v_cvt_pk_bf16_f32 v79, v110, v111
    s_nop 1
    v_mfma_f32_32x32x16_bf16 v[128:143], v[56:59], v[72:75], v[128:143]
    v_mfma_f32_32x32x16_bf16 v[128:143], v[60:63], v[76:79], v[128:143]
    s_nop 7
    s_nop 7
    s_mov_b64 s[28:29], 0
    v_mov_b32 v144, 0
    v_fma_f32 v144, v112, 0, v144
    v_fma_f32 v144, v113, 0, v144
    v_fma_f32 v144, v114, 0, v144
    v_fma_f32 v144, v115, 0, v144
    v_fma_f32 v144, v116, 0, v144
    v_fma_f32 v144, v117, 0, v144
    v_fma_f32 v144, v118, 0, v144
    v_fma_f32 v144, v119, 0, v144
    v_fma_f32 v144, v120, 0, v144
    v_fma_f32 v144, v121, 0, v144
    v_fma_f32 v144, v122, 0, v144
    v_mov_b32 v145, v122
    v_mov_b32 v146, v122
    v_cmp_u_f32 vcc, v144, v144
    s_nop 1
    s_or_b64 s[28:29], s[28:29], vcc
    v_permlane32_swap_b32 v145, v146
    s_nop 1
    v_cmp_nle_f32 vcc, 0xd800000, v145
    s_nop 1
    s_or_b64 s[28:29], s[28:29], vcc
    v_mov_b32 v144, 0
    v_fma_f32 v144, v128, 0, v144
    v_fma_f32 v144, v129, 0, v144
    v_fma_f32 v144, v130, 0, v144
    v_fma_f32 v144, v131, 0, v144
    v_fma_f32 v144, v132, 0, v144
    v_fma_f32 v144, v133, 0, v144
    v_fma_f32 v144, v134, 0, v144
    v_fma_f32 v144, v135, 0, v144
    v_fma_f32 v144, v136, 0, v144
    v_fma_f32 v144, v137, 0, v144
    v_fma_f32 v144, v138, 0, v144
    v_mov_b32 v145, v138
    v_mov_b32 v146, v138
    v_cmp_u_f32 vcc, v144, v144
    s_nop 1
    s_or_b64 s[28:29], s[28:29], vcc
    v_permlane32_swap_b32 v145, v146
    s_nop 1
    v_cmp_nle_f32 vcc, 0xd800000, v145
    s_nop 1
    s_or_b64 s[28:29], s[28:29], vcc
    s_cmp_eq_u64 s[28:29], 0
    s_cbranch_scc1 parallel_sum__softmax_full_mha__dense_activation_relu__prompt_kernel_norm
    s_add_u32 s8, s6, 2359296
    s_addc_u32 s9, s7, 0
    s_and_b32 s9, s9, 0xffff
    s_mov_b32 s10, 5242880
    s_mov_b32 s11, 0x20000
    v_and_b32 v5, 31, v0
    v_lshlrev_b32 v3, 2, v5
    v_lshrrev_b32 v6, 5, v0
    v_mul_u32_u24 v6, 320, v6
    v_min_u32 v7, 19, v5
    v_lshlrev_b32 v7, 4, v7
    v_add_u32 v4, v6, v7
    v_mov_b32 v37, 0x3f803f80
    v_mov_b32 v148, 0xff800000
    v_mov_b32 v149, 0xff800000
    s_mul_i32 s22, s16, 163840
    s_mov_b32 exec_hi, 0
    v_mov_b32 v21, 0
    v_mov_b32 v29, 0
    s_mov_b32 exec_hi, -1
    s_mov_b32 s30, 0
parallel_sum__softmax_full_mha__dense_activation_relu__prompt_kernel_slow1:
    s_lshr_b32 s23, s30, 3
    s_mul_i32 s23, s23, 20480
    s_add_u32 s23, s23, s22
    s_and_b32 s24, s30, 7
    s_lshl_b32 s25, s24, 10
    s_add_u32 s25, s25, s23
    s_lshl_b32 s26, s24, 7
    s_add_u32 s26, s26, s23
    s_add_u32 s26, s26, 8192
    s_mul_i32 s27, s24, 1280
    s_add_u32 s27, s27, s23
    s_add_u32 s27, s27, 9216
    buffer_load_dwordx4 v[32:35], v1, s[8:11], s25 offen sc1
    buffer_load_dword v36, v3, s[8:11], s26 offen sc1
    s_waitcnt vmcnt(0)
    v_mfma_f32_32x32x16_bf16 v[80:95], v[32:35], v[16:19], 0
    v_mfma_f32_32x32x16_bf16 v[96:111], v[32:35], v[24:27], 0
    v_mfma_f32_32x32x8_bf16 v[80:95], v[36:37], v[20:21], v[80:95]
    v_mfma_f32_32x32x8_bf16 v[96:111], v[36:37], v[28:29], v[96:111]
    s_nop 7
    s_nop 7
    s_nop 3
    v_max3_f32 v148, v148, v80, v81
    v_max3_f32 v148, v148, v82, v83
    v_max3_f32 v148, v148, v84, v85
    v_max3_f32 v148, v148, v86, v87
    v_max3_f32 v148, v148, v88, v89
    v_max3_f32 v148, v148, v90, v91
    v_max3_f32 v148, v148, v92, v93
    v_max3_f32 v148, v148, v94, v95
    v_max3_f32 v149, v149, v96, v97
    v_max3_f32 v149, v149, v98, v99
    v_max3_f32 v149, v149, v100, v101
    v_max3_f32 v149, v149, v102, v103
    v_max3_f32 v149, v149, v104, v105
    v_max3_f32 v149, v149, v106, v107
    v_max3_f32 v149, v149, v108, v109
    v_max3_f32 v149, v149, v110, v111
    s_add_u32 s30, s30, 1
    s_cmp_lt_u32 s30, 64
    s_cbranch_scc1 parallel_sum__softmax_full_mha__dense_activation_relu__prompt_kernel_slow1
    v_mov_b32 v144, v148
    s_nop 1
    v_permlane32_swap_b32 v148, v144
    s_nop 1
    v_max_f32 v148, v148, v144
    v_cvt_pk_bf16_f32 v144, v148, v148
    v_lshlrev_b32 v144, 16, v144
    v_sub_f32 v145, v148, v144
    s_mov_b32 exec_hi, 0
    v_cvt_pk_bf16_f32 v21, -v144, -v145
    s_mov_b32 exec_hi, -1
    v_mov_b32 v144, v149
    s_nop 1
    v_permlane32_swap_b32 v149, v144
    s_nop 1
    v_max_f32 v149, v149, v144
    v_cvt_pk_bf16_f32 v144, v149, v149
    v_lshlrev_b32 v144, 16, v144
    v_sub_f32 v145, v149, v144
    s_mov_b32 exec_hi, 0
    v_cvt_pk_bf16_f32 v29, -v144, -v145
    s_mov_b32 exec_hi, -1
    v_mov_b32 v112, 0
    v_mov_b32 v128, 0
    v_mov_b32 v113, 0
    v_mov_b32 v129, 0
    v_mov_b32 v114, 0
    v_mov_b32 v130, 0
    v_mov_b32 v115, 0
    v_mov_b32 v131, 0
    v_mov_b32 v116, 0
    v_mov_b32 v132, 0
    v_mov_b32 v117, 0
    v_mov_b32 v133, 0
    v_mov_b32 v118, 0
    v_mov_b32 v134, 0
    v_mov_b32 v119, 0
    v_mov_b32 v135, 0
    v_mov_b32 v120, 0
    v_mov_b32 v136, 0
    v_mov_b32 v121, 0
    v_mov_b32 v137, 0
    v_mov_b32 v122, 0
    v_mov_b32 v138, 0
    v_mov_b32 v123, 0
    v_mov_b32 v139, 0
    v_mov_b32 v124, 0
    v_mov_b32 v140, 0
    v_mov_b32 v125, 0
    v_mov_b32 v141, 0
    v_mov_b32 v126, 0
    v_mov_b32 v142, 0
    v_mov_b32 v127, 0
    v_mov_b32 v143, 0
    s_mov_b32 s30, 0
parallel_sum__softmax_full_mha__dense_activation_relu__prompt_kernel_slow2:
    s_lshr_b32 s23, s30, 3
    s_mul_i32 s23, s23, 20480
    s_add_u32 s23, s23, s22
    s_and_b32 s24, s30, 7
    s_lshl_b32 s25, s24, 10
    s_add_u32 s25, s25, s23
    s_lshl_b32 s26, s24, 7
    s_add_u32 s26, s26, s23
    s_add_u32 s26, s26, 8192
    s_mul_i32 s27, s24, 1280
    s_add_u32 s27, s27, s23
    s_add_u32 s27, s27, 9216
    buffer_load_dwordx4 v[32:35], v1, s[8:11], s25 offen sc1
    buffer_load_dword v36, v3, s[8:11], s26 offen sc1
    buffer_load_dwordx4 v[48:51], v4, s[8:11], s27 offen sc1
    buffer_load_dwordx4 v[52:55], v4, s[8:11], s27 offen offset:640 sc1
    s_waitcnt vmcnt(0)
    v_mfma_f32_32x32x16_bf16 v[80:95], v[32:35], v[16:19], 0
    v_mfma_f32_32x32x16_bf16 v[96:111], v[32:35], v[24:27], 0
    v_mfma_f32_32x32x8_bf16 v[80:95], v[36:37], v[20:21], v[80:95]
    v_mfma_f32_32x32x8_bf16 v[96:111], v[36:37], v[28:29], v[96:111]
    s_nop 7
    s_nop 7
    s_nop 3
    v_exp_f32 v80, v80
    v_exp_f32 v81, v81
    v_exp_f32 v82, v82
    v_exp_f32 v83, v83
    v_exp_f32 v84, v84
    v_exp_f32 v85, v85
    v_exp_f32 v86, v86
    v_exp_f32 v87, v87
    v_exp_f32 v88, v88
    v_exp_f32 v89, v89
    v_exp_f32 v90, v90
    v_exp_f32 v91, v91
    v_exp_f32 v92, v92
    v_exp_f32 v93, v93
    v_exp_f32 v94, v94
    v_exp_f32 v95, v95
    s_nop 0
    v_cvt_pk_bf16_f32 v64, v80, v81
    v_cvt_pk_bf16_f32 v65, v82, v83
    v_cvt_pk_bf16_f32 v66, v84, v85
    v_cvt_pk_bf16_f32 v67, v86, v87
    v_cvt_pk_bf16_f32 v68, v88, v89
    v_cvt_pk_bf16_f32 v69, v90, v91
    v_cvt_pk_bf16_f32 v70, v92, v93
    v_cvt_pk_bf16_f32 v71, v94, v95
    v_exp_f32 v96, v96
    v_exp_f32 v97, v97
    v_exp_f32 v98, v98
    v_exp_f32 v99, v99
    v_exp_f32 v100, v100
    v_exp_f32 v101, v101
    v_exp_f32 v102, v102
    v_exp_f32 v103, v103
    v_exp_f32 v104, v104
    v_exp_f32 v105, v105
    v_exp_f32 v106, v106
    v_exp_f32 v107, v107
    v_exp_f32 v108, v108
    v_exp_f32 v109, v109
    v_exp_f32 v110, v110
    v_exp_f32 v111, v111
    s_nop 0
    v_cvt_pk_bf16_f32 v72, v96, v97
    v_cvt_pk_bf16_f32 v73, v98, v99
    v_cvt_pk_bf16_f32 v74, v100, v101
    v_cvt_pk_bf16_f32 v75, v102, v103
    v_cvt_pk_bf16_f32 v76, v104, v105
    v_cvt_pk_bf16_f32 v77, v106, v107
    v_cvt_pk_bf16_f32 v78, v108, v109
    v_cvt_pk_bf16_f32 v79, v110, v111
    s_nop 1
    v_mfma_f32_32x32x16_bf16 v[112:127], v[48:51], v[64:67], v[112:127]
    v_mfma_f32_32x32x16_bf16 v[112:127], v[52:55], v[68:71], v[112:127]
    v_mfma_f32_32x32x16_bf16 v[128:143], v[48:51], v[72:75], v[128:143]
    v_mfma_f32_32x32x16_bf16 v[128:143], v[52:55], v[76:79], v[128:143]
    s_nop 7
    s_add_u32 s30, s30, 1
    s_cmp_lt_u32 s30, 64
    s_cbranch_scc1 parallel_sum__softmax_full_mha__dense_activation_relu__prompt_kernel_slow2
    s_nop 7
    s_nop 7
parallel_sum__softmax_full_mha__dense_activation_relu__prompt_kernel_norm:
    s_lshl_b32 s21, s18, 5
    s_add_u32 s21, s21, s16
    s_lshl_b32 s19, s21, 10
    s_lshl_b32 s21, s21, 7
    s_add_u32 s21, s21, 2097152
    v_lshrrev_b32 v146, 2, v1
    v_mov_b32 v144, v122
    v_mov_b32 v145, v122
    s_nop 1
    v_permlane32_swap_b32 v144, v145
    s_nop 1
    v_rcp_f32 v144, v144
    s_nop 0
    v_mul_f32 v112, v112, v144
    v_mul_f32 v113, v113, v144
    v_mul_f32 v114, v114, v144
    v_mul_f32 v115, v115, v144
    v_mul_f32 v116, v116, v144
    v_mul_f32 v117, v117, v144
    v_mul_f32 v118, v118, v144
    v_mul_f32 v119, v119, v144
    v_mul_f32 v120, v120, v144
    v_mul_f32 v121, v121, v144
    v_cvt_pk_bf16_f32 v112, v112, v113
    v_cvt_pk_bf16_f32 v113, v114, v115
    v_cvt_pk_bf16_f32 v114, v116, v117
    v_cvt_pk_bf16_f32 v115, v118, v119
    v_cvt_pk_bf16_f32 v116, v120, v121
    buffer_store_dwordx4 v[112:115], v1, s[32:35], s19 offen sc1
    s_mov_b32 exec_hi, 0
    buffer_store_dword v116, v146, s[32:35], s21 offen sc1
    s_mov_b32 exec_hi, -1
    s_add_u32 s19, s19, 32768
    s_add_u32 s21, s21, 4096
    v_mov_b32 v144, v138
    v_mov_b32 v145, v138
    s_nop 1
    v_permlane32_swap_b32 v144, v145
    s_nop 1
    v_rcp_f32 v144, v144
    s_nop 0
    v_mul_f32 v128, v128, v144
    v_mul_f32 v129, v129, v144
    v_mul_f32 v130, v130, v144
    v_mul_f32 v131, v131, v144
    v_mul_f32 v132, v132, v144
    v_mul_f32 v133, v133, v144
    v_mul_f32 v134, v134, v144
    v_mul_f32 v135, v135, v144
    v_mul_f32 v136, v136, v144
    v_mul_f32 v137, v137, v144
    v_cvt_pk_bf16_f32 v128, v128, v129
    v_cvt_pk_bf16_f32 v129, v130, v131
    v_cvt_pk_bf16_f32 v130, v132, v133
    v_cvt_pk_bf16_f32 v131, v134, v135
    v_cvt_pk_bf16_f32 v132, v136, v137
    buffer_store_dwordx4 v[128:131], v1, s[32:35], s19 offen sc1
    s_mov_b32 exec_hi, 0
    buffer_store_dword v132, v146, s[32:35], s21 offen sc1
    s_mov_b32 exec_hi, -1
    s_waitcnt vmcnt(0)
parallel_sum__softmax_full_mha__dense_activation_relu__prompt_kernel_fin:
    s_barrier
    s_cmp_eq_u32 s20, 4
    s_cbranch_scc0 parallel_sum__softmax_full_mha__dense_activation_relu__prompt_kernel_nosig
    s_add_u32 s92, s6, 39321600
    s_addc_u32 s93, s7, 0
    s_add_u32 s54, s17, 0
    s_lshl_b32 s54, s54, 7
    s_lshr_b32 s55, s22, 2
    s_add_u32 s55, s55, 8
    s_lshl_b32 s55, s55, 7
    v_mov_b32 v2, s54
    v_mov_b32 v3, s55
    v_mov_b32 v4, 1
    s_mov_b64 exec, 1
    global_atomic_add v2, v4, s[92:93] sc1
    global_atomic_add v3, v4, s[92:93] sc1
    s_mov_b64 exec, -1
parallel_sum__softmax_full_mha__dense_activation_relu__prompt_kernel_nosig:
    s_load_dwordx2 s[4:5], s[0:1], 0
    s_load_dwordx2 s[6:7], s[0:1], 64
    s_load_dwordx2 s[36:37], s[0:1], 16
    s_load_dwordx2 s[38:39], s[0:1], 48
    s_and_b32 s16, s2, 7
    s_lshr_b32 s17, s2, 3
    s_mul_i32 s18, s16, 63
    s_add_u32 s18, s18, 1
    s_lshr_b32 s18, s18, 1
    s_add_u32 s19, s16, 1
    s_mul_i32 s19, s19, 63
    s_add_u32 s19, s19, 1
    s_lshr_b32 s19, s19, 1
    s_add_u32 s18, s18, s17
    s_cmp_ge_u32 s18, s19
    s_cbranch_scc1 parallel_sum__softmax_full_mha__dense_activation_relu__prompt_kernel_p3end
    s_mul_i32 s21, s18, 7282
    s_lshr_b32 s21, s21, 16
    s_mul_i32 s22, s21, 9
    s_sub_u32 s22, s18, s22
    s_mul_i32 s23, s21, 3
    s_lshl_b32 s24, s21, 1
    s_add_u32 s24, s24, 8
    s_cmp_lt_u32 s21, 8
    s_cselect_b32 s23, s23, s24
    s_cselect_b32 s25, 3, 2
    v_lshrrev_b32 v2, 3, v0
    s_movk_i32 s27, 1152
    v_mul_lo_u32 v3, v2, s27
    v_bfe_u32 v4, v0, 4, 1
    v_bfe_u32 v5, v0, 2, 1
    v_xor_b32 v4, v4, v5
    v_lshlrev_b32 v4, 6, v4
    v_and_b32 v5, 3, v0
    v_lshlrev_b32 v5, 4, v5
    v_add3_u32 v3, v3, v4, v5
    v_lshlrev_b32 v1, 4, v0
    s_lshl_b32 s28, s22, 7
    s_mul_i32 s29, s20, 82944
    s_add_u32 s28, s28, s29
    s_mul_i32 s30, s20, 9216
    s_add_u32 s26, s23, s20
    s_waitcnt lgkmcnt(0)
    s_mov_b32 s44, s36
    s_and_b32 s45, s37, 0xffff
    s_mov_b32 s46, 663552
    s_mov_b32 s47, 0x20000
    s_add_u32 m0, s30, 0
    s_add_u32 s29, s28, 0
    buffer_load_dwordx4 v3, s[44:47], s29 offen lds
    s_add_u32 m0, s30, 1024
    s_add_u32 s29, s28, 9216
    buffer_load_dwordx4 v3, s[44:47], s29 offen lds
    s_add_u32 m0, s30, 2048
    s_add_u32 s29, s28, 18432
    buffer_load_dwordx4 v3, s[44:47], s29 offen lds
    s_add_u32 m0, s30, 3072
    s_add_u32 s29, s28, 27648
    buffer_load_dwordx4 v3, s[44:47], s29 offen lds
    s_add_u32 m0, s30, 4096
    s_add_u32 s29, s28, 36864
    buffer_load_dwordx4 v3, s[44:47], s29 offen lds
    s_add_u32 m0, s30, 5120
    s_add_u32 s29, s28, 46080
    buffer_load_dwordx4 v3, s[44:47], s29 offen lds
    s_add_u32 m0, s30, 6144
    s_add_u32 s29, s28, 55296
    buffer_load_dwordx4 v3, s[44:47], s29 offen lds
    s_add_u32 m0, s30, 7168
    s_add_u32 s29, s28, 64512
    buffer_load_dwordx4 v3, s[44:47], s29 offen lds
    s_add_u32 m0, s30, 8192
    s_add_u32 s29, s28, 73728
    buffer_load_dwordx4 v3, s[44:47], s29 offen lds
    s_cmp_ge_u32 s20, s25
    s_cbranch_scc1 parallel_sum__softmax_full_mha__dense_activation_relu__prompt_kernel_p3idle
    s_add_u32 s12, s6, 7602176
    s_addc_u32 s13, s7, 0
    s_and_b32 s13, s13, 0xffff
    s_mov_b32 s14, 2359296
    s_mov_b32 s15, 0x20000
    s_mov_b32 s8, s4
    s_and_b32 s9, s5, 0xffff
    s_mov_b32 s10, 2359296
    s_mov_b32 s11, 0x20000
    s_add_u32 s40, s6, 28835840
    s_addc_u32 s41, s7, 0
    s_and_b32 s41, s41, 0xffff
    s_mov_b32 s42, 10485760
    s_mov_b32 s43, 0x20000
    s_mov_b32 s48, s38
    s_and_b32 s49, s39, 0xffff
    s_mov_b32 s50, 2359296
    s_mov_b32 s51, 0x20000
    s_lshl_b32 s31, s20, 12
    s_add_u32 s31, s31, 73728
    s_mul_i32 s32, s26, 36864
    s_lshl_b32 s34, s22, 7
    s_add_u32 s32, s32, s34
    s_mul_i32 s35, s26, 36864
    s_lshl_b32 s34, s22, 12
    s_add_u32 s35, s35, s34
    s_lshl_b32 s33, s26, 15
    s_lshl_b32 s59, s26, 12
    s_add_u32 s59, s59, 2097152
    v_lshrrev_b32 v6, 1, v2
    v_and_b32 v7, 7, v0
    v_add_u32 v8, 0, v6
    v_and_b32 v8, 7, v8
    v_xor_b32 v8, v8, v7
    v_lshlrev_b32 v8, 4, v8
    v_mad_u32_u24 v8, v2, s27, v8
    s_add_u32 m0, s31, 0
    s_add_u32 s29, s32, 0
    buffer_load_dwordx4 v8, s[8:11], s29 offen lds
    v_add_u32 v8, 4, v6
    v_and_b32 v8, 7, v8
    v_xor_b32 v8, v8, v7
    v_lshlrev_b32 v8, 4, v8
    v_mad_u32_u24 v8, v2, s27, v8
    s_add_u32 m0, s31, 1024
    s_add_u32 s29, s32, 9216
    buffer_load_dwordx4 v8, s[8:11], s29 offen lds
    v_add_u32 v8, 8, v6
    v_and_b32 v8, 7, v8
    v_xor_b32 v8, v8, v7
    v_lshlrev_b32 v8, 4, v8
    v_mad_u32_u24 v8, v2, s27, v8
    s_add_u32 m0, s31, 2048
    s_add_u32 s29, s32, 18432
    buffer_load_dwordx4 v8, s[8:11], s29 offen lds
    v_add_u32 v8, 12, v6
    v_and_b32 v8, 7, v8
    v_xor_b32 v8, v8, v7
    v_lshlrev_b32 v8, 4, v8
    v_mad_u32_u24 v8, v2, s27, v8
    s_add_u32 m0, s31, 3072
    s_add_u32 s29, s32, 27648
    buffer_load_dwordx4 v8, s[8:11], s29 offen lds
    v_and_b32 v2, 15, v0
    v_lshrrev_b32 v3, 2, v2
    v_and_b32 v4, 3, v2
    v_lshlrev_b32 v4, 3, v4
    v_bfe_u32 v5, v0, 4, 1
    v_lshlrev_b32 v5, 5, v5
    v_add_u32 v4, v4, v5
    v_lshrrev_b32 v5, 5, v0
    v_lshrrev_b32 v6, 1, v3
    v_lshlrev_b32 v7, 6, v6
    v_lshlrev_b32 v8, 2, v5
    v_add_u32 v9, v8, v3
    v_lshlrev_b32 v9, 7, v9
    v_add3_u32 v10, v9, v4, v7
    v_xor_b32 v7, 64, v7
    v_add3_u32 v11, v9, v4, v7
    v_xor_b32 v7, 64, v7
    v_add_u32 v9, v8, v6
    v_mul_u32_u24 v9, 18, v9
    v_and_b32 v3, 1, v3
    v_add3_u32 v9, v9, v3, 16
    v_lshlrev_b32 v9, 7, v9
    v_add3_u32 v12, v9, v4, v7
    v_xor_b32 v7, 64, v7
    v_add3_u32 v13, v9, v4, v7
    v_add_u32 v14, 36864, v10
    v_add_u32 v15, 36864, v11
    v_and_b32 v2, 31, v0
    v_lshrrev_b32 v3, 5, v0
    v_lshlrev_b32 v3, 2, v3
    v_sub_u32 v2, v2, v3
    v_mov_b32 v4, 0x3f80
    v_mov_b32 v5, 0x3f800000
    v_cmp_eq_u32 vcc, 0, v2
    v_cmp_eq_u32 s[52:53], 1, v2
    s_nop 0
    v_cndmask_b32 v6, 0, v4, vcc
    v_cndmask_b32 v7, 0, v5, s[52:53]
    v_or_b32 v80, v6, v7
    v_cmp_eq_u32 vcc, 2, v2
    v_cmp_eq_u32 s[52:53], 3, v2
    s_nop 0
    v_cndmask_b32 v6, 0, v4, vcc
    v_cndmask_b32 v7, 0, v5, s[52:53]
    v_or_b32 v81, v6, v7
    v_cmp_eq_u32 vcc, 8, v2
    v_cmp_eq_u32 s[52:53], 9, v2
    s_nop 0
    v_cndmask_b32 v6, 0, v4, vcc
    v_cndmask_b32 v7, 0, v5, s[52:53]
    v_or_b32 v82, v6, v7
    v_cmp_eq_u32 vcc, 10, v2
    v_cmp_eq_u32 s[52:53], 11, v2
    s_nop 0
    v_cndmask_b32 v6, 0, v4, vcc
    v_cndmask_b32 v7, 0, v5, s[52:53]
    v_or_b32 v83, v6, v7
    v_cmp_eq_u32 vcc, 16, v2
    v_cmp_eq_u32 s[52:53], 17, v2
    s_nop 0
    v_cndmask_b32 v6, 0, v4, vcc
    v_cndmask_b32 v7, 0, v5, s[52:53]
    v_or_b32 v84, v6, v7
    v_cmp_eq_u32 vcc, 18, v2
    v_cmp_eq_u32 s[52:53], 19, v2
    s_nop 0
    v_cndmask_b32 v6, 0, v4, vcc
    v_cndmask_b32 v7, 0, v5, s[52:53]
    v_or_b32 v85, v6, v7
    v_cmp_eq_u32 vcc, 24, v2
    v_cmp_eq_u32 s[52:53], 25, v2
    s_nop 0
    v_cndmask_b32 v6, 0, v4, vcc
    v_cndmask_b32 v7, 0, v5, s[52:53]
    v_or_b32 v86, v6, v7
    v_cmp_eq_u32 vcc, 26, v2
    v_cmp_eq_u32 s[52:53], 27, v2
    s_nop 0
    v_cndmask_b32 v6, 0, v4, vcc
    v_cndmask_b32 v7, 0, v5, s[52:53]
    v_or_b32 v87, v6, v7
    s_add_u32 s92, s6, 39321600
    s_addc_u32 s93, s7, 0
    s_add_u32 s58, s23, s25
    s_sub_u32 s58, s58, 1
    s_lshr_b32 s54, s23, 3
    s_lshl_b32 s54, s54, 7
    s_lshr_b32 s55, s58, 3
    s_lshl_b32 s55, s55, 7
    s_lshr_b32 s56, s23, 2
    s_add_u32 s56, s56, 8
    s_lshl_b32 s56, s56, 7
    s_lshr_b32 s57, s58, 2
    s_add_u32 s57, s57, 8
    s_lshl_b32 s57, s57, 7
    s_cmp_eq_u32 s20, 0
    s_cbranch_scc0 parallel_sum__softmax_full_mha__dense_activation_relu__prompt_kernel_p3nopoll1
    s_mov_b32 s94, 65536
parallel_sum__softmax_full_mha__dense_activation_relu__prompt_kernel_poll_p3a:
    v_mov_b32 v2, s56
    global_load_dword v4, v2, s[92:93] sc1
    v_mov_b32 v2, s57
    global_load_dword v5, v2, s[92:93] sc1
    v_mov_b32 v2, s54
    global_load_dword v6, v2, s[92:93] sc1
    v_mov_b32 v2, s55
    global_load_dword v7, v2, s[92:93] sc1
    s_waitcnt vmcnt(0)
    v_readfirstlane_b32 s95, v4
    s_nop 0
    s_cmp_ge_u32 s95, 16
    s_cbranch_scc0 parallel_sum__softmax_full_mha__dense_activation_relu__prompt_kernel_again_p3a
    v_readfirstlane_b32 s95, v5
    s_nop 0
    s_cmp_ge_u32 s95, 16
    s_cbranch_scc0 parallel_sum__softmax_full_mha__dense_activation_relu__prompt_kernel_again_p3a
    v_readfirstlane_b32 s95, v6
    s_nop 0
    s_cmp_ge_u32 s95, 32
    s_cbranch_scc0 parallel_sum__softmax_full_mha__dense_activation_relu__prompt_kernel_again_p3a
    v_readfirstlane_b32 s95, v7
    s_nop 0
    s_cmp_ge_u32 s95, 32
    s_cbranch_scc0 parallel_sum__softmax_full_mha__dense_activation_relu__prompt_kernel_again_p3a
    s_branch parallel_sum__softmax_full_mha__dense_activation_relu__prompt_kernel_ok_p3a
parallel_sum__softmax_full_mha__dense_activation_relu__prompt_kernel_again_p3a:
    s_sub_u32 s94, s94, 1
    s_cmp_eq_u32 s94, 0
    s_cbranch_scc1 parallel_sum__softmax_full_mha__dense_activation_relu__prompt_kernel_ok_p3a
    s_sleep 2
    s_branch parallel_sum__softmax_full_mha__dense_activation_relu__prompt_kernel_poll_p3a
parallel_sum__softmax_full_mha__dense_activation_relu__prompt_kernel_ok_p3a:
parallel_sum__softmax_full_mha__dense_activation_relu__prompt_kernel_p3nopoll1:
    s_waitcnt vmcnt(0)
    s_barrier
    v_and_b32 v8, 31, v0
    v_lshlrev_b32 v8, 2, v8
    v_lshrrev_b32 v9, 5, v0
    v_lshlrev_b32 v9, 9, v9
    v_add_u32 v8, v8, v9
    s_add_u32 s29, s33, 0
    buffer_load_dwordx4 v[112:115], v1, s[12:15], s29 offen sc1
    s_add_u32 s29, s33, 1024
    buffer_load_dwordx4 v[116:119], v1, s[12:15], s29 offen sc1
    s_add_u32 s29, s33, 2048
    buffer_load_dwordx4 v[120:123], v1, s[12:15], s29 offen sc1
    s_add_u32 s29, s33, 3072
    buffer_load_dwordx4 v[124:127], v1, s[12:15], s29 offen sc1
    s_add_u32 s29, s33, 4096
    buffer_load_dwordx4 v[128:131], v1, s[12:15], s29 offen sc1
    s_add_u32 s29, s33, 5120
    buffer_load_dwordx4 v[132:135], v1, s[12:15], s29 offen sc1
    s_add_u32 s29, s33, 6144
    buffer_load_dwordx4 v[136:139], v1, s[12:15], s29 offen sc1
    s_add_u32 s29, s33, 7168
    buffer_load_dwordx4 v[140:143], v1, s[12:15], s29 offen sc1
    s_add_u32 s29, s33, 8192
    buffer_load_dwordx4 v[144:147], v1, s[12:15], s29 offen sc1
    s_add_u32 s29, s33, 9216
    buffer_load_dwordx4 v[148:151], v1, s[12:15], s29 offen sc1
    s_add_u32 s29, s33, 10240
    buffer_load_dwordx4 v[152:155], v1, s[12:15], s29 offen sc1
    s_add_u32 s29, s33, 11264
    buffer_load_dwordx4 v[156:159], v1, s[12:15], s29 offen sc1
    s_add_u32 s29, s33, 12288
    buffer_load_dwordx4 v[160:163], v1, s[12:15], s29 offen sc1
    s_add_u32 s29, s33, 13312
    buffer_load_dwordx4 v[164:167], v1, s[12:15], s29 offen sc1
    s_add_u32 s29, s33, 14336
    buffer_load_dwordx4 v[168:171], v1, s[12:15], s29 offen sc1
    s_add_u32 s29, s33, 15360
    buffer_load_dwordx4 v[172:175], v1, s[12:15], s29 offen sc1
    s_add_u32 s29, s33, 16384
    buffer_load_dwordx4 v[176:179], v1, s[12:15], s29 offen sc1
    s_add_u32 s29, s33, 17408
    buffer_load_dwordx4 v[180:183], v1, s[12:15], s29 offen sc1
    s_add_u32 s29, s33, 18432
    buffer_load_dwordx4 v[184:187], v1, s[12:15], s29 offen sc1
    s_add_u32 s29, s33, 19456
    buffer_load_dwordx4 v[188:191], v1, s[12:15], s29 offen sc1
    s_add_u32 s29, s33, 20480
    buffer_load_dwordx4 v[192:195], v1, s[12:15], s29 offen sc1
    s_add_u32 s29, s33, 21504
    buffer_load_dwordx4 v[196:199], v1, s[12:15], s29 offen sc1
    s_add_u32 s29, s33, 22528
    buffer_load_dwordx4 v[200:203], v1, s[12:15], s29 offen sc1
    s_add_u32 s29, s33, 23552
    buffer_load_dwordx4 v[204:207], v1, s[12:15], s29 offen sc1
    s_add_u32 s29, s33, 24576
    buffer_load_dwordx4 v[208:211], v1, s[12:15], s29 offen sc1
    s_add_u32 s29, s33, 25600
    buffer_load_dwordx4 v[212:215], v1, s[12:15], s29 offen sc1
    s_add_u32 s29, s33, 26624
    buffer_load_dwordx4 v[216:219], v1, s[12:15], s29 offen sc1
    s_add_u32 s29, s33, 27648
    buffer_load_dwordx4 v[220:223], v1, s[12:15], s29 offen sc1
    s_add_u32 s29, s33, 28672
    buffer_load_dwordx4 v[224:227], v1, s[12:15], s29 offen sc1
    s_add_u32 s29, s33, 29696
    buffer_load_dwordx4 v[228:231], v1, s[12:15], s29 offen sc1
    s_add_u32 s29, s33, 30720
    buffer_load_dwordx4 v[232:235], v1, s[12:15], s29 offen sc1
    s_add_u32 s29, s33, 31744
    buffer_load_dwordx4 v[236:239], v1, s[12:15], s29 offen sc1
    s_add_u32 s29, s59, 0
    buffer_load_dword v240, v8, s[12:15], s29 offen sc1
    s_add_u32 s29, s59, 128
    buffer_load_dword v241, v8, s[12:15], s29 offen sc1
    s_add_u32 s29, s59, 256
    buffer_load_dword v242, v8, s[12:15], s29 offen sc1
    s_add_u32 s29, s59, 384
    buffer_load_dword v243, v8, s[12:15], s29 offen sc1
    s_add_u32 s29, s59, 1024
    buffer_load_dword v244, v8, s[12:15], s29 offen sc1
    s_add_u32 s29, s59, 1152
    buffer_load_dword v245, v8, s[12:15], s29 offen sc1
    s_add_u32 s29, s59, 1280
    buffer_load_dword v246, v8, s[12:15], s29 offen sc1
    s_add_u32 s29, s59, 1408
    buffer_load_dword v247, v8, s[12:15], s29 offen sc1
    s_add_u32 s29, s59, 2048
    buffer_load_dword v248, v8, s[12:15], s29 offen sc1
    s_add_u32 s29, s59, 2176
    buffer_load_dword v249, v8, s[12:15], s29 offen sc1
    s_add_u32 s29, s59, 2304
    buffer_load_dword v250, v8, s[12:15], s29 offen sc1
    s_add_u32 s29, s59, 2432
    buffer_load_dword v251, v8, s[12:15], s29 offen sc1
    s_add_u32 s29, s59, 3072
    buffer_load_dword v252, v8, s[12:15], s29 offen sc1
    s_add_u32 s29, s59, 3200
    buffer_load_dword v253, v8, s[12:15], s29 offen sc1
    s_add_u32 s29, s59, 3328
    buffer_load_dword v254, v8, s[12:15], s29 offen sc1
    s_add_u32 s29, s59, 3456
    buffer_load_dword v255, v8, s[12:15], s29 offen sc1
    ds_read_b64_tr_b16 v[48:49], v10 offset:0
    ds_read_b64_tr_b16 v[50:51], v10 offset:1024
    ds_read_b64_tr_b16 v[52:53], v11 offset:0
    ds_read_b64_tr_b16 v[54:55], v11 offset:1024
    ds_read_b64_tr_b16 v[56:57], v11 offset:2304
    ds_read_b64_tr_b16 v[58:59], v11 offset:3328
    ds_read_b64_tr_b16 v[60:61], v10 offset:2304
    ds_read_b64_tr_b16 v[62:63], v10 offset:3328
    ds_read_b64_tr_b16 v[64:65], v10 offset:4608
    ds_read_b64_tr_b16 v[66:67], v10 offset:5632
    s_waitcnt vmcnt(47)
    s_waitcnt lgkmcnt(8)
    v_mfma_f32_32x32x16_bf16 v[16:31], v[48:51], v[112:115], 0
    ds_read_b64_tr_b16 v[68:69], v11 offset:4608
    ds_read_b64_tr_b16 v[70:71], v11 offset:5632
    s_waitcnt lgkmcnt(8)
    v_mfma_f32_32x32x16_bf16 v[32:47], v[52:55], v[112:115], 0
    ds_read_b64_tr_b16 v[72:73], v11 offset:6912
    ds_read_b64_tr_b16 v[74:75], v11 offset:7936
    s_waitcnt vmcnt(46)
    s_waitcnt lgkmcnt(8)
    v_mfma_f32_32x32x16_bf16 v[16:31], v[56:59], v[116:119], v[16:31]
    ds_read_b64_tr_b16 v[76:77], v10 offset:6912
    ds_read_b64_tr_b16 v[78:79], v10 offset:7936
    s_waitcnt lgkmcnt(8)
    v_mfma_f32_32x32x16_bf16 v[32:47], v[60:63], v[116:119], v[32:47]
    ds_read_b64_tr_b16 v[48:49], v10 offset:9216
    ds_read_b64_tr_b16 v[50:51], v10 offset:10240
    s_waitcnt vmcnt(45)
    s_waitcnt lgkmcnt(8)
    v_mfma_f32_32x32x16_bf16 v[16:31], v[64:67], v[120:123], v[16:31]
    ds_read_b64_tr_b16 v[52:53], v11 offset:9216
    ds_read_b64_tr_b16 v[54:55], v11 offset:10240
    s_waitcnt lgkmcnt(8)
    v_mfma_f32_32x32x16_bf16 v[32:47], v[68:71], v[120:123], v[32:47]
    ds_read_b64_tr_b16 v[56:57], v11 offset:11520
    ds_read_b64_tr_b16 v[58:59], v11 offset:12544
    s_add_u32 s29, s35, 0
    buffer_load_dwordx4 v[112:115], v1, s[40:43], s29 offen sc1
    s_waitcnt vmcnt(45)
    s_waitcnt lgkmcnt(8)
    v_mfma_f32_32x32x16_bf16 v[16:31], v[72:75], v[124:127], v[16:31]
    ds_read_b64_tr_b16 v[60:61], v10 offset:11520
    ds_read_b64_tr_b16 v[62:63], v10 offset:12544
    s_waitcnt lgkmcnt(8)
    v_mfma_f32_32x32x16_bf16 v[32:47], v[76:79], v[124:127], v[32:47]
    ds_read_b64_tr_b16 v[64:65], v10 offset:13824
    ds_read_b64_tr_b16 v[66:67], v10 offset:14848
    s_add_u32 s29, s35, 1024
    buffer_load_dwordx4 v[116:119], v1, s[40:43], s29 offen sc1
    s_waitcnt vmcnt(45)
    s_waitcnt lgkmcnt(8)
    v_mfma_f32_32x32x16_bf16 v[16:31], v[48:51], v[128:131], v[16:31]
    ds_read_b64_tr_b16 v[68:69], v11 offset:13824
    ds_read_b64_tr_b16 v[70:71], v11 offset:14848
    s_waitcnt lgkmcnt(8)
    v_mfma_f32_32x32x16_bf16 v[32:47], v[52:55], v[128:131], v[32:47]
    ds_read_b64_tr_b16 v[72:73], v11 offset:16128
    ds_read_b64_tr_b16 v[74:75], v11 offset:17152
    s_add_u32 s29, s35, 2048
    buffer_load_dwordx4 v[120:123], v1, s[40:43], s29 offen sc1
    s_waitcnt vmcnt(45)
    s_waitcnt lgkmcnt(8)
    v_mfma_f32_32x32x16_bf16 v[16:31], v[56:59], v[132:135], v[16:31]
    ds_read_b64_tr_b16 v[76:77], v10 offset:16128
    ds_read_b64_tr_b16 v[78:79], v10 offset:17152
    s_waitcnt lgkmcnt(8)
    v_mfma_f32_32x32x16_bf16 v[32:47], v[60:63], v[132:135], v[32:47]
    ds_read_b64_tr_b16 v[48:49], v10 offset:18432
    ds_read_b64_tr_b16 v[50:51], v10 offset:19456
    s_add_u32 s29, s35, 3072
    buffer_load_dwordx4 v[124:127], v1, s[40:43], s29 offen sc1
    s_waitcnt vmcnt(45)
    s_waitcnt lgkmcnt(8)
    v_mfma_f32_32x32x16_bf16 v[16:31], v[64:67], v[136:139], v[16:31]
    ds_read_b64_tr_b16 v[52:53], v11 offset:18432
    ds_read_b64_tr_b16 v[54:55], v11 offset:19456
    s_waitcnt lgkmcnt(8)
    v_mfma_f32_32x32x16_bf16 v[32:47], v[68:71], v[136:139], v[32:47]
    ds_read_b64_tr_b16 v[56:57], v11 offset:20736
    ds_read_b64_tr_b16 v[58:59], v11 offset:21760
    s_add_u32 s29, s35, 2359296
    buffer_load_dwordx4 v[128:131], v1, s[40:43], s29 offen sc1
    s_waitcnt vmcnt(45)
    s_waitcnt lgkmcnt(8)
    v_mfma_f32_32x32x16_bf16 v[16:31], v[72:75], v[140:143], v[16:31]
    ds_read_b64_tr_b16 v[60:61], v10 offset:20736
    ds_read_b64_tr_b16 v[62:63], v10 offset:21760
    s_waitcnt lgkmcnt(8)
    v_mfma_f32_32x32x16_bf16 v[32:47], v[76:79], v[140:143], v[32:47]
    ds_read_b64_tr_b16 v[64:65], v10 offset:23040
    ds_read_b64_tr_b16 v[66:67], v10 offset:24064
    s_add_u32 s29, s35, 2360320
    buffer_load_dwordx4 v[132:135], v1, s[40:43], s29 offen sc1
    s_waitcnt vmcnt(45)
    s_waitcnt lgkmcnt(8)
    v_mfma_f32_32x32x16_bf16 v[16:31], v[48:51], v[144:147], v[16:31]
    ds_read_b64_tr_b16 v[68:69], v11 offset:23040
    ds_read_b64_tr_b16 v[70:71], v11 offset:24064
    s_waitcnt lgkmcnt(8)
    v_mfma_f32_32x32x16_bf16 v[32:47], v[52:55], v[144:147], v[32:47]
    ds_read_b64_tr_b16 v[72:73], v11 offset:25344
    ds_read_b64_tr_b16 v[74:75], v11 offset:26368
    s_add_u32 s29, s35, 2361344
    buffer_load_dwordx4 v[136:139], v1, s[40:43], s29 offen sc1
    s_waitcnt vmcnt(45)
    s_waitcnt lgkmcnt(8)
    v_mfma_f32_32x32x16_bf16 v[16:31], v[56:59], v[148:151], v[16:31]
    ds_read_b64_tr_b16 v[76:77], v10 offset:25344
    ds_read_b64_tr_b16 v[78:79], v10 offset:26368
    s_waitcnt lgkmcnt(8)
    v_mfma_f32_32x32x16_bf16 v[32:47], v[60:63], v[148:151], v[32:47]
    ds_read_b64_tr_b16 v[48:49], v10 offset:27648
    ds_read_b64_tr_b16 v[50:51], v10 offset:28672
    s_add_u32 s29, s35, 2362368
    buffer_load_dwordx4 v[140:143], v1, s[40:43], s29 offen sc1
    s_waitcnt vmcnt(45)
    s_waitcnt lgkmcnt(8)
    v_mfma_f32_32x32x16_bf16 v[16:31], v[64:67], v[152:155], v[16:31]
    ds_read_b64_tr_b16 v[52:53], v11 offset:27648
    ds_read_b64_tr_b16 v[54:55], v11 offset:28672
    s_waitcnt lgkmcnt(8)
    v_mfma_f32_32x32x16_bf16 v[32:47], v[68:71], v[152:155], v[32:47]
    ds_read_b64_tr_b16 v[56:57], v11 offset:29952
    ds_read_b64_tr_b16 v[58:59], v11 offset:30976
    s_add_u32 s29, s35, 4718592
    buffer_load_dwordx4 v[144:147], v1, s[40:43], s29 offen sc1
    s_waitcnt vmcnt(45)
    s_waitcnt lgkmcnt(8)
    v_mfma_f32_32x32x16_bf16 v[16:31], v[72:75], v[156:159], v[16:31]
    ds_read_b64_tr_b16 v[60:61], v10 offset:29952
    ds_read_b64_tr_b16 v[62:63], v10 offset:30976
    s_waitcnt lgkmcnt(8)
    v_mfma_f32_32x32x16_bf16 v[32:47], v[76:79], v[156:159], v[32:47]
    ds_read_b64_tr_b16 v[64:65], v10 offset:32256
    ds_read_b64_tr_b16 v[66:67], v10 offset:33280
    s_add_u32 s29, s35, 4719616
    buffer_load_dwordx4 v[148:151], v1, s[40:43], s29 offen sc1
    s_waitcnt vmcnt(45)
    s_waitcnt lgkmcnt(8)
    v_mfma_f32_32x32x16_bf16 v[16:31], v[48:51], v[160:163], v[16:31]
    ds_read_b64_tr_b16 v[68:69], v11 offset:32256
    ds_read_b64_tr_b16 v[70:71], v11 offset:33280
    s_waitcnt lgkmcnt(8)
    v_mfma_f32_32x32x16_bf16 v[32:47], v[52:55], v[160:163], v[32:47]
    ds_read_b64_tr_b16 v[72:73], v11 offset:34560
    ds_read_b64_tr_b16 v[74:75], v11 offset:35584
    s_add_u32 s29, s35, 4720640
    buffer_load_dwordx4 v[152:155], v1, s[40:43], s29 offen sc1
    s_waitcnt vmcnt(45)
    s_waitcnt lgkmcnt(8)
    v_mfma_f32_32x32x16_bf16 v[16:31], v[56:59], v[164:167], v[16:31]
    ds_read_b64_tr_b16 v[76:77], v10 offset:34560
    ds_read_b64_tr_b16 v[78:79], v10 offset:35584
    s_waitcnt lgkmcnt(8)
    v_mfma_f32_32x32x16_bf16 v[32:47], v[60:63], v[164:167], v[32:47]
    ds_read_b64_tr_b16 v[48:49], v14 offset:0
    ds_read_b64_tr_b16 v[50:51], v14 offset:1024
    s_add_u32 s29, s35, 4721664
    buffer_load_dwordx4 v[156:159], v1, s[40:43], s29 offen sc1
    s_waitcnt vmcnt(45)
    s_waitcnt lgkmcnt(8)
    v_mfma_f32_32x32x16_bf16 v[16:31], v[64:67], v[168:171], v[16:31]
    ds_read_b64_tr_b16 v[52:53], v15 offset:0
    ds_read_b64_tr_b16 v[54:55], v15 offset:1024
    s_waitcnt lgkmcnt(8)
    v_mfma_f32_32x32x16_bf16 v[32:47], v[68:71], v[168:171], v[32:47]
    ds_read_b64_tr_b16 v[56:57], v15 offset:2304
    ds_read_b64_tr_b16 v[58:59], v15 offset:3328
    s_add_u32 s29, s35, 7077888
    buffer_load_dwordx4 v[160:163], v1, s[40:43], s29 offen sc1
    s_waitcnt vmcnt(45)
    s_waitcnt lgkmcnt(8)
    v_mfma_f32_32x32x16_bf16 v[16:31], v[72:75], v[172:175], v[16:31]
    ds_read_b64_tr_b16 v[60:61], v14 offset:2304
    ds_read_b64_tr_b16 v[62:63], v14 offset:3328
    s_waitcnt lgkmcnt(8)
    v_mfma_f32_32x32x16_bf16 v[32:47], v[76:79], v[172:175], v[32:47]
    ds_read_b64_tr_b16 v[64:65], v14 offset:4608
    ds_read_b64_tr_b16 v[66:67], v14 offset:5632
    s_add_u32 s29, s35, 7078912
    buffer_load_dwordx4 v[164:167], v1, s[40:43], s29 offen sc1
    s_waitcnt vmcnt(45)
    s_waitcnt lgkmcnt(8)
    v_mfma_f32_32x32x16_bf16 v[16:31], v[48:51], v[176:179], v[16:31]
    ds_read_b64_tr_b16 v[68:69], v15 offset:4608
    ds_read_b64_tr_b16 v[70:71], v15 offset:5632
    s_waitcnt lgkmcnt(8)
    v_mfma_f32_32x32x16_bf16 v[32:47], v[52:55], v[176:179], v[32:47]
    ds_read_b64_tr_b16 v[72:73], v15 offset:6912
    ds_read_b64_tr_b16 v[74:75], v15 offset:7936
    s_add_u32 s29, s35, 7079936
    buffer_load_dwordx4 v[168:171], v1, s[40:43], s29 offen sc1
    s_waitcnt vmcnt(45)
    s_waitcnt lgkmcnt(8)
    v_mfma_f32_32x32x16_bf16 v[16:31], v[56:59], v[180:183], v[16:31]
    ds_read_b64_tr_b16 v[76:77], v14 offset:6912
    ds_read_b64_tr_b16 v[78:79], v14 offset:7936
    s_waitcnt lgkmcnt(8)
    v_mfma_f32_32x32x16_bf16 v[32:47], v[60:63], v[180:183], v[32:47]
    ds_read_b64_tr_b16 v[48:49], v14 offset:9216
    ds_read_b64_tr_b16 v[50:51], v14 offset:10240
    s_add_u32 s29, s35, 7080960
    buffer_load_dwordx4 v[172:175], v1, s[40:43], s29 offen sc1
    s_waitcnt vmcnt(45)
    s_waitcnt lgkmcnt(8)
    v_mfma_f32_32x32x16_bf16 v[16:31], v[64:67], v[184:187], v[16:31]
    ds_read_b64_tr_b16 v[52:53], v15 offset:9216
    ds_read_b64_tr_b16 v[54:55], v15 offset:10240
    s_waitcnt lgkmcnt(8)
    v_mfma_f32_32x32x16_bf16 v[32:47], v[68:71], v[184:187], v[32:47]
    ds_read_b64_tr_b16 v[56:57], v15 offset:11520
    ds_read_b64_tr_b16 v[58:59], v15 offset:12544
    s_lshl_b32 s60, s26, 12
    s_add_u32 s60, s60, 9437184
    s_add_u32 s61, s60, 2048
    s_cmp_eq_u32 s22, 6
    s_cselect_b32 s60, s61, s60
    s_cselect_b32 s61, 1, 0
    s_cmp_eq_u32 s22, 2
    s_cselect_b32 s61, 1, s61
    s_cmp_eq_u32 s61, 1
    s_cselect_b32 s60, s60, 0x40000000
    s_add_u32 s29, s60, 0
    buffer_load_dwordx4 v[176:179], v1, s[40:43], s29 offen sc1
    s_waitcnt vmcnt(45)
    s_waitcnt lgkmcnt(8)
    v_mfma_f32_32x32x16_bf16 v[16:31], v[72:75], v[188:191], v[16:31]
    ds_read_b64_tr_b16 v[60:61], v14 offset:11520
    ds_read_b64_tr_b16 v[62:63], v14 offset:12544
    s_waitcnt lgkmcnt(8)
    v_mfma_f32_32x32x16_bf16 v[32:47], v[76:79], v[188:191], v[32:47]
    ds_read_b64_tr_b16 v[64:65], v14 offset:13824
    ds_read_b64_tr_b16 v[66:67], v14 offset:14848
    s_add_u32 s29, s60, 1024
    buffer_load_dwordx4 v[180:183], v1, s[40:43], s29 offen sc1
    s_waitcnt vmcnt(45)
    s_waitcnt lgkmcnt(8)
    v_mfma_f32_32x32x16_bf16 v[16:31], v[48:51], v[192:195], v[16:31]
    ds_read_b64_tr_b16 v[68:69], v15 offset:13824
    ds_read_b64_tr_b16 v[70:71], v15 offset:14848
    s_waitcnt lgkmcnt(8)
    v_mfma_f32_32x32x16_bf16 v[32:47], v[52:55], v[192:195], v[32:47]
    ds_read_b64_tr_b16 v[72:73], v15 offset:16128
    ds_read_b64_tr_b16 v[74:75], v15 offset:17152
    s_add_u32 s29, s60, 262144
    buffer_load_dwordx4 v[184:187], v1, s[40:43], s29 offen sc1
    s_waitcnt vmcnt(45)
    s_waitcnt lgkmcnt(8)
    v_mfma_f32_32x32x16_bf16 v[16:31], v[56:59], v[196:199], v[16:31]
    ds_read_b64_tr_b16 v[76:77], v14 offset:16128
    ds_read_b64_tr_b16 v[78:79], v14 offset:17152
    s_waitcnt lgkmcnt(8)
    v_mfma_f32_32x32x16_bf16 v[32:47], v[60:63], v[196:199], v[32:47]
    ds_read_b64_tr_b16 v[48:49], v14 offset:18432
    ds_read_b64_tr_b16 v[50:51], v14 offset:19456
    s_add_u32 s29, s60, 263168
    buffer_load_dwordx4 v[188:191], v1, s[40:43], s29 offen sc1
    s_waitcnt vmcnt(45)
    s_waitcnt lgkmcnt(8)
    v_mfma_f32_32x32x16_bf16 v[16:31], v[64:67], v[200:203], v[16:31]
    ds_read_b64_tr_b16 v[52:53], v15 offset:18432
    ds_read_b64_tr_b16 v[54:55], v15 offset:19456
    s_waitcnt lgkmcnt(8)
    v_mfma_f32_32x32x16_bf16 v[32:47], v[68:71], v[200:203], v[32:47]
    ds_read_b64_tr_b16 v[56:57], v15 offset:20736
    ds_read_b64_tr_b16 v[58:59], v15 offset:21760
    s_add_u32 s29, s60, 524288
    buffer_load_dwordx4 v[192:195], v1, s[40:43], s29 offen sc1
    s_waitcnt vmcnt(45)
    s_waitcnt lgkmcnt(8)
    v_mfma_f32_32x32x16_bf16 v[16:31], v[72:75], v[204:207], v[16:31]
    ds_read_b64_tr_b16 v[60:61], v14 offset:20736
    ds_read_b64_tr_b16 v[62:63], v14 offset:21760
    s_waitcnt lgkmcnt(8)
    v_mfma_f32_32x32x16_bf16 v[32:47], v[76:79], v[204:207], v[32:47]
    ds_read_b64_tr_b16 v[64:65], v14 offset:23040
    ds_read_b64_tr_b16 v[66:67], v14 offset:24064
    s_add_u32 s29, s60, 525312
    buffer_load_dwordx4 v[196:199], v1, s[40:43], s29 offen sc1
    s_waitcnt vmcnt(45)
    s_waitcnt lgkmcnt(8)
    v_mfma_f32_32x32x16_bf16 v[16:31], v[48:51], v[208:211], v[16:31]
    ds_read_b64_tr_b16 v[68:69], v15 offset:23040
    ds_read_b64_tr_b16 v[70:71], v15 offset:24064
    s_waitcnt lgkmcnt(8)
    v_mfma_f32_32x32x16_bf16 v[32:47], v[52:55], v[208:211], v[32:47]
    ds_read_b64_tr_b16 v[72:73], v15 offset:25344
    ds_read_b64_tr_b16 v[74:75], v15 offset:26368
    s_add_u32 s29, s60, 786432
    buffer_load_dwordx4 v[200:203], v1, s[40:43], s29 offen sc1
    s_waitcnt vmcnt(45)
    s_waitcnt lgkmcnt(8)
    v_mfma_f32_32x32x16_bf16 v[16:31], v[56:59], v[212:215], v[16:31]
    ds_read_b64_tr_b16 v[76:77], v14 offset:25344
    ds_read_b64_tr_b16 v[78:79], v14 offset:26368
    s_waitcnt lgkmcnt(8)
    v_mfma_f32_32x32x16_bf16 v[32:47], v[60:63], v[212:215], v[32:47]
    ds_read_b64_tr_b16 v[48:49], v14 offset:27648
    ds_read_b64_tr_b16 v[50:51], v14 offset:28672
    s_add_u32 s29, s60, 787456
    buffer_load_dwordx4 v[204:207], v1, s[40:43], s29 offen sc1
    s_waitcnt vmcnt(45)
    s_waitcnt lgkmcnt(8)
    v_mfma_f32_32x32x16_bf16 v[16:31], v[64:67], v[216:219], v[16:31]
    ds_read_b64_tr_b16 v[52:53], v15 offset:27648
    ds_read_b64_tr_b16 v[54:55], v15 offset:28672
    s_waitcnt lgkmcnt(8)
    v_mfma_f32_32x32x16_bf16 v[32:47], v[68:71], v[216:219], v[32:47]
    ds_read_b64_tr_b16 v[56:57], v15 offset:29952
    ds_read_b64_tr_b16 v[58:59], v15 offset:30976
    s_waitcnt vmcnt(44)
    s_waitcnt lgkmcnt(8)
    v_mfma_f32_32x32x16_bf16 v[16:31], v[72:75], v[220:223], v[16:31]
    ds_read_b64_tr_b16 v[60:61], v14 offset:29952
    ds_read_b64_tr_b16 v[62:63], v14 offset:30976
    s_waitcnt lgkmcnt(8)
    v_mfma_f32_32x32x16_bf16 v[32:47], v[76:79], v[220:223], v[32:47]
    ds_read_b64_tr_b16 v[64:65], v14 offset:32256
    ds_read_b64_tr_b16 v[66:67], v14 offset:33280
    s_waitcnt vmcnt(43)
    s_waitcnt lgkmcnt(8)
    v_mfma_f32_32x32x16_bf16 v[16:31], v[48:51], v[224:227], v[16:31]
    ds_read_b64_tr_b16 v[68:69], v15 offset:32256
    ds_read_b64_tr_b16 v[70:71], v15 offset:33280
    s_waitcnt lgkmcnt(8)
    v_mfma_f32_32x32x16_bf16 v[32:47], v[52:55], v[224:227], v[32:47]
    ds_read_b64_tr_b16 v[72:73], v15 offset:34560
    ds_read_b64_tr_b16 v[74:75], v15 offset:35584
    s_waitcnt vmcnt(42)
    s_waitcnt lgkmcnt(8)
    v_mfma_f32_32x32x16_bf16 v[16:31], v[56:59], v[228:231], v[16:31]
    ds_read_b64_tr_b16 v[76:77], v14 offset:34560
    ds_read_b64_tr_b16 v[78:79], v14 offset:35584
    s_waitcnt lgkmcnt(8)
    v_mfma_f32_32x32x16_bf16 v[32:47], v[60:63], v[228:231], v[32:47]
    ds_read_b64_tr_b16 v[48:49], v12 offset:0
    ds_read_b64_tr_b16 v[50:51], v12 offset:4608
    s_waitcnt vmcnt(41)
    s_waitcnt lgkmcnt(8)
    v_mfma_f32_32x32x16_bf16 v[16:31], v[64:67], v[232:235], v[16:31]
    ds_read_b64_tr_b16 v[52:53], v13 offset:0
    ds_read_b64_tr_b16 v[54:55], v13 offset:4608
    s_waitcnt lgkmcnt(8)
    v_mfma_f32_32x32x16_bf16 v[32:47], v[68:71], v[232:235], v[32:47]
    ds_read_b64_tr_b16 v[56:57], v12 offset:18432
    ds_read_b64_tr_b16 v[58:59], v12 offset:23040
    s_waitcnt vmcnt(40)
    s_waitcnt lgkmcnt(8)
    v_mfma_f32_32x32x16_bf16 v[16:31], v[72:75], v[236:239], v[16:31]
    ds_read_b64_tr_b16 v[60:61], v13 offset:18432
    ds_read_b64_tr_b16 v[62:63], v13 offset:23040
    s_waitcnt lgkmcnt(8)
    v_mfma_f32_32x32x16_bf16 v[32:47], v[76:79], v[236:239], v[32:47]
    ds_read_b64_tr_b16 v[64:65], v12 offset:36864
    ds_read_b64_tr_b16 v[66:67], v12 offset:41472
    s_waitcnt vmcnt(36)
    s_waitcnt lgkmcnt(8)
    v_mfma_f32_32x32x16_bf16 v[16:31], v[48:51], v[240:243], v[16:31]
    ds_read_b64_tr_b16 v[68:69], v13 offset:36864
    ds_read_b64_tr_b16 v[70:71], v13 offset:41472
    s_waitcnt lgkmcnt(8)
    v_mfma_f32_32x32x16_bf16 v[32:47], v[52:55], v[240:243], v[32:47]
    ds_read_b64_tr_b16 v[72:73], v12 offset:55296
    ds_read_b64_tr_b16 v[74:75], v12 offset:59904
    s_waitcnt vmcnt(32)
    s_waitcnt lgkmcnt(8)
    v_mfma_f32_32x32x16_bf16 v[16:31], v[56:59], v[244:247], v[16:31]
    ds_read_b64_tr_b16 v[76:77], v13 offset:55296
    ds_read_b64_tr_b16 v[78:79], v13 offset:59904
    s_waitcnt lgkmcnt(8)
    v_mfma_f32_32x32x16_bf16 v[32:47], v[60:63], v[244:247], v[32:47]
    s_waitcnt vmcnt(28)
    s_waitcnt lgkmcnt(6)
    v_mfma_f32_32x32x16_bf16 v[16:31], v[64:67], v[248:251], v[16:31]
    s_waitcnt lgkmcnt(4)
    v_mfma_f32_32x32x16_bf16 v[32:47], v[68:71], v[248:251], v[32:47]
    s_waitcnt vmcnt(24)
    s_waitcnt lgkmcnt(2)
    v_mfma_f32_32x32x16_bf16 v[16:31], v[72:75], v[252:255], v[16:31]
    s_waitcnt lgkmcnt(0)
    v_mfma_f32_32x32x16_bf16 v[32:47], v[76:79], v[252:255], v[32:47]
    v_and_b32 v2, 31, v0
    v_lshrrev_b32 v3, 1, v2
    v_and_b32 v3, 7, v3
    v_lshlrev_b32 v2, 7, v2
    v_lshrrev_b32 v4, 5, v0
    v_lshlrev_b32 v4, 3, v4
    v_add3_u32 v2, v2, v4, s31
    v_xor_b32 v5, 0, v3
    v_lshlrev_b32 v5, 4, v5
    v_add_u32 v5, v5, v2
    ds_read_b64 v[88:89], v5
    v_xor_b32 v5, 1, v3
    v_lshlrev_b32 v5, 4, v5
    v_add_u32 v5, v5, v2
    ds_read_b64 v[90:91], v5
    v_xor_b32 v5, 2, v3
    v_lshlrev_b32 v5, 4, v5
    v_add_u32 v5, v5, v2
    ds_read_b64 v[92:93], v5
    v_xor_b32 v5, 3, v3
    v_lshlrev_b32 v5, 4, v5
    v_add_u32 v5, v5, v2
    ds_read_b64 v[94:95], v5
    v_xor_b32 v5, 4, v3
    v_lshlrev_b32 v5, 4, v5
    v_add_u32 v5, v5, v2
    ds_read_b64 v[96:97], v5
    v_xor_b32 v5, 5, v3
    v_lshlrev_b32 v5, 4, v5
    v_add_u32 v5, v5, v2
    ds_read_b64 v[98:99], v5
    v_xor_b32 v5, 6, v3
    v_lshlrev_b32 v5, 4, v5
    v_add_u32 v5, v5, v2
    ds_read_b64 v[100:101], v5
    v_xor_b32 v5, 7, v3
    v_lshlrev_b32 v5, 4, v5
    v_add_u32 v5, v5, v2
    ds_read_b64 v[102:103], v5
    s_waitcnt vmcnt(23)
    v_mfma_f32_32x32x16_bf16 v[16:31], v[80:83], v[112:115], v[16:31]
    s_waitcnt vmcnt(22)
    v_mfma_f32_32x32x16_bf16 v[16:31], v[84:87], v[116:119], v[16:31]
    s_waitcnt vmcnt(21)
    v_mfma_f32_32x32x16_bf16 v[32:47], v[80:83], v[120:123], v[32:47]
    s_waitcnt vmcnt(20)
    v_mfma_f32_32x32x16_bf16 v[32:47], v[84:87], v[124:127], v[32:47]
    s_waitcnt vmcnt(19)
    v_mfma_f32_32x32x16_bf16 v[16:31], v[80:83], v[128:131], v[16:31]
    s_waitcnt vmcnt(18)
    v_mfma_f32_32x32x16_bf16 v[16:31], v[84:87], v[132:135], v[16:31]
    s_waitcnt vmcnt(17)
    v_mfma_f32_32x32x16_bf16 v[32:47], v[80:83], v[136:139], v[32:47]
    s_waitcnt vmcnt(16)
    v_mfma_f32_32x32x16_bf16 v[32:47], v[84:87], v[140:143], v[32:47]
    s_waitcnt vmcnt(15)
    v_mfma_f32_32x32x16_bf16 v[16:31], v[80:83], v[144:147], v[16:31]
    s_waitcnt vmcnt(14)
    v_mfma_f32_32x32x16_bf16 v[16:31], v[84:87], v[148:151], v[16:31]
    s_waitcnt vmcnt(13)
    v_mfma_f32_32x32x16_bf16 v[32:47], v[80:83], v[152:155], v[32:47]
    s_waitcnt vmcnt(12)
    v_mfma_f32_32x32x16_bf16 v[32:47], v[84:87], v[156:159], v[32:47]
    s_waitcnt vmcnt(11)
    v_mfma_f32_32x32x16_bf16 v[16:31], v[80:83], v[160:163], v[16:31]
    s_waitcnt vmcnt(10)
    v_mfma_f32_32x32x16_bf16 v[16:31], v[84:87], v[164:167], v[16:31]
    s_waitcnt vmcnt(9)
    v_mfma_f32_32x32x16_bf16 v[32:47], v[80:83], v[168:171], v[32:47]
    s_waitcnt vmcnt(8)
    v_mfma_f32_32x32x16_bf16 v[32:47], v[84:87], v[172:175], v[32:47]
    s_waitcnt lgkmcnt(0)
    v_mfma_f32_32x32x16_bf16 v[16:31], v[80:83], v[88:91], v[16:31]
    v_mfma_f32_32x32x16_bf16 v[16:31], v[84:87], v[92:95], v[16:31]
    v_mfma_f32_32x32x16_bf16 v[32:47], v[80:83], v[96:99], v[32:47]
    v_mfma_f32_32x32x16_bf16 v[32:47], v[84:87], v[100:103], v[32:47]
    s_waitcnt vmcnt(0)
    s_cmp_eq_u32 s22, 2
    s_cbranch_scc0 parallel_sum__softmax_full_mha__dense_activation_relu__prompt_kernel_nox0
    v_mfma_f32_32x32x16_bf16 v[16:31], v[80:83], v[176:179], v[16:31]
    v_mfma_f32_32x32x16_bf16 v[16:31], v[84:87], v[180:183], v[16:31]
    v_mfma_f32_32x32x16_bf16 v[16:31], v[80:83], v[184:187], v[16:31]
    v_mfma_f32_32x32x16_bf16 v[16:31], v[84:87], v[188:191], v[16:31]
    v_mfma_f32_32x32x16_bf16 v[16:31], v[80:83], v[192:195], v[16:31]
    v_mfma_f32_32x32x16_bf16 v[16:31], v[84:87], v[196:199], v[16:31]
    v_mfma_f32_32x32x16_bf16 v[16:31], v[80:83], v[200:203], v[16:31]
    v_mfma_f32_32x32x16_bf16 v[16:31], v[84:87], v[204:207], v[16:31]
parallel_sum__softmax_full_mha__dense_activation_relu__prompt_kernel_nox0:
    s_cmp_eq_u32 s22, 6
    s_cbranch_scc0 parallel_sum__softmax_full_mha__dense_activation_relu__prompt_kernel_nox1
    v_mfma_f32_32x32x16_bf16 v[32:47], v[80:83], v[176:179], v[32:47]
    v_mfma_f32_32x32x16_bf16 v[32:47], v[84:87], v[180:183], v[32:47]
    v_mfma_f32_32x32x16_bf16 v[32:47], v[80:83], v[184:187], v[32:47]
    v_mfma_f32_32x32x16_bf16 v[32:47], v[84:87], v[188:191], v[32:47]
    v_mfma_f32_32x32x16_bf16 v[32:47], v[80:83], v[192:195], v[32:47]
    v_mfma_f32_32x32x16_bf16 v[32:47], v[84:87], v[196:199], v[32:47]
    v_mfma_f32_32x32x16_bf16 v[32:47], v[80:83], v[200:203], v[32:47]
    v_mfma_f32_32x32x16_bf16 v[32:47], v[84:87], v[204:207], v[32:47]
parallel_sum__softmax_full_mha__dense_activation_relu__prompt_kernel_nox1:
    v_and_b32 v2, 31, v0
    v_lshrrev_b32 v3, 1, v2
    v_and_b32 v3, 7, v3
    v_lshlrev_b32 v2, 7, v2
    v_lshrrev_b32 v4, 5, v0
    v_lshlrev_b32 v4, 3, v4
    v_add3_u32 v2, v2, v4, s31
    s_nop 7
    s_nop 7
    v_cvt_pk_bf16_f32 v16, v16, v17
    v_cvt_pk_bf16_f32 v17, v18, v19
    v_cvt_pk_bf16_f32 v18, v20, v21
    v_cvt_pk_bf16_f32 v19, v22, v23
    v_cvt_pk_bf16_f32 v20, v24, v25
    v_cvt_pk_bf16_f32 v21, v26, v27
    v_cvt_pk_bf16_f32 v22, v28, v29
    v_cvt_pk_bf16_f32 v23, v30, v31
    v_xor_b32 v5, 0, v3
    v_lshlrev_b32 v5, 4, v5
    v_add_u32 v5, v5, v2
    ds_write_b64 v5, v[16:17]
    v_xor_b32 v5, 1, v3
    v_lshlrev_b32 v5, 4, v5
    v_add_u32 v5, v5, v2
    ds_write_b64 v5, v[18:19]
    v_xor_b32 v5, 2, v3
    v_lshlrev_b32 v5, 4, v5
    v_add_u32 v5, v5, v2
    ds_write_b64 v5, v[20:21]
    v_xor_b32 v5, 3, v3
    v_lshlrev_b32 v5, 4, v5
    v_add_u32 v5, v5, v2
    ds_write_b64 v5, v[22:23]
    v_cvt_pk_bf16_f32 v32, v32, v33
    v_cvt_pk_bf16_f32 v33, v34, v35
    v_cvt_pk_bf16_f32 v34, v36, v37
    v_cvt_pk_bf16_f32 v35, v38, v39
    v_cvt_pk_bf16_f32 v36, v40, v41
    v_cvt_pk_bf16_f32 v37, v42, v43
    v_cvt_pk_bf16_f32 v38, v44, v45
    v_cvt_pk_bf16_f32 v39, v46, v47
    v_xor_b32 v5, 4, v3
    v_lshlrev_b32 v5, 4, v5
    v_add_u32 v5, v5, v2
    ds_write_b64 v5, v[32:33]
    v_xor_b32 v5, 5, v3
    v_lshlrev_b32 v5, 4, v5
    v_add_u32 v5, v5, v2
    ds_write_b64 v5, v[34:35]
    v_xor_b32 v5, 6, v3
    v_lshlrev_b32 v5, 4, v5
    v_add_u32 v5, v5, v2
    ds_write_b64 v5, v[36:37]
    v_xor_b32 v5, 7, v3
    v_lshlrev_b32 v5, 4, v5
    v_add_u32 v5, v5, v2
    ds_write_b64 v5, v[38:39]
    v_lshrrev_b32 v2, 3, v0
    v_lshrrev_b32 v6, 1, v2
    v_and_b32 v7, 7, v0
    v_add_u32 v9, s31, v1
    s_waitcnt lgkmcnt(0)
    ds_read_b128 v[48:51], v9 offset:0
    ds_read_b128 v[52:55], v9 offset:1024
    ds_read_b128 v[56:59], v9 offset:2048
    ds_read_b128 v[60:63], v9 offset:3072
    v_add_u32 v8, 0, v6
    v_and_b32 v8, 7, v8
    v_xor_b32 v8, v8, v7
    v_lshlrev_b32 v8, 4, v8
    v_mad_u32_u24 v8, v2, s27, v8
    s_add_u32 s29, s32, 0
    s_waitcnt lgkmcnt(3)
    buffer_store_dwordx4 v[48:51], v8, s[48:51], s29 offen sc1
    v_add_u32 v8, 4, v6
    v_and_b32 v8, 7, v8
    v_xor_b32 v8, v8, v7
    v_lshlrev_b32 v8, 4, v8
    v_mad_u32_u24 v8, v2, s27, v8
    s_add_u32 s29, s32, 9216
    s_waitcnt lgkmcnt(2)
    buffer_store_dwordx4 v[52:55], v8, s[48:51], s29 offen sc1
    v_add_u32 v8, 8, v6
    v_and_b32 v8, 7, v8
    v_xor_b32 v8, v8, v7
    v_lshlrev_b32 v8, 4, v8
    v_mad_u32_u24 v8, v2, s27, v8
    s_add_u32 s29, s32, 18432
    s_waitcnt lgkmcnt(1)
    buffer_store_dwordx4 v[56:59], v8, s[48:51], s29 offen sc1
    v_add_u32 v8, 12, v6
    v_and_b32 v8, 7, v8
    v_xor_b32 v8, v8, v7
    v_lshlrev_b32 v8, 4, v8
    v_mad_u32_u24 v8, v2, s27, v8
    s_add_u32 s29, s32, 27648
    s_waitcnt lgkmcnt(0)
    buffer_store_dwordx4 v[60:63], v8, s[48:51], s29 offen sc1
    s_branch parallel_sum__softmax_full_mha__dense_activation_relu__prompt_kernel_p3end
parallel_sum__softmax_full_mha__dense_activation_relu__prompt_kernel_p3idle:
    s_waitcnt vmcnt(0)
    s_barrier
parallel_sum__softmax_full_mha__dense_activation_relu__prompt_kernel_p3end:
parallel_sum__softmax_full_mha__dense_activation_relu__prompt_kernel_end:
    s_endpgm
.section .rodata,"a"
.p2align 6
.amdhsa_kernel parallel_sum__softmax_full_mha__dense_activation_relu__prompt_kernel
  .amdhsa_next_free_vgpr 256
  .amdhsa_next_free_sgpr 102
  .amdhsa_accum_offset 256
  .amdhsa_group_segment_fixed_size 0
  .amdhsa_kernarg_size 72
  .amdhsa_user_sgpr_count 2
  .amdhsa_user_sgpr_kernarg_segment_ptr 1
  .amdhsa_system_sgpr_workgroup_id_x 1
.end_amdhsa_kernel
.text
```
